```python
import torch

def _softmax(x, axis=-1):
    return torch.softmax(x, dim=axis)

def _gelu(x):
    return torch.nn.functional.gelu(x, approximate='tanh')

def _silu(x):
    return torch.nn.functional.silu(x)

def _sigmoid(x):
    return torch.sigmoid(x)

def _layernorm(x, axis=-1, eps=1e-05):
    m = x.mean(dim=axis, keepdim=True)
    v = x.var(dim=axis, keepdim=True, unbiased=False)
    return (x - m) / torch.sqrt(v + eps)

def _scatter_add(tgt, idx, src, axis=0):
    return tgt.clone().index_add_(axis, idx, src)

def _segment_sum(src, seg, n):
    out = torch.zeros((n,) + src.shape[1:], dtype=src.dtype)
    return out.index_add_(0, seg, src)

def _pad(x, pw):
    flat = tuple((v for pair in reversed(pw) for v in pair))
    return torch.nn.functional.pad(x, flat)
kernel_name = 'gated_mix__compressed_kv_cla__mixer_gmlp__prompt'

def setup_inputs():

    _w = lambda a: (lambda t: t.to(torch.bfloat16) if t.is_floating_point() else t)(torch.as_tensor(a))

    def _A_setup():
        B, H, Sq, Sk, D, M = (1, 16, 2048, 2048, 256, 448)
        Dc = 4 * D
        return {'x': _w((lambda *s: torch.randn(*s, dtype=torch.bfloat16) * 0.05)(B, Sq, M)), 'c_kv': _w((lambda *s: torch.randn(*s, dtype=torch.bfloat16) * 0.8)(B, Sk, Dc)), 'w_q': _w((lambda *s: torch.randn(*s, dtype=torch.bfloat16) * 6.4)(M, H, D) * M ** (-0.5)), 'w_uk': _w((lambda *s: torch.randn(*s, dtype=torch.bfloat16) * 6.4)(Dc, H, D) * Dc ** (-0.5)), 'w_uv': _w((lambda *s: torch.randn(*s, dtype=torch.bfloat16) * 0.8)(Dc, H, D) * Dc ** (-0.5)), 'w_o': _w((lambda *s: torch.randn(*s, dtype=torch.bfloat16) * 0.8)(H, D, M) * (H * D) ** (-0.5))}
    _A_in = _A_setup()

    def _B_setup():
        B, S, D, F = (1, 2048, 448, 1792)
        Fh = F // 2
        return {'x': _w((lambda *s: torch.randn(*s, dtype=torch.bfloat16) * 0.05)(B, S, D)), 'w_in': _w((lambda *s: torch.randn(*s, dtype=torch.bfloat16) * 0.4)(D, 2 * Fh)), 'w_sp': _w(0.01 * (lambda *s: torch.randn(*s, dtype=torch.bfloat16) * 0.4)(S, S)), 'b_sp': _w(1.0 + 0.01 * (lambda *s: torch.randn(*s, dtype=torch.bfloat16) * 0.05)(S)), 'w_out': _w((lambda *s: torch.randn(*s, dtype=torch.bfloat16) * 0.05)(Fh, D))}
    _B_in = _B_setup()
    return {'A_x': _A_in['x'], 'A_c_kv': _A_in['c_kv'], 'A_w_q': _A_in['w_q'], 'A_w_uk': _A_in['w_uk'], 'A_w_uv': _A_in['w_uv'], 'A_w_o': _A_in['w_o'], 'B_x': _B_in['x'], 'B_w_in': _B_in['w_in'], 'B_w_sp': _B_in['w_sp'], 'B_b_sp': _B_in['b_sp'], 'B_w_out': _B_in['w_out'], 'gate_w': _w((lambda *s: torch.randn(*s, dtype=torch.bfloat16) * 0.05)(448) * 16.0)}

def reference(A_x, A_c_kv, A_w_q, A_w_uk, A_w_uv, A_w_o, B_x, B_w_in, B_w_sp, B_b_sp, B_w_out, gate_w):

    def _A_ref(x, c_kv, w_q, w_uk, w_uv, w_o):
        B, Sq, M = (x.shape[0], x.shape[1], x.shape[2])
        Sk = c_kv.shape[1]
        H, D = (w_q.shape[1], w_q.shape[2])
        q = torch.einsum('bqm,mhd->bhqd', x, w_q)
        k = torch.einsum('bkc,chd->bhkd', c_kv, w_uk)
        v = torch.einsum('bkc,chd->bhkd', c_kv, w_uv)
        scores = torch.einsum('bhqd,bhkd->bhqk', q, k) * D ** (-0.5)
        off = Sk - Sq
        qi = torch.arange(Sq)[:, None]
        kj = torch.arange(Sk)[None, :]
        cmask = kj <= qi + off
        scores = torch.where(cmask[None, None], scores, -1000000000.0)
        p = _softmax(scores, axis=-1)
        ctx = torch.einsum('bhqk,bhkd->bhqd', p, v)
        return torch.einsum('bhqd,hdm->bqm', ctx, w_o)

    def _B_ref(x, w_in, w_sp, b_sp, w_out):
        B, S, D = x.shape
        F = w_in.shape[-1]
        Fh = F // 2
        z = _gelu(torch.einsum('bsd,df->bsf', x, w_in))
        z1 = z[..., :Fh].clone()
        z2 = _layernorm(z[..., Fh:], axis=-1)
        g = torch.einsum('ts,bsf->btf', w_sp, z2) + b_sp[None, :, None]
        return torch.einsum('bsf,fd->bsd', z1 * g, w_out)
    x = A_x
    g = _sigmoid((x * gate_w).sum(-1, keepdims=True))
    a = _A_ref(x, A_c_kv, A_w_q, A_w_uk, A_w_uv, A_w_o)
    b = _B_ref(x, B_w_in, B_w_sp, B_b_sp, B_w_out)
    return g * a + (1 - g) * b
```

```asm
; @launch grid=(256,1,1) block=(256,1,1) lds=163840
.amdgcn_target "amdgcn-amd-amdhsa--gfx950"
.macro MM a:vararg
 v_mfma_f32_16x16x32_bf16 \a
.endm
.macro RQ a:vararg
 ds_read_b128 \a
.endm
.macro RT a:vararg
 ds_read_b64_tr_b16 \a
.endm
.macro BL a:vararg
 buffer_load_dwordx4 \a
.endm
.macro CV a:vararg
 v_cvt_pk_bf16_f32 \a
.endm
.macro AW a:vararg
 v_accvgpr_write_b32 \a
.endm
.macro AR a:vararg
 v_accvgpr_read_b32 \a
.endm
.macro BS a:vararg
 buffer_store_dwordx4 \a
.endm
.macro PM a:vararg
 v_pk_mul_f32 \a
.endm
.text
.globl gated_mix__compressed_kv_cla__mixer_gmlp__prompt_kernel
.p2align 8
.type gated_mix__compressed_kv_cla__mixer_gmlp__prompt_kernel,@function
gated_mix__compressed_kv_cla__mixer_gmlp__prompt_kernel:
 s_cmp_lt_u32 s2,256
 s_cbranch_scc1 L_go
 s_endpgm
L_go:
 s_load_dwordx16 s[40:55],s[0:1],0
 s_load_dwordx8 s[56:63],s[0:1],64
 s_load_dwordx4 s[64:67],s[0:1],96
 s_load_dwordx2 s[68:69],s[0:1],112
 v_lshrrev_b32 v1,6,v0
 s_nop 0
 v_readfirstlane_b32 s35,v1
 v_and_b32 v0,63,v0
 v_lshlrev_b32 v6,4,v0
 s_getpc_b64 s[4:5]
L_pc:
 s_lshr_b32 s6,s2,3
 s_lshl_b32 s6,s6,2
 s_add_u32 s6,s6,s35
 s_lshl_b32 s6,s6,10
 v_add_u32 v1,s6,v6
 s_mov_b32 s7,L_codeend-L_pc-16
 v_min_u32 v2,s7,v1
 global_load_dwordx4 v[68:71],v2,s[4:5]
 v_add_u32 v1,131072,v1
 v_min_u32 v2,s7,v1
 global_load_dwordx4 v[68:71],v2,s[4:5]
 v_add_u32 v1,131072,v1
 s_and_b32 s3,s2,7
 s_lshr_b32 s73,s2,3
 s_lshr_b32 s70,s73,2
 s_and_b32 s72,s73,1
 s_bfe_u32 s6,s73,0x10001
 s_lshl_b32 s71,s3,1
 s_add_u32 s71,s71,s6
 s_sub_u32 s6,s73,14
 s_and_b32 s83,s3,1
 s_mul_i32 s83,s83,14
 s_add_u32 s6,s6,s83
 s_lshr_b32 s83,s6,2
 s_and_b32 s6,s6,3
 s_lshr_b32 s82,s3,1
 s_lshl_b32 s82,s82,2
 s_add_u32 s82,s82,s6
 s_lshl_b32 s100,s3,7
 s_mov_b32 s26,s2
 v_lshlrev_b32 v37,4,v0
 s_and_b32 s33,s2,7
 s_lshr_b32 s31,s2,3
 s_and_b32 s32,s31,1
 s_lshl_b32 s33,s33,1
 s_add_u32 s74,s33,s32
 s_lshr_b32 s31,s31,1
 s_lshl_b32 s31,s31,2
 s_mov_b32 s4,0x89abcdef
 s_mov_b32 s5,0x45012367
 s_lshr_b64 s[4:5],s[4:5],s31
 s_and_b32 s86,s4,15
 s_mov_b32 s4,0x0
 s_mov_b32 s5,0xfedc00
 s_lshr_b64 s[4:5],s[4:5],s31
 s_and_b32 s32,s4,15
 s_mov_b32 s4,0x0
 s_mov_b32 s5,0x0
 s_lshr_b64 s[4:5],s[4:5],s31
 s_and_b32 s80,s4,15
 s_mov_b32 s4,0x8763210
 s_mov_b32 s5,0x45000000
 s_lshr_b64 s[4:5],s[4:5],s31
 s_and_b32 s25,s4,15
 s_cmp_lg_u32 s32,0
 s_cselect_b32 s75,s32,s86
 s_cselect_b32 s76,22,0
 s_cselect_b32 s78,1,0
 s_lshl_b32 s77,s75,1
 s_add_u32 s77,s77,2
 s_cmp_gt_u32 s86,11
 s_cselect_b32 s78,2,s78
 s_cselect_b32 s77,22,s77
 s_lshl_b32 s79,s74,3
 s_add_u32 s79,s79,s75
 s_sub_u32 s79,s79,9
 s_waitcnt lgkmcnt(0)
 s_mov_b32 s52,s2
 s_add_u32 s0,s68,100663296
 s_addc_u32 s1,s69,0
 s_mov_b32 s2,16384
 s_mov_b32 s3,0x20000
 s_mov_b32 s97,s25
 s_cmp_ge_u32 s73,28
 s_cbranch_scc1 L_roleZ
 s_mov_b32 s8,s42
 s_mov_b32 s9,s43
 s_mov_b32 s10,4194304
 s_mov_b32 s11,0x20000
 s_lshl_b32 s20,s70,19
 v_lshrrev_b32 v1,3,v0
 s_mul_i32 s26,s35,131072
 v_mul_u32_u24 v1,2048,v1
 v_lshrrev_b32 v2,4,v0
 v_xor_b32 v2,v2,v0
 v_and_b32 v2,7,v2
 v_lshl_add_u32 v1,v2,4,v1
 v_add_u32 v8,s26,v1
 v_xor_b32 v2,64,v8
 v_add_u32 v9,15360,v2
 v_add_u32 v10,30720,v8
 v_add_u32 v11,30720,v9
 v_add_u32 v12,65536,v8
 v_add_u32 v13,65536,v9
 v_add_u32 v14,96256,v8
 v_add_u32 v15,96256,v9
 s_mul_i32 s22,s35,8192
 s_add_u32 m0,s22,0
 s_nop 0
 BL v8,s[8:11],s20 offen  lds
 BL v9,s[8:11],s20 offen offset:1024  lds
 BL v10,s[8:11],s20 offen offset:2048  lds
 BL v11,s[8:11],s20 offen offset:3072  lds
 s_add_u32 m0,s22,4096
 s_nop 0
 BL v12,s[8:11],s20 offen  lds
 BL v13,s[8:11],s20 offen offset:1024  lds
 BL v14,s[8:11],s20 offen offset:2048  lds
 BL v15,s[8:11],s20 offen offset:3072  lds
 s_add_u32 s20,s20,128
 s_add_u32 s22,s22,32768
 s_sub_u32 s34,s22,98304
 s_min_u32 s22,s22,s34
 s_cmp_eq_u32 s72,0
 s_cselect_b32 s12,s46,s48
 s_cselect_b32 s13,s47,s49
 s_mov_b32 s14,8388608
 s_mov_b32 s15,0x20000
 s_lshl_b32 s21,s71,9
 v_lshrrev_b32 v1,5,v0
 v_and_b32 v2,31,v0
 v_bfe_u32 v3,v1,0,1
 v_lshlrev_b32 v3,1,v3
 v_xor_b32 v2,v2,v3
 v_lshlrev_b32 v2,4,v2
 s_mul_i32 s26,s35,131072
 v_mul_u32_u24 v1,8192,v1
 v_add_u32 v1,s26,v1
 v_add_u32 v16,v2,v1
 v_xor_b32 v3,64,v2
 v_add_u32 v17,v3,v1
 v_add_u32 v17,15360,v17
 v_add_u32 v18,30720,v16
 v_add_u32 v19,30720,v17
 v_xor_b32 v3,128,v2
 v_add_u32 v20,v3,v1
 v_add_u32 v20,65536,v20
 v_xor_b32 v3,192,v2
 v_add_u32 v21,v3,v1
 v_add_u32 v21,80896,v21
 v_add_u32 v22,30720,v20
 v_add_u32 v23,30720,v21
 s_mul_i32 s23,s35,8192
 s_add_u32 m0,s23,98304
 s_nop 0
 BL v16,s[12:15],s21 offen  lds
 BL v17,s[12:15],s21 offen offset:1024  lds
 BL v18,s[12:15],s21 offen offset:2048  lds
 BL v19,s[12:15],s21 offen offset:3072  lds
 s_add_u32 m0,s23,102400
 s_nop 0
 BL v20,s[12:15],s21 offen  lds
 BL v21,s[12:15],s21 offen offset:1024  lds
 BL v22,s[12:15],s21 offen offset:2048  lds
 BL v23,s[12:15],s21 offen offset:3072  lds
 s_add_u32 s21,s21,524288
 s_add_u32 s23,s23,32768
 s_sub_u32 s34,s23,65536
 s_min_u32 s23,s23,s34
 s_add_u32 m0,s22,0
 s_nop 0
 BL v8,s[8:11],s20 offen  lds
 BL v9,s[8:11],s20 offen offset:1024  lds
 BL v10,s[8:11],s20 offen offset:2048  lds
 BL v11,s[8:11],s20 offen offset:3072  lds
 s_add_u32 m0,s22,4096
 s_nop 0
 BL v12,s[8:11],s20 offen  lds
 BL v13,s[8:11],s20 offen offset:1024  lds
 BL v14,s[8:11],s20 offen offset:2048  lds
 BL v15,s[8:11],s20 offen offset:3072  lds
 s_add_u32 s20,s20,128
 s_add_u32 s22,s22,32768
 s_sub_u32 s34,s22,98304
 s_min_u32 s22,s22,s34
 s_add_u32 m0,s23,98304
 s_nop 0
 BL v16,s[12:15],s21 offen  lds
 BL v17,s[12:15],s21 offen offset:1024  lds
 BL v18,s[12:15],s21 offen offset:2048  lds
 BL v19,s[12:15],s21 offen offset:3072  lds
 s_add_u32 m0,s23,102400
 s_nop 0
 BL v20,s[12:15],s21 offen  lds
 BL v21,s[12:15],s21 offen offset:1024  lds
 BL v22,s[12:15],s21 offen offset:2048  lds
 BL v23,s[12:15],s21 offen offset:3072  lds
 s_add_u32 s21,s21,524288
 s_add_u32 s23,s23,32768
 s_sub_u32 s34,s23,65536
 s_min_u32 s23,s23,s34
 s_add_u32 m0,s22,0
 s_nop 0
 BL v8,s[8:11],s20 offen  lds
 BL v9,s[8:11],s20 offen offset:1024  lds
 s_lshl_b32 s26,s70,2
 s_add_u32 s26,s26,s35
 s_lshl_b32 s26,s26,14
 v_lshrrev_b32 v1,5,v0
 v_lshlrev_b32 v1,13,v1
 v_and_b32 v2,31,v0
 v_lshl_add_u32 v1,v2,4,v1
 v_add_u32 v36,s26,v1
 s_add_u32 s85,s21,0
 BL v[68:71],v36,s[12:15],s85 offen
 s_add_u32 s85,s21,524288
 BL v[68:71],v36,s[12:15],s85 offen
 s_mov_b32 s4,s54
 s_mov_b32 s5,s55
 s_mov_b32 s6,1605632
 s_mov_b32 s7,0x20000
 s_lshl_b32 s87,s52,2
 s_add_u32 s87,s87,s35
 s_lshl_b32 s87,s87,10
 BL v[68:71],v6,s[4:7],s87 offen
 s_add_u32 s87,s87,1048576
 BL v[68:71],v6,s[4:7],s87 offen
 s_add_u32 s87,s87,1048576
 s_mov_b32 s4,s42
 s_mov_b32 s5,s43
 s_mov_b32 s6,4194304
 s_mov_b32 s7,0x20000
 s_lshl_b32 s26,s52,2
 s_add_u32 s26,s26,s35
 s_lshl_b32 s26,s26,10
 s_add_u32 s26,s26,3670016
 BL v[68:71],v6,s[4:7],s26 offen
L_kv:
 s_and_b32 s26,s35,1
 v_and_b32 v1,15,v0
 s_mul_i32 s26,s26,16384
 v_lshl_add_u32 v1,v1,7,s26
 v_lshrrev_b32 v2,4,v0
 v_bfe_u32 v3,v0,1,3
 v_xor_b32 v2,v2,v3
 v_lshl_add_u32 v24,v2,4,v1
 v_xor_b32 v25,64,v24
 v_bfe_u32 v1,v0,2,2
 v_lshrrev_b32 v2,4,v0
 v_lshl_add_u32 v2,v2,3,v1
 v_bfe_u32 v4,v2,0,1
 v_bfe_u32 v5,v2,1,1
 v_lshl_or_b32 v4,v5,1,v4
 v_bfe_u32 v5,v2,3,1
 v_lshl_or_b32 v4,v5,2,v4
 v_mul_u32_u24 v2,512,v2
 v_and_b32 v3,3,v0
 v_lshl_add_u32 v2,v3,3,v2
 v_add_u32 v2,98304,v2
 s_lshr_b32 s26,s35,1
 s_mul_i32 s26,s26,8
 v_xor_b32 v4,s26,v4
 v_xor_b32 v3,0,v4
 v_lshl_add_u32 v26,v3,5,v2
 v_xor_b32 v3,1,v4
 v_lshl_add_u32 v27,v3,5,v2
 v_xor_b32 v3,2,v4
 v_lshl_add_u32 v28,v3,5,v2
 v_xor_b32 v3,3,v4
 v_lshl_add_u32 v29,v3,5,v2
 v_xor_b32 v3,4,v4
 v_lshl_add_u32 v30,v3,5,v2
 v_xor_b32 v3,5,v4
 v_lshl_add_u32 v31,v3,5,v2
 v_xor_b32 v3,6,v4
 v_lshl_add_u32 v32,v3,5,v2
 v_xor_b32 v3,7,v4
 v_lshl_add_u32 v33,v3,5,v2
 s_mov_b32 s24,0
 s_mov_b32 s25,0
 v_mov_b32 v200,0
 v_mov_b32 v201,0
 v_mov_b32 v202,0
 v_mov_b32 v203,0
 v_mov_b32 v72,0
 v_mov_b32 v73,0
 v_mov_b32 v74,0
 v_mov_b32 v75,0
 v_mov_b32 v204,0
 v_mov_b32 v205,0
 v_mov_b32 v206,0
 v_mov_b32 v207,0
 v_mov_b32 v76,0
 v_mov_b32 v77,0
 v_mov_b32 v78,0
 v_mov_b32 v79,0
 v_mov_b32 v208,0
 v_mov_b32 v209,0
 v_mov_b32 v210,0
 v_mov_b32 v211,0
 v_mov_b32 v80,0
 v_mov_b32 v81,0
 v_mov_b32 v82,0
 v_mov_b32 v83,0
 v_mov_b32 v212,0
 v_mov_b32 v213,0
 v_mov_b32 v214,0
 v_mov_b32 v215,0
 v_mov_b32 v84,0
 v_mov_b32 v85,0
 v_mov_b32 v86,0
 v_mov_b32 v87,0
 v_mov_b32 v216,0
 v_mov_b32 v217,0
 v_mov_b32 v218,0
 v_mov_b32 v219,0
 v_mov_b32 v88,0
 v_mov_b32 v89,0
 v_mov_b32 v90,0
 v_mov_b32 v91,0
 v_mov_b32 v220,0
 v_mov_b32 v221,0
 v_mov_b32 v222,0
 v_mov_b32 v223,0
 v_mov_b32 v92,0
 v_mov_b32 v93,0
 v_mov_b32 v94,0
 v_mov_b32 v95,0
 v_mov_b32 v224,0
 v_mov_b32 v225,0
 v_mov_b32 v226,0
 v_mov_b32 v227,0
 v_mov_b32 v96,0
 v_mov_b32 v97,0
 v_mov_b32 v98,0
 v_mov_b32 v99,0
 v_mov_b32 v228,0
 v_mov_b32 v229,0
 v_mov_b32 v230,0
 v_mov_b32 v231,0
 v_mov_b32 v100,0
 v_mov_b32 v101,0
 v_mov_b32 v102,0
 v_mov_b32 v103,0
 v_mov_b32 v232,0
 v_mov_b32 v233,0
 v_mov_b32 v234,0
 v_mov_b32 v235,0
 v_mov_b32 v104,0
 v_mov_b32 v105,0
 v_mov_b32 v106,0
 v_mov_b32 v107,0
 v_mov_b32 v236,0
 v_mov_b32 v237,0
 v_mov_b32 v238,0
 v_mov_b32 v239,0
 v_mov_b32 v108,0
 v_mov_b32 v109,0
 v_mov_b32 v110,0
 v_mov_b32 v111,0
 v_mov_b32 v240,0
 v_mov_b32 v241,0
 v_mov_b32 v242,0
 v_mov_b32 v243,0
 v_mov_b32 v112,0
 v_mov_b32 v113,0
 v_mov_b32 v114,0
 v_mov_b32 v115,0
 v_mov_b32 v244,0
 v_mov_b32 v245,0
 v_mov_b32 v246,0
 v_mov_b32 v247,0
 v_mov_b32 v116,0
 v_mov_b32 v117,0
 v_mov_b32 v118,0
 v_mov_b32 v119,0
 v_mov_b32 v248,0
 v_mov_b32 v249,0
 v_mov_b32 v250,0
 v_mov_b32 v251,0
 v_mov_b32 v120,0
 v_mov_b32 v121,0
 v_mov_b32 v122,0
 v_mov_b32 v123,0
 v_mov_b32 v252,0
 v_mov_b32 v253,0
 v_mov_b32 v254,0
 v_mov_b32 v255,0
 v_mov_b32 v124,0
 v_mov_b32 v125,0
 v_mov_b32 v126,0
 v_mov_b32 v127,0
 v_mov_b32 v128,0
 v_mov_b32 v129,0
 v_mov_b32 v130,0
 v_mov_b32 v131,0
 v_mov_b32 v132,0
 v_mov_b32 v133,0
 v_mov_b32 v134,0
 v_mov_b32 v135,0
 v_mov_b32 v136,0
 v_mov_b32 v137,0
 v_mov_b32 v138,0
 v_mov_b32 v139,0
 v_mov_b32 v140,0
 v_mov_b32 v141,0
 v_mov_b32 v142,0
 v_mov_b32 v143,0
 v_mov_b32 v144,0
 v_mov_b32 v145,0
 v_mov_b32 v146,0
 v_mov_b32 v147,0
 v_mov_b32 v148,0
 v_mov_b32 v149,0
 v_mov_b32 v150,0
 v_mov_b32 v151,0
 v_mov_b32 v152,0
 v_mov_b32 v153,0
 v_mov_b32 v154,0
 v_mov_b32 v155,0
 v_mov_b32 v156,0
 v_mov_b32 v157,0
 v_mov_b32 v158,0
 v_mov_b32 v159,0
 v_mov_b32 v160,0
 v_mov_b32 v161,0
 v_mov_b32 v162,0
 v_mov_b32 v163,0
 v_mov_b32 v164,0
 v_mov_b32 v165,0
 v_mov_b32 v166,0
 v_mov_b32 v167,0
 v_mov_b32 v168,0
 v_mov_b32 v169,0
 v_mov_b32 v170,0
 v_mov_b32 v171,0
 v_mov_b32 v172,0
 v_mov_b32 v173,0
 v_mov_b32 v174,0
 v_mov_b32 v175,0
 v_mov_b32 v176,0
 v_mov_b32 v177,0
 v_mov_b32 v178,0
 v_mov_b32 v179,0
 v_mov_b32 v180,0
 v_mov_b32 v181,0
 v_mov_b32 v182,0
 v_mov_b32 v183,0
 v_mov_b32 v184,0
 v_mov_b32 v185,0
 v_mov_b32 v186,0
 v_mov_b32 v187,0
 v_mov_b32 v188,0
 v_mov_b32 v189,0
 v_mov_b32 v190,0
 v_mov_b32 v191,0
 v_mov_b32 v192,0
 v_mov_b32 v193,0
 v_mov_b32 v194,0
 v_mov_b32 v195,0
 v_mov_b32 v196,0
 v_mov_b32 v197,0
 v_mov_b32 v198,0
 v_mov_b32 v199,0
 AW a184,0
 AW a185,0
 AW a186,0
 AW a187,0
 AW a188,0
 AW a189,0
 AW a190,0
 AW a191,0
 AW a192,0
 AW a193,0
 AW a194,0
 AW a195,0
 AW a196,0
 AW a197,0
 AW a198,0
 AW a199,0
 AW a200,0
 AW a201,0
 AW a202,0
 AW a203,0
 AW a204,0
 AW a205,0
 AW a206,0
 AW a207,0
 AW a208,0
 AW a209,0
 AW a210,0
 AW a211,0
 AW a212,0
 AW a213,0
 AW a214,0
 AW a215,0
 AW a216,0
 AW a217,0
 AW a218,0
 AW a219,0
 AW a220,0
 AW a221,0
 AW a222,0
 AW a223,0
 AW a224,0
 AW a225,0
 AW a226,0
 AW a227,0
 AW a228,0
 AW a229,0
 AW a230,0
 AW a231,0
 AW a232,0
 AW a233,0
 AW a234,0
 AW a235,0
 AW a236,0
 AW a237,0
 AW a238,0
 AW a239,0
 AW a240,0
 AW a241,0
 AW a242,0
 AW a243,0
 AW a244,0
 AW a245,0
 AW a246,0
 AW a247,0
 AW a248,0
 AW a249,0
 AW a250,0
 AW a251,0
 AW a252,0
 AW a253,0
 AW a254,0
 AW a255,0
 s_waitcnt vmcnt(23)
 s_barrier
 RQ a[0:3],v24
 RT a[64:65],v26
 RT a[66:67],v26 offset:2048
 RT a[68:69],v27
 RT a[70:71],v27 offset:2048
 RT a[72:73],v28
 RT a[74:75],v28 offset:2048
 RT a[76:77],v29
 RT a[78:79],v29 offset:2048
 RT a[80:81],v30
 RT a[82:83],v30 offset:2048
 RT a[84:85],v31
 RT a[86:87],v31 offset:2048
 RT a[88:89],v32
 RT a[90:91],v32 offset:2048
 RT a[92:93],v33
 RT a[94:95],v33 offset:2048
 RQ a[4:7],v24 offset:2048
 RQ a[8:11],v24 offset:4096
 RQ a[12:15],v24 offset:6144
 RQ a[16:19],v24 offset:8192
 RQ a[20:23],v24 offset:10240
 RQ a[24:27],v24 offset:12288
 RQ a[28:31],v24 offset:14336
 s_mov_b32 s4,s44
 s_mov_b32 s5,s45
 s_mov_b32 s6,3670016
 s_mov_b32 s7,0x20000
 s_lshl_b32 s87,s52,2
 s_add_u32 s87,s87,s35
 s_lshl_b32 s87,s87,10
 s_lshr_b32 s99,s100,8
 s_bfe_u32 s53,s100,0x10007
 s_lshl_b32 s53,s53,3
 s_lshr_b32 s98,s73,2
 s_add_u32 s53,s53,s98
 s_and_b32 s98,s73,3
 s_mov_b32 s28,0
 s_cmp_eq_u32 s72,1
 s_cbranch_scc1 L_V
 s_mov_b32 s84,12304
 s_branch kv0
 .p2align 6
kv0:
 s_waitcnt lgkmcnt(0)
 MM v[200:203],a[64:67],a[0:3],v[200:203]
 RQ a[32:35],v25
 MM v[72:75],a[68:71],a[0:3],v[72:75]
 s_add_u32 s31,s24,32768
 s_sub_u32 s33,s31,98304
 MM v[204:207],a[72:75],a[0:3],v[204:207]
 RT a[96:97],v26 offset:16384
 MM v[76:79],a[76:79],a[0:3],v[76:79]
 s_min_u32 s33,s31,s33
 s_sub_u32 s31,s33,s24
 MM v[208:211],a[80:83],a[0:3],v[208:211]
 RT a[98:99],v26 offset:18432
 MM v[80:83],a[84:87],a[0:3],v[80:83]
 BL v10,s[8:11],s20 offen offset:2048  lds
 s_mov_b32 s24,s33
 MM v[212:215],a[88:91],a[0:3],v[212:215]
 RT a[100:101],v27 offset:16384
 MM v[84:87],a[92:95],a[0:3],v[84:87]
 s_add_u32 s32,s25,32768
 s_sub_u32 s33,s32,65536
 MM v[216:219],a[64:67],a[4:7],v[216:219]
 RT a[102:103],v27 offset:18432
 MM v[88:91],a[68:71],a[4:7],v[88:91]
 s_min_u32 s33,s32,s33
 s_sub_u32 s32,s33,s25
 MM v[220:223],a[72:75],a[4:7],v[220:223]
 RT a[104:105],v28 offset:16384
 MM v[92:95],a[76:79],a[4:7],v[92:95]
 BL v11,s[8:11],s20 offen offset:3072  lds
 s_mov_b32 s25,s33
 MM v[224:227],a[80:83],a[4:7],v[224:227]
 RT a[106:107],v28 offset:18432
 MM v[96:99],a[84:87],a[4:7],v[96:99]
 MM v[228:231],a[88:91],a[4:7],v[228:231]
 RT a[108:109],v29 offset:16384
 MM v[100:103],a[92:95],a[4:7],v[100:103]
 MM v[232:235],a[64:67],a[8:11],v[232:235]
 RT a[110:111],v29 offset:18432
 MM v[104:107],a[68:71],a[8:11],v[104:107]
 MM v[236:239],a[72:75],a[8:11],v[236:239]
 RT a[112:113],v30 offset:16384
 s_add_u32 m0,s22,4096
 MM v[108:111],a[76:79],a[8:11],v[108:111]
 BL v12,s[8:11],s20 offen  lds
 MM v[240:243],a[80:83],a[8:11],v[240:243]
 RT a[114:115],v30 offset:18432
 MM v[112:115],a[84:87],a[8:11],v[112:115]
 MM v[244:247],a[88:91],a[8:11],v[244:247]
 RT a[116:117],v31 offset:16384
 MM v[116:119],a[92:95],a[8:11],v[116:119]
 MM v[248:251],a[64:67],a[12:15],v[248:251]
 RT a[118:119],v31 offset:18432
 MM v[120:123],a[68:71],a[12:15],v[120:123]
 BL v13,s[8:11],s20 offen offset:1024  lds
 MM v[252:255],a[72:75],a[12:15],v[252:255]
 RT a[120:121],v32 offset:16384
 MM v[124:127],a[76:79],a[12:15],v[124:127]
 MM v[128:131],a[80:83],a[12:15],v[128:131]
 RT a[122:123],v32 offset:18432
 MM v[132:135],a[84:87],a[12:15],v[132:135]
 MM v[136:139],a[88:91],a[12:15],v[136:139]
 RT a[124:125],v33 offset:16384
 MM v[140:143],a[92:95],a[12:15],v[140:143]
 MM v[144:147],a[64:67],a[16:19],v[144:147]
 RT a[126:127],v33 offset:18432
 MM v[148:151],a[68:71],a[16:19],v[148:151]
 BL v14,s[8:11],s20 offen offset:2048  lds
 MM v[152:155],a[72:75],a[16:19],v[152:155]
 RQ a[36:39],v25 offset:2048
 MM v[156:159],a[76:79],a[16:19],v[156:159]
 MM v[160:163],a[80:83],a[16:19],v[160:163]
 RQ a[40:43],v25 offset:4096
 MM v[164:167],a[84:87],a[16:19],v[164:167]
 MM v[168:171],a[88:91],a[16:19],v[168:171]
 RQ a[44:47],v25 offset:6144
 MM v[172:175],a[92:95],a[16:19],v[172:175]
 BL v15,s[8:11],s20 offen offset:3072  lds
 MM v[176:179],a[64:67],a[20:23],v[176:179]
 RQ a[48:51],v25 offset:8192
 s_add_u32 s20,s20,128
 MM v[180:183],a[68:71],a[20:23],v[180:183]
 s_add_u32 s22,s22,32768
 s_add_u32 s28,s28,1
 MM v[184:187],a[72:75],a[20:23],v[184:187]
 RQ a[52:55],v25 offset:10240
 s_sub_u32 s34,s22,98304
 s_min_u32 s22,s22,s34
 MM v[188:191],a[76:79],a[20:23],v[188:191]
 MM v[192:195],a[80:83],a[20:23],v[192:195]
 RQ a[56:59],v25 offset:12288
 MM v[196:199],a[84:87],a[20:23],v[196:199]
 MM a[184:187],a[88:91],a[20:23],a[184:187]
 RQ a[60:63],v25 offset:14336
 MM a[188:191],a[92:95],a[20:23],a[188:191]
 v_add_u32 v24,s31,v24
 MM a[192:195],a[64:67],a[24:27],a[192:195]
 v_add_u32 v25,s31,v25
 MM a[196:199],a[68:71],a[24:27],a[196:199]
 MM a[200:203],a[72:75],a[24:27],a[200:203]
 v_add_u32 v26,s32,v26
 MM a[204:207],a[76:79],a[24:27],a[204:207]
 MM a[208:211],a[80:83],a[24:27],a[208:211]
 v_add_u32 v27,s32,v27
 MM a[212:215],a[84:87],a[24:27],a[212:215]
 v_add_u32 v28,s32,v28
 MM a[216:219],a[88:91],a[24:27],a[216:219]
 MM a[220:223],a[92:95],a[24:27],a[220:223]
 v_add_u32 v29,s32,v29
 MM a[224:227],a[64:67],a[28:31],a[224:227]
 MM a[228:231],a[68:71],a[28:31],a[228:231]
 v_add_u32 v30,s32,v30
 MM a[232:235],a[72:75],a[28:31],a[232:235]
 v_add_u32 v31,s32,v31
 MM a[236:239],a[76:79],a[28:31],a[236:239]
 MM a[240:243],a[80:83],a[28:31],a[240:243]
 v_add_u32 v32,s32,v32
 MM a[244:247],a[84:87],a[28:31],a[244:247]
 MM a[248:251],a[88:91],a[28:31],a[248:251]
 v_add_u32 v33,s32,v33
 MM a[252:255],a[92:95],a[28:31],a[252:255]
 s_waitcnt vmcnt(10)
 s_waitcnt lgkmcnt(0)
 s_barrier
 MM v[200:203],a[96:99],a[32:35],v[200:203]
 RQ a[0:3],v24
 s_add_u32 m0,s23,98304
 MM v[72:75],a[100:103],a[32:35],v[72:75]
 BL v16,s[12:15],s21 offen  lds
 MM v[204:207],a[104:107],a[32:35],v[204:207]
 RT a[64:65],v26
 MM v[76:79],a[108:111],a[32:35],v[76:79]
 MM v[208:211],a[112:115],a[32:35],v[208:211]
 RT a[66:67],v26 offset:2048
 MM v[80:83],a[116:119],a[32:35],v[80:83]
 MM v[212:215],a[120:123],a[32:35],v[212:215]
 RT a[68:69],v27
 MM v[84:87],a[124:127],a[32:35],v[84:87]
 BL v17,s[12:15],s21 offen offset:1024  lds
 MM v[216:219],a[96:99],a[36:39],v[216:219]
 RT a[70:71],v27 offset:2048
 MM v[88:91],a[100:103],a[36:39],v[88:91]
 MM v[220:223],a[104:107],a[36:39],v[220:223]
 RT a[72:73],v28
 MM v[92:95],a[108:111],a[36:39],v[92:95]
 MM v[224:227],a[112:115],a[36:39],v[224:227]
 RT a[74:75],v28 offset:2048
 MM v[96:99],a[116:119],a[36:39],v[96:99]
 MM v[228:231],a[120:123],a[36:39],v[228:231]
 RT a[76:77],v29
 MM v[100:103],a[124:127],a[36:39],v[100:103]
 BL v18,s[12:15],s21 offen offset:2048  lds
 MM v[232:235],a[96:99],a[40:43],v[232:235]
 RT a[78:79],v29 offset:2048
 MM v[104:107],a[100:103],a[40:43],v[104:107]
 MM v[236:239],a[104:107],a[40:43],v[236:239]
 RT a[80:81],v30
 MM v[108:111],a[108:111],a[40:43],v[108:111]
 MM v[240:243],a[112:115],a[40:43],v[240:243]
 RT a[82:83],v30 offset:2048
 MM v[112:115],a[116:119],a[40:43],v[112:115]
 BL v19,s[12:15],s21 offen offset:3072  lds
 MM v[244:247],a[120:123],a[40:43],v[244:247]
 RT a[84:85],v31
 MM v[116:119],a[124:127],a[40:43],v[116:119]
 MM v[248:251],a[96:99],a[44:47],v[248:251]
 RT a[86:87],v31 offset:2048
 MM v[120:123],a[100:103],a[44:47],v[120:123]
 MM v[252:255],a[104:107],a[44:47],v[252:255]
 RT a[88:89],v32
 MM v[124:127],a[108:111],a[44:47],v[124:127]
 MM v[128:131],a[112:115],a[44:47],v[128:131]
 RT a[90:91],v32 offset:2048
 s_add_u32 m0,s23,102400
 MM v[132:135],a[116:119],a[44:47],v[132:135]
 BL v20,s[12:15],s21 offen  lds
 MM v[136:139],a[120:123],a[44:47],v[136:139]
 RT a[92:93],v33
 MM v[140:143],a[124:127],a[44:47],v[140:143]
 MM v[144:147],a[96:99],a[48:51],v[144:147]
 RT a[94:95],v33 offset:2048
 MM v[148:151],a[100:103],a[48:51],v[148:151]
 MM v[152:155],a[104:107],a[48:51],v[152:155]
 RQ a[4:7],v24 offset:2048
 MM v[156:159],a[108:111],a[48:51],v[156:159]
 BL v21,s[12:15],s21 offen offset:1024  lds
 MM v[160:163],a[112:115],a[48:51],v[160:163]
 RQ a[8:11],v24 offset:4096
 MM v[164:167],a[116:119],a[48:51],v[164:167]
 MM v[168:171],a[120:123],a[48:51],v[168:171]
 RQ a[12:15],v24 offset:6144
 MM v[172:175],a[124:127],a[48:51],v[172:175]
 MM v[176:179],a[96:99],a[52:55],v[176:179]
 RQ a[16:19],v24 offset:8192
 MM v[180:183],a[100:103],a[52:55],v[180:183]
 MM v[184:187],a[104:107],a[52:55],v[184:187]
 RQ a[20:23],v24 offset:10240
 MM v[188:191],a[108:111],a[52:55],v[188:191]
 BL v22,s[12:15],s21 offen offset:2048  lds
 MM v[192:195],a[112:115],a[52:55],v[192:195]
 RQ a[24:27],v24 offset:12288
 MM v[196:199],a[116:119],a[52:55],v[196:199]
 MM a[184:187],a[120:123],a[52:55],a[184:187]
 RQ a[28:31],v24 offset:14336
 MM a[188:191],a[124:127],a[52:55],a[188:191]
 MM a[192:195],a[96:99],a[56:59],a[192:195]
 BL v23,s[12:15],s21 offen offset:3072  lds
 MM a[196:199],a[100:103],a[56:59],a[196:199]
 s_add_u32 s21,s21,524288
 MM a[200:203],a[104:107],a[56:59],a[200:203]
 s_add_u32 s23,s23,32768
 s_sub_u32 s34,s23,65536
 s_min_u32 s23,s23,s34
 MM a[204:207],a[108:111],a[56:59],a[204:207]
 MM a[208:211],a[112:115],a[56:59],a[208:211]
 BL v[68:71],v6,s[4:7],s87 offen
 MM a[212:215],a[116:119],a[56:59],a[212:215]
 s_add_u32 s87,s87,1048576
 MM a[216:219],a[120:123],a[56:59],a[216:219]
 s_add_u32 s85,s21,1048576
 MM a[220:223],a[124:127],a[56:59],a[220:223]
 BL v[68:71],v36,s[12:15],s85 offen
 MM a[224:227],a[96:99],a[60:63],a[224:227]
 MM a[228:231],a[100:103],a[60:63],a[228:231]
 MM a[232:235],a[104:107],a[60:63],a[232:235]
 s_add_u32 m0,s22,0
 MM a[236:239],a[108:111],a[60:63],a[236:239]
 BL v8,s[8:11],s20 offen  lds
 MM a[240:243],a[112:115],a[60:63],a[240:243]
 MM a[244:247],a[116:119],a[60:63],a[244:247]
 MM a[248:251],a[120:123],a[60:63],a[248:251]
 BL v9,s[8:11],s20 offen offset:1024  lds
 MM a[252:255],a[124:127],a[60:63],a[252:255]
 s_bitcmp0_b32 s84,s28
 s_cbranch_scc1 kv0
 s_branch kv0_hk
kv0_x:
 s_sub_u32 s26,s73,14
 s_cmp_lt_u32 s26,14
 s_cbranch_scc1 kv0_g
 s_waitcnt lgkmcnt(0)
 MM v[200:203],a[64:67],a[0:3],v[200:203]
 RQ a[32:35],v25
 s_mov_b32 s88,s40
 MM v[72:75],a[68:71],a[0:3],v[72:75]
 s_add_u32 s31,s24,32768
 s_sub_u32 s33,s31,98304
 MM v[204:207],a[72:75],a[0:3],v[204:207]
 RT a[96:97],v26 offset:16384
 s_mov_b32 s89,s41
 MM v[76:79],a[76:79],a[0:3],v[76:79]
 s_min_u32 s33,s31,s33
 s_sub_u32 s31,s33,s24
 MM v[208:211],a[80:83],a[0:3],v[208:211]
 RT a[98:99],v26 offset:18432
 s_mov_b32 s90,1835008
 MM v[80:83],a[84:87],a[0:3],v[80:83]
 BL v10,s[8:11],s20 offen offset:2048  lds
 s_mov_b32 s24,s33
 MM v[212:215],a[88:91],a[0:3],v[212:215]
 RT a[100:101],v27 offset:16384
 s_mov_b32 s91,0x20000
 MM v[84:87],a[92:95],a[0:3],v[84:87]
 s_add_u32 s32,s25,32768
 s_sub_u32 s33,s32,65536
 MM v[216:219],a[64:67],a[4:7],v[216:219]
 RT a[102:103],v27 offset:18432
 s_mul_i32 s36,s97,114688
 MM v[88:91],a[68:71],a[4:7],v[88:91]
 s_min_u32 s33,s32,s33
 s_sub_u32 s32,s33,s25
 v_lshrrev_b32 v1,3,v0
 MM v[220:223],a[72:75],a[4:7],v[220:223]
 RT a[104:105],v28 offset:16384
 s_mul_i32 s26,s35,28672
 MM v[92:95],a[76:79],a[4:7],v[92:95]
 BL v11,s[8:11],s20 offen offset:3072  lds
 s_mov_b32 s25,s33
 MM v[224:227],a[80:83],a[4:7],v[224:227]
 RT a[106:107],v28 offset:18432
 v_mul_u32_u24 v1,896,v1
 MM v[96:99],a[84:87],a[4:7],v[96:99]
 v_lshrrev_b32 v2,4,v0
 v_xor_b32 v2,v2,v0
 MM v[228:231],a[88:91],a[4:7],v[228:231]
 RT a[108:109],v29 offset:16384
 v_and_b32 v2,7,v2
 MM v[100:103],a[92:95],a[4:7],v[100:103]
 v_lshl_add_u32 v1,v2,4,v1
 v_add_u32 v38,s26,v1
 MM v[232:235],a[64:67],a[8:11],v[232:235]
 RT a[110:111],v29 offset:18432
 MM v[104:107],a[68:71],a[8:11],v[104:107]
 v_xor_b32 v2,64,v38
 MM v[236:239],a[72:75],a[8:11],v[236:239]
 RT a[112:113],v30 offset:16384
 s_add_u32 m0,s22,4096
 MM v[108:111],a[76:79],a[8:11],v[108:111]
 BL v12,s[8:11],s20 offen  lds
 MM v[240:243],a[80:83],a[8:11],v[240:243]
 RT a[114:115],v30 offset:18432
 v_add_u32 v39,6144,v2
 MM v[112:115],a[84:87],a[8:11],v[112:115]
 v_add_u32 v40,12288,v38
 v_add_u32 v41,12288,v39
 MM v[244:247],a[88:91],a[8:11],v[244:247]
 RT a[116:117],v31 offset:16384
 s_mul_i32 s38,s35,4096
 MM v[116:119],a[92:95],a[8:11],v[116:119]
 s_mov_b32 s92,s44
 MM v[248:251],a[64:67],a[12:15],v[248:251]
 RT a[118:119],v31 offset:18432
 MM v[120:123],a[68:71],a[12:15],v[120:123]
 BL v13,s[8:11],s20 offen offset:1024  lds
 MM v[252:255],a[72:75],a[12:15],v[252:255]
 RT a[120:121],v32 offset:16384
 s_mov_b32 s93,s45
 MM v[124:127],a[76:79],a[12:15],v[124:127]
 s_mov_b32 s94,3670016
 s_mov_b32 s95,0x20000
 MM v[128:131],a[80:83],a[12:15],v[128:131]
 RT a[122:123],v32 offset:18432
 MM v[132:135],a[84:87],a[12:15],v[132:135]
 s_lshl_b32 s37,s74,9
 MM v[136:139],a[88:91],a[12:15],v[136:139]
 RT a[124:125],v33 offset:16384
 v_lshrrev_b32 v1,5,v0
 MM v[140:143],a[92:95],a[12:15],v[140:143]
 v_and_b32 v2,31,v0
 MM v[144:147],a[64:67],a[16:19],v[144:147]
 RT a[126:127],v33 offset:18432
 v_bfe_u32 v3,v1,0,1
 MM v[148:151],a[68:71],a[16:19],v[148:151]
 BL v14,s[8:11],s20 offen offset:2048  lds
 MM v[152:155],a[72:75],a[16:19],v[152:155]
 RQ a[36:39],v25 offset:2048
 v_lshlrev_b32 v3,1,v3
 MM v[156:159],a[76:79],a[16:19],v[156:159]
 v_xor_b32 v2,v2,v3
 MM v[160:163],a[80:83],a[16:19],v[160:163]
 RQ a[40:43],v25 offset:4096
 v_lshlrev_b32 v2,4,v2
 MM v[164:167],a[84:87],a[16:19],v[164:167]
 MM v[168:171],a[88:91],a[16:19],v[168:171]
 RQ a[44:47],v25 offset:6144
 s_mul_i32 s26,s35,131072
 MM v[172:175],a[92:95],a[16:19],v[172:175]
 BL v15,s[8:11],s20 offen offset:3072  lds
 MM v[176:179],a[64:67],a[20:23],v[176:179]
 RQ a[48:51],v25 offset:8192
 s_add_u32 s20,s20,128
 MM v[180:183],a[68:71],a[20:23],v[180:183]
 s_add_u32 s22,s22,32768
 v_mul_u32_u24 v1,8192,v1
 MM v[184:187],a[72:75],a[20:23],v[184:187]
 RQ a[52:55],v25 offset:10240
 s_sub_u32 s34,s22,98304
 s_min_u32 s22,s22,s34
 MM v[188:191],a[76:79],a[20:23],v[188:191]
 v_add_u32 v1,s26,v1
 v_add_u32 v42,v2,v1
 MM v[192:195],a[80:83],a[20:23],v[192:195]
 RQ a[56:59],v25 offset:12288
 v_xor_b32 v3,64,v2
 MM v[196:199],a[84:87],a[20:23],v[196:199]
 v_add_u32 v43,v3,v1
 MM a[184:187],a[88:91],a[20:23],a[184:187]
 RQ a[60:63],v25 offset:14336
 v_add_u32 v43,15360,v43
 MM a[188:191],a[92:95],a[20:23],a[188:191]
 v_add_u32 v24,s31,v24
 v_add_u32 v44,30720,v42
 MM a[192:195],a[64:67],a[24:27],a[192:195]
 v_add_u32 v25,s31,v25
 v_add_u32 v45,30720,v43
 MM a[196:199],a[68:71],a[24:27],a[196:199]
 MM a[200:203],a[72:75],a[24:27],a[200:203]
 v_add_u32 v26,s32,v26
 v_xor_b32 v3,128,v2
 MM a[204:207],a[76:79],a[24:27],a[204:207]
 v_add_u32 v46,v3,v1
 MM a[208:211],a[80:83],a[24:27],a[208:211]
 v_add_u32 v27,s32,v27
 v_add_u32 v46,65536,v46
 MM a[212:215],a[84:87],a[24:27],a[212:215]
 v_add_u32 v28,s32,v28
 MM a[216:219],a[88:91],a[24:27],a[216:219]
 v_xor_b32 v3,192,v2
 MM a[220:223],a[92:95],a[24:27],a[220:223]
 v_add_u32 v29,s32,v29
 v_add_u32 v47,v3,v1
 MM a[224:227],a[64:67],a[28:31],a[224:227]
 v_add_u32 v47,80896,v47
 MM a[228:231],a[68:71],a[28:31],a[228:231]
 v_add_u32 v30,s32,v30
 MM a[232:235],a[72:75],a[28:31],a[232:235]
 v_add_u32 v31,s32,v31
 v_add_u32 v48,30720,v46
 MM a[236:239],a[76:79],a[28:31],a[236:239]
 v_add_u32 v49,30720,v47
 MM a[240:243],a[80:83],a[28:31],a[240:243]
 v_add_u32 v32,s32,v32
 s_mul_i32 s39,s35,8192
 MM a[244:247],a[84:87],a[28:31],a[244:247]
 MM a[248:251],a[88:91],a[28:31],a[248:251]
 v_add_u32 v33,s32,v33
 MM a[252:255],a[92:95],a[28:31],a[252:255]
 s_waitcnt vmcnt(10)
 s_waitcnt lgkmcnt(0)
 s_barrier
 MM v[200:203],a[96:99],a[32:35],v[200:203]
 RQ a[0:3],v24
 s_add_u32 m0,s23,98304
 MM v[72:75],a[100:103],a[32:35],v[72:75]
 BL v16,s[12:15],s21 offen  lds
 MM v[204:207],a[104:107],a[32:35],v[204:207]
 RT a[64:65],v26
 MM v[76:79],a[108:111],a[32:35],v[76:79]
 MM v[208:211],a[112:115],a[32:35],v[208:211]
 RT a[66:67],v26 offset:2048
 MM v[80:83],a[116:119],a[32:35],v[80:83]
 MM v[212:215],a[120:123],a[32:35],v[212:215]
 RT a[68:69],v27
 MM v[84:87],a[124:127],a[32:35],v[84:87]
 BL v17,s[12:15],s21 offen offset:1024  lds
 MM v[216:219],a[96:99],a[36:39],v[216:219]
 RT a[70:71],v27 offset:2048
 MM v[88:91],a[100:103],a[36:39],v[88:91]
 MM v[220:223],a[104:107],a[36:39],v[220:223]
 RT a[72:73],v28
 MM v[92:95],a[108:111],a[36:39],v[92:95]
 MM v[224:227],a[112:115],a[36:39],v[224:227]
 RT a[74:75],v28 offset:2048
 MM v[96:99],a[116:119],a[36:39],v[96:99]
 MM v[228:231],a[120:123],a[36:39],v[228:231]
 RT a[76:77],v29
 MM v[100:103],a[124:127],a[36:39],v[100:103]
 BL v18,s[12:15],s21 offen offset:2048  lds
 MM v[232:235],a[96:99],a[40:43],v[232:235]
 RT a[78:79],v29 offset:2048
 MM v[104:107],a[100:103],a[40:43],v[104:107]
 MM v[236:239],a[104:107],a[40:43],v[236:239]
 RT a[80:81],v30
 MM v[108:111],a[108:111],a[40:43],v[108:111]
 MM v[240:243],a[112:115],a[40:43],v[240:243]
 RT a[82:83],v30 offset:2048
 MM v[112:115],a[116:119],a[40:43],v[112:115]
 MM v[244:247],a[120:123],a[40:43],v[244:247]
 RT a[84:85],v31
 MM v[116:119],a[124:127],a[40:43],v[116:119]
 BL v19,s[12:15],s21 offen offset:3072  lds
 MM v[248:251],a[96:99],a[44:47],v[248:251]
 RT a[86:87],v31 offset:2048
 MM v[120:123],a[100:103],a[44:47],v[120:123]
 MM v[252:255],a[104:107],a[44:47],v[252:255]
 RT a[88:89],v32
 MM v[124:127],a[108:111],a[44:47],v[124:127]
 MM v[128:131],a[112:115],a[44:47],v[128:131]
 RT a[90:91],v32 offset:2048
 MM v[132:135],a[116:119],a[44:47],v[132:135]
 MM v[136:139],a[120:123],a[44:47],v[136:139]
 RT a[92:93],v33
 s_add_u32 m0,s23,102400
 MM v[140:143],a[124:127],a[44:47],v[140:143]
 BL v20,s[12:15],s21 offen  lds
 MM v[144:147],a[96:99],a[48:51],v[144:147]
 RT a[94:95],v33 offset:2048
 MM v[148:151],a[100:103],a[48:51],v[148:151]
 MM v[152:155],a[104:107],a[48:51],v[152:155]
 RQ a[4:7],v24 offset:2048
 MM v[156:159],a[108:111],a[48:51],v[156:159]
 MM v[160:163],a[112:115],a[48:51],v[160:163]
 RQ a[8:11],v24 offset:4096
 MM v[164:167],a[116:119],a[48:51],v[164:167]
 MM v[168:171],a[120:123],a[48:51],v[168:171]
 RQ a[12:15],v24 offset:6144
 MM v[172:175],a[124:127],a[48:51],v[172:175]
 BL v21,s[12:15],s21 offen offset:1024  lds
 MM v[176:179],a[96:99],a[52:55],v[176:179]
 RQ a[16:19],v24 offset:8192
 MM v[180:183],a[100:103],a[52:55],v[180:183]
 MM v[184:187],a[104:107],a[52:55],v[184:187]
 RQ a[20:23],v24 offset:10240
 MM v[188:191],a[108:111],a[52:55],v[188:191]
 MM v[192:195],a[112:115],a[52:55],v[192:195]
 RQ a[24:27],v24 offset:12288
 MM v[196:199],a[116:119],a[52:55],v[196:199]
 MM a[184:187],a[120:123],a[52:55],a[184:187]
 RQ a[28:31],v24 offset:14336
 MM a[188:191],a[124:127],a[52:55],a[188:191]
 BL v22,s[12:15],s21 offen offset:2048  lds
 MM a[192:195],a[96:99],a[56:59],a[192:195]
 MM a[196:199],a[100:103],a[56:59],a[196:199]
 MM a[200:203],a[104:107],a[56:59],a[200:203]
 MM a[204:207],a[108:111],a[56:59],a[204:207]
 BL v23,s[12:15],s21 offen offset:3072  lds
 MM a[208:211],a[112:115],a[56:59],a[208:211]
 s_add_u32 s21,s21,524288
 MM a[212:215],a[116:119],a[56:59],a[212:215]
 s_add_u32 s23,s23,32768
 s_sub_u32 s34,s23,65536
 s_min_u32 s23,s23,s34
 MM a[216:219],a[120:123],a[56:59],a[216:219]
 s_add_u32 m0,s38,32768
 MM a[220:223],a[124:127],a[56:59],a[220:223]
 BL v38,s[88:91],s36 offen  lds
 MM a[224:227],a[96:99],a[60:63],a[224:227]
 MM a[228:231],a[100:103],a[60:63],a[228:231]
 MM a[232:235],a[104:107],a[60:63],a[232:235]
 MM a[236:239],a[108:111],a[60:63],a[236:239]
 BL v39,s[88:91],s36 offen offset:1024  lds
 MM a[240:243],a[112:115],a[60:63],a[240:243]
 MM a[244:247],a[116:119],a[60:63],a[244:247]
 MM a[248:251],a[120:123],a[60:63],a[248:251]
 MM a[252:255],a[124:127],a[60:63],a[252:255]
 BL v40,s[88:91],s36 offen offset:2048  lds
 s_waitcnt lgkmcnt(0)
 MM v[200:203],a[64:67],a[0:3],v[200:203]
 RQ a[32:35],v25
 s_mov_b32 s26,s35
 MM v[72:75],a[68:71],a[0:3],v[72:75]
 s_add_u32 s31,s24,32768
 s_sub_u32 s33,s31,98304
 MM v[204:207],a[72:75],a[0:3],v[204:207]
 RT a[96:97],v26 offset:16384
 v_and_b32 v1,15,v0
 MM v[76:79],a[76:79],a[0:3],v[76:79]
 s_min_u32 s33,s31,s33
 s_sub_u32 s31,s33,s24
 MM v[208:211],a[80:83],a[0:3],v[208:211]
 RT a[98:99],v26 offset:18432
 MM v[80:83],a[84:87],a[0:3],v[80:83]
 s_mov_b32 s24,s33
 s_mul_i32 s26,s26,4096
 MM v[212:215],a[88:91],a[0:3],v[212:215]
 RT a[100:101],v27 offset:16384
 MM v[84:87],a[92:95],a[0:3],v[84:87]
 BL v41,s[88:91],s36 offen offset:3072  lds
 s_add_u32 s32,s25,32768
 s_sub_u32 s33,s32,65536
 MM v[216:219],a[64:67],a[4:7],v[216:219]
 RT a[102:103],v27 offset:18432
 s_add_u32 s36,s36,128
 MM v[88:91],a[68:71],a[4:7],v[88:91]
 s_min_u32 s33,s32,s33
 s_sub_u32 s32,s33,s25
 MM v[220:223],a[72:75],a[4:7],v[220:223]
 RT a[104:105],v28 offset:16384
 v_lshl_add_u32 v1,v1,7,s26
 MM v[92:95],a[76:79],a[4:7],v[92:95]
 s_mov_b32 s25,s33
 v_lshrrev_b32 v2,4,v0
 MM v[224:227],a[80:83],a[4:7],v[224:227]
 RT a[106:107],v28 offset:18432
 MM v[96:99],a[84:87],a[4:7],v[96:99]
 v_bfe_u32 v3,v0,1,3
 MM v[228:231],a[88:91],a[4:7],v[228:231]
 RT a[108:109],v29 offset:16384
 s_add_u32 m0,s38,49152
 MM v[100:103],a[92:95],a[4:7],v[100:103]
 BL v38,s[88:91],s36 offen  lds
 MM v[232:235],a[64:67],a[8:11],v[232:235]
 RT a[110:111],v29 offset:18432
 v_xor_b32 v2,v2,v3
 MM v[104:107],a[68:71],a[8:11],v[104:107]
 MM v[236:239],a[72:75],a[8:11],v[236:239]
 RT a[112:113],v30 offset:16384
 v_lshl_add_u32 v50,v2,4,v1
 MM v[108:111],a[76:79],a[8:11],v[108:111]
 MM v[240:243],a[80:83],a[8:11],v[240:243]
 RT a[114:115],v30 offset:18432
 MM v[112:115],a[84:87],a[8:11],v[112:115]
 v_xor_b32 v51,64,v50
 MM v[244:247],a[88:91],a[8:11],v[244:247]
 RT a[116:117],v31 offset:16384
 MM v[116:119],a[92:95],a[8:11],v[116:119]
 BL v39,s[88:91],s36 offen offset:1024  lds
 MM v[248:251],a[64:67],a[12:15],v[248:251]
 RT a[118:119],v31 offset:18432
 v_bfe_u32 v1,v0,2,2
 MM v[120:123],a[68:71],a[12:15],v[120:123]
 MM v[252:255],a[72:75],a[12:15],v[252:255]
 RT a[120:121],v32 offset:16384
 v_lshrrev_b32 v2,4,v0
 MM v[124:127],a[76:79],a[12:15],v[124:127]
 MM v[128:131],a[80:83],a[12:15],v[128:131]
 RT a[122:123],v32 offset:18432
 MM v[132:135],a[84:87],a[12:15],v[132:135]
 v_lshl_add_u32 v2,v2,3,v1
 MM v[136:139],a[88:91],a[12:15],v[136:139]
 RT a[124:125],v33 offset:16384
 MM v[140:143],a[92:95],a[12:15],v[140:143]
 BL v40,s[88:91],s36 offen offset:2048  lds
 MM v[144:147],a[64:67],a[16:19],v[144:147]
 RT a[126:127],v33 offset:18432
 v_bfe_u32 v4,v2,0,1
 MM v[148:151],a[68:71],a[16:19],v[148:151]
 MM v[152:155],a[72:75],a[16:19],v[152:155]
 RQ a[36:39],v25 offset:2048
 v_bfe_u32 v5,v2,1,1
 MM v[156:159],a[76:79],a[16:19],v[156:159]
 MM v[160:163],a[80:83],a[16:19],v[160:163]
 RQ a[40:43],v25 offset:4096
 MM v[164:167],a[84:87],a[16:19],v[164:167]
 v_lshl_or_b32 v4,v5,1,v4
 MM v[168:171],a[88:91],a[16:19],v[168:171]
 RQ a[44:47],v25 offset:6144
 MM v[172:175],a[92:95],a[16:19],v[172:175]
 BL v41,s[88:91],s36 offen offset:3072  lds
 MM v[176:179],a[64:67],a[20:23],v[176:179]
 RQ a[48:51],v25 offset:8192
 s_add_u32 s36,s36,128
 MM v[180:183],a[68:71],a[20:23],v[180:183]
 v_bfe_u32 v5,v2,3,1
 MM v[184:187],a[72:75],a[20:23],v[184:187]
 RQ a[52:55],v25 offset:10240
 v_lshl_or_b32 v4,v5,2,v4
 MM v[188:191],a[76:79],a[20:23],v[188:191]
 MM v[192:195],a[80:83],a[20:23],v[192:195]
 RQ a[56:59],v25 offset:12288
 MM v[196:199],a[84:87],a[20:23],v[196:199]
 v_mul_u32_u24 v2,512,v2
 MM a[184:187],a[88:91],a[20:23],a[184:187]
 RQ a[60:63],v25 offset:14336
 MM a[188:191],a[92:95],a[20:23],a[188:191]
 v_add_u32 v24,s31,v24
 MM a[192:195],a[64:67],a[24:27],a[192:195]
 v_add_u32 v25,s31,v25
 v_and_b32 v3,3,v0
 MM a[196:199],a[68:71],a[24:27],a[196:199]
 MM a[200:203],a[72:75],a[24:27],a[200:203]
 v_add_u32 v26,s32,v26
 v_lshl_add_u32 v2,v3,3,v2
 MM a[204:207],a[76:79],a[24:27],a[204:207]
 MM a[208:211],a[80:83],a[24:27],a[208:211]
 v_add_u32 v27,s32,v27
 MM a[212:215],a[84:87],a[24:27],a[212:215]
 v_add_u32 v28,s32,v28
 v_add_u32 v2,65536,v2
 MM a[216:219],a[88:91],a[24:27],a[216:219]
 MM a[220:223],a[92:95],a[24:27],a[220:223]
 v_add_u32 v29,s32,v29
 MM a[224:227],a[64:67],a[28:31],a[224:227]
 s_mov_b32 s26,0
 MM a[228:231],a[68:71],a[28:31],a[228:231]
 v_add_u32 v30,s32,v30
 MM a[232:235],a[72:75],a[28:31],a[232:235]
 v_add_u32 v31,s32,v31
 s_mul_i32 s26,s26,16
 MM a[236:239],a[76:79],a[28:31],a[236:239]
 MM a[240:243],a[80:83],a[28:31],a[240:243]
 v_add_u32 v32,s32,v32
 MM a[244:247],a[84:87],a[28:31],a[244:247]
 v_xor_b32 v4,s26,v4
 MM a[248:251],a[88:91],a[28:31],a[248:251]
 v_add_u32 v33,s32,v33
 MM a[252:255],a[92:95],a[28:31],a[252:255]
 s_waitcnt vmcnt(8)
 s_waitcnt lgkmcnt(0)
 s_barrier
 MM v[200:203],a[96:99],a[32:35],v[200:203]
 RQ a[0:3],v24
 s_add_u32 m0,s39,65536
 MM v[72:75],a[100:103],a[32:35],v[72:75]
 BL v42,s[92:95],s37 offen  lds
 MM v[204:207],a[104:107],a[32:35],v[204:207]
 RT a[64:65],v26
 v_xor_b32 v3,0,v4
 MM v[76:79],a[108:111],a[32:35],v[76:79]
 v_lshl_add_u32 v52,v3,5,v2
 MM v[208:211],a[112:115],a[32:35],v[208:211]
 RT a[66:67],v26 offset:2048
 MM v[80:83],a[116:119],a[32:35],v[80:83]
 v_xor_b32 v3,1,v4
 MM v[212:215],a[120:123],a[32:35],v[212:215]
 RT a[68:69],v27
 MM v[84:87],a[124:127],a[32:35],v[84:87]
 BL v43,s[92:95],s37 offen offset:1024  lds
 MM v[216:219],a[96:99],a[36:39],v[216:219]
 RT a[70:71],v27 offset:2048
 v_lshl_add_u32 v53,v3,5,v2
 MM v[88:91],a[100:103],a[36:39],v[88:91]
 MM v[220:223],a[104:107],a[36:39],v[220:223]
 RT a[72:73],v28
 v_xor_b32 v3,2,v4
 MM v[92:95],a[108:111],a[36:39],v[92:95]
 MM v[224:227],a[112:115],a[36:39],v[224:227]
 RT a[74:75],v28 offset:2048
 MM v[96:99],a[116:119],a[36:39],v[96:99]
 v_lshl_add_u32 v54,v3,5,v2
 MM v[228:231],a[120:123],a[36:39],v[228:231]
 RT a[76:77],v29
 MM v[100:103],a[124:127],a[36:39],v[100:103]
 BL v44,s[92:95],s37 offen offset:2048  lds
 MM v[232:235],a[96:99],a[40:43],v[232:235]
 RT a[78:79],v29 offset:2048
 v_xor_b32 v3,3,v4
 MM v[104:107],a[100:103],a[40:43],v[104:107]
 MM v[236:239],a[104:107],a[40:43],v[236:239]
 RT a[80:81],v30
 v_lshl_add_u32 v55,v3,5,v2
 MM v[108:111],a[108:111],a[40:43],v[108:111]
 MM v[240:243],a[112:115],a[40:43],v[240:243]
 RT a[82:83],v30 offset:2048
 MM v[112:115],a[116:119],a[40:43],v[112:115]
 v_xor_b32 v3,4,v4
 MM v[244:247],a[120:123],a[40:43],v[244:247]
 RT a[84:85],v31
 MM v[116:119],a[124:127],a[40:43],v[116:119]
 BL v45,s[92:95],s37 offen offset:3072  lds
 MM v[248:251],a[96:99],a[44:47],v[248:251]
 RT a[86:87],v31 offset:2048
 v_lshl_add_u32 v56,v3,5,v2
 MM v[120:123],a[100:103],a[44:47],v[120:123]
 MM v[252:255],a[104:107],a[44:47],v[252:255]
 RT a[88:89],v32
 v_xor_b32 v3,5,v4
 MM v[124:127],a[108:111],a[44:47],v[124:127]
 MM v[128:131],a[112:115],a[44:47],v[128:131]
 RT a[90:91],v32 offset:2048
 MM v[132:135],a[116:119],a[44:47],v[132:135]
 v_lshl_add_u32 v57,v3,5,v2
 MM v[136:139],a[120:123],a[44:47],v[136:139]
 RT a[92:93],v33
 s_add_u32 m0,s39,69632
 MM v[140:143],a[124:127],a[44:47],v[140:143]
 BL v46,s[92:95],s37 offen  lds
 MM v[144:147],a[96:99],a[48:51],v[144:147]
 RT a[94:95],v33 offset:2048
 v_xor_b32 v3,6,v4
 MM v[148:151],a[100:103],a[48:51],v[148:151]
 MM v[152:155],a[104:107],a[48:51],v[152:155]
 RQ a[4:7],v24 offset:2048
 v_lshl_add_u32 v58,v3,5,v2
 MM v[156:159],a[108:111],a[48:51],v[156:159]
 MM v[160:163],a[112:115],a[48:51],v[160:163]
 RQ a[8:11],v24 offset:4096
 MM v[164:167],a[116:119],a[48:51],v[164:167]
 v_xor_b32 v3,7,v4
 MM v[168:171],a[120:123],a[48:51],v[168:171]
 RQ a[12:15],v24 offset:6144
 MM v[172:175],a[124:127],a[48:51],v[172:175]
 BL v47,s[92:95],s37 offen offset:1024  lds
 MM v[176:179],a[96:99],a[52:55],v[176:179]
 RQ a[16:19],v24 offset:8192
 v_lshl_add_u32 v59,v3,5,v2
 MM v[180:183],a[100:103],a[52:55],v[180:183]
 MM v[184:187],a[104:107],a[52:55],v[184:187]
 RQ a[20:23],v24 offset:10240
 v_add_u32 v60,65536,v52
 MM v[188:191],a[108:111],a[52:55],v[188:191]
 MM v[192:195],a[112:115],a[52:55],v[192:195]
 RQ a[24:27],v24 offset:12288
 MM v[196:199],a[116:119],a[52:55],v[196:199]
 v_add_u32 v61,65536,v53
 MM a[184:187],a[120:123],a[52:55],a[184:187]
 RQ a[28:31],v24 offset:14336
 MM a[188:191],a[124:127],a[52:55],a[188:191]
 BL v48,s[92:95],s37 offen offset:2048  lds
 MM a[192:195],a[96:99],a[56:59],a[192:195]
 v_add_u32 v62,65536,v54
 MM a[196:199],a[100:103],a[56:59],a[196:199]
 MM a[200:203],a[104:107],a[56:59],a[200:203]
 v_add_u32 v63,65536,v55
 MM a[204:207],a[108:111],a[56:59],a[204:207]
 BL v49,s[92:95],s37 offen offset:3072  lds
 MM a[208:211],a[112:115],a[56:59],a[208:211]
 s_add_u32 s37,s37,524288
 MM a[212:215],a[116:119],a[56:59],a[212:215]
 v_add_u32 v64,65536,v56
 MM a[216:219],a[120:123],a[56:59],a[216:219]
 s_add_u32 m0,s39,98304
 MM a[220:223],a[124:127],a[56:59],a[220:223]
 BL v42,s[92:95],s37 offen  lds
 MM a[224:227],a[96:99],a[60:63],a[224:227]
 v_add_u32 v65,65536,v57
 MM a[228:231],a[100:103],a[60:63],a[228:231]
 MM a[232:235],a[104:107],a[60:63],a[232:235]
 v_add_u32 v66,65536,v58
 MM a[236:239],a[108:111],a[60:63],a[236:239]
 BL v43,s[92:95],s37 offen offset:1024  lds
 MM a[240:243],a[112:115],a[60:63],a[240:243]
 MM a[244:247],a[116:119],a[60:63],a[244:247]
 v_add_u32 v67,65536,v59
 MM a[248:251],a[120:123],a[60:63],a[248:251]
 MM a[252:255],a[124:127],a[60:63],a[252:255]
 BL v44,s[92:95],s37 offen offset:2048  lds
 s_waitcnt lgkmcnt(0)
 MM v[200:203],a[64:67],a[0:3],v[200:203]
 RQ a[32:35],v25
 MM v[72:75],a[68:71],a[0:3],v[72:75]
 MM v[204:207],a[72:75],a[0:3],v[204:207]
 RT a[96:97],v26 offset:16384
 MM v[76:79],a[76:79],a[0:3],v[76:79]
 MM v[208:211],a[80:83],a[0:3],v[208:211]
 RT a[98:99],v26 offset:18432
 MM v[80:83],a[84:87],a[0:3],v[80:83]
 MM v[212:215],a[88:91],a[0:3],v[212:215]
 RT a[100:101],v27 offset:16384
 MM v[84:87],a[92:95],a[0:3],v[84:87]
 BL v45,s[92:95],s37 offen offset:3072  lds
 MM v[216:219],a[64:67],a[4:7],v[216:219]
 RT a[102:103],v27 offset:18432
 MM v[88:91],a[68:71],a[4:7],v[88:91]
 MM v[220:223],a[72:75],a[4:7],v[220:223]
 RT a[104:105],v28 offset:16384
 MM v[92:95],a[76:79],a[4:7],v[92:95]
 MM v[224:227],a[80:83],a[4:7],v[224:227]
 RT a[106:107],v28 offset:18432
 MM v[96:99],a[84:87],a[4:7],v[96:99]
 MM v[228:231],a[88:91],a[4:7],v[228:231]
 RT a[108:109],v29 offset:16384
 s_add_u32 m0,s39,102400
 MM v[100:103],a[92:95],a[4:7],v[100:103]
 BL v46,s[92:95],s37 offen  lds
 MM v[232:235],a[64:67],a[8:11],v[232:235]
 RT a[110:111],v29 offset:18432
 MM v[104:107],a[68:71],a[8:11],v[104:107]
 MM v[236:239],a[72:75],a[8:11],v[236:239]
 RT a[112:113],v30 offset:16384
 MM v[108:111],a[76:79],a[8:11],v[108:111]
 MM v[240:243],a[80:83],a[8:11],v[240:243]
 RT a[114:115],v30 offset:18432
 MM v[112:115],a[84:87],a[8:11],v[112:115]
 MM v[244:247],a[88:91],a[8:11],v[244:247]
 RT a[116:117],v31 offset:16384
 MM v[116:119],a[92:95],a[8:11],v[116:119]
 BL v47,s[92:95],s37 offen offset:1024  lds
 MM v[248:251],a[64:67],a[12:15],v[248:251]
 RT a[118:119],v31 offset:18432
 MM v[120:123],a[68:71],a[12:15],v[120:123]
 MM v[252:255],a[72:75],a[12:15],v[252:255]
 RT a[120:121],v32 offset:16384
 MM v[124:127],a[76:79],a[12:15],v[124:127]
 MM v[128:131],a[80:83],a[12:15],v[128:131]
 RT a[122:123],v32 offset:18432
 MM v[132:135],a[84:87],a[12:15],v[132:135]
 MM v[136:139],a[88:91],a[12:15],v[136:139]
 RT a[124:125],v33 offset:16384
 MM v[140:143],a[92:95],a[12:15],v[140:143]
 BL v48,s[92:95],s37 offen offset:2048  lds
 MM v[144:147],a[64:67],a[16:19],v[144:147]
 RT a[126:127],v33 offset:18432
 MM v[148:151],a[68:71],a[16:19],v[148:151]
 MM v[152:155],a[72:75],a[16:19],v[152:155]
 RQ a[36:39],v25 offset:2048
 MM v[156:159],a[76:79],a[16:19],v[156:159]
 MM v[160:163],a[80:83],a[16:19],v[160:163]
 RQ a[40:43],v25 offset:4096
 MM v[164:167],a[84:87],a[16:19],v[164:167]
 MM v[168:171],a[88:91],a[16:19],v[168:171]
 RQ a[44:47],v25 offset:6144
 MM v[172:175],a[92:95],a[16:19],v[172:175]
 BL v49,s[92:95],s37 offen offset:3072  lds
 MM v[176:179],a[64:67],a[20:23],v[176:179]
 RQ a[48:51],v25 offset:8192
 s_add_u32 s37,s37,524288
 MM v[180:183],a[68:71],a[20:23],v[180:183]
 MM v[184:187],a[72:75],a[20:23],v[184:187]
 RQ a[52:55],v25 offset:10240
 MM v[188:191],a[76:79],a[20:23],v[188:191]
 MM v[192:195],a[80:83],a[20:23],v[192:195]
 RQ a[56:59],v25 offset:12288
 MM v[196:199],a[84:87],a[20:23],v[196:199]
 MM a[184:187],a[88:91],a[20:23],a[184:187]
 RQ a[60:63],v25 offset:14336
 MM a[188:191],a[92:95],a[20:23],a[188:191]
 MM a[192:195],a[64:67],a[24:27],a[192:195]
 MM a[196:199],a[68:71],a[24:27],a[196:199]
 MM a[200:203],a[72:75],a[24:27],a[200:203]
 MM a[204:207],a[76:79],a[24:27],a[204:207]
 MM a[208:211],a[80:83],a[24:27],a[208:211]
 MM a[212:215],a[84:87],a[24:27],a[212:215]
 MM a[216:219],a[88:91],a[24:27],a[216:219]
 MM a[220:223],a[92:95],a[24:27],a[220:223]
 MM a[224:227],a[64:67],a[28:31],a[224:227]
 MM a[228:231],a[68:71],a[28:31],a[228:231]
 MM a[232:235],a[72:75],a[28:31],a[232:235]
 MM a[236:239],a[76:79],a[28:31],a[236:239]
 MM a[240:243],a[80:83],a[28:31],a[240:243]
 MM a[244:247],a[84:87],a[28:31],a[244:247]
 MM a[248:251],a[88:91],a[28:31],a[248:251]
 MM a[252:255],a[92:95],a[28:31],a[252:255]
 s_waitcnt lgkmcnt(0)
 s_barrier
 MM v[200:203],a[96:99],a[32:35],v[200:203]
 s_add_u32 m0,s38,0
 MM v[72:75],a[100:103],a[32:35],v[72:75]
 BL v38,s[88:91],s36 offen  lds
 MM v[204:207],a[104:107],a[32:35],v[204:207]
 MM v[76:79],a[108:111],a[32:35],v[76:79]
 MM v[208:211],a[112:115],a[32:35],v[208:211]
 MM v[80:83],a[116:119],a[32:35],v[80:83]
 MM v[212:215],a[120:123],a[32:35],v[212:215]
 MM v[84:87],a[124:127],a[32:35],v[84:87]
 MM v[216:219],a[96:99],a[36:39],v[216:219]
 MM v[88:91],a[100:103],a[36:39],v[88:91]
 MM v[220:223],a[104:107],a[36:39],v[220:223]
 MM v[92:95],a[108:111],a[36:39],v[92:95]
 BL v39,s[88:91],s36 offen offset:1024  lds
 MM v[224:227],a[112:115],a[36:39],v[224:227]
 MM v[96:99],a[116:119],a[36:39],v[96:99]
 MM v[228:231],a[120:123],a[36:39],v[228:231]
 MM v[100:103],a[124:127],a[36:39],v[100:103]
 MM v[232:235],a[96:99],a[40:43],v[232:235]
 MM v[104:107],a[100:103],a[40:43],v[104:107]
 MM v[236:239],a[104:107],a[40:43],v[236:239]
 MM v[108:111],a[108:111],a[40:43],v[108:111]
 MM v[240:243],a[112:115],a[40:43],v[240:243]
 MM v[112:115],a[116:119],a[40:43],v[112:115]
 BL v40,s[88:91],s36 offen offset:2048  lds
 MM v[244:247],a[120:123],a[40:43],v[244:247]
 MM v[116:119],a[124:127],a[40:43],v[116:119]
 MM v[248:251],a[96:99],a[44:47],v[248:251]
 MM v[120:123],a[100:103],a[44:47],v[120:123]
 MM v[252:255],a[104:107],a[44:47],v[252:255]
 MM v[124:127],a[108:111],a[44:47],v[124:127]
 MM v[128:131],a[112:115],a[44:47],v[128:131]
 MM v[132:135],a[116:119],a[44:47],v[132:135]
 MM v[136:139],a[120:123],a[44:47],v[136:139]
 MM v[140:143],a[124:127],a[44:47],v[140:143]
 BL v41,s[88:91],s36 offen offset:3072  lds
 MM v[144:147],a[96:99],a[48:51],v[144:147]
 s_add_u32 s36,s36,128
 MM v[148:151],a[100:103],a[48:51],v[148:151]
 MM v[152:155],a[104:107],a[48:51],v[152:155]
 MM v[156:159],a[108:111],a[48:51],v[156:159]
 MM v[160:163],a[112:115],a[48:51],v[160:163]
 MM v[164:167],a[116:119],a[48:51],v[164:167]
 MM v[168:171],a[120:123],a[48:51],v[168:171]
 MM v[172:175],a[124:127],a[48:51],v[172:175]
 MM v[176:179],a[96:99],a[52:55],v[176:179]
 MM v[180:183],a[100:103],a[52:55],v[180:183]
 MM v[184:187],a[104:107],a[52:55],v[184:187]
 s_add_u32 m0,s39,131072
 MM v[188:191],a[108:111],a[52:55],v[188:191]
 BL v42,s[92:95],s37 offen  lds
 MM v[192:195],a[112:115],a[52:55],v[192:195]
 MM v[196:199],a[116:119],a[52:55],v[196:199]
 MM a[184:187],a[120:123],a[52:55],a[184:187]
 MM a[188:191],a[124:127],a[52:55],a[188:191]
 MM a[192:195],a[96:99],a[56:59],a[192:195]
 MM a[196:199],a[100:103],a[56:59],a[196:199]
 MM a[200:203],a[104:107],a[56:59],a[200:203]
 BL v43,s[92:95],s37 offen offset:1024  lds
 MM a[204:207],a[108:111],a[56:59],a[204:207]
 MM a[208:211],a[112:115],a[56:59],a[208:211]
 MM a[212:215],a[116:119],a[56:59],a[212:215]
 MM a[216:219],a[120:123],a[56:59],a[216:219]
 MM a[220:223],a[124:127],a[56:59],a[220:223]
 BL v44,s[92:95],s37 offen offset:2048  lds
 MM a[224:227],a[96:99],a[60:63],a[224:227]
 MM a[228:231],a[100:103],a[60:63],a[228:231]
 MM a[232:235],a[104:107],a[60:63],a[232:235]
 MM a[236:239],a[108:111],a[60:63],a[236:239]
 MM a[240:243],a[112:115],a[60:63],a[240:243]
 BL v45,s[92:95],s37 offen offset:3072  lds
 MM a[244:247],a[116:119],a[60:63],a[244:247]
 MM a[248:251],a[120:123],a[60:63],a[248:251]
 MM a[252:255],a[124:127],a[60:63],a[252:255]
 s_add_u32 m0,s39,135168
 s_nop 0
 BL v46,s[92:95],s37 offen  lds
 BL v47,s[92:95],s37 offen offset:1024  lds
 BL v48,s[92:95],s37 offen offset:2048  lds
 BL v49,s[92:95],s37 offen offset:3072  lds
 s_add_u32 s37,s37,524288
 s_mov_b32 s16,s68
 s_mov_b32 s17,s69
 s_mov_b32 s18,33554432
 s_mov_b32 s19,0x20000
 s_and_b32 s85,s35,1
 s_lshl_b32 s84,s70,1
 s_add_u32 s84,s84,s85
 s_lshl_b32 s84,s84,16
 s_lshr_b32 s85,s35,1
 s_lshl_b32 s85,s85,12
 s_add_u32 s84,s84,s85
 s_lshl_b32 s85,s71,20
 s_add_u32 s84,s84,s85
 s_mov_b32 s29,4096
 s_mov_b32 s30,4096
 AR v12,a184
 AR v13,a185
 AR v14,a186
 AR v15,a187
 AR v16,a188
 AR v17,a189
 AR v18,a190
 AR v19,a191
 CV v8,v12,v13
 CV v9,v14,v15
 CV v10,v16,v17
 CV v11,v18,v19
 s_add_u32 s85,s84,40960
 BS v[8:11],v6,s[16:19],s85 offen offset:3072 sc1
 AR v24,a192
 AR v25,a193
 AR v26,a194
 AR v27,a195
 AR v28,a196
 AR v29,a197
 AR v30,a198
 AR v31,a199
 CV v20,v24,v25
 CV v21,v26,v27
 CV v22,v28,v29
 CV v23,v30,v31
 s_add_u32 s85,s84,49152
 BS v[20:23],v6,s[16:19],s85 offen sc1
 AR v12,a200
 AR v13,a201
 AR v14,a202
 AR v15,a203
 AR v16,a204
 AR v17,a205
 AR v18,a206
 AR v19,a207
 CV v8,v12,v13
 CV v9,v14,v15
 CV v10,v16,v17
 CV v11,v18,v19
 s_add_u32 s85,s84,49152
 BS v[8:11],v6,s[16:19],s85 offen offset:1024 sc1
 AR v24,a208
 AR v25,a209
 AR v26,a210
 AR v27,a211
 AR v28,a212
 AR v29,a213
 AR v30,a214
 AR v31,a215
 CV v20,v24,v25
 CV v21,v26,v27
 CV v22,v28,v29
 CV v23,v30,v31
 s_add_u32 s85,s84,49152
 BS v[20:23],v6,s[16:19],s85 offen offset:2048 sc1
 AR v12,a216
 AR v13,a217
 AR v14,a218
 AR v15,a219
 AR v16,a220
 AR v17,a221
 AR v18,a222
 AR v19,a223
 CV v8,v12,v13
 CV v9,v14,v15
 CV v10,v16,v17
 CV v11,v18,v19
 s_add_u32 s85,s84,49152
 BS v[8:11],v6,s[16:19],s85 offen offset:3072 sc1
 AR v24,a224
 AR v25,a225
 AR v26,a226
 AR v27,a227
 AR v28,a228
 AR v29,a229
 AR v30,a230
 AR v31,a231
 CV v20,v24,v25
 CV v21,v26,v27
 CV v22,v28,v29
 CV v23,v30,v31
 s_add_u32 s85,s84,57344
 BS v[20:23],v6,s[16:19],s85 offen sc1
 AR v12,a232
 AR v13,a233
 AR v14,a234
 AR v15,a235
 AR v16,a236
 AR v17,a237
 AR v18,a238
 AR v19,a239
 CV v8,v12,v13
 CV v9,v14,v15
 CV v10,v16,v17
 CV v11,v18,v19
 s_add_u32 s85,s84,57344
 BS v[8:11],v6,s[16:19],s85 offen offset:1024 sc1
 AR v24,a240
 AR v25,a241
 AR v26,a242
 AR v27,a243
 AR v28,a244
 AR v29,a245
 AR v30,a246
 AR v31,a247
 CV v20,v24,v25
 CV v21,v26,v27
 CV v22,v28,v29
 CV v23,v30,v31
 s_add_u32 s85,s84,57344
 BS v[20:23],v6,s[16:19],s85 offen offset:2048 sc1
 AR v12,a248
 AR v13,a249
 AR v14,a250
 AR v15,a251
 AR v16,a252
 AR v17,a253
 AR v18,a254
 AR v19,a255
 CV v8,v12,v13
 CV v9,v14,v15
 CV v10,v16,v17
 CV v11,v18,v19
 s_add_u32 s85,s84,57344
 BS v[8:11],v6,s[16:19],s85 offen offset:3072 sc1
 CV v128,v128,v129
 CV v129,v130,v131
 CV v130,v132,v133
 CV v131,v134,v135
 AW a152,v128
 AW a153,v129
 AW a154,v130
 AW a155,v131
 CV v136,v136,v137
 CV v137,v138,v139
 CV v138,v140,v141
 CV v139,v142,v143
 AW a156,v136
 AW a157,v137
 AW a158,v138
 AW a159,v139
 CV v144,v144,v145
 CV v145,v146,v147
 CV v146,v148,v149
 CV v147,v150,v151
 AW a160,v144
 AW a161,v145
 AW a162,v146
 AW a163,v147
 CV v152,v152,v153
 CV v153,v154,v155
 CV v154,v156,v157
 CV v155,v158,v159
 AW a164,v152
 AW a165,v153
 AW a166,v154
 AW a167,v155
 CV v160,v160,v161
 CV v161,v162,v163
 CV v162,v164,v165
 CV v163,v166,v167
 AW a168,v160
 AW a169,v161
 AW a170,v162
 AW a171,v163
 CV v168,v168,v169
 CV v169,v170,v171
 CV v170,v172,v173
 CV v171,v174,v175
 AW a172,v168
 AW a173,v169
 AW a174,v170
 AW a175,v171
 CV v176,v176,v177
 CV v177,v178,v179
 CV v178,v180,v181
 CV v179,v182,v183
 AW a176,v176
 AW a177,v177
 AW a178,v178
 AW a179,v179
 CV v184,v184,v185
 CV v185,v186,v187
 CV v186,v188,v189
 CV v187,v190,v191
 AW a180,v184
 AW a181,v185
 AW a182,v186
 AW a183,v187
 CV v192,v192,v193
 CV v193,v194,v195
 CV v194,v196,v197
 CV v195,v198,v199
 AW a184,v192
 AW a185,v193
 AW a186,v194
 AW a187,v195
 CV v200,v200,v201
 CV v201,v202,v203
 CV v202,v72,v73
 CV v203,v74,v75
 CV v204,v204,v205
 CV v205,v206,v207
 CV v206,v76,v77
 CV v207,v78,v79
 CV v208,v208,v209
 CV v209,v210,v211
 CV v210,v80,v81
 CV v211,v82,v83
 CV v212,v212,v213
 CV v213,v214,v215
 CV v214,v84,v85
 CV v215,v86,v87
 CV v216,v216,v217
 CV v217,v218,v219
 CV v218,v88,v89
 CV v219,v90,v91
 CV v220,v220,v221
 CV v221,v222,v223
 CV v222,v92,v93
 CV v223,v94,v95
 CV v224,v224,v225
 CV v225,v226,v227
 CV v226,v96,v97
 CV v227,v98,v99
 CV v228,v228,v229
 CV v229,v230,v231
 CV v230,v100,v101
 CV v231,v102,v103
 CV v232,v232,v233
 CV v233,v234,v235
 CV v234,v104,v105
 CV v235,v106,v107
 CV v236,v236,v237
 CV v237,v238,v239
 CV v238,v108,v109
 CV v239,v110,v111
 CV v240,v240,v241
 CV v241,v242,v243
 CV v242,v112,v113
 CV v243,v114,v115
 CV v244,v244,v245
 CV v245,v246,v247
 CV v246,v116,v117
 CV v247,v118,v119
 CV v248,v248,v249
 CV v249,v250,v251
 CV v250,v120,v121
 CV v251,v122,v123
 CV v252,v252,v253
 CV v253,v254,v255
 CV v254,v124,v125
 CV v255,v126,v127
 s_branch L_q
L_V:
 s_mov_b32 s84,12304
 s_branch kv1
 .p2align 6
kv1:
 s_waitcnt lgkmcnt(0)
 MM v[200:203],a[0:3],a[64:67],v[200:203]
 RQ a[32:35],v25
 MM v[204:207],a[0:3],a[68:71],v[204:207]
 s_add_u32 s31,s24,32768
 s_sub_u32 s33,s31,98304
 MM v[208:211],a[0:3],a[72:75],v[208:211]
 RT a[96:97],v26 offset:16384
 MM v[212:215],a[0:3],a[76:79],v[212:215]
 s_min_u32 s33,s31,s33
 s_sub_u32 s31,s33,s24
 MM v[216:219],a[0:3],a[80:83],v[216:219]
 RT a[98:99],v26 offset:18432
 MM v[220:223],a[0:3],a[84:87],v[220:223]
 BL v10,s[8:11],s20 offen offset:2048  lds
 s_mov_b32 s24,s33
 MM v[224:227],a[0:3],a[88:91],v[224:227]
 RT a[100:101],v27 offset:16384
 MM v[228:231],a[0:3],a[92:95],v[228:231]
 s_add_u32 s32,s25,32768
 s_sub_u32 s33,s32,65536
 MM v[72:75],a[4:7],a[64:67],v[72:75]
 RT a[102:103],v27 offset:18432
 MM v[76:79],a[4:7],a[68:71],v[76:79]
 s_min_u32 s33,s32,s33
 s_sub_u32 s32,s33,s25
 MM v[80:83],a[4:7],a[72:75],v[80:83]
 RT a[104:105],v28 offset:16384
 MM v[84:87],a[4:7],a[76:79],v[84:87]
 BL v11,s[8:11],s20 offen offset:3072  lds
 s_mov_b32 s25,s33
 MM v[88:91],a[4:7],a[80:83],v[88:91]
 RT a[106:107],v28 offset:18432
 MM v[92:95],a[4:7],a[84:87],v[92:95]
 MM v[96:99],a[4:7],a[88:91],v[96:99]
 RT a[108:109],v29 offset:16384
 MM v[100:103],a[4:7],a[92:95],v[100:103]
 MM v[232:235],a[8:11],a[64:67],v[232:235]
 RT a[110:111],v29 offset:18432
 MM v[236:239],a[8:11],a[68:71],v[236:239]
 MM v[240:243],a[8:11],a[72:75],v[240:243]
 RT a[112:113],v30 offset:16384
 s_add_u32 m0,s22,4096
 MM v[244:247],a[8:11],a[76:79],v[244:247]
 BL v12,s[8:11],s20 offen  lds
 MM v[248:251],a[8:11],a[80:83],v[248:251]
 RT a[114:115],v30 offset:18432
 MM v[252:255],a[8:11],a[84:87],v[252:255]
 MM v[128:131],a[8:11],a[88:91],v[128:131]
 RT a[116:117],v31 offset:16384
 MM v[136:139],a[8:11],a[92:95],v[136:139]
 MM v[104:107],a[12:15],a[64:67],v[104:107]
 RT a[118:119],v31 offset:18432
 MM v[108:111],a[12:15],a[68:71],v[108:111]
 BL v13,s[8:11],s20 offen offset:1024  lds
 MM v[112:115],a[12:15],a[72:75],v[112:115]
 RT a[120:121],v32 offset:16384
 MM v[116:119],a[12:15],a[76:79],v[116:119]
 MM v[120:123],a[12:15],a[80:83],v[120:123]
 RT a[122:123],v32 offset:18432
 MM v[124:127],a[12:15],a[84:87],v[124:127]
 MM v[132:135],a[12:15],a[88:91],v[132:135]
 RT a[124:125],v33 offset:16384
 MM v[140:143],a[12:15],a[92:95],v[140:143]
 MM v[144:147],a[16:19],a[64:67],v[144:147]
 RT a[126:127],v33 offset:18432
 MM v[152:155],a[16:19],a[68:71],v[152:155]
 BL v14,s[8:11],s20 offen offset:2048  lds
 MM v[160:163],a[16:19],a[72:75],v[160:163]
 RQ a[36:39],v25 offset:2048
 MM v[168:171],a[16:19],a[76:79],v[168:171]
 MM v[176:179],a[16:19],a[80:83],v[176:179]
 RQ a[40:43],v25 offset:4096
 MM v[184:187],a[16:19],a[84:87],v[184:187]
 MM v[192:195],a[16:19],a[88:91],v[192:195]
 RQ a[44:47],v25 offset:6144
 MM a[184:187],a[16:19],a[92:95],a[184:187]
 BL v15,s[8:11],s20 offen offset:3072  lds
 MM v[148:151],a[20:23],a[64:67],v[148:151]
 RQ a[48:51],v25 offset:8192
 s_add_u32 s20,s20,128
 MM v[156:159],a[20:23],a[68:71],v[156:159]
 s_add_u32 s22,s22,32768
 s_add_u32 s28,s28,1
 MM v[164:167],a[20:23],a[72:75],v[164:167]
 RQ a[52:55],v25 offset:10240
 s_sub_u32 s34,s22,98304
 s_min_u32 s22,s22,s34
 MM v[172:175],a[20:23],a[76:79],v[172:175]
 MM v[180:183],a[20:23],a[80:83],v[180:183]
 RQ a[56:59],v25 offset:12288
 MM v[188:191],a[20:23],a[84:87],v[188:191]
 MM v[196:199],a[20:23],a[88:91],v[196:199]
 RQ a[60:63],v25 offset:14336
 MM a[188:191],a[20:23],a[92:95],a[188:191]
 v_add_u32 v24,s31,v24
 MM a[192:195],a[24:27],a[64:67],a[192:195]
 v_add_u32 v25,s31,v25
 MM a[200:203],a[24:27],a[68:71],a[200:203]
 MM a[208:211],a[24:27],a[72:75],a[208:211]
 v_add_u32 v26,s32,v26
 MM a[216:219],a[24:27],a[76:79],a[216:219]
 MM a[224:227],a[24:27],a[80:83],a[224:227]
 v_add_u32 v27,s32,v27
 MM a[232:235],a[24:27],a[84:87],a[232:235]
 v_add_u32 v28,s32,v28
 MM a[240:243],a[24:27],a[88:91],a[240:243]
 MM a[248:251],a[24:27],a[92:95],a[248:251]
 v_add_u32 v29,s32,v29
 MM a[196:199],a[28:31],a[64:67],a[196:199]
 MM a[204:207],a[28:31],a[68:71],a[204:207]
 v_add_u32 v30,s32,v30
 MM a[212:215],a[28:31],a[72:75],a[212:215]
 v_add_u32 v31,s32,v31
 MM a[220:223],a[28:31],a[76:79],a[220:223]
 MM a[228:231],a[28:31],a[80:83],a[228:231]
 v_add_u32 v32,s32,v32
 MM a[236:239],a[28:31],a[84:87],a[236:239]
 MM a[244:247],a[28:31],a[88:91],a[244:247]
 v_add_u32 v33,s32,v33
 MM a[252:255],a[28:31],a[92:95],a[252:255]
 s_waitcnt vmcnt(10)
 s_waitcnt lgkmcnt(0)
 s_barrier
 MM v[200:203],a[32:35],a[96:99],v[200:203]
 RQ a[0:3],v24
 s_add_u32 m0,s23,98304
 MM v[204:207],a[32:35],a[100:103],v[204:207]
 BL v16,s[12:15],s21 offen  lds
 MM v[208:211],a[32:35],a[104:107],v[208:211]
 RT a[64:65],v26
 MM v[212:215],a[32:35],a[108:111],v[212:215]
 MM v[216:219],a[32:35],a[112:115],v[216:219]
 RT a[66:67],v26 offset:2048
 MM v[220:223],a[32:35],a[116:119],v[220:223]
 MM v[224:227],a[32:35],a[120:123],v[224:227]
 RT a[68:69],v27
 MM v[228:231],a[32:35],a[124:127],v[228:231]
 BL v17,s[12:15],s21 offen offset:1024  lds
 MM v[72:75],a[36:39],a[96:99],v[72:75]
 RT a[70:71],v27 offset:2048
 MM v[76:79],a[36:39],a[100:103],v[76:79]
 MM v[80:83],a[36:39],a[104:107],v[80:83]
 RT a[72:73],v28
 MM v[84:87],a[36:39],a[108:111],v[84:87]
 MM v[88:91],a[36:39],a[112:115],v[88:91]
 RT a[74:75],v28 offset:2048
 MM v[92:95],a[36:39],a[116:119],v[92:95]
 MM v[96:99],a[36:39],a[120:123],v[96:99]
 RT a[76:77],v29
 MM v[100:103],a[36:39],a[124:127],v[100:103]
 BL v18,s[12:15],s21 offen offset:2048  lds
 MM v[232:235],a[40:43],a[96:99],v[232:235]
 RT a[78:79],v29 offset:2048
 MM v[236:239],a[40:43],a[100:103],v[236:239]
 MM v[240:243],a[40:43],a[104:107],v[240:243]
 RT a[80:81],v30
 MM v[244:247],a[40:43],a[108:111],v[244:247]
 MM v[248:251],a[40:43],a[112:115],v[248:251]
 RT a[82:83],v30 offset:2048
 MM v[252:255],a[40:43],a[116:119],v[252:255]
 BL v19,s[12:15],s21 offen offset:3072  lds
 MM v[128:131],a[40:43],a[120:123],v[128:131]
 RT a[84:85],v31
 MM v[136:139],a[40:43],a[124:127],v[136:139]
 MM v[104:107],a[44:47],a[96:99],v[104:107]
 RT a[86:87],v31 offset:2048
 MM v[108:111],a[44:47],a[100:103],v[108:111]
 MM v[112:115],a[44:47],a[104:107],v[112:115]
 RT a[88:89],v32
 MM v[116:119],a[44:47],a[108:111],v[116:119]
 MM v[120:123],a[44:47],a[112:115],v[120:123]
 RT a[90:91],v32 offset:2048
 s_add_u32 m0,s23,102400
 MM v[124:127],a[44:47],a[116:119],v[124:127]
 BL v20,s[12:15],s21 offen  lds
 MM v[132:135],a[44:47],a[120:123],v[132:135]
 RT a[92:93],v33
 MM v[140:143],a[44:47],a[124:127],v[140:143]
 MM v[144:147],a[48:51],a[96:99],v[144:147]
 RT a[94:95],v33 offset:2048
 MM v[152:155],a[48:51],a[100:103],v[152:155]
 MM v[160:163],a[48:51],a[104:107],v[160:163]
 RQ a[4:7],v24 offset:2048
 MM v[168:171],a[48:51],a[108:111],v[168:171]
 BL v21,s[12:15],s21 offen offset:1024  lds
 MM v[176:179],a[48:51],a[112:115],v[176:179]
 RQ a[8:11],v24 offset:4096
 MM v[184:187],a[48:51],a[116:119],v[184:187]
 MM v[192:195],a[48:51],a[120:123],v[192:195]
 RQ a[12:15],v24 offset:6144
 MM a[184:187],a[48:51],a[124:127],a[184:187]
 MM v[148:151],a[52:55],a[96:99],v[148:151]
 RQ a[16:19],v24 offset:8192
 MM v[156:159],a[52:55],a[100:103],v[156:159]
 MM v[164:167],a[52:55],a[104:107],v[164:167]
 RQ a[20:23],v24 offset:10240
 MM v[172:175],a[52:55],a[108:111],v[172:175]
 BL v22,s[12:15],s21 offen offset:2048  lds
 MM v[180:183],a[52:55],a[112:115],v[180:183]
 RQ a[24:27],v24 offset:12288
 MM v[188:191],a[52:55],a[116:119],v[188:191]
 MM v[196:199],a[52:55],a[120:123],v[196:199]
 RQ a[28:31],v24 offset:14336
 MM a[188:191],a[52:55],a[124:127],a[188:191]
 MM a[192:195],a[56:59],a[96:99],a[192:195]
 BL v23,s[12:15],s21 offen offset:3072  lds
 MM a[200:203],a[56:59],a[100:103],a[200:203]
 s_add_u32 s21,s21,524288
 MM a[208:211],a[56:59],a[104:107],a[208:211]
 s_add_u32 s23,s23,32768
 s_sub_u32 s34,s23,65536
 s_min_u32 s23,s23,s34
 MM a[216:219],a[56:59],a[108:111],a[216:219]
 MM a[224:227],a[56:59],a[112:115],a[224:227]
 BL v[68:71],v6,s[4:7],s87 offen
 MM a[232:235],a[56:59],a[116:119],a[232:235]
 s_add_u32 s87,s87,1048576
 MM a[240:243],a[56:59],a[120:123],a[240:243]
 s_add_u32 s85,s21,1048576
 MM a[248:251],a[56:59],a[124:127],a[248:251]
 BL v[68:71],v36,s[12:15],s85 offen
 MM a[196:199],a[60:63],a[96:99],a[196:199]
 MM a[204:207],a[60:63],a[100:103],a[204:207]
 MM a[212:215],a[60:63],a[104:107],a[212:215]
 s_add_u32 m0,s22,0
 MM a[220:223],a[60:63],a[108:111],a[220:223]
 BL v8,s[8:11],s20 offen  lds
 MM a[228:231],a[60:63],a[112:115],a[228:231]
 MM a[236:239],a[60:63],a[116:119],a[236:239]
 MM a[244:247],a[60:63],a[120:123],a[244:247]
 BL v9,s[8:11],s20 offen offset:1024  lds
 MM a[252:255],a[60:63],a[124:127],a[252:255]
 s_bitcmp0_b32 s84,s28
 s_cbranch_scc1 kv1
 s_branch kv1_hk
kv1_x:
 s_sub_u32 s26,s73,14
 s_cmp_lt_u32 s26,14
 s_cbranch_scc1 kv1_g
 s_waitcnt lgkmcnt(0)
 MM v[200:203],a[0:3],a[64:67],v[200:203]
 RQ a[32:35],v25
 s_mov_b32 s88,s40
 MM v[204:207],a[0:3],a[68:71],v[204:207]
 s_add_u32 s31,s24,32768
 s_sub_u32 s33,s31,98304
 MM v[208:211],a[0:3],a[72:75],v[208:211]
 RT a[96:97],v26 offset:16384
 s_mov_b32 s89,s41
 MM v[212:215],a[0:3],a[76:79],v[212:215]
 s_min_u32 s33,s31,s33
 s_sub_u32 s31,s33,s24
 MM v[216:219],a[0:3],a[80:83],v[216:219]
 RT a[98:99],v26 offset:18432
 s_mov_b32 s90,1835008
 MM v[220:223],a[0:3],a[84:87],v[220:223]
 BL v10,s[8:11],s20 offen offset:2048  lds
 s_mov_b32 s24,s33
 MM v[224:227],a[0:3],a[88:91],v[224:227]
 RT a[100:101],v27 offset:16384
 s_mov_b32 s91,0x20000
 MM v[228:231],a[0:3],a[92:95],v[228:231]
 s_add_u32 s32,s25,32768
 s_sub_u32 s33,s32,65536
 MM v[72:75],a[4:7],a[64:67],v[72:75]
 RT a[102:103],v27 offset:18432
 s_mul_i32 s36,s97,114688
 MM v[76:79],a[4:7],a[68:71],v[76:79]
 s_min_u32 s33,s32,s33
 s_sub_u32 s32,s33,s25
 v_lshrrev_b32 v1,3,v0
 MM v[80:83],a[4:7],a[72:75],v[80:83]
 RT a[104:105],v28 offset:16384
 s_mul_i32 s26,s35,28672
 MM v[84:87],a[4:7],a[76:79],v[84:87]
 BL v11,s[8:11],s20 offen offset:3072  lds
 s_mov_b32 s25,s33
 MM v[88:91],a[4:7],a[80:83],v[88:91]
 RT a[106:107],v28 offset:18432
 v_mul_u32_u24 v1,896,v1
 MM v[92:95],a[4:7],a[84:87],v[92:95]
 v_lshrrev_b32 v2,4,v0
 v_xor_b32 v2,v2,v0
 MM v[96:99],a[4:7],a[88:91],v[96:99]
 RT a[108:109],v29 offset:16384
 v_and_b32 v2,7,v2
 MM v[100:103],a[4:7],a[92:95],v[100:103]
 v_lshl_add_u32 v1,v2,4,v1
 v_add_u32 v38,s26,v1
 MM v[232:235],a[8:11],a[64:67],v[232:235]
 RT a[110:111],v29 offset:18432
 MM v[236:239],a[8:11],a[68:71],v[236:239]
 v_xor_b32 v2,64,v38
 MM v[240:243],a[8:11],a[72:75],v[240:243]
 RT a[112:113],v30 offset:16384
 s_add_u32 m0,s22,4096
 MM v[244:247],a[8:11],a[76:79],v[244:247]
 BL v12,s[8:11],s20 offen  lds
 MM v[248:251],a[8:11],a[80:83],v[248:251]
 RT a[114:115],v30 offset:18432
 v_add_u32 v39,6144,v2
 MM v[252:255],a[8:11],a[84:87],v[252:255]
 v_add_u32 v40,12288,v38
 v_add_u32 v41,12288,v39
 MM v[128:131],a[8:11],a[88:91],v[128:131]
 RT a[116:117],v31 offset:16384
 s_mul_i32 s38,s35,4096
 MM v[136:139],a[8:11],a[92:95],v[136:139]
 s_mov_b32 s92,s44
 MM v[104:107],a[12:15],a[64:67],v[104:107]
 RT a[118:119],v31 offset:18432
 MM v[108:111],a[12:15],a[68:71],v[108:111]
 BL v13,s[8:11],s20 offen offset:1024  lds
 MM v[112:115],a[12:15],a[72:75],v[112:115]
 RT a[120:121],v32 offset:16384
 s_mov_b32 s93,s45
 MM v[116:119],a[12:15],a[76:79],v[116:119]
 s_mov_b32 s94,3670016
 s_mov_b32 s95,0x20000
 MM v[120:123],a[12:15],a[80:83],v[120:123]
 RT a[122:123],v32 offset:18432
 MM v[124:127],a[12:15],a[84:87],v[124:127]
 s_lshl_b32 s37,s74,9
 MM v[132:135],a[12:15],a[88:91],v[132:135]
 RT a[124:125],v33 offset:16384
 v_lshrrev_b32 v1,5,v0
 MM v[140:143],a[12:15],a[92:95],v[140:143]
 v_and_b32 v2,31,v0
 MM v[144:147],a[16:19],a[64:67],v[144:147]
 RT a[126:127],v33 offset:18432
 v_bfe_u32 v3,v1,0,1
 MM v[152:155],a[16:19],a[68:71],v[152:155]
 BL v14,s[8:11],s20 offen offset:2048  lds
 MM v[160:163],a[16:19],a[72:75],v[160:163]
 RQ a[36:39],v25 offset:2048
 v_lshlrev_b32 v3,1,v3
 MM v[168:171],a[16:19],a[76:79],v[168:171]
 v_xor_b32 v2,v2,v3
 MM v[176:179],a[16:19],a[80:83],v[176:179]
 RQ a[40:43],v25 offset:4096
 v_lshlrev_b32 v2,4,v2
 MM v[184:187],a[16:19],a[84:87],v[184:187]
 MM v[192:195],a[16:19],a[88:91],v[192:195]
 RQ a[44:47],v25 offset:6144
 s_mul_i32 s26,s35,131072
 MM a[184:187],a[16:19],a[92:95],a[184:187]
 BL v15,s[8:11],s20 offen offset:3072  lds
 MM v[148:151],a[20:23],a[64:67],v[148:151]
 RQ a[48:51],v25 offset:8192
 s_add_u32 s20,s20,128
 MM v[156:159],a[20:23],a[68:71],v[156:159]
 s_add_u32 s22,s22,32768
 v_mul_u32_u24 v1,8192,v1
 MM v[164:167],a[20:23],a[72:75],v[164:167]
 RQ a[52:55],v25 offset:10240
 s_sub_u32 s34,s22,98304
 s_min_u32 s22,s22,s34
 MM v[172:175],a[20:23],a[76:79],v[172:175]
 v_add_u32 v1,s26,v1
 v_add_u32 v42,v2,v1
 MM v[180:183],a[20:23],a[80:83],v[180:183]
 RQ a[56:59],v25 offset:12288
 v_xor_b32 v3,64,v2
 MM v[188:191],a[20:23],a[84:87],v[188:191]
 v_add_u32 v43,v3,v1
 MM v[196:199],a[20:23],a[88:91],v[196:199]
 RQ a[60:63],v25 offset:14336
 v_add_u32 v43,15360,v43
 MM a[188:191],a[20:23],a[92:95],a[188:191]
 v_add_u32 v24,s31,v24
 v_add_u32 v44,30720,v42
 MM a[192:195],a[24:27],a[64:67],a[192:195]
 v_add_u32 v25,s31,v25
 v_add_u32 v45,30720,v43
 MM a[200:203],a[24:27],a[68:71],a[200:203]
 MM a[208:211],a[24:27],a[72:75],a[208:211]
 v_add_u32 v26,s32,v26
 v_xor_b32 v3,128,v2
 MM a[216:219],a[24:27],a[76:79],a[216:219]
 v_add_u32 v46,v3,v1
 MM a[224:227],a[24:27],a[80:83],a[224:227]
 v_add_u32 v27,s32,v27
 v_add_u32 v46,65536,v46
 MM a[232:235],a[24:27],a[84:87],a[232:235]
 v_add_u32 v28,s32,v28
 MM a[240:243],a[24:27],a[88:91],a[240:243]
 v_xor_b32 v3,192,v2
 MM a[248:251],a[24:27],a[92:95],a[248:251]
 v_add_u32 v29,s32,v29
 v_add_u32 v47,v3,v1
 MM a[196:199],a[28:31],a[64:67],a[196:199]
 v_add_u32 v47,80896,v47
 MM a[204:207],a[28:31],a[68:71],a[204:207]
 v_add_u32 v30,s32,v30
 MM a[212:215],a[28:31],a[72:75],a[212:215]
 v_add_u32 v31,s32,v31
 v_add_u32 v48,30720,v46
 MM a[220:223],a[28:31],a[76:79],a[220:223]
 v_add_u32 v49,30720,v47
 MM a[228:231],a[28:31],a[80:83],a[228:231]
 v_add_u32 v32,s32,v32
 s_mul_i32 s39,s35,8192
 MM a[236:239],a[28:31],a[84:87],a[236:239]
 MM a[244:247],a[28:31],a[88:91],a[244:247]
 v_add_u32 v33,s32,v33
 MM a[252:255],a[28:31],a[92:95],a[252:255]
 s_waitcnt vmcnt(10)
 s_waitcnt lgkmcnt(0)
 s_barrier
 MM v[200:203],a[32:35],a[96:99],v[200:203]
 RQ a[0:3],v24
 s_add_u32 m0,s23,98304
 MM v[204:207],a[32:35],a[100:103],v[204:207]
 BL v16,s[12:15],s21 offen  lds
 MM v[208:211],a[32:35],a[104:107],v[208:211]
 RT a[64:65],v26
 MM v[212:215],a[32:35],a[108:111],v[212:215]
 MM v[216:219],a[32:35],a[112:115],v[216:219]
 RT a[66:67],v26 offset:2048
 MM v[220:223],a[32:35],a[116:119],v[220:223]
 MM v[224:227],a[32:35],a[120:123],v[224:227]
 RT a[68:69],v27
 MM v[228:231],a[32:35],a[124:127],v[228:231]
 BL v17,s[12:15],s21 offen offset:1024  lds
 MM v[72:75],a[36:39],a[96:99],v[72:75]
 RT a[70:71],v27 offset:2048
 MM v[76:79],a[36:39],a[100:103],v[76:79]
 MM v[80:83],a[36:39],a[104:107],v[80:83]
 RT a[72:73],v28
 MM v[84:87],a[36:39],a[108:111],v[84:87]
 MM v[88:91],a[36:39],a[112:115],v[88:91]
 RT a[74:75],v28 offset:2048
 MM v[92:95],a[36:39],a[116:119],v[92:95]
 MM v[96:99],a[36:39],a[120:123],v[96:99]
 RT a[76:77],v29
 MM v[100:103],a[36:39],a[124:127],v[100:103]
 BL v18,s[12:15],s21 offen offset:2048  lds
 MM v[232:235],a[40:43],a[96:99],v[232:235]
 RT a[78:79],v29 offset:2048
 MM v[236:239],a[40:43],a[100:103],v[236:239]
 MM v[240:243],a[40:43],a[104:107],v[240:243]
 RT a[80:81],v30
 MM v[244:247],a[40:43],a[108:111],v[244:247]
 MM v[248:251],a[40:43],a[112:115],v[248:251]
 RT a[82:83],v30 offset:2048
 MM v[252:255],a[40:43],a[116:119],v[252:255]
 MM v[128:131],a[40:43],a[120:123],v[128:131]
 RT a[84:85],v31
 MM v[136:139],a[40:43],a[124:127],v[136:139]
 BL v19,s[12:15],s21 offen offset:3072  lds
 MM v[104:107],a[44:47],a[96:99],v[104:107]
 RT a[86:87],v31 offset:2048
 MM v[108:111],a[44:47],a[100:103],v[108:111]
 MM v[112:115],a[44:47],a[104:107],v[112:115]
 RT a[88:89],v32
 MM v[116:119],a[44:47],a[108:111],v[116:119]
 MM v[120:123],a[44:47],a[112:115],v[120:123]
 RT a[90:91],v32 offset:2048
 MM v[124:127],a[44:47],a[116:119],v[124:127]
 MM v[132:135],a[44:47],a[120:123],v[132:135]
 RT a[92:93],v33
 s_add_u32 m0,s23,102400
 MM v[140:143],a[44:47],a[124:127],v[140:143]
 BL v20,s[12:15],s21 offen  lds
 MM v[144:147],a[48:51],a[96:99],v[144:147]
 RT a[94:95],v33 offset:2048
 MM v[152:155],a[48:51],a[100:103],v[152:155]
 MM v[160:163],a[48:51],a[104:107],v[160:163]
 RQ a[4:7],v24 offset:2048
 MM v[168:171],a[48:51],a[108:111],v[168:171]
 MM v[176:179],a[48:51],a[112:115],v[176:179]
 RQ a[8:11],v24 offset:4096
 MM v[184:187],a[48:51],a[116:119],v[184:187]
 MM v[192:195],a[48:51],a[120:123],v[192:195]
 RQ a[12:15],v24 offset:6144
 MM a[184:187],a[48:51],a[124:127],a[184:187]
 BL v21,s[12:15],s21 offen offset:1024  lds
 MM v[148:151],a[52:55],a[96:99],v[148:151]
 RQ a[16:19],v24 offset:8192
 MM v[156:159],a[52:55],a[100:103],v[156:159]
 MM v[164:167],a[52:55],a[104:107],v[164:167]
 RQ a[20:23],v24 offset:10240
 MM v[172:175],a[52:55],a[108:111],v[172:175]
 MM v[180:183],a[52:55],a[112:115],v[180:183]
 RQ a[24:27],v24 offset:12288
 MM v[188:191],a[52:55],a[116:119],v[188:191]
 MM v[196:199],a[52:55],a[120:123],v[196:199]
 RQ a[28:31],v24 offset:14336
 MM a[188:191],a[52:55],a[124:127],a[188:191]
 BL v22,s[12:15],s21 offen offset:2048  lds
 MM a[192:195],a[56:59],a[96:99],a[192:195]
 MM a[200:203],a[56:59],a[100:103],a[200:203]
 MM a[208:211],a[56:59],a[104:107],a[208:211]
 MM a[216:219],a[56:59],a[108:111],a[216:219]
 BL v23,s[12:15],s21 offen offset:3072  lds
 MM a[224:227],a[56:59],a[112:115],a[224:227]
 s_add_u32 s21,s21,524288
 MM a[232:235],a[56:59],a[116:119],a[232:235]
 s_add_u32 s23,s23,32768
 s_sub_u32 s34,s23,65536
 s_min_u32 s23,s23,s34
 MM a[240:243],a[56:59],a[120:123],a[240:243]
 s_add_u32 m0,s38,32768
 MM a[248:251],a[56:59],a[124:127],a[248:251]
 BL v38,s[88:91],s36 offen  lds
 MM a[196:199],a[60:63],a[96:99],a[196:199]
 MM a[204:207],a[60:63],a[100:103],a[204:207]
 MM a[212:215],a[60:63],a[104:107],a[212:215]
 MM a[220:223],a[60:63],a[108:111],a[220:223]
 BL v39,s[88:91],s36 offen offset:1024  lds
 MM a[228:231],a[60:63],a[112:115],a[228:231]
 MM a[236:239],a[60:63],a[116:119],a[236:239]
 MM a[244:247],a[60:63],a[120:123],a[244:247]
 MM a[252:255],a[60:63],a[124:127],a[252:255]
 BL v40,s[88:91],s36 offen offset:2048  lds
 s_waitcnt lgkmcnt(0)
 MM v[200:203],a[0:3],a[64:67],v[200:203]
 RQ a[32:35],v25
 s_mov_b32 s26,s35
 MM v[204:207],a[0:3],a[68:71],v[204:207]
 s_add_u32 s31,s24,32768
 s_sub_u32 s33,s31,98304
 MM v[208:211],a[0:3],a[72:75],v[208:211]
 RT a[96:97],v26 offset:16384
 v_and_b32 v1,15,v0
 MM v[212:215],a[0:3],a[76:79],v[212:215]
 s_min_u32 s33,s31,s33
 s_sub_u32 s31,s33,s24
 MM v[216:219],a[0:3],a[80:83],v[216:219]
 RT a[98:99],v26 offset:18432
 MM v[220:223],a[0:3],a[84:87],v[220:223]
 s_mov_b32 s24,s33
 s_mul_i32 s26,s26,4096
 MM v[224:227],a[0:3],a[88:91],v[224:227]
 RT a[100:101],v27 offset:16384
 MM v[228:231],a[0:3],a[92:95],v[228:231]
 BL v41,s[88:91],s36 offen offset:3072  lds
 s_add_u32 s32,s25,32768
 s_sub_u32 s33,s32,65536
 MM v[72:75],a[4:7],a[64:67],v[72:75]
 RT a[102:103],v27 offset:18432
 s_add_u32 s36,s36,128
 MM v[76:79],a[4:7],a[68:71],v[76:79]
 s_min_u32 s33,s32,s33
 s_sub_u32 s32,s33,s25
 MM v[80:83],a[4:7],a[72:75],v[80:83]
 RT a[104:105],v28 offset:16384
 v_lshl_add_u32 v1,v1,7,s26
 MM v[84:87],a[4:7],a[76:79],v[84:87]
 s_mov_b32 s25,s33
 v_lshrrev_b32 v2,4,v0
 MM v[88:91],a[4:7],a[80:83],v[88:91]
 RT a[106:107],v28 offset:18432
 MM v[92:95],a[4:7],a[84:87],v[92:95]
 v_bfe_u32 v3,v0,1,3
 MM v[96:99],a[4:7],a[88:91],v[96:99]
 RT a[108:109],v29 offset:16384
 s_add_u32 m0,s38,49152
 MM v[100:103],a[4:7],a[92:95],v[100:103]
 BL v38,s[88:91],s36 offen  lds
 MM v[232:235],a[8:11],a[64:67],v[232:235]
 RT a[110:111],v29 offset:18432
 v_xor_b32 v2,v2,v3
 MM v[236:239],a[8:11],a[68:71],v[236:239]
 MM v[240:243],a[8:11],a[72:75],v[240:243]
 RT a[112:113],v30 offset:16384
 v_lshl_add_u32 v50,v2,4,v1
 MM v[244:247],a[8:11],a[76:79],v[244:247]
 MM v[248:251],a[8:11],a[80:83],v[248:251]
 RT a[114:115],v30 offset:18432
 MM v[252:255],a[8:11],a[84:87],v[252:255]
 v_xor_b32 v51,64,v50
 MM v[128:131],a[8:11],a[88:91],v[128:131]
 RT a[116:117],v31 offset:16384
 MM v[136:139],a[8:11],a[92:95],v[136:139]
 BL v39,s[88:91],s36 offen offset:1024  lds
 MM v[104:107],a[12:15],a[64:67],v[104:107]
 RT a[118:119],v31 offset:18432
 v_bfe_u32 v1,v0,2,2
 MM v[108:111],a[12:15],a[68:71],v[108:111]
 MM v[112:115],a[12:15],a[72:75],v[112:115]
 RT a[120:121],v32 offset:16384
 v_lshrrev_b32 v2,4,v0
 MM v[116:119],a[12:15],a[76:79],v[116:119]
 MM v[120:123],a[12:15],a[80:83],v[120:123]
 RT a[122:123],v32 offset:18432
 MM v[124:127],a[12:15],a[84:87],v[124:127]
 v_lshl_add_u32 v2,v2,3,v1
 MM v[132:135],a[12:15],a[88:91],v[132:135]
 RT a[124:125],v33 offset:16384
 MM v[140:143],a[12:15],a[92:95],v[140:143]
 BL v40,s[88:91],s36 offen offset:2048  lds
 MM v[144:147],a[16:19],a[64:67],v[144:147]
 RT a[126:127],v33 offset:18432
 v_bfe_u32 v4,v2,0,1
 MM v[152:155],a[16:19],a[68:71],v[152:155]
 MM v[160:163],a[16:19],a[72:75],v[160:163]
 RQ a[36:39],v25 offset:2048
 v_bfe_u32 v5,v2,1,1
 MM v[168:171],a[16:19],a[76:79],v[168:171]
 MM v[176:179],a[16:19],a[80:83],v[176:179]
 RQ a[40:43],v25 offset:4096
 MM v[184:187],a[16:19],a[84:87],v[184:187]
 v_lshl_or_b32 v4,v5,1,v4
 MM v[192:195],a[16:19],a[88:91],v[192:195]
 RQ a[44:47],v25 offset:6144
 MM a[184:187],a[16:19],a[92:95],a[184:187]
 BL v41,s[88:91],s36 offen offset:3072  lds
 MM v[148:151],a[20:23],a[64:67],v[148:151]
 RQ a[48:51],v25 offset:8192
 s_add_u32 s36,s36,128
 MM v[156:159],a[20:23],a[68:71],v[156:159]
 v_bfe_u32 v5,v2,3,1
 MM v[164:167],a[20:23],a[72:75],v[164:167]
 RQ a[52:55],v25 offset:10240
 v_lshl_or_b32 v4,v5,2,v4
 MM v[172:175],a[20:23],a[76:79],v[172:175]
 MM v[180:183],a[20:23],a[80:83],v[180:183]
 RQ a[56:59],v25 offset:12288
 MM v[188:191],a[20:23],a[84:87],v[188:191]
 v_mul_u32_u24 v2,512,v2
 MM v[196:199],a[20:23],a[88:91],v[196:199]
 RQ a[60:63],v25 offset:14336
 MM a[188:191],a[20:23],a[92:95],a[188:191]
 v_add_u32 v24,s31,v24
 MM a[192:195],a[24:27],a[64:67],a[192:195]
 v_add_u32 v25,s31,v25
 v_and_b32 v3,3,v0
 MM a[200:203],a[24:27],a[68:71],a[200:203]
 MM a[208:211],a[24:27],a[72:75],a[208:211]
 v_add_u32 v26,s32,v26
 v_lshl_add_u32 v2,v3,3,v2
 MM a[216:219],a[24:27],a[76:79],a[216:219]
 MM a[224:227],a[24:27],a[80:83],a[224:227]
 v_add_u32 v27,s32,v27
 MM a[232:235],a[24:27],a[84:87],a[232:235]
 v_add_u32 v28,s32,v28
 v_add_u32 v2,65536,v2
 MM a[240:243],a[24:27],a[88:91],a[240:243]
 MM a[248:251],a[24:27],a[92:95],a[248:251]
 v_add_u32 v29,s32,v29
 MM a[196:199],a[28:31],a[64:67],a[196:199]
 s_mov_b32 s26,0
 MM a[204:207],a[28:31],a[68:71],a[204:207]
 v_add_u32 v30,s32,v30
 MM a[212:215],a[28:31],a[72:75],a[212:215]
 v_add_u32 v31,s32,v31
 s_mul_i32 s26,s26,16
 MM a[220:223],a[28:31],a[76:79],a[220:223]
 MM a[228:231],a[28:31],a[80:83],a[228:231]
 v_add_u32 v32,s32,v32
 MM a[236:239],a[28:31],a[84:87],a[236:239]
 v_xor_b32 v4,s26,v4
 MM a[244:247],a[28:31],a[88:91],a[244:247]
 v_add_u32 v33,s32,v33
 MM a[252:255],a[28:31],a[92:95],a[252:255]
 s_waitcnt vmcnt(8)
 s_waitcnt lgkmcnt(0)
 s_barrier
 MM v[200:203],a[32:35],a[96:99],v[200:203]
 RQ a[0:3],v24
 s_add_u32 m0,s39,65536
 MM v[204:207],a[32:35],a[100:103],v[204:207]
 BL v42,s[92:95],s37 offen  lds
 MM v[208:211],a[32:35],a[104:107],v[208:211]
 RT a[64:65],v26
 v_xor_b32 v3,0,v4
 MM v[212:215],a[32:35],a[108:111],v[212:215]
 v_lshl_add_u32 v52,v3,5,v2
 MM v[216:219],a[32:35],a[112:115],v[216:219]
 RT a[66:67],v26 offset:2048
 MM v[220:223],a[32:35],a[116:119],v[220:223]
 v_xor_b32 v3,1,v4
 MM v[224:227],a[32:35],a[120:123],v[224:227]
 RT a[68:69],v27
 MM v[228:231],a[32:35],a[124:127],v[228:231]
 BL v43,s[92:95],s37 offen offset:1024  lds
 MM v[72:75],a[36:39],a[96:99],v[72:75]
 RT a[70:71],v27 offset:2048
 v_lshl_add_u32 v53,v3,5,v2
 MM v[76:79],a[36:39],a[100:103],v[76:79]
 MM v[80:83],a[36:39],a[104:107],v[80:83]
 RT a[72:73],v28
 v_xor_b32 v3,2,v4
 MM v[84:87],a[36:39],a[108:111],v[84:87]
 MM v[88:91],a[36:39],a[112:115],v[88:91]
 RT a[74:75],v28 offset:2048
 MM v[92:95],a[36:39],a[116:119],v[92:95]
 v_lshl_add_u32 v54,v3,5,v2
 MM v[96:99],a[36:39],a[120:123],v[96:99]
 RT a[76:77],v29
 MM v[100:103],a[36:39],a[124:127],v[100:103]
 BL v44,s[92:95],s37 offen offset:2048  lds
 MM v[232:235],a[40:43],a[96:99],v[232:235]
 RT a[78:79],v29 offset:2048
 v_xor_b32 v3,3,v4
 MM v[236:239],a[40:43],a[100:103],v[236:239]
 MM v[240:243],a[40:43],a[104:107],v[240:243]
 RT a[80:81],v30
 v_lshl_add_u32 v55,v3,5,v2
 MM v[244:247],a[40:43],a[108:111],v[244:247]
 MM v[248:251],a[40:43],a[112:115],v[248:251]
 RT a[82:83],v30 offset:2048
 MM v[252:255],a[40:43],a[116:119],v[252:255]
 v_xor_b32 v3,4,v4
 MM v[128:131],a[40:43],a[120:123],v[128:131]
 RT a[84:85],v31
 MM v[136:139],a[40:43],a[124:127],v[136:139]
 BL v45,s[92:95],s37 offen offset:3072  lds
 MM v[104:107],a[44:47],a[96:99],v[104:107]
 RT a[86:87],v31 offset:2048
 v_lshl_add_u32 v56,v3,5,v2
 MM v[108:111],a[44:47],a[100:103],v[108:111]
 MM v[112:115],a[44:47],a[104:107],v[112:115]
 RT a[88:89],v32
 v_xor_b32 v3,5,v4
 MM v[116:119],a[44:47],a[108:111],v[116:119]
 MM v[120:123],a[44:47],a[112:115],v[120:123]
 RT a[90:91],v32 offset:2048
 MM v[124:127],a[44:47],a[116:119],v[124:127]
 v_lshl_add_u32 v57,v3,5,v2
 MM v[132:135],a[44:47],a[120:123],v[132:135]
 RT a[92:93],v33
 s_add_u32 m0,s39,69632
 MM v[140:143],a[44:47],a[124:127],v[140:143]
 BL v46,s[92:95],s37 offen  lds
 MM v[144:147],a[48:51],a[96:99],v[144:147]
 RT a[94:95],v33 offset:2048
 v_xor_b32 v3,6,v4
 MM v[152:155],a[48:51],a[100:103],v[152:155]
 MM v[160:163],a[48:51],a[104:107],v[160:163]
 RQ a[4:7],v24 offset:2048
 v_lshl_add_u32 v58,v3,5,v2
 MM v[168:171],a[48:51],a[108:111],v[168:171]
 MM v[176:179],a[48:51],a[112:115],v[176:179]
 RQ a[8:11],v24 offset:4096
 MM v[184:187],a[48:51],a[116:119],v[184:187]
 v_xor_b32 v3,7,v4
 MM v[192:195],a[48:51],a[120:123],v[192:195]
 RQ a[12:15],v24 offset:6144
 MM a[184:187],a[48:51],a[124:127],a[184:187]
 BL v47,s[92:95],s37 offen offset:1024  lds
 MM v[148:151],a[52:55],a[96:99],v[148:151]
 RQ a[16:19],v24 offset:8192
 v_lshl_add_u32 v59,v3,5,v2
 MM v[156:159],a[52:55],a[100:103],v[156:159]
 MM v[164:167],a[52:55],a[104:107],v[164:167]
 RQ a[20:23],v24 offset:10240
 v_add_u32 v60,65536,v52
 MM v[172:175],a[52:55],a[108:111],v[172:175]
 MM v[180:183],a[52:55],a[112:115],v[180:183]
 RQ a[24:27],v24 offset:12288
 MM v[188:191],a[52:55],a[116:119],v[188:191]
 v_add_u32 v61,65536,v53
 MM v[196:199],a[52:55],a[120:123],v[196:199]
 RQ a[28:31],v24 offset:14336
 MM a[188:191],a[52:55],a[124:127],a[188:191]
 BL v48,s[92:95],s37 offen offset:2048  lds
 MM a[192:195],a[56:59],a[96:99],a[192:195]
 v_add_u32 v62,65536,v54
 MM a[200:203],a[56:59],a[100:103],a[200:203]
 MM a[208:211],a[56:59],a[104:107],a[208:211]
 v_add_u32 v63,65536,v55
 MM a[216:219],a[56:59],a[108:111],a[216:219]
 BL v49,s[92:95],s37 offen offset:3072  lds
 MM a[224:227],a[56:59],a[112:115],a[224:227]
 s_add_u32 s37,s37,524288
 MM a[232:235],a[56:59],a[116:119],a[232:235]
 v_add_u32 v64,65536,v56
 MM a[240:243],a[56:59],a[120:123],a[240:243]
 s_add_u32 m0,s39,98304
 MM a[248:251],a[56:59],a[124:127],a[248:251]
 BL v42,s[92:95],s37 offen  lds
 MM a[196:199],a[60:63],a[96:99],a[196:199]
 v_add_u32 v65,65536,v57
 MM a[204:207],a[60:63],a[100:103],a[204:207]
 MM a[212:215],a[60:63],a[104:107],a[212:215]
 v_add_u32 v66,65536,v58
 MM a[220:223],a[60:63],a[108:111],a[220:223]
 BL v43,s[92:95],s37 offen offset:1024  lds
 MM a[228:231],a[60:63],a[112:115],a[228:231]
 MM a[236:239],a[60:63],a[116:119],a[236:239]
 v_add_u32 v67,65536,v59
 MM a[244:247],a[60:63],a[120:123],a[244:247]
 MM a[252:255],a[60:63],a[124:127],a[252:255]
 BL v44,s[92:95],s37 offen offset:2048  lds
 s_waitcnt lgkmcnt(0)
 MM v[200:203],a[0:3],a[64:67],v[200:203]
 RQ a[32:35],v25
 MM v[204:207],a[0:3],a[68:71],v[204:207]
 MM v[208:211],a[0:3],a[72:75],v[208:211]
 RT a[96:97],v26 offset:16384
 MM v[212:215],a[0:3],a[76:79],v[212:215]
 MM v[216:219],a[0:3],a[80:83],v[216:219]
 RT a[98:99],v26 offset:18432
 MM v[220:223],a[0:3],a[84:87],v[220:223]
 MM v[224:227],a[0:3],a[88:91],v[224:227]
 RT a[100:101],v27 offset:16384
 MM v[228:231],a[0:3],a[92:95],v[228:231]
 BL v45,s[92:95],s37 offen offset:3072  lds
 MM v[72:75],a[4:7],a[64:67],v[72:75]
 RT a[102:103],v27 offset:18432
 MM v[76:79],a[4:7],a[68:71],v[76:79]
 MM v[80:83],a[4:7],a[72:75],v[80:83]
 RT a[104:105],v28 offset:16384
 MM v[84:87],a[4:7],a[76:79],v[84:87]
 MM v[88:91],a[4:7],a[80:83],v[88:91]
 RT a[106:107],v28 offset:18432
 MM v[92:95],a[4:7],a[84:87],v[92:95]
 MM v[96:99],a[4:7],a[88:91],v[96:99]
 RT a[108:109],v29 offset:16384
 s_add_u32 m0,s39,102400
 MM v[100:103],a[4:7],a[92:95],v[100:103]
 BL v46,s[92:95],s37 offen  lds
 MM v[232:235],a[8:11],a[64:67],v[232:235]
 RT a[110:111],v29 offset:18432
 MM v[236:239],a[8:11],a[68:71],v[236:239]
 MM v[240:243],a[8:11],a[72:75],v[240:243]
 RT a[112:113],v30 offset:16384
 MM v[244:247],a[8:11],a[76:79],v[244:247]
 MM v[248:251],a[8:11],a[80:83],v[248:251]
 RT a[114:115],v30 offset:18432
 MM v[252:255],a[8:11],a[84:87],v[252:255]
 MM v[128:131],a[8:11],a[88:91],v[128:131]
 RT a[116:117],v31 offset:16384
 MM v[136:139],a[8:11],a[92:95],v[136:139]
 BL v47,s[92:95],s37 offen offset:1024  lds
 MM v[104:107],a[12:15],a[64:67],v[104:107]
 RT a[118:119],v31 offset:18432
 MM v[108:111],a[12:15],a[68:71],v[108:111]
 MM v[112:115],a[12:15],a[72:75],v[112:115]
 RT a[120:121],v32 offset:16384
 MM v[116:119],a[12:15],a[76:79],v[116:119]
 MM v[120:123],a[12:15],a[80:83],v[120:123]
 RT a[122:123],v32 offset:18432
 MM v[124:127],a[12:15],a[84:87],v[124:127]
 MM v[132:135],a[12:15],a[88:91],v[132:135]
 RT a[124:125],v33 offset:16384
 MM v[140:143],a[12:15],a[92:95],v[140:143]
 BL v48,s[92:95],s37 offen offset:2048  lds
 MM v[144:147],a[16:19],a[64:67],v[144:147]
 RT a[126:127],v33 offset:18432
 MM v[152:155],a[16:19],a[68:71],v[152:155]
 MM v[160:163],a[16:19],a[72:75],v[160:163]
 RQ a[36:39],v25 offset:2048
 MM v[168:171],a[16:19],a[76:79],v[168:171]
 MM v[176:179],a[16:19],a[80:83],v[176:179]
 RQ a[40:43],v25 offset:4096
 MM v[184:187],a[16:19],a[84:87],v[184:187]
 MM v[192:195],a[16:19],a[88:91],v[192:195]
 RQ a[44:47],v25 offset:6144
 MM a[184:187],a[16:19],a[92:95],a[184:187]
 BL v49,s[92:95],s37 offen offset:3072  lds
 MM v[148:151],a[20:23],a[64:67],v[148:151]
 RQ a[48:51],v25 offset:8192
 s_add_u32 s37,s37,524288
 MM v[156:159],a[20:23],a[68:71],v[156:159]
 MM v[164:167],a[20:23],a[72:75],v[164:167]
 RQ a[52:55],v25 offset:10240
 MM v[172:175],a[20:23],a[76:79],v[172:175]
 MM v[180:183],a[20:23],a[80:83],v[180:183]
 RQ a[56:59],v25 offset:12288
 MM v[188:191],a[20:23],a[84:87],v[188:191]
 MM v[196:199],a[20:23],a[88:91],v[196:199]
 RQ a[60:63],v25 offset:14336
 MM a[188:191],a[20:23],a[92:95],a[188:191]
 MM a[192:195],a[24:27],a[64:67],a[192:195]
 MM a[200:203],a[24:27],a[68:71],a[200:203]
 MM a[208:211],a[24:27],a[72:75],a[208:211]
 MM a[216:219],a[24:27],a[76:79],a[216:219]
 MM a[224:227],a[24:27],a[80:83],a[224:227]
 MM a[232:235],a[24:27],a[84:87],a[232:235]
 MM a[240:243],a[24:27],a[88:91],a[240:243]
 MM a[248:251],a[24:27],a[92:95],a[248:251]
 MM a[196:199],a[28:31],a[64:67],a[196:199]
 MM a[204:207],a[28:31],a[68:71],a[204:207]
 MM a[212:215],a[28:31],a[72:75],a[212:215]
 MM a[220:223],a[28:31],a[76:79],a[220:223]
 MM a[228:231],a[28:31],a[80:83],a[228:231]
 MM a[236:239],a[28:31],a[84:87],a[236:239]
 MM a[244:247],a[28:31],a[88:91],a[244:247]
 MM a[252:255],a[28:31],a[92:95],a[252:255]
 s_waitcnt lgkmcnt(0)
 s_barrier
 MM v[200:203],a[32:35],a[96:99],v[200:203]
 s_add_u32 m0,s38,0
 MM v[204:207],a[32:35],a[100:103],v[204:207]
 BL v38,s[88:91],s36 offen  lds
 MM v[208:211],a[32:35],a[104:107],v[208:211]
 MM v[212:215],a[32:35],a[108:111],v[212:215]
 MM v[216:219],a[32:35],a[112:115],v[216:219]
 MM v[220:223],a[32:35],a[116:119],v[220:223]
 MM v[224:227],a[32:35],a[120:123],v[224:227]
 MM v[228:231],a[32:35],a[124:127],v[228:231]
 MM v[72:75],a[36:39],a[96:99],v[72:75]
 MM v[76:79],a[36:39],a[100:103],v[76:79]
 MM v[80:83],a[36:39],a[104:107],v[80:83]
 MM v[84:87],a[36:39],a[108:111],v[84:87]
 BL v39,s[88:91],s36 offen offset:1024  lds
 MM v[88:91],a[36:39],a[112:115],v[88:91]
 MM v[92:95],a[36:39],a[116:119],v[92:95]
 MM v[96:99],a[36:39],a[120:123],v[96:99]
 MM v[100:103],a[36:39],a[124:127],v[100:103]
 MM v[232:235],a[40:43],a[96:99],v[232:235]
 MM v[236:239],a[40:43],a[100:103],v[236:239]
 MM v[240:243],a[40:43],a[104:107],v[240:243]
 MM v[244:247],a[40:43],a[108:111],v[244:247]
 MM v[248:251],a[40:43],a[112:115],v[248:251]
 MM v[252:255],a[40:43],a[116:119],v[252:255]
 BL v40,s[88:91],s36 offen offset:2048  lds
 MM v[128:131],a[40:43],a[120:123],v[128:131]
 MM v[136:139],a[40:43],a[124:127],v[136:139]
 MM v[104:107],a[44:47],a[96:99],v[104:107]
 MM v[108:111],a[44:47],a[100:103],v[108:111]
 MM v[112:115],a[44:47],a[104:107],v[112:115]
 MM v[116:119],a[44:47],a[108:111],v[116:119]
 MM v[120:123],a[44:47],a[112:115],v[120:123]
 MM v[124:127],a[44:47],a[116:119],v[124:127]
 MM v[132:135],a[44:47],a[120:123],v[132:135]
 MM v[140:143],a[44:47],a[124:127],v[140:143]
 BL v41,s[88:91],s36 offen offset:3072  lds
 MM v[144:147],a[48:51],a[96:99],v[144:147]
 s_add_u32 s36,s36,128
 MM v[152:155],a[48:51],a[100:103],v[152:155]
 MM v[160:163],a[48:51],a[104:107],v[160:163]
 MM v[168:171],a[48:51],a[108:111],v[168:171]
 MM v[176:179],a[48:51],a[112:115],v[176:179]
 MM v[184:187],a[48:51],a[116:119],v[184:187]
 MM v[192:195],a[48:51],a[120:123],v[192:195]
 MM a[184:187],a[48:51],a[124:127],a[184:187]
 MM v[148:151],a[52:55],a[96:99],v[148:151]
 MM v[156:159],a[52:55],a[100:103],v[156:159]
 MM v[164:167],a[52:55],a[104:107],v[164:167]
 s_add_u32 m0,s39,131072
 MM v[172:175],a[52:55],a[108:111],v[172:175]
 BL v42,s[92:95],s37 offen  lds
 MM v[180:183],a[52:55],a[112:115],v[180:183]
 MM v[188:191],a[52:55],a[116:119],v[188:191]
 MM v[196:199],a[52:55],a[120:123],v[196:199]
 MM a[188:191],a[52:55],a[124:127],a[188:191]
 MM a[192:195],a[56:59],a[96:99],a[192:195]
 MM a[200:203],a[56:59],a[100:103],a[200:203]
 MM a[208:211],a[56:59],a[104:107],a[208:211]
 BL v43,s[92:95],s37 offen offset:1024  lds
 MM a[216:219],a[56:59],a[108:111],a[216:219]
 MM a[224:227],a[56:59],a[112:115],a[224:227]
 MM a[232:235],a[56:59],a[116:119],a[232:235]
 MM a[240:243],a[56:59],a[120:123],a[240:243]
 MM a[248:251],a[56:59],a[124:127],a[248:251]
 BL v44,s[92:95],s37 offen offset:2048  lds
 MM a[196:199],a[60:63],a[96:99],a[196:199]
 MM a[204:207],a[60:63],a[100:103],a[204:207]
 MM a[212:215],a[60:63],a[104:107],a[212:215]
 MM a[220:223],a[60:63],a[108:111],a[220:223]
 MM a[228:231],a[60:63],a[112:115],a[228:231]
 BL v45,s[92:95],s37 offen offset:3072  lds
 MM a[236:239],a[60:63],a[116:119],a[236:239]
 MM a[244:247],a[60:63],a[120:123],a[244:247]
 MM a[252:255],a[60:63],a[124:127],a[252:255]
 s_add_u32 m0,s39,135168
 s_nop 0
 BL v46,s[92:95],s37 offen  lds
 BL v47,s[92:95],s37 offen offset:1024  lds
 BL v48,s[92:95],s37 offen offset:2048  lds
 BL v49,s[92:95],s37 offen offset:3072  lds
 s_add_u32 s37,s37,524288
 s_mov_b32 s16,s68
 s_mov_b32 s17,s69
 s_mov_b32 s18,33554432
 s_mov_b32 s19,0x20000
 s_and_b32 s85,s35,1
 s_lshl_b32 s84,s70,1
 s_add_u32 s84,s84,s85
 s_lshl_b32 s84,s84,16
 s_lshr_b32 s85,s35,1
 s_lshl_b32 s85,s85,13
 s_add_u32 s84,s84,s85
 s_lshl_b32 s85,s71,20
 s_add_u32 s84,s84,s85
 s_add_u32 s84,s84,16777216
 s_mov_b32 s29,0
 s_mov_b32 s30,8192
 AR v12,a184
 AR v13,a185
 AR v14,a186
 AR v15,a187
 AR v16,a188
 AR v17,a189
 AR v18,a190
 AR v19,a191
 CV v8,v12,v13
 CV v9,v14,v15
 CV v10,v16,v17
 CV v11,v18,v19
 s_add_u32 s85,s84,36864
 BS v[8:11],v6,s[16:19],s85 offen offset:3072 sc1
 AR v24,a192
 AR v25,a193
 AR v26,a194
 AR v27,a195
 AR v28,a196
 AR v29,a197
 AR v30,a198
 AR v31,a199
 CV v20,v24,v25
 CV v21,v26,v27
 CV v22,v28,v29
 CV v23,v30,v31
 s_add_u32 s85,s84,49152
 BS v[20:23],v6,s[16:19],s85 offen sc1
 AR v12,a200
 AR v13,a201
 AR v14,a202
 AR v15,a203
 AR v16,a204
 AR v17,a205
 AR v18,a206
 AR v19,a207
 CV v8,v12,v13
 CV v9,v14,v15
 CV v10,v16,v17
 CV v11,v18,v19
 s_add_u32 s85,s84,49152
 BS v[8:11],v6,s[16:19],s85 offen offset:1024 sc1
 AR v24,a208
 AR v25,a209
 AR v26,a210
 AR v27,a211
 AR v28,a212
 AR v29,a213
 AR v30,a214
 AR v31,a215
 CV v20,v24,v25
 CV v21,v26,v27
 CV v22,v28,v29
 CV v23,v30,v31
 s_add_u32 s85,s84,49152
 BS v[20:23],v6,s[16:19],s85 offen offset:2048 sc1
 AR v12,a216
 AR v13,a217
 AR v14,a218
 AR v15,a219
 AR v16,a220
 AR v17,a221
 AR v18,a222
 AR v19,a223
 CV v8,v12,v13
 CV v9,v14,v15
 CV v10,v16,v17
 CV v11,v18,v19
 s_add_u32 s85,s84,49152
 BS v[8:11],v6,s[16:19],s85 offen offset:3072 sc1
 AR v24,a224
 AR v25,a225
 AR v26,a226
 AR v27,a227
 AR v28,a228
 AR v29,a229
 AR v30,a230
 AR v31,a231
 CV v20,v24,v25
 CV v21,v26,v27
 CV v22,v28,v29
 CV v23,v30,v31
 s_add_u32 s85,s84,53248
 BS v[20:23],v6,s[16:19],s85 offen sc1
 AR v12,a232
 AR v13,a233
 AR v14,a234
 AR v15,a235
 AR v16,a236
 AR v17,a237
 AR v18,a238
 AR v19,a239
 CV v8,v12,v13
 CV v9,v14,v15
 CV v10,v16,v17
 CV v11,v18,v19
 s_add_u32 s85,s84,53248
 BS v[8:11],v6,s[16:19],s85 offen offset:1024 sc1
 AR v24,a240
 AR v25,a241
 AR v26,a242
 AR v27,a243
 AR v28,a244
 AR v29,a245
 AR v30,a246
 AR v31,a247
 CV v20,v24,v25
 CV v21,v26,v27
 CV v22,v28,v29
 CV v23,v30,v31
 s_add_u32 s85,s84,53248
 BS v[20:23],v6,s[16:19],s85 offen offset:2048 sc1
 AR v12,a248
 AR v13,a249
 AR v14,a250
 AR v15,a251
 AR v16,a252
 AR v17,a253
 AR v18,a254
 AR v19,a255
 CV v8,v12,v13
 CV v9,v14,v15
 CV v10,v16,v17
 CV v11,v18,v19
 s_add_u32 s85,s84,53248
 BS v[8:11],v6,s[16:19],s85 offen offset:3072 sc1
 CV v128,v128,v129
 CV v129,v130,v131
 CV v130,v132,v133
 CV v131,v134,v135
 AW a152,v128
 AW a153,v129
 AW a154,v130
 AW a155,v131
 CV v136,v136,v137
 CV v137,v138,v139
 CV v138,v140,v141
 CV v139,v142,v143
 AW a156,v136
 AW a157,v137
 AW a158,v138
 AW a159,v139
 CV v144,v144,v145
 CV v145,v146,v147
 CV v146,v148,v149
 CV v147,v150,v151
 AW a160,v144
 AW a161,v145
 AW a162,v146
 AW a163,v147
 CV v152,v152,v153
 CV v153,v154,v155
 CV v154,v156,v157
 CV v155,v158,v159
 AW a164,v152
 AW a165,v153
 AW a166,v154
 AW a167,v155
 CV v160,v160,v161
 CV v161,v162,v163
 CV v162,v164,v165
 CV v163,v166,v167
 AW a168,v160
 AW a169,v161
 AW a170,v162
 AW a171,v163
 CV v168,v168,v169
 CV v169,v170,v171
 CV v170,v172,v173
 CV v171,v174,v175
 AW a172,v168
 AW a173,v169
 AW a174,v170
 AW a175,v171
 CV v176,v176,v177
 CV v177,v178,v179
 CV v178,v180,v181
 CV v179,v182,v183
 AW a176,v176
 AW a177,v177
 AW a178,v178
 AW a179,v179
 CV v184,v184,v185
 CV v185,v186,v187
 CV v186,v188,v189
 CV v187,v190,v191
 AW a180,v184
 AW a181,v185
 AW a182,v186
 AW a183,v187
 CV v192,v192,v193
 CV v193,v194,v195
 CV v194,v196,v197
 CV v195,v198,v199
 AW a184,v192
 AW a185,v193
 AW a186,v194
 AW a187,v195
 CV v200,v200,v201
 CV v201,v202,v203
 CV v202,v72,v73
 CV v203,v74,v75
 CV v204,v204,v205
 CV v205,v206,v207
 CV v206,v76,v77
 CV v207,v78,v79
 CV v208,v208,v209
 CV v209,v210,v211
 CV v210,v80,v81
 CV v211,v82,v83
 CV v212,v212,v213
 CV v213,v214,v215
 CV v214,v84,v85
 CV v215,v86,v87
 CV v216,v216,v217
 CV v217,v218,v219
 CV v218,v88,v89
 CV v219,v90,v91
 CV v220,v220,v221
 CV v221,v222,v223
 CV v222,v92,v93
 CV v223,v94,v95
 CV v224,v224,v225
 CV v225,v226,v227
 CV v226,v96,v97
 CV v227,v98,v99
 CV v228,v228,v229
 CV v229,v230,v231
 CV v230,v100,v101
 CV v231,v102,v103
 CV v232,v232,v233
 CV v233,v234,v235
 CV v234,v104,v105
 CV v235,v106,v107
 CV v236,v236,v237
 CV v237,v238,v239
 CV v238,v108,v109
 CV v239,v110,v111
 CV v240,v240,v241
 CV v241,v242,v243
 CV v242,v112,v113
 CV v243,v114,v115
 CV v244,v244,v245
 CV v245,v246,v247
 CV v246,v116,v117
 CV v247,v118,v119
 CV v248,v248,v249
 CV v249,v250,v251
 CV v250,v120,v121
 CV v251,v122,v123
 CV v252,v252,v253
 CV v253,v254,v255
 CV v254,v124,v125
 CV v255,v126,v127
 s_branch L_q
L_q:
 s_cmp_lt_u32 s73,28
 s_cbranch_scc1 L_q2
 BS v[200:203],v6,s[16:19],s84 offen sc1
 BS v[204:207],v6,s[16:19],s84 offen offset:1024 sc1
 BS v[208:211],v6,s[16:19],s84 offen offset:2048 sc1
 BS v[212:215],v6,s[16:19],s84 offen offset:3072 sc1
 s_add_u32 s84,s84,4096
 s_add_u32 s84,s84,s29
 BS v[216:219],v6,s[16:19],s84 offen sc1
 BS v[220:223],v6,s[16:19],s84 offen offset:1024 sc1
 BS v[224:227],v6,s[16:19],s84 offen offset:2048 sc1
 BS v[228:231],v6,s[16:19],s84 offen offset:3072 sc1
 s_add_u32 s84,s84,4096
 s_add_u32 s84,s84,s30
 BS v[232:235],v6,s[16:19],s84 offen sc1
 BS v[236:239],v6,s[16:19],s84 offen offset:1024 sc1
 BS v[240:243],v6,s[16:19],s84 offen offset:2048 sc1
 BS v[244:247],v6,s[16:19],s84 offen offset:3072 sc1
 s_add_u32 s84,s84,4096
 s_add_u32 s84,s84,s29
 BS v[248:251],v6,s[16:19],s84 offen sc1
 BS v[252:255],v6,s[16:19],s84 offen offset:1024 sc1
 BS a[152:155],v6,s[16:19],s84 offen offset:2048 sc1
 BS a[156:159],v6,s[16:19],s84 offen offset:3072 sc1
 s_add_u32 s84,s84,4096
 s_add_u32 s84,s84,s30
 BS a[160:163],v6,s[16:19],s84 offen sc1
 BS a[164:167],v6,s[16:19],s84 offen offset:1024 sc1
 BS a[168:171],v6,s[16:19],s84 offen offset:2048 sc1
 BS a[172:175],v6,s[16:19],s84 offen offset:3072 sc1
 s_add_u32 s84,s84,4096
 s_add_u32 s84,s84,s29
 BS a[176:179],v6,s[16:19],s84 offen sc1
 BS a[180:183],v6,s[16:19],s84 offen offset:1024 sc1
 BS a[184:187],v6,s[16:19],s84 offen offset:2048 sc1
 s_mov_b32 s18,0
L_q2:
 s_waitcnt vmcnt(29)
 s_barrier
 RQ a[0:3],v50 offset:32768
 RQ a[4:7],v50 offset:34816
 RT a[16:17],v52
 RT a[18:19],v52 offset:2048
 RT a[20:21],v53
 RT a[22:23],v53 offset:2048
 RT a[24:25],v54
 RT a[26:27],v54 offset:2048
 RT a[28:29],v55
 RT a[30:31],v55 offset:2048
 RT a[32:33],v56
 RT a[34:35],v56 offset:2048
 RT a[36:37],v57
 RT a[38:39],v57 offset:2048
 RT a[40:41],v58
 RT a[42:43],v58 offset:2048
 RT a[44:45],v59
 RT a[46:47],v59 offset:2048
 RT a[48:49],v52 offset:256
 RT a[50:51],v52 offset:2304
 RT a[52:53],v53 offset:256
 RT a[54:55],v53 offset:2304
 RT a[56:57],v54 offset:256
 RT a[58:59],v54 offset:2304
 RT a[60:61],v55 offset:256
 RT a[62:63],v55 offset:2304
 RT a[64:65],v56 offset:256
 RT a[66:67],v56 offset:2304
 RT a[68:69],v57 offset:256
 RT a[70:71],v57 offset:2304
 RT a[72:73],v58 offset:256
 RT a[74:75],v58 offset:2304
 RT a[76:77],v59 offset:256
 RT a[78:79],v59 offset:2304
 s_waitcnt lgkmcnt(15)
 MM v[136:139],a[16:19],a[0:3],0
 RQ a[8:11],v51 offset:32768
 RQ a[12:15],v51 offset:34816
 MM v[168:171],a[16:19],a[4:7],0
 RT a[80:81],v52 offset:16384
 MM v[72:75],a[20:23],a[0:3],0
 RT a[82:83],v52 offset:18432
 s_add_u32 m0,s38,16384
 MM v[104:107],a[20:23],a[4:7],0
 RT a[84:85],v53 offset:16384
 BL v38,s[88:91],s36 offen  lds
 MM v[140:143],a[24:27],a[0:3],0
 RT a[86:87],v53 offset:18432
 RT a[88:89],v54 offset:16384
 MM v[172:175],a[24:27],a[4:7],0
 RT a[90:91],v54 offset:18432
 MM v[76:79],a[28:31],a[0:3],0
 RT a[92:93],v55 offset:16384
 MM v[108:111],a[28:31],a[4:7],0
 RT a[94:95],v55 offset:18432
 BL v39,s[88:91],s36 offen offset:1024  lds
 MM v[144:147],a[32:35],a[0:3],0
 RT a[96:97],v56 offset:16384
 RT a[98:99],v56 offset:18432
 MM v[176:179],a[32:35],a[4:7],0
 RT a[100:101],v57 offset:16384
 MM v[80:83],a[36:39],a[0:3],0
 RT a[102:103],v57 offset:18432
 MM v[112:115],a[36:39],a[4:7],0
 RT a[104:105],v58 offset:16384
 MM v[148:151],a[40:43],a[0:3],0
 RT a[106:107],v58 offset:18432
 RT a[108:109],v59 offset:16384
 MM v[180:183],a[40:43],a[4:7],0
 RT a[110:111],v59 offset:18432
 BL v40,s[88:91],s36 offen offset:2048  lds
 MM v[84:87],a[44:47],a[0:3],0
 RT a[112:113],v52 offset:16640
 MM v[116:119],a[44:47],a[4:7],0
 RT a[114:115],v52 offset:18688
 s_waitcnt lgkmcnt(15)
 MM v[152:155],a[48:51],a[0:3],0
 RT a[116:117],v53 offset:16640
 RT a[118:119],v53 offset:18688
 MM v[184:187],a[48:51],a[4:7],0
 RT a[120:121],v54 offset:16640
 MM v[88:91],a[52:55],a[0:3],0
 RT a[122:123],v54 offset:18688
 BL v41,s[88:91],s36 offen offset:3072  lds
 MM v[120:123],a[52:55],a[4:7],0
 RT a[124:125],v55 offset:16640
 s_add_u32 s36,s36,128
 MM v[156:159],a[56:59],a[0:3],0
 RT a[126:127],v55 offset:18688
 RT a[128:129],v56 offset:16640
 MM v[188:191],a[56:59],a[4:7],0
 RT a[130:131],v56 offset:18688
 MM v[92:95],a[60:63],a[0:3],0
 RT a[132:133],v57 offset:16640
 MM v[124:127],a[60:63],a[4:7],0
 RT a[134:135],v57 offset:18688
 BS v[200:203],v6,s[16:19],s84 offen sc1
 MM v[160:163],a[64:67],a[0:3],0
 RT a[136:137],v58 offset:16640
 RT a[138:139],v58 offset:18688
 MM v[192:195],a[64:67],a[4:7],0
 RT a[140:141],v59 offset:16640
 MM v[96:99],a[68:71],a[0:3],0
 RT a[142:143],v59 offset:18688
 MM v[128:131],a[68:71],a[4:7],0
 BS v[204:207],v6,s[16:19],s84 offen offset:1024 sc1
 MM v[164:167],a[72:75],a[0:3],0
 MM v[196:199],a[72:75],a[4:7],0
 MM v[100:103],a[76:79],a[0:3],0
 MM v[132:135],a[76:79],a[4:7],0
 s_waitcnt vmcnt(27)
 s_waitcnt lgkmcnt(0)
 s_barrier
 MM v[136:139],a[80:83],a[8:11],v[136:139]
 RQ a[0:3],v50 offset:49152
 RQ a[4:7],v50 offset:51200
 s_add_u32 m0,s39,65536
 MM v[168:171],a[80:83],a[12:15],v[168:171]
 RT a[16:17],v52 offset:32768
 BL v42,s[92:95],s37 offen  lds
 MM v[72:75],a[84:87],a[8:11],v[72:75]
 RT a[18:19],v52 offset:34816
 MM v[104:107],a[84:87],a[12:15],v[104:107]
 RT a[20:21],v53 offset:32768
 MM v[140:143],a[88:91],a[8:11],v[140:143]
 RT a[22:23],v53 offset:34816
 BL v43,s[92:95],s37 offen offset:1024  lds
 MM v[172:175],a[88:91],a[12:15],v[172:175]
 RT a[24:25],v54 offset:32768
 MM v[76:79],a[92:95],a[8:11],v[76:79]
 RT a[26:27],v54 offset:34816
 MM v[108:111],a[92:95],a[12:15],v[108:111]
 RT a[28:29],v55 offset:32768
 MM v[144:147],a[96:99],a[8:11],v[144:147]
 RT a[30:31],v55 offset:34816
 BL v44,s[92:95],s37 offen offset:2048  lds
 MM v[176:179],a[96:99],a[12:15],v[176:179]
 RT a[32:33],v56 offset:32768
 MM v[80:83],a[100:103],a[8:11],v[80:83]
 RT a[34:35],v56 offset:34816
 RT a[36:37],v57 offset:32768
 MM v[112:115],a[100:103],a[12:15],v[112:115]
 RT a[38:39],v57 offset:34816
 MM v[148:151],a[104:107],a[8:11],v[148:151]
 RT a[40:41],v58 offset:32768
 MM v[180:183],a[104:107],a[12:15],v[180:183]
 RT a[42:43],v58 offset:34816
 BL v45,s[92:95],s37 offen offset:3072  lds
 MM v[84:87],a[108:111],a[8:11],v[84:87]
 RT a[44:45],v59 offset:32768
 MM v[116:119],a[108:111],a[12:15],v[116:119]
 RT a[46:47],v59 offset:34816
 MM v[152:155],a[112:115],a[8:11],v[152:155]
 RT a[48:49],v52 offset:33024
 s_add_u32 m0,s39,69632
 MM v[184:187],a[112:115],a[12:15],v[184:187]
 RT a[50:51],v52 offset:35072
 BL v46,s[92:95],s37 offen  lds
 MM v[88:91],a[116:119],a[8:11],v[88:91]
 RT a[52:53],v53 offset:33024
 MM v[120:123],a[116:119],a[12:15],v[120:123]
 RT a[54:55],v53 offset:35072
 MM v[156:159],a[120:123],a[8:11],v[156:159]
 RT a[56:57],v54 offset:33024
 RT a[58:59],v54 offset:35072
 MM v[188:191],a[120:123],a[12:15],v[188:191]
 RT a[60:61],v55 offset:33024
 BL v47,s[92:95],s37 offen offset:1024  lds
 MM v[92:95],a[124:127],a[8:11],v[92:95]
 RT a[62:63],v55 offset:35072
 MM v[124:127],a[124:127],a[12:15],v[124:127]
 RT a[64:65],v56 offset:33024
 MM v[160:163],a[128:131],a[8:11],v[160:163]
 RT a[66:67],v56 offset:35072
 MM v[192:195],a[128:131],a[12:15],v[192:195]
 RT a[68:69],v57 offset:33024
 BL v48,s[92:95],s37 offen offset:2048  lds
 MM v[96:99],a[132:135],a[8:11],v[96:99]
 RT a[70:71],v57 offset:35072
 MM v[128:131],a[132:135],a[12:15],v[128:131]
 RT a[72:73],v58 offset:33024
 MM v[164:167],a[136:139],a[8:11],v[164:167]
 RT a[74:75],v58 offset:35072
 MM v[196:199],a[136:139],a[12:15],v[196:199]
 RT a[76:77],v59 offset:33024
 RT a[78:79],v59 offset:35072
 MM v[100:103],a[140:143],a[8:11],v[100:103]
 BL v49,s[92:95],s37 offen offset:3072  lds
 s_add_u32 s37,s37,524288
 MM v[132:135],a[140:143],a[12:15],v[132:135]
 BS v[208:211],v6,s[16:19],s84 offen offset:2048 sc1
 s_waitcnt lgkmcnt(15)
 MM v[136:139],a[16:19],a[0:3],v[136:139]
 RQ a[8:11],v51 offset:49152
 RQ a[12:15],v51 offset:51200
 MM v[168:171],a[16:19],a[4:7],v[168:171]
 RT a[80:81],v52 offset:49152
 MM v[72:75],a[20:23],a[0:3],v[72:75]
 RT a[82:83],v52 offset:51200
 s_add_u32 m0,s38,32768
 MM v[104:107],a[20:23],a[4:7],v[104:107]
 RT a[84:85],v53 offset:49152
 BL v38,s[88:91],s36 offen  lds
 MM v[140:143],a[24:27],a[0:3],v[140:143]
 RT a[86:87],v53 offset:51200
 RT a[88:89],v54 offset:49152
 MM v[172:175],a[24:27],a[4:7],v[172:175]
 RT a[90:91],v54 offset:51200
 MM v[76:79],a[28:31],a[0:3],v[76:79]
 RT a[92:93],v55 offset:49152
 MM v[108:111],a[28:31],a[4:7],v[108:111]
 RT a[94:95],v55 offset:51200
 BL v39,s[88:91],s36 offen offset:1024  lds
 MM v[144:147],a[32:35],a[0:3],v[144:147]
 RT a[96:97],v56 offset:49152
 RT a[98:99],v56 offset:51200
 MM v[176:179],a[32:35],a[4:7],v[176:179]
 RT a[100:101],v57 offset:49152
 MM v[80:83],a[36:39],a[0:3],v[80:83]
 RT a[102:103],v57 offset:51200
 MM v[112:115],a[36:39],a[4:7],v[112:115]
 RT a[104:105],v58 offset:49152
 MM v[148:151],a[40:43],a[0:3],v[148:151]
 RT a[106:107],v58 offset:51200
 RT a[108:109],v59 offset:49152
 MM v[180:183],a[40:43],a[4:7],v[180:183]
 RT a[110:111],v59 offset:51200
 BL v40,s[88:91],s36 offen offset:2048  lds
 MM v[84:87],a[44:47],a[0:3],v[84:87]
 RT a[112:113],v52 offset:49408
 MM v[116:119],a[44:47],a[4:7],v[116:119]
 RT a[114:115],v52 offset:51456
 s_waitcnt lgkmcnt(15)
 MM v[152:155],a[48:51],a[0:3],v[152:155]
 RT a[116:117],v53 offset:49408
 RT a[118:119],v53 offset:51456
 MM v[184:187],a[48:51],a[4:7],v[184:187]
 RT a[120:121],v54 offset:49408
 MM v[88:91],a[52:55],a[0:3],v[88:91]
 RT a[122:123],v54 offset:51456
 BL v41,s[88:91],s36 offen offset:3072  lds
 MM v[120:123],a[52:55],a[4:7],v[120:123]
 RT a[124:125],v55 offset:49408
 s_add_u32 s36,s36,128
 MM v[156:159],a[56:59],a[0:3],v[156:159]
 RT a[126:127],v55 offset:51456
 RT a[128:129],v56 offset:49408
 MM v[188:191],a[56:59],a[4:7],v[188:191]
 RT a[130:131],v56 offset:51456
 MM v[92:95],a[60:63],a[0:3],v[92:95]
 RT a[132:133],v57 offset:49408
 MM v[124:127],a[60:63],a[4:7],v[124:127]
 RT a[134:135],v57 offset:51456
 BS v[212:215],v6,s[16:19],s84 offen offset:3072 sc1
 MM v[160:163],a[64:67],a[0:3],v[160:163]
 RT a[136:137],v58 offset:49408
 RT a[138:139],v58 offset:51456
 MM v[192:195],a[64:67],a[4:7],v[192:195]
 RT a[140:141],v59 offset:49408
 MM v[96:99],a[68:71],a[0:3],v[96:99]
 RT a[142:143],v59 offset:51456
 MM v[128:131],a[68:71],a[4:7],v[128:131]
 s_add_u32 s84,s84,4096
 s_add_u32 s84,s84,s29
 BS v[216:219],v6,s[16:19],s84 offen sc1
 MM v[164:167],a[72:75],a[0:3],v[164:167]
 MM v[196:199],a[72:75],a[4:7],v[196:199]
 MM v[100:103],a[76:79],a[0:3],v[100:103]
 MM v[132:135],a[76:79],a[4:7],v[132:135]
 s_waitcnt vmcnt(30)
 s_waitcnt lgkmcnt(0)
 s_barrier
 MM v[136:139],a[80:83],a[8:11],v[136:139]
 RQ a[0:3],v50
 RQ a[4:7],v50 offset:2048
 s_add_u32 m0,s39,98304
 MM v[168:171],a[80:83],a[12:15],v[168:171]
 RT a[16:17],v60
 BL v42,s[92:95],s37 offen  lds
 MM v[72:75],a[84:87],a[8:11],v[72:75]
 RT a[18:19],v60 offset:2048
 MM v[104:107],a[84:87],a[12:15],v[104:107]
 RT a[20:21],v61
 MM v[140:143],a[88:91],a[8:11],v[140:143]
 RT a[22:23],v61 offset:2048
 BL v43,s[92:95],s37 offen offset:1024  lds
 MM v[172:175],a[88:91],a[12:15],v[172:175]
 RT a[24:25],v62
 MM v[76:79],a[92:95],a[8:11],v[76:79]
 RT a[26:27],v62 offset:2048
 MM v[108:111],a[92:95],a[12:15],v[108:111]
 RT a[28:29],v63
 MM v[144:147],a[96:99],a[8:11],v[144:147]
 RT a[30:31],v63 offset:2048
 BL v44,s[92:95],s37 offen offset:2048  lds
 MM v[176:179],a[96:99],a[12:15],v[176:179]
 RT a[32:33],v64
 MM v[80:83],a[100:103],a[8:11],v[80:83]
 RT a[34:35],v64 offset:2048
 RT a[36:37],v65
 MM v[112:115],a[100:103],a[12:15],v[112:115]
 RT a[38:39],v65 offset:2048
 MM v[148:151],a[104:107],a[8:11],v[148:151]
 RT a[40:41],v66
 MM v[180:183],a[104:107],a[12:15],v[180:183]
 RT a[42:43],v66 offset:2048
 BL v45,s[92:95],s37 offen offset:3072  lds
 MM v[84:87],a[108:111],a[8:11],v[84:87]
 RT a[44:45],v67
 MM v[116:119],a[108:111],a[12:15],v[116:119]
 RT a[46:47],v67 offset:2048
 MM v[152:155],a[112:115],a[8:11],v[152:155]
 RT a[48:49],v60 offset:256
 s_add_u32 m0,s39,102400
 MM v[184:187],a[112:115],a[12:15],v[184:187]
 RT a[50:51],v60 offset:2304
 BL v46,s[92:95],s37 offen  lds
 MM v[88:91],a[116:119],a[8:11],v[88:91]
 RT a[52:53],v61 offset:256
 MM v[120:123],a[116:119],a[12:15],v[120:123]
 RT a[54:55],v61 offset:2304
 MM v[156:159],a[120:123],a[8:11],v[156:159]
 RT a[56:57],v62 offset:256
 RT a[58:59],v62 offset:2304
 MM v[188:191],a[120:123],a[12:15],v[188:191]
 RT a[60:61],v63 offset:256
 BL v47,s[92:95],s37 offen offset:1024  lds
 MM v[92:95],a[124:127],a[8:11],v[92:95]
 RT a[62:63],v63 offset:2304
 MM v[124:127],a[124:127],a[12:15],v[124:127]
 RT a[64:65],v64 offset:256
 MM v[160:163],a[128:131],a[8:11],v[160:163]
 RT a[66:67],v64 offset:2304
 MM v[192:195],a[128:131],a[12:15],v[192:195]
 RT a[68:69],v65 offset:256
 BL v48,s[92:95],s37 offen offset:2048  lds
 MM v[96:99],a[132:135],a[8:11],v[96:99]
 RT a[70:71],v65 offset:2304
 MM v[128:131],a[132:135],a[12:15],v[128:131]
 RT a[72:73],v66 offset:256
 MM v[164:167],a[136:139],a[8:11],v[164:167]
 RT a[74:75],v66 offset:2304
 MM v[196:199],a[136:139],a[12:15],v[196:199]
 RT a[76:77],v67 offset:256
 RT a[78:79],v67 offset:2304
 MM v[100:103],a[140:143],a[8:11],v[100:103]
 BL v49,s[92:95],s37 offen offset:3072  lds
 s_add_u32 s37,s37,524288
 MM v[132:135],a[140:143],a[12:15],v[132:135]
 BS v[220:223],v6,s[16:19],s84 offen offset:1024 sc1
 s_waitcnt lgkmcnt(15)
 MM v[136:139],a[16:19],a[0:3],v[136:139]
 RQ a[8:11],v51
 RQ a[12:15],v51 offset:2048
 MM v[168:171],a[16:19],a[4:7],v[168:171]
 RT a[80:81],v60 offset:16384
 MM v[72:75],a[20:23],a[0:3],v[72:75]
 RT a[82:83],v60 offset:18432
 s_add_u32 m0,s38,49152
 MM v[104:107],a[20:23],a[4:7],v[104:107]
 RT a[84:85],v61 offset:16384
 BL v38,s[88:91],s36 offen  lds
 MM v[140:143],a[24:27],a[0:3],v[140:143]
 RT a[86:87],v61 offset:18432
 RT a[88:89],v62 offset:16384
 MM v[172:175],a[24:27],a[4:7],v[172:175]
 RT a[90:91],v62 offset:18432
 MM v[76:79],a[28:31],a[0:3],v[76:79]
 RT a[92:93],v63 offset:16384
 MM v[108:111],a[28:31],a[4:7],v[108:111]
 RT a[94:95],v63 offset:18432
 BL v39,s[88:91],s36 offen offset:1024  lds
 MM v[144:147],a[32:35],a[0:3],v[144:147]
 RT a[96:97],v64 offset:16384
 RT a[98:99],v64 offset:18432
 MM v[176:179],a[32:35],a[4:7],v[176:179]
 RT a[100:101],v65 offset:16384
 MM v[80:83],a[36:39],a[0:3],v[80:83]
 RT a[102:103],v65 offset:18432
 MM v[112:115],a[36:39],a[4:7],v[112:115]
 RT a[104:105],v66 offset:16384
 MM v[148:151],a[40:43],a[0:3],v[148:151]
 RT a[106:107],v66 offset:18432
 RT a[108:109],v67 offset:16384
 MM v[180:183],a[40:43],a[4:7],v[180:183]
 RT a[110:111],v67 offset:18432
 BL v40,s[88:91],s36 offen offset:2048  lds
 MM v[84:87],a[44:47],a[0:3],v[84:87]
 RT a[112:113],v60 offset:16640
 MM v[116:119],a[44:47],a[4:7],v[116:119]
 RT a[114:115],v60 offset:18688
 s_waitcnt lgkmcnt(15)
 MM v[152:155],a[48:51],a[0:3],v[152:155]
 RT a[116:117],v61 offset:16640
 RT a[118:119],v61 offset:18688
 MM v[184:187],a[48:51],a[4:7],v[184:187]
 RT a[120:121],v62 offset:16640
 MM v[88:91],a[52:55],a[0:3],v[88:91]
 RT a[122:123],v62 offset:18688
 BL v41,s[88:91],s36 offen offset:3072  lds
 MM v[120:123],a[52:55],a[4:7],v[120:123]
 RT a[124:125],v63 offset:16640
 s_add_u32 s36,s36,128
 MM v[156:159],a[56:59],a[0:3],v[156:159]
 RT a[126:127],v63 offset:18688
 RT a[128:129],v64 offset:16640
 MM v[188:191],a[56:59],a[4:7],v[188:191]
 RT a[130:131],v64 offset:18688
 MM v[92:95],a[60:63],a[0:3],v[92:95]
 RT a[132:133],v65 offset:16640
 MM v[124:127],a[60:63],a[4:7],v[124:127]
 RT a[134:135],v65 offset:18688
 BS v[224:227],v6,s[16:19],s84 offen offset:2048 sc1
 MM v[160:163],a[64:67],a[0:3],v[160:163]
 RT a[136:137],v66 offset:16640
 RT a[138:139],v66 offset:18688
 MM v[192:195],a[64:67],a[4:7],v[192:195]
 RT a[140:141],v67 offset:16640
 MM v[96:99],a[68:71],a[0:3],v[96:99]
 RT a[142:143],v67 offset:18688
 MM v[128:131],a[68:71],a[4:7],v[128:131]
 BS v[228:231],v6,s[16:19],s84 offen offset:3072 sc1
 MM v[164:167],a[72:75],a[0:3],v[164:167]
 MM v[196:199],a[72:75],a[4:7],v[196:199]
 MM v[100:103],a[76:79],a[0:3],v[100:103]
 MM v[132:135],a[76:79],a[4:7],v[132:135]
 s_waitcnt vmcnt(22)
 s_waitcnt lgkmcnt(0)
 s_barrier
 MM v[136:139],a[80:83],a[8:11],v[136:139]
 RQ a[0:3],v50 offset:16384
 RQ a[4:7],v50 offset:18432
 s_add_u32 m0,s39,131072
 MM v[168:171],a[80:83],a[12:15],v[168:171]
 RT a[16:17],v52
 BL v42,s[92:95],s37 offen  lds
 MM v[72:75],a[84:87],a[8:11],v[72:75]
 RT a[18:19],v52 offset:2048
 MM v[104:107],a[84:87],a[12:15],v[104:107]
 RT a[20:21],v53
 MM v[140:143],a[88:91],a[8:11],v[140:143]
 RT a[22:23],v53 offset:2048
 BL v43,s[92:95],s37 offen offset:1024  lds
 MM v[172:175],a[88:91],a[12:15],v[172:175]
 RT a[24:25],v54
 MM v[76:79],a[92:95],a[8:11],v[76:79]
 RT a[26:27],v54 offset:2048
 MM v[108:111],a[92:95],a[12:15],v[108:111]
 RT a[28:29],v55
 MM v[144:147],a[96:99],a[8:11],v[144:147]
 RT a[30:31],v55 offset:2048
 BL v44,s[92:95],s37 offen offset:2048  lds
 MM v[176:179],a[96:99],a[12:15],v[176:179]
 RT a[32:33],v56
 MM v[80:83],a[100:103],a[8:11],v[80:83]
 RT a[34:35],v56 offset:2048
 RT a[36:37],v57
 MM v[112:115],a[100:103],a[12:15],v[112:115]
 RT a[38:39],v57 offset:2048
 MM v[148:151],a[104:107],a[8:11],v[148:151]
 RT a[40:41],v58
 MM v[180:183],a[104:107],a[12:15],v[180:183]
 RT a[42:43],v58 offset:2048
 BL v45,s[92:95],s37 offen offset:3072  lds
 MM v[84:87],a[108:111],a[8:11],v[84:87]
 RT a[44:45],v59
 MM v[116:119],a[108:111],a[12:15],v[116:119]
 RT a[46:47],v59 offset:2048
 MM v[152:155],a[112:115],a[8:11],v[152:155]
 RT a[48:49],v52 offset:256
 s_add_u32 m0,s39,135168
 MM v[184:187],a[112:115],a[12:15],v[184:187]
 RT a[50:51],v52 offset:2304
 BL v46,s[92:95],s37 offen  lds
 MM v[88:91],a[116:119],a[8:11],v[88:91]
 RT a[52:53],v53 offset:256
 MM v[120:123],a[116:119],a[12:15],v[120:123]
 RT a[54:55],v53 offset:2304
 MM v[156:159],a[120:123],a[8:11],v[156:159]
 RT a[56:57],v54 offset:256
 RT a[58:59],v54 offset:2304
 MM v[188:191],a[120:123],a[12:15],v[188:191]
 RT a[60:61],v55 offset:256
 BL v47,s[92:95],s37 offen offset:1024  lds
 MM v[92:95],a[124:127],a[8:11],v[92:95]
 RT a[62:63],v55 offset:2304
 MM v[124:127],a[124:127],a[12:15],v[124:127]
 RT a[64:65],v56 offset:256
 MM v[160:163],a[128:131],a[8:11],v[160:163]
 RT a[66:67],v56 offset:2304
 MM v[192:195],a[128:131],a[12:15],v[192:195]
 RT a[68:69],v57 offset:256
 BL v48,s[92:95],s37 offen offset:2048  lds
 MM v[96:99],a[132:135],a[8:11],v[96:99]
 RT a[70:71],v57 offset:2304
 MM v[128:131],a[132:135],a[12:15],v[128:131]
 RT a[72:73],v58 offset:256
 MM v[164:167],a[136:139],a[8:11],v[164:167]
 RT a[74:75],v58 offset:2304
 MM v[196:199],a[136:139],a[12:15],v[196:199]
 RT a[76:77],v59 offset:256
 RT a[78:79],v59 offset:2304
 MM v[100:103],a[140:143],a[8:11],v[100:103]
 BL v49,s[92:95],s37 offen offset:3072  lds
 s_add_u32 s37,s37,524288
 MM v[132:135],a[140:143],a[12:15],v[132:135]
 s_add_u32 s84,s84,4096
 s_add_u32 s84,s84,s30
 BS v[232:235],v6,s[16:19],s84 offen sc1
 s_cmp_lt_u32 s73,28
 s_cbranch_scc1 L_nz2
 v_mov_b32 v70,0
 global_load_dword v71,v70,s[66:67] sc1
 s_mov_b32 s27,0
wzz_chk:
 s_waitcnt vmcnt(0)
 v_cmp_le_u32 vcc,32,v71
 s_nop 1
 s_cmp_eq_u64 vcc,-1
 s_cbranch_scc1 wzz_ok
 s_add_u32 s27,s27,1
 s_cmp_ge_u32 s27,400000
 s_cbranch_scc1 wzz_ok
 s_sleep 1
 global_load_dword v71,v70,s[66:67] sc1
 s_waitcnt vmcnt(0)
 s_branch wzz_chk
wzz_ok:
 s_lshl_b32 s26,s73,2
 s_add_u32 s26,s26,s100
 s_cmp_lg_u32 s35,0
 s_cbranch_scc1 kz_ns
 v_mov_b32 v1,0
 v_mov_b32 v2,1
 s_mov_b64 exec,1
 buffer_store_dword v2,v1,s[0:3],s26 offen sc1
 s_mov_b64 exec,-1
kz_ns:
L_nz2:
 s_waitcnt lgkmcnt(15)
 MM v[136:139],a[16:19],a[0:3],v[136:139]
 RQ a[8:11],v51 offset:16384
 RQ a[12:15],v51 offset:18432
 MM v[168:171],a[16:19],a[4:7],v[168:171]
 RT a[80:81],v52 offset:16384
 MM v[72:75],a[20:23],a[0:3],v[72:75]
 RT a[82:83],v52 offset:18432
 s_add_u32 m0,s38,0
 MM v[104:107],a[20:23],a[4:7],v[104:107]
 RT a[84:85],v53 offset:16384
 BL v38,s[88:91],s36 offen  lds
 MM v[140:143],a[24:27],a[0:3],v[140:143]
 RT a[86:87],v53 offset:18432
 RT a[88:89],v54 offset:16384
 MM v[172:175],a[24:27],a[4:7],v[172:175]
 RT a[90:91],v54 offset:18432
 MM v[76:79],a[28:31],a[0:3],v[76:79]
 RT a[92:93],v55 offset:16384
 MM v[108:111],a[28:31],a[4:7],v[108:111]
 RT a[94:95],v55 offset:18432
 BL v39,s[88:91],s36 offen offset:1024  lds
 MM v[144:147],a[32:35],a[0:3],v[144:147]
 RT a[96:97],v56 offset:16384
 RT a[98:99],v56 offset:18432
 MM v[176:179],a[32:35],a[4:7],v[176:179]
 RT a[100:101],v57 offset:16384
 MM v[80:83],a[36:39],a[0:3],v[80:83]
 RT a[102:103],v57 offset:18432
 MM v[112:115],a[36:39],a[4:7],v[112:115]
 RT a[104:105],v58 offset:16384
 MM v[148:151],a[40:43],a[0:3],v[148:151]
 RT a[106:107],v58 offset:18432
 RT a[108:109],v59 offset:16384
 MM v[180:183],a[40:43],a[4:7],v[180:183]
 RT a[110:111],v59 offset:18432
 BL v40,s[88:91],s36 offen offset:2048  lds
 MM v[84:87],a[44:47],a[0:3],v[84:87]
 RT a[112:113],v52 offset:16640
 MM v[116:119],a[44:47],a[4:7],v[116:119]
 RT a[114:115],v52 offset:18688
 s_waitcnt lgkmcnt(15)
 MM v[152:155],a[48:51],a[0:3],v[152:155]
 RT a[116:117],v53 offset:16640
 RT a[118:119],v53 offset:18688
 MM v[184:187],a[48:51],a[4:7],v[184:187]
 RT a[120:121],v54 offset:16640
 MM v[88:91],a[52:55],a[0:3],v[88:91]
 RT a[122:123],v54 offset:18688
 BL v41,s[88:91],s36 offen offset:3072  lds
 BS v[236:239],v6,s[16:19],s84 offen offset:1024 sc1
 MM v[120:123],a[52:55],a[4:7],v[120:123]
 RT a[124:125],v55 offset:16640
 s_add_u32 s36,s36,128
 MM v[156:159],a[56:59],a[0:3],v[156:159]
 RT a[126:127],v55 offset:18688
 RT a[128:129],v56 offset:16640
 MM v[188:191],a[56:59],a[4:7],v[188:191]
 RT a[130:131],v56 offset:18688
 MM v[92:95],a[60:63],a[0:3],v[92:95]
 RT a[132:133],v57 offset:16640
 MM v[124:127],a[60:63],a[4:7],v[124:127]
 RT a[134:135],v57 offset:18688
 MM v[160:163],a[64:67],a[0:3],v[160:163]
 RT a[136:137],v58 offset:16640
 RT a[138:139],v58 offset:18688
 MM v[192:195],a[64:67],a[4:7],v[192:195]
 RT a[140:141],v59 offset:16640
 MM v[96:99],a[68:71],a[0:3],v[96:99]
 RT a[142:143],v59 offset:18688
 MM v[128:131],a[68:71],a[4:7],v[128:131]
 BS v[240:243],v6,s[16:19],s84 offen offset:2048 sc1
 MM v[164:167],a[72:75],a[0:3],v[164:167]
 MM v[196:199],a[72:75],a[4:7],v[196:199]
 MM v[100:103],a[76:79],a[0:3],v[100:103]
 MM v[132:135],a[76:79],a[4:7],v[132:135]
 s_waitcnt vmcnt(22)
 s_waitcnt lgkmcnt(0)
 s_barrier
 MM v[136:139],a[80:83],a[8:11],v[136:139]
 RQ a[0:3],v50 offset:32768
 RQ a[4:7],v50 offset:34816
 s_add_u32 m0,s39,65536
 MM v[168:171],a[80:83],a[12:15],v[168:171]
 RT a[16:17],v52 offset:32768
 BL v42,s[92:95],s37 offen  lds
 MM v[72:75],a[84:87],a[8:11],v[72:75]
 RT a[18:19],v52 offset:34816
 MM v[104:107],a[84:87],a[12:15],v[104:107]
 RT a[20:21],v53 offset:32768
 MM v[140:143],a[88:91],a[8:11],v[140:143]
 RT a[22:23],v53 offset:34816
 BL v43,s[92:95],s37 offen offset:1024  lds
 MM v[172:175],a[88:91],a[12:15],v[172:175]
 RT a[24:25],v54 offset:32768
 MM v[76:79],a[92:95],a[8:11],v[76:79]
 RT a[26:27],v54 offset:34816
 MM v[108:111],a[92:95],a[12:15],v[108:111]
 RT a[28:29],v55 offset:32768
 MM v[144:147],a[96:99],a[8:11],v[144:147]
 RT a[30:31],v55 offset:34816
 BL v44,s[92:95],s37 offen offset:2048  lds
 MM v[176:179],a[96:99],a[12:15],v[176:179]
 RT a[32:33],v56 offset:32768
 MM v[80:83],a[100:103],a[8:11],v[80:83]
 RT a[34:35],v56 offset:34816
 RT a[36:37],v57 offset:32768
 MM v[112:115],a[100:103],a[12:15],v[112:115]
 RT a[38:39],v57 offset:34816
 MM v[148:151],a[104:107],a[8:11],v[148:151]
 RT a[40:41],v58 offset:32768
 MM v[180:183],a[104:107],a[12:15],v[180:183]
 RT a[42:43],v58 offset:34816
 BL v45,s[92:95],s37 offen offset:3072  lds
 MM v[84:87],a[108:111],a[8:11],v[84:87]
 RT a[44:45],v59 offset:32768
 MM v[116:119],a[108:111],a[12:15],v[116:119]
 RT a[46:47],v59 offset:34816
 MM v[152:155],a[112:115],a[8:11],v[152:155]
 RT a[48:49],v52 offset:33024
 s_add_u32 m0,s39,69632
 MM v[184:187],a[112:115],a[12:15],v[184:187]
 RT a[50:51],v52 offset:35072
 BL v46,s[92:95],s37 offen  lds
 MM v[88:91],a[116:119],a[8:11],v[88:91]
 RT a[52:53],v53 offset:33024
 BS v[244:247],v6,s[16:19],s84 offen offset:3072 sc1
 MM v[120:123],a[116:119],a[12:15],v[120:123]
 RT a[54:55],v53 offset:35072
 MM v[156:159],a[120:123],a[8:11],v[156:159]
 RT a[56:57],v54 offset:33024
 RT a[58:59],v54 offset:35072
 MM v[188:191],a[120:123],a[12:15],v[188:191]
 RT a[60:61],v55 offset:33024
 BL v47,s[92:95],s37 offen offset:1024  lds
 MM v[92:95],a[124:127],a[8:11],v[92:95]
 RT a[62:63],v55 offset:35072
 MM v[124:127],a[124:127],a[12:15],v[124:127]
 RT a[64:65],v56 offset:33024
 MM v[160:163],a[128:131],a[8:11],v[160:163]
 RT a[66:67],v56 offset:35072
 MM v[192:195],a[128:131],a[12:15],v[192:195]
 RT a[68:69],v57 offset:33024
 BL v48,s[92:95],s37 offen offset:2048  lds
 MM v[96:99],a[132:135],a[8:11],v[96:99]
 RT a[70:71],v57 offset:35072
 MM v[128:131],a[132:135],a[12:15],v[128:131]
 RT a[72:73],v58 offset:33024
 MM v[164:167],a[136:139],a[8:11],v[164:167]
 RT a[74:75],v58 offset:35072
 MM v[196:199],a[136:139],a[12:15],v[196:199]
 RT a[76:77],v59 offset:33024
 RT a[78:79],v59 offset:35072
 MM v[100:103],a[140:143],a[8:11],v[100:103]
 BL v49,s[92:95],s37 offen offset:3072  lds
 s_add_u32 s37,s37,524288
 MM v[132:135],a[140:143],a[12:15],v[132:135]
 s_add_u32 s84,s84,4096
 s_add_u32 s84,s84,s29
 BS v[248:251],v6,s[16:19],s84 offen sc1
 s_waitcnt lgkmcnt(15)
 MM v[136:139],a[16:19],a[0:3],v[136:139]
 RQ a[8:11],v51 offset:32768
 RQ a[12:15],v51 offset:34816
 MM v[168:171],a[16:19],a[4:7],v[168:171]
 RT a[80:81],v52 offset:49152
 MM v[72:75],a[20:23],a[0:3],v[72:75]
 RT a[82:83],v52 offset:51200
 s_mul_i32 s36,s86,114688
 s_add_u32 m0,s38,16384
 MM v[104:107],a[20:23],a[4:7],v[104:107]
 RT a[84:85],v53 offset:49152
 BL v38,s[88:91],s36 offen  lds
 MM v[140:143],a[24:27],a[0:3],v[140:143]
 RT a[86:87],v53 offset:51200
 RT a[88:89],v54 offset:49152
 MM v[172:175],a[24:27],a[4:7],v[172:175]
 RT a[90:91],v54 offset:51200
 MM v[76:79],a[28:31],a[0:3],v[76:79]
 RT a[92:93],v55 offset:49152
 MM v[108:111],a[28:31],a[4:7],v[108:111]
 RT a[94:95],v55 offset:51200
 BL v39,s[88:91],s36 offen offset:1024  lds
 MM v[144:147],a[32:35],a[0:3],v[144:147]
 RT a[96:97],v56 offset:49152
 RT a[98:99],v56 offset:51200
 MM v[176:179],a[32:35],a[4:7],v[176:179]
 RT a[100:101],v57 offset:49152
 MM v[80:83],a[36:39],a[0:3],v[80:83]
 RT a[102:103],v57 offset:51200
 MM v[112:115],a[36:39],a[4:7],v[112:115]
 RT a[104:105],v58 offset:49152
 MM v[148:151],a[40:43],a[0:3],v[148:151]
 RT a[106:107],v58 offset:51200
 RT a[108:109],v59 offset:49152
 MM v[180:183],a[40:43],a[4:7],v[180:183]
 RT a[110:111],v59 offset:51200
 BL v40,s[88:91],s36 offen offset:2048  lds
 MM v[84:87],a[44:47],a[0:3],v[84:87]
 RT a[112:113],v52 offset:49408
 MM v[116:119],a[44:47],a[4:7],v[116:119]
 RT a[114:115],v52 offset:51456
 s_waitcnt lgkmcnt(15)
 MM v[152:155],a[48:51],a[0:3],v[152:155]
 RT a[116:117],v53 offset:49408
 RT a[118:119],v53 offset:51456
 MM v[184:187],a[48:51],a[4:7],v[184:187]
 RT a[120:121],v54 offset:49408
 MM v[88:91],a[52:55],a[0:3],v[88:91]
 RT a[122:123],v54 offset:51456
 BL v41,s[88:91],s36 offen offset:3072  lds
 MM v[120:123],a[52:55],a[4:7],v[120:123]
 RT a[124:125],v55 offset:49408
 s_add_u32 s36,s36,128
 MM v[156:159],a[56:59],a[0:3],v[156:159]
 RT a[126:127],v55 offset:51456
 RT a[128:129],v56 offset:49408
 MM v[188:191],a[56:59],a[4:7],v[188:191]
 RT a[130:131],v56 offset:51456
 MM v[92:95],a[60:63],a[0:3],v[92:95]
 RT a[132:133],v57 offset:49408
 MM v[124:127],a[60:63],a[4:7],v[124:127]
 RT a[134:135],v57 offset:51456
 BS v[252:255],v6,s[16:19],s84 offen offset:1024 sc1
 MM v[160:163],a[64:67],a[0:3],v[160:163]
 RT a[136:137],v58 offset:49408
 RT a[138:139],v58 offset:51456
 MM v[192:195],a[64:67],a[4:7],v[192:195]
 RT a[140:141],v59 offset:49408
 MM v[96:99],a[68:71],a[0:3],v[96:99]
 RT a[142:143],v59 offset:51456
 MM v[128:131],a[68:71],a[4:7],v[128:131]
 BS a[152:155],v6,s[16:19],s84 offen offset:2048 sc1
 MM v[164:167],a[72:75],a[0:3],v[164:167]
 MM v[196:199],a[72:75],a[4:7],v[196:199]
 MM v[100:103],a[76:79],a[0:3],v[100:103]
 MM v[132:135],a[76:79],a[4:7],v[132:135]
 s_waitcnt vmcnt(23)
 s_waitcnt lgkmcnt(0)
 s_barrier
 MM v[136:139],a[80:83],a[8:11],v[136:139]
 RQ a[0:3],v50 offset:49152
 RQ a[4:7],v50 offset:51200
 s_lshl_b32 s37,s74,9
 s_add_u32 m0,s39,98304
 MM v[168:171],a[80:83],a[12:15],v[168:171]
 RT a[16:17],v60
 BL v42,s[92:95],s37 offen  lds
 MM v[72:75],a[84:87],a[8:11],v[72:75]
 RT a[18:19],v60 offset:2048
 MM v[104:107],a[84:87],a[12:15],v[104:107]
 RT a[20:21],v61
 MM v[140:143],a[88:91],a[8:11],v[140:143]
 RT a[22:23],v61 offset:2048
 BL v43,s[92:95],s37 offen offset:1024  lds
 MM v[172:175],a[88:91],a[12:15],v[172:175]
 RT a[24:25],v62
 MM v[76:79],a[92:95],a[8:11],v[76:79]
 RT a[26:27],v62 offset:2048
 MM v[108:111],a[92:95],a[12:15],v[108:111]
 RT a[28:29],v63
 MM v[144:147],a[96:99],a[8:11],v[144:147]
 RT a[30:31],v63 offset:2048
 BL v44,s[92:95],s37 offen offset:2048  lds
 MM v[176:179],a[96:99],a[12:15],v[176:179]
 RT a[32:33],v64
 MM v[80:83],a[100:103],a[8:11],v[80:83]
 RT a[34:35],v64 offset:2048
 RT a[36:37],v65
 MM v[112:115],a[100:103],a[12:15],v[112:115]
 RT a[38:39],v65 offset:2048
 MM v[148:151],a[104:107],a[8:11],v[148:151]
 RT a[40:41],v66
 MM v[180:183],a[104:107],a[12:15],v[180:183]
 RT a[42:43],v66 offset:2048
 BL v45,s[92:95],s37 offen offset:3072  lds
 MM v[84:87],a[108:111],a[8:11],v[84:87]
 RT a[44:45],v67
 MM v[116:119],a[108:111],a[12:15],v[116:119]
 RT a[46:47],v67 offset:2048
 MM v[152:155],a[112:115],a[8:11],v[152:155]
 RT a[48:49],v60 offset:256
 s_add_u32 m0,s39,102400
 MM v[184:187],a[112:115],a[12:15],v[184:187]
 RT a[50:51],v60 offset:2304
 BL v46,s[92:95],s37 offen  lds
 MM v[88:91],a[116:119],a[8:11],v[88:91]
 RT a[52:53],v61 offset:256
 MM v[120:123],a[116:119],a[12:15],v[120:123]
 RT a[54:55],v61 offset:2304
 MM v[156:159],a[120:123],a[8:11],v[156:159]
 RT a[56:57],v62 offset:256
 RT a[58:59],v62 offset:2304
 MM v[188:191],a[120:123],a[12:15],v[188:191]
 RT a[60:61],v63 offset:256
 BL v47,s[92:95],s37 offen offset:1024  lds
 MM v[92:95],a[124:127],a[8:11],v[92:95]
 RT a[62:63],v63 offset:2304
 MM v[124:127],a[124:127],a[12:15],v[124:127]
 RT a[64:65],v64 offset:256
 MM v[160:163],a[128:131],a[8:11],v[160:163]
 RT a[66:67],v64 offset:2304
 MM v[192:195],a[128:131],a[12:15],v[192:195]
 RT a[68:69],v65 offset:256
 BL v48,s[92:95],s37 offen offset:2048  lds
 MM v[96:99],a[132:135],a[8:11],v[96:99]
 RT a[70:71],v65 offset:2304
 MM v[128:131],a[132:135],a[12:15],v[128:131]
 RT a[72:73],v66 offset:256
 MM v[164:167],a[136:139],a[8:11],v[164:167]
 RT a[74:75],v66 offset:2304
 MM v[196:199],a[136:139],a[12:15],v[196:199]
 RT a[76:77],v67 offset:256
 RT a[78:79],v67 offset:2304
 MM v[100:103],a[140:143],a[8:11],v[100:103]
 BL v49,s[92:95],s37 offen offset:3072  lds
 s_add_u32 s37,s37,524288
 MM v[132:135],a[140:143],a[12:15],v[132:135]
 BS a[156:159],v6,s[16:19],s84 offen offset:3072 sc1
 s_waitcnt lgkmcnt(15)
 MM v[136:139],a[16:19],a[0:3],v[136:139]
 RQ a[8:11],v51 offset:49152
 RQ a[12:15],v51 offset:51200
 MM v[168:171],a[16:19],a[4:7],v[168:171]
 RT a[80:81],v60 offset:16384
 MM v[72:75],a[20:23],a[0:3],v[72:75]
 RT a[82:83],v60 offset:18432
 s_add_u32 m0,s38,32768
 MM v[104:107],a[20:23],a[4:7],v[104:107]
 RT a[84:85],v61 offset:16384
 BL v38,s[88:91],s36 offen  lds
 MM v[140:143],a[24:27],a[0:3],v[140:143]
 RT a[86:87],v61 offset:18432
 RT a[88:89],v62 offset:16384
 MM v[172:175],a[24:27],a[4:7],v[172:175]
 RT a[90:91],v62 offset:18432
 MM v[76:79],a[28:31],a[0:3],v[76:79]
 RT a[92:93],v63 offset:16384
 MM v[108:111],a[28:31],a[4:7],v[108:111]
 RT a[94:95],v63 offset:18432
 BL v39,s[88:91],s36 offen offset:1024  lds
 MM v[144:147],a[32:35],a[0:3],v[144:147]
 RT a[96:97],v64 offset:16384
 RT a[98:99],v64 offset:18432
 MM v[176:179],a[32:35],a[4:7],v[176:179]
 RT a[100:101],v65 offset:16384
 MM v[80:83],a[36:39],a[0:3],v[80:83]
 RT a[102:103],v65 offset:18432
 MM v[112:115],a[36:39],a[4:7],v[112:115]
 RT a[104:105],v66 offset:16384
 MM v[148:151],a[40:43],a[0:3],v[148:151]
 RT a[106:107],v66 offset:18432
 RT a[108:109],v67 offset:16384
 MM v[180:183],a[40:43],a[4:7],v[180:183]
 RT a[110:111],v67 offset:18432
 BL v40,s[88:91],s36 offen offset:2048  lds
 MM v[84:87],a[44:47],a[0:3],v[84:87]
 RT a[112:113],v60 offset:16640
 MM v[116:119],a[44:47],a[4:7],v[116:119]
 RT a[114:115],v60 offset:18688
 s_waitcnt lgkmcnt(15)
 MM v[152:155],a[48:51],a[0:3],v[152:155]
 RT a[116:117],v61 offset:16640
 RT a[118:119],v61 offset:18688
 MM v[184:187],a[48:51],a[4:7],v[184:187]
 RT a[120:121],v62 offset:16640
 MM v[88:91],a[52:55],a[0:3],v[88:91]
 RT a[122:123],v62 offset:18688
 BL v41,s[88:91],s36 offen offset:3072  lds
 MM v[120:123],a[52:55],a[4:7],v[120:123]
 RT a[124:125],v63 offset:16640
 s_add_u32 s36,s36,128
 MM v[156:159],a[56:59],a[0:3],v[156:159]
 RT a[126:127],v63 offset:18688
 RT a[128:129],v64 offset:16640
 MM v[188:191],a[56:59],a[4:7],v[188:191]
 RT a[130:131],v64 offset:18688
 MM v[92:95],a[60:63],a[0:3],v[92:95]
 RT a[132:133],v65 offset:16640
 MM v[124:127],a[60:63],a[4:7],v[124:127]
 RT a[134:135],v65 offset:18688
 s_add_u32 s84,s84,4096
 s_add_u32 s84,s84,s30
 BS a[160:163],v6,s[16:19],s84 offen sc1
 MM v[160:163],a[64:67],a[0:3],v[160:163]
 RT a[136:137],v66 offset:16640
 RT a[138:139],v66 offset:18688
 MM v[192:195],a[64:67],a[4:7],v[192:195]
 RT a[140:141],v67 offset:16640
 MM v[96:99],a[68:71],a[0:3],v[96:99]
 RT a[142:143],v67 offset:18688
 MM v[128:131],a[68:71],a[4:7],v[128:131]
 BS a[164:167],v6,s[16:19],s84 offen offset:1024 sc1
 MM v[164:167],a[72:75],a[0:3],v[164:167]
 MM v[196:199],a[72:75],a[4:7],v[196:199]
 MM v[100:103],a[76:79],a[0:3],v[100:103]
 MM v[132:135],a[76:79],a[4:7],v[132:135]
 s_waitcnt vmcnt(22)
 s_waitcnt lgkmcnt(0)
 s_barrier
 MM v[136:139],a[80:83],a[8:11],v[136:139]
 RQ a[0:3],v50
 RQ a[4:7],v50 offset:2048
 s_add_u32 m0,s39,131072
 MM v[168:171],a[80:83],a[12:15],v[168:171]
 RT a[16:17],v52
 BL v42,s[92:95],s37 offen  lds
 MM v[72:75],a[84:87],a[8:11],v[72:75]
 RT a[18:19],v52 offset:2048
 MM v[104:107],a[84:87],a[12:15],v[104:107]
 RT a[20:21],v53
 MM v[140:143],a[88:91],a[8:11],v[140:143]
 RT a[22:23],v53 offset:2048
 BL v43,s[92:95],s37 offen offset:1024  lds
 MM v[172:175],a[88:91],a[12:15],v[172:175]
 RT a[24:25],v54
 MM v[76:79],a[92:95],a[8:11],v[76:79]
 RT a[26:27],v54 offset:2048
 MM v[108:111],a[92:95],a[12:15],v[108:111]
 RT a[28:29],v55
 MM v[144:147],a[96:99],a[8:11],v[144:147]
 RT a[30:31],v55 offset:2048
 BL v44,s[92:95],s37 offen offset:2048  lds
 MM v[176:179],a[96:99],a[12:15],v[176:179]
 RT a[32:33],v56
 MM v[80:83],a[100:103],a[8:11],v[80:83]
 RT a[34:35],v56 offset:2048
 RT a[36:37],v57
 MM v[112:115],a[100:103],a[12:15],v[112:115]
 RT a[38:39],v57 offset:2048
 MM v[148:151],a[104:107],a[8:11],v[148:151]
 RT a[40:41],v58
 MM v[180:183],a[104:107],a[12:15],v[180:183]
 RT a[42:43],v58 offset:2048
 BL v45,s[92:95],s37 offen offset:3072  lds
 MM v[84:87],a[108:111],a[8:11],v[84:87]
 RT a[44:45],v59
 MM v[116:119],a[108:111],a[12:15],v[116:119]
 RT a[46:47],v59 offset:2048
 MM v[152:155],a[112:115],a[8:11],v[152:155]
 RT a[48:49],v52 offset:256
 s_add_u32 m0,s39,135168
 MM v[184:187],a[112:115],a[12:15],v[184:187]
 RT a[50:51],v52 offset:2304
 BL v46,s[92:95],s37 offen  lds
 MM v[88:91],a[116:119],a[8:11],v[88:91]
 RT a[52:53],v53 offset:256
 MM v[120:123],a[116:119],a[12:15],v[120:123]
 RT a[54:55],v53 offset:2304
 MM v[156:159],a[120:123],a[8:11],v[156:159]
 RT a[56:57],v54 offset:256
 RT a[58:59],v54 offset:2304
 MM v[188:191],a[120:123],a[12:15],v[188:191]
 RT a[60:61],v55 offset:256
 BL v47,s[92:95],s37 offen offset:1024  lds
 MM v[92:95],a[124:127],a[8:11],v[92:95]
 RT a[62:63],v55 offset:2304
 MM v[124:127],a[124:127],a[12:15],v[124:127]
 RT a[64:65],v56 offset:256
 MM v[160:163],a[128:131],a[8:11],v[160:163]
 RT a[66:67],v56 offset:2304
 MM v[192:195],a[128:131],a[12:15],v[192:195]
 RT a[68:69],v57 offset:256
 BL v48,s[92:95],s37 offen offset:2048  lds
 MM v[96:99],a[132:135],a[8:11],v[96:99]
 RT a[70:71],v57 offset:2304
 MM v[128:131],a[132:135],a[12:15],v[128:131]
 RT a[72:73],v58 offset:256
 MM v[164:167],a[136:139],a[8:11],v[164:167]
 RT a[74:75],v58 offset:2304
 MM v[196:199],a[136:139],a[12:15],v[196:199]
 RT a[76:77],v59 offset:256
 RT a[78:79],v59 offset:2304
 MM v[100:103],a[140:143],a[8:11],v[100:103]
 BL v49,s[92:95],s37 offen offset:3072  lds
 s_add_u32 s37,s37,524288
 MM v[132:135],a[140:143],a[12:15],v[132:135]
 BS a[168:171],v6,s[16:19],s84 offen offset:2048 sc1
 s_waitcnt lgkmcnt(15)
 MM v[136:139],a[16:19],a[0:3],v[136:139]
 RQ a[8:11],v51
 RQ a[12:15],v51 offset:2048
 MM v[168:171],a[16:19],a[4:7],v[168:171]
 RT a[80:81],v52 offset:16384
 MM v[72:75],a[20:23],a[0:3],v[72:75]
 RT a[82:83],v52 offset:18432
 s_add_u32 m0,s38,49152
 MM v[104:107],a[20:23],a[4:7],v[104:107]
 RT a[84:85],v53 offset:16384
 BL v38,s[88:91],s36 offen  lds
 MM v[140:143],a[24:27],a[0:3],v[140:143]
 RT a[86:87],v53 offset:18432
 RT a[88:89],v54 offset:16384
 MM v[172:175],a[24:27],a[4:7],v[172:175]
 RT a[90:91],v54 offset:18432
 MM v[76:79],a[28:31],a[0:3],v[76:79]
 RT a[92:93],v55 offset:16384
 MM v[108:111],a[28:31],a[4:7],v[108:111]
 RT a[94:95],v55 offset:18432
 BL v39,s[88:91],s36 offen offset:1024  lds
 MM v[144:147],a[32:35],a[0:3],v[144:147]
 RT a[96:97],v56 offset:16384
 RT a[98:99],v56 offset:18432
 MM v[176:179],a[32:35],a[4:7],v[176:179]
 RT a[100:101],v57 offset:16384
 MM v[80:83],a[36:39],a[0:3],v[80:83]
 RT a[102:103],v57 offset:18432
 MM v[112:115],a[36:39],a[4:7],v[112:115]
 RT a[104:105],v58 offset:16384
 MM v[148:151],a[40:43],a[0:3],v[148:151]
 RT a[106:107],v58 offset:18432
 RT a[108:109],v59 offset:16384
 MM v[180:183],a[40:43],a[4:7],v[180:183]
 RT a[110:111],v59 offset:18432
 BL v40,s[88:91],s36 offen offset:2048  lds
 MM v[84:87],a[44:47],a[0:3],v[84:87]
 RT a[112:113],v52 offset:16640
 MM v[116:119],a[44:47],a[4:7],v[116:119]
 RT a[114:115],v52 offset:18688
 s_waitcnt lgkmcnt(15)
 MM v[152:155],a[48:51],a[0:3],v[152:155]
 RT a[116:117],v53 offset:16640
 RT a[118:119],v53 offset:18688
 MM v[184:187],a[48:51],a[4:7],v[184:187]
 RT a[120:121],v54 offset:16640
 MM v[88:91],a[52:55],a[0:3],v[88:91]
 RT a[122:123],v54 offset:18688
 BL v41,s[88:91],s36 offen offset:3072  lds
 BS a[172:175],v6,s[16:19],s84 offen offset:3072 sc1
 MM v[120:123],a[52:55],a[4:7],v[120:123]
 RT a[124:125],v55 offset:16640
 s_add_u32 s36,s36,128
 MM v[156:159],a[56:59],a[0:3],v[156:159]
 RT a[126:127],v55 offset:18688
 RT a[128:129],v56 offset:16640
 MM v[188:191],a[56:59],a[4:7],v[188:191]
 RT a[130:131],v56 offset:18688
 MM v[92:95],a[60:63],a[0:3],v[92:95]
 RT a[132:133],v57 offset:16640
 MM v[124:127],a[60:63],a[4:7],v[124:127]
 RT a[134:135],v57 offset:18688
 MM v[160:163],a[64:67],a[0:3],v[160:163]
 RT a[136:137],v58 offset:16640
 RT a[138:139],v58 offset:18688
 MM v[192:195],a[64:67],a[4:7],v[192:195]
 RT a[140:141],v59 offset:16640
 MM v[96:99],a[68:71],a[0:3],v[96:99]
 RT a[142:143],v59 offset:18688
 MM v[128:131],a[68:71],a[4:7],v[128:131]
 s_add_u32 s84,s84,4096
 s_add_u32 s84,s84,s29
 BS a[176:179],v6,s[16:19],s84 offen sc1
 MM v[164:167],a[72:75],a[0:3],v[164:167]
 MM v[196:199],a[72:75],a[4:7],v[196:199]
 MM v[100:103],a[76:79],a[0:3],v[100:103]
 MM v[132:135],a[76:79],a[4:7],v[132:135]
 s_waitcnt vmcnt(22)
 s_waitcnt lgkmcnt(0)
 s_barrier
 MM v[136:139],a[80:83],a[8:11],v[136:139]
 RQ a[0:3],v50 offset:16384
 RQ a[4:7],v50 offset:18432
 s_add_u32 m0,s39,65536
 MM v[168:171],a[80:83],a[12:15],v[168:171]
 RT a[16:17],v52 offset:32768
 BL v42,s[92:95],s37 offen  lds
 MM v[72:75],a[84:87],a[8:11],v[72:75]
 RT a[18:19],v52 offset:34816
 MM v[104:107],a[84:87],a[12:15],v[104:107]
 RT a[20:21],v53 offset:32768
 MM v[140:143],a[88:91],a[8:11],v[140:143]
 RT a[22:23],v53 offset:34816
 BL v43,s[92:95],s37 offen offset:1024  lds
 MM v[172:175],a[88:91],a[12:15],v[172:175]
 RT a[24:25],v54 offset:32768
 MM v[76:79],a[92:95],a[8:11],v[76:79]
 RT a[26:27],v54 offset:34816
 MM v[108:111],a[92:95],a[12:15],v[108:111]
 RT a[28:29],v55 offset:32768
 MM v[144:147],a[96:99],a[8:11],v[144:147]
 RT a[30:31],v55 offset:34816
 BL v44,s[92:95],s37 offen offset:2048  lds
 MM v[176:179],a[96:99],a[12:15],v[176:179]
 RT a[32:33],v56 offset:32768
 MM v[80:83],a[100:103],a[8:11],v[80:83]
 RT a[34:35],v56 offset:34816
 RT a[36:37],v57 offset:32768
 MM v[112:115],a[100:103],a[12:15],v[112:115]
 RT a[38:39],v57 offset:34816
 MM v[148:151],a[104:107],a[8:11],v[148:151]
 RT a[40:41],v58 offset:32768
 MM v[180:183],a[104:107],a[12:15],v[180:183]
 RT a[42:43],v58 offset:34816
 BL v45,s[92:95],s37 offen offset:3072  lds
 MM v[84:87],a[108:111],a[8:11],v[84:87]
 RT a[44:45],v59 offset:32768
 MM v[116:119],a[108:111],a[12:15],v[116:119]
 RT a[46:47],v59 offset:34816
 MM v[152:155],a[112:115],a[8:11],v[152:155]
 RT a[48:49],v52 offset:33024
 s_add_u32 m0,s39,69632
 MM v[184:187],a[112:115],a[12:15],v[184:187]
 RT a[50:51],v52 offset:35072
 BL v46,s[92:95],s37 offen  lds
 MM v[88:91],a[116:119],a[8:11],v[88:91]
 RT a[52:53],v53 offset:33024
 BS a[180:183],v6,s[16:19],s84 offen offset:1024 sc1
 MM v[120:123],a[116:119],a[12:15],v[120:123]
 RT a[54:55],v53 offset:35072
 MM v[156:159],a[120:123],a[8:11],v[156:159]
 RT a[56:57],v54 offset:33024
 RT a[58:59],v54 offset:35072
 MM v[188:191],a[120:123],a[12:15],v[188:191]
 RT a[60:61],v55 offset:33024
 BL v47,s[92:95],s37 offen offset:1024  lds
 MM v[92:95],a[124:127],a[8:11],v[92:95]
 RT a[62:63],v55 offset:35072
 MM v[124:127],a[124:127],a[12:15],v[124:127]
 RT a[64:65],v56 offset:33024
 MM v[160:163],a[128:131],a[8:11],v[160:163]
 RT a[66:67],v56 offset:35072
 MM v[192:195],a[128:131],a[12:15],v[192:195]
 RT a[68:69],v57 offset:33024
 BL v48,s[92:95],s37 offen offset:2048  lds
 MM v[96:99],a[132:135],a[8:11],v[96:99]
 RT a[70:71],v57 offset:35072
 MM v[128:131],a[132:135],a[12:15],v[128:131]
 RT a[72:73],v58 offset:33024
 MM v[164:167],a[136:139],a[8:11],v[164:167]
 RT a[74:75],v58 offset:35072
 MM v[196:199],a[136:139],a[12:15],v[196:199]
 RT a[76:77],v59 offset:33024
 RT a[78:79],v59 offset:35072
 MM v[100:103],a[140:143],a[8:11],v[100:103]
 BL v49,s[92:95],s37 offen offset:3072  lds
 s_add_u32 s37,s37,524288
 MM v[132:135],a[140:143],a[12:15],v[132:135]
 BS a[184:187],v6,s[16:19],s84 offen offset:2048 sc1
 v_mov_b32 v4,0x3db8aa3b
 PM v[136:137],v[136:137],v[4:5] op_sel_hi:[1,0]
 PM v[138:139],v[138:139],v[4:5] op_sel_hi:[1,0]
 PM v[72:73],v[72:73],v[4:5] op_sel_hi:[1,0]
 PM v[74:75],v[74:75],v[4:5] op_sel_hi:[1,0]
 CV v136,v136,v137
 CV v137,v138,v139
 CV v138,v72,v73
 CV v139,v74,v75
 PM v[140:141],v[140:141],v[4:5] op_sel_hi:[1,0]
 PM v[142:143],v[142:143],v[4:5] op_sel_hi:[1,0]
 PM v[76:77],v[76:77],v[4:5] op_sel_hi:[1,0]
 PM v[78:79],v[78:79],v[4:5] op_sel_hi:[1,0]
 CV v140,v140,v141
 CV v141,v142,v143
 CV v142,v76,v77
 CV v143,v78,v79
 PM v[144:145],v[144:145],v[4:5] op_sel_hi:[1,0]
 PM v[146:147],v[146:147],v[4:5] op_sel_hi:[1,0]
 PM v[80:81],v[80:81],v[4:5] op_sel_hi:[1,0]
 PM v[82:83],v[82:83],v[4:5] op_sel_hi:[1,0]
 CV v144,v144,v145
 CV v145,v146,v147
 CV v146,v80,v81
 CV v147,v82,v83
 PM v[148:149],v[148:149],v[4:5] op_sel_hi:[1,0]
 PM v[150:151],v[150:151],v[4:5] op_sel_hi:[1,0]
 PM v[84:85],v[84:85],v[4:5] op_sel_hi:[1,0]
 PM v[86:87],v[86:87],v[4:5] op_sel_hi:[1,0]
 CV v148,v148,v149
 CV v149,v150,v151
 CV v150,v84,v85
 CV v151,v86,v87
 PM v[152:153],v[152:153],v[4:5] op_sel_hi:[1,0]
 PM v[154:155],v[154:155],v[4:5] op_sel_hi:[1,0]
 PM v[88:89],v[88:89],v[4:5] op_sel_hi:[1,0]
 PM v[90:91],v[90:91],v[4:5] op_sel_hi:[1,0]
 CV v152,v152,v153
 CV v153,v154,v155
 CV v154,v88,v89
 CV v155,v90,v91
 PM v[156:157],v[156:157],v[4:5] op_sel_hi:[1,0]
 PM v[158:159],v[158:159],v[4:5] op_sel_hi:[1,0]
 PM v[92:93],v[92:93],v[4:5] op_sel_hi:[1,0]
 PM v[94:95],v[94:95],v[4:5] op_sel_hi:[1,0]
 CV v156,v156,v157
 CV v157,v158,v159
 CV v158,v92,v93
 CV v159,v94,v95
 PM v[160:161],v[160:161],v[4:5] op_sel_hi:[1,0]
 PM v[162:163],v[162:163],v[4:5] op_sel_hi:[1,0]
 PM v[96:97],v[96:97],v[4:5] op_sel_hi:[1,0]
 PM v[98:99],v[98:99],v[4:5] op_sel_hi:[1,0]
 CV v160,v160,v161
 CV v161,v162,v163
 CV v162,v96,v97
 CV v163,v98,v99
 PM v[164:165],v[164:165],v[4:5] op_sel_hi:[1,0]
 PM v[166:167],v[166:167],v[4:5] op_sel_hi:[1,0]
 PM v[100:101],v[100:101],v[4:5] op_sel_hi:[1,0]
 PM v[102:103],v[102:103],v[4:5] op_sel_hi:[1,0]
 CV v164,v164,v165
 CV v165,v166,v167
 CV v166,v100,v101
 CV v167,v102,v103
 PM v[168:169],v[168:169],v[4:5] op_sel_hi:[1,0]
 PM v[170:171],v[170:171],v[4:5] op_sel_hi:[1,0]
 PM v[104:105],v[104:105],v[4:5] op_sel_hi:[1,0]
 PM v[106:107],v[106:107],v[4:5] op_sel_hi:[1,0]
 CV v168,v168,v169
 CV v169,v170,v171
 CV v170,v104,v105
 CV v171,v106,v107
 PM v[172:173],v[172:173],v[4:5] op_sel_hi:[1,0]
 PM v[174:175],v[174:175],v[4:5] op_sel_hi:[1,0]
 PM v[108:109],v[108:109],v[4:5] op_sel_hi:[1,0]
 PM v[110:111],v[110:111],v[4:5] op_sel_hi:[1,0]
 CV v172,v172,v173
 CV v173,v174,v175
 CV v174,v108,v109
 CV v175,v110,v111
 PM v[176:177],v[176:177],v[4:5] op_sel_hi:[1,0]
 PM v[178:179],v[178:179],v[4:5] op_sel_hi:[1,0]
 PM v[112:113],v[112:113],v[4:5] op_sel_hi:[1,0]
 PM v[114:115],v[114:115],v[4:5] op_sel_hi:[1,0]
 CV v176,v176,v177
 CV v177,v178,v179
 CV v178,v112,v113
 CV v179,v114,v115
 PM v[180:181],v[180:181],v[4:5] op_sel_hi:[1,0]
 PM v[182:183],v[182:183],v[4:5] op_sel_hi:[1,0]
 PM v[116:117],v[116:117],v[4:5] op_sel_hi:[1,0]
 PM v[118:119],v[118:119],v[4:5] op_sel_hi:[1,0]
 CV v180,v180,v181
 CV v181,v182,v183
 CV v182,v116,v117
 CV v183,v118,v119
 PM v[184:185],v[184:185],v[4:5] op_sel_hi:[1,0]
 PM v[186:187],v[186:187],v[4:5] op_sel_hi:[1,0]
 PM v[120:121],v[120:121],v[4:5] op_sel_hi:[1,0]
 PM v[122:123],v[122:123],v[4:5] op_sel_hi:[1,0]
 CV v184,v184,v185
 CV v185,v186,v187
 CV v186,v120,v121
 CV v187,v122,v123
 PM v[188:189],v[188:189],v[4:5] op_sel_hi:[1,0]
 PM v[190:191],v[190:191],v[4:5] op_sel_hi:[1,0]
 PM v[124:125],v[124:125],v[4:5] op_sel_hi:[1,0]
 PM v[126:127],v[126:127],v[4:5] op_sel_hi:[1,0]
 CV v188,v188,v189
 CV v189,v190,v191
 CV v190,v124,v125
 CV v191,v126,v127
 PM v[192:193],v[192:193],v[4:5] op_sel_hi:[1,0]
 PM v[194:195],v[194:195],v[4:5] op_sel_hi:[1,0]
 PM v[128:129],v[128:129],v[4:5] op_sel_hi:[1,0]
 PM v[130:131],v[130:131],v[4:5] op_sel_hi:[1,0]
 CV v192,v192,v193
 CV v193,v194,v195
 CV v194,v128,v129
 CV v195,v130,v131
 PM v[196:197],v[196:197],v[4:5] op_sel_hi:[1,0]
 PM v[198:199],v[198:199],v[4:5] op_sel_hi:[1,0]
 PM v[132:133],v[132:133],v[4:5] op_sel_hi:[1,0]
 PM v[134:135],v[134:135],v[4:5] op_sel_hi:[1,0]
 CV v196,v196,v197
 CV v197,v198,v199
 CV v198,v132,v133
 CV v199,v134,v135
 s_add_u32 s16,s68,33554432
 s_addc_u32 s17,s69,0
 s_mov_b32 s18,16777216
 s_mov_b32 s19,0x20000
 s_lshl_b32 s101,s97,2
 s_add_u32 s101,s101,s35
 s_lshl_b32 s101,s101,14
 s_lshl_b32 s26,s74,20
 s_add_u32 s101,s101,s26
 s_cmp_ge_u32 s73,28
 s_cbranch_scc1 L_roleZ2
 s_waitcnt lgkmcnt(15)
 MM v[200:203],a[16:19],a[0:3],0
 RQ a[8:11],v51 offset:16384
 RQ a[12:15],v51 offset:18432
 MM v[232:235],a[16:19],a[4:7],0
 RT a[80:81],v52 offset:49152
 MM v[80:83],a[20:23],a[0:3],0
 RT a[82:83],v52 offset:51200
 s_add_u32 m0,s38,0
 MM v[112:115],a[20:23],a[4:7],0
 RT a[84:85],v53 offset:49152
 BL v38,s[88:91],s36 offen  lds
 MM v[204:207],a[24:27],a[0:3],0
 RT a[86:87],v53 offset:51200
 RT a[88:89],v54 offset:49152
 MM v[236:239],a[24:27],a[4:7],0
 RT a[90:91],v54 offset:51200
 MM v[84:87],a[28:31],a[0:3],0
 RT a[92:93],v55 offset:49152
 MM v[116:119],a[28:31],a[4:7],0
 RT a[94:95],v55 offset:51200
 BL v39,s[88:91],s36 offen offset:1024  lds
 MM v[208:211],a[32:35],a[0:3],0
 RT a[96:97],v56 offset:49152
 RT a[98:99],v56 offset:51200
 MM v[240:243],a[32:35],a[4:7],0
 RT a[100:101],v57 offset:49152
 MM v[88:91],a[36:39],a[0:3],0
 RT a[102:103],v57 offset:51200
 MM v[120:123],a[36:39],a[4:7],0
 RT a[104:105],v58 offset:49152
 MM v[212:215],a[40:43],a[0:3],0
 RT a[106:107],v58 offset:51200
 RT a[108:109],v59 offset:49152
 MM v[244:247],a[40:43],a[4:7],0
 RT a[110:111],v59 offset:51200
 BL v40,s[88:91],s36 offen offset:2048  lds
 MM v[92:95],a[44:47],a[0:3],0
 RT a[112:113],v52 offset:49408
 MM v[124:127],a[44:47],a[4:7],0
 RT a[114:115],v52 offset:51456
 s_waitcnt lgkmcnt(15)
 MM v[216:219],a[48:51],a[0:3],0
 RT a[116:117],v53 offset:49408
 RT a[118:119],v53 offset:51456
 MM v[248:251],a[48:51],a[4:7],0
 RT a[120:121],v54 offset:49408
 MM v[96:99],a[52:55],a[0:3],0
 RT a[122:123],v54 offset:51456
 BL v41,s[88:91],s36 offen offset:3072  lds
 MM v[128:131],a[52:55],a[4:7],0
 RT a[124:125],v55 offset:49408
 s_add_u32 s36,s36,128
 MM v[220:223],a[56:59],a[0:3],0
 RT a[126:127],v55 offset:51456
 RT a[128:129],v56 offset:49408
 MM v[252:255],a[56:59],a[4:7],0
 RT a[130:131],v56 offset:51456
 MM v[100:103],a[60:63],a[0:3],0
 RT a[132:133],v57 offset:49408
 MM v[132:135],a[60:63],a[4:7],0
 RT a[134:135],v57 offset:51456
 MM v[224:227],a[64:67],a[0:3],0
 RT a[136:137],v58 offset:49408
 RT a[138:139],v58 offset:51456
 MM v[72:75],a[64:67],a[4:7],0
 RT a[140:141],v59 offset:49408
 MM v[104:107],a[68:71],a[0:3],0
 RT a[142:143],v59 offset:51456
 MM a[144:147],a[68:71],a[4:7],0
 BS v[136:139],v6,s[16:19],s101 offen sc1
 MM v[228:231],a[72:75],a[0:3],0
 MM v[76:79],a[72:75],a[4:7],0
 MM v[108:111],a[76:79],a[0:3],0
 MM a[148:151],a[76:79],a[4:7],0
 s_waitcnt vmcnt(22)
 s_waitcnt lgkmcnt(0)
 s_barrier
 MM v[200:203],a[80:83],a[8:11],v[200:203]
 RQ a[0:3],v50 offset:32768
 RQ a[4:7],v50 offset:34816
 s_add_u32 m0,s39,98304
 MM v[232:235],a[80:83],a[12:15],v[232:235]
 RT a[16:17],v60
 BL v42,s[92:95],s37 offen  lds
 MM v[80:83],a[84:87],a[8:11],v[80:83]
 RT a[18:19],v60 offset:2048
 MM v[112:115],a[84:87],a[12:15],v[112:115]
 RT a[20:21],v61
 MM v[204:207],a[88:91],a[8:11],v[204:207]
 RT a[22:23],v61 offset:2048
 BL v43,s[92:95],s37 offen offset:1024  lds
 MM v[236:239],a[88:91],a[12:15],v[236:239]
 RT a[24:25],v62
 MM v[84:87],a[92:95],a[8:11],v[84:87]
 RT a[26:27],v62 offset:2048
 MM v[116:119],a[92:95],a[12:15],v[116:119]
 RT a[28:29],v63
 MM v[208:211],a[96:99],a[8:11],v[208:211]
 RT a[30:31],v63 offset:2048
 BL v44,s[92:95],s37 offen offset:2048  lds
 MM v[240:243],a[96:99],a[12:15],v[240:243]
 RT a[32:33],v64
 MM v[88:91],a[100:103],a[8:11],v[88:91]
 RT a[34:35],v64 offset:2048
 RT a[36:37],v65
 MM v[120:123],a[100:103],a[12:15],v[120:123]
 RT a[38:39],v65 offset:2048
 MM v[212:215],a[104:107],a[8:11],v[212:215]
 RT a[40:41],v66
 MM v[244:247],a[104:107],a[12:15],v[244:247]
 RT a[42:43],v66 offset:2048
 BL v45,s[92:95],s37 offen offset:3072  lds
 MM v[92:95],a[108:111],a[8:11],v[92:95]
 RT a[44:45],v67
 MM v[124:127],a[108:111],a[12:15],v[124:127]
 RT a[46:47],v67 offset:2048
 MM v[216:219],a[112:115],a[8:11],v[216:219]
 RT a[48:49],v60 offset:256
 s_add_u32 m0,s39,102400
 MM v[248:251],a[112:115],a[12:15],v[248:251]
 RT a[50:51],v60 offset:2304
 BL v46,s[92:95],s37 offen  lds
 MM v[96:99],a[116:119],a[8:11],v[96:99]
 RT a[52:53],v61 offset:256
 MM v[128:131],a[116:119],a[12:15],v[128:131]
 RT a[54:55],v61 offset:2304
 MM v[220:223],a[120:123],a[8:11],v[220:223]
 RT a[56:57],v62 offset:256
 RT a[58:59],v62 offset:2304
 MM v[252:255],a[120:123],a[12:15],v[252:255]
 RT a[60:61],v63 offset:256
 BL v47,s[92:95],s37 offen offset:1024  lds
 MM v[100:103],a[124:127],a[8:11],v[100:103]
 RT a[62:63],v63 offset:2304
 MM v[132:135],a[124:127],a[12:15],v[132:135]
 RT a[64:65],v64 offset:256
 MM v[224:227],a[128:131],a[8:11],v[224:227]
 RT a[66:67],v64 offset:2304
 MM v[72:75],a[128:131],a[12:15],v[72:75]
 RT a[68:69],v65 offset:256
 BL v48,s[92:95],s37 offen offset:2048  lds
 MM v[104:107],a[132:135],a[8:11],v[104:107]
 RT a[70:71],v65 offset:2304
 MM a[144:147],a[132:135],a[12:15],a[144:147]
 RT a[72:73],v66 offset:256
 MM v[228:231],a[136:139],a[8:11],v[228:231]
 RT a[74:75],v66 offset:2304
 MM v[76:79],a[136:139],a[12:15],v[76:79]
 RT a[76:77],v67 offset:256
 RT a[78:79],v67 offset:2304
 MM v[108:111],a[140:143],a[8:11],v[108:111]
 BL v49,s[92:95],s37 offen offset:3072  lds
 s_add_u32 s37,s37,524288
 MM a[148:151],a[140:143],a[12:15],a[148:151]
 BS v[140:143],v6,s[16:19],s101 offen offset:1024 sc1
 v_mov_b32 v70,0
 global_load_dword v71,v70,s[66:67] sc1
 s_waitcnt lgkmcnt(15)
 MM v[200:203],a[16:19],a[0:3],v[200:203]
 RQ a[8:11],v51 offset:32768
 RQ a[12:15],v51 offset:34816
 MM v[232:235],a[16:19],a[4:7],v[232:235]
 RT a[80:81],v60 offset:16384
 MM v[80:83],a[20:23],a[0:3],v[80:83]
 RT a[82:83],v60 offset:18432
 s_add_u32 m0,s38,16384
 MM v[112:115],a[20:23],a[4:7],v[112:115]
 RT a[84:85],v61 offset:16384
 BL v38,s[88:91],s36 offen  lds
 MM v[204:207],a[24:27],a[0:3],v[204:207]
 RT a[86:87],v61 offset:18432
 RT a[88:89],v62 offset:16384
 MM v[236:239],a[24:27],a[4:7],v[236:239]
 RT a[90:91],v62 offset:18432
 MM v[84:87],a[28:31],a[0:3],v[84:87]
 RT a[92:93],v63 offset:16384
 MM v[116:119],a[28:31],a[4:7],v[116:119]
 RT a[94:95],v63 offset:18432
 BL v39,s[88:91],s36 offen offset:1024  lds
 MM v[208:211],a[32:35],a[0:3],v[208:211]
 RT a[96:97],v64 offset:16384
 RT a[98:99],v64 offset:18432
 MM v[240:243],a[32:35],a[4:7],v[240:243]
 RT a[100:101],v65 offset:16384
 MM v[88:91],a[36:39],a[0:3],v[88:91]
 RT a[102:103],v65 offset:18432
 MM v[120:123],a[36:39],a[4:7],v[120:123]
 RT a[104:105],v66 offset:16384
 MM v[212:215],a[40:43],a[0:3],v[212:215]
 RT a[106:107],v66 offset:18432
 RT a[108:109],v67 offset:16384
 MM v[244:247],a[40:43],a[4:7],v[244:247]
 RT a[110:111],v67 offset:18432
 BL v40,s[88:91],s36 offen offset:2048  lds
 MM v[92:95],a[44:47],a[0:3],v[92:95]
 RT a[112:113],v60 offset:16640
 MM v[124:127],a[44:47],a[4:7],v[124:127]
 RT a[114:115],v60 offset:18688
 s_waitcnt lgkmcnt(15)
 MM v[216:219],a[48:51],a[0:3],v[216:219]
 RT a[116:117],v61 offset:16640
 RT a[118:119],v61 offset:18688
 MM v[248:251],a[48:51],a[4:7],v[248:251]
 RT a[120:121],v62 offset:16640
 MM v[96:99],a[52:55],a[0:3],v[96:99]
 RT a[122:123],v62 offset:18688
 BL v41,s[88:91],s36 offen offset:3072  lds
 MM v[128:131],a[52:55],a[4:7],v[128:131]
 RT a[124:125],v63 offset:16640
 s_add_u32 s36,s36,128
 MM v[220:223],a[56:59],a[0:3],v[220:223]
 RT a[126:127],v63 offset:18688
 RT a[128:129],v64 offset:16640
 MM v[252:255],a[56:59],a[4:7],v[252:255]
 RT a[130:131],v64 offset:18688
 MM v[100:103],a[60:63],a[0:3],v[100:103]
 RT a[132:133],v65 offset:16640
 MM v[132:135],a[60:63],a[4:7],v[132:135]
 RT a[134:135],v65 offset:18688
 BS v[144:147],v6,s[16:19],s101 offen offset:2048 sc1
 MM v[224:227],a[64:67],a[0:3],v[224:227]
 RT a[136:137],v66 offset:16640
 RT a[138:139],v66 offset:18688
 MM v[72:75],a[64:67],a[4:7],v[72:75]
 RT a[140:141],v67 offset:16640
 MM v[104:107],a[68:71],a[0:3],v[104:107]
 RT a[142:143],v67 offset:18688
 MM a[144:147],a[68:71],a[4:7],a[144:147]
 BS v[148:151],v6,s[16:19],s101 offen offset:3072 sc1
 MM v[228:231],a[72:75],a[0:3],v[228:231]
 MM v[76:79],a[72:75],a[4:7],v[76:79]
 MM v[108:111],a[76:79],a[0:3],v[108:111]
 MM a[148:151],a[76:79],a[4:7],a[148:151]
 s_waitcnt vmcnt(22)
 s_waitcnt lgkmcnt(0)
 s_barrier
 MM v[200:203],a[80:83],a[8:11],v[200:203]
 RQ a[0:3],v50 offset:49152
 RQ a[4:7],v50 offset:51200
 s_add_u32 m0,s39,131072
 MM v[232:235],a[80:83],a[12:15],v[232:235]
 RT a[16:17],v52
 BL v42,s[92:95],s37 offen  lds
 MM v[80:83],a[84:87],a[8:11],v[80:83]
 RT a[18:19],v52 offset:2048
 MM v[112:115],a[84:87],a[12:15],v[112:115]
 RT a[20:21],v53
 MM v[204:207],a[88:91],a[8:11],v[204:207]
 RT a[22:23],v53 offset:2048
 BL v43,s[92:95],s37 offen offset:1024  lds
 MM v[236:239],a[88:91],a[12:15],v[236:239]
 RT a[24:25],v54
 MM v[84:87],a[92:95],a[8:11],v[84:87]
 RT a[26:27],v54 offset:2048
 MM v[116:119],a[92:95],a[12:15],v[116:119]
 RT a[28:29],v55
 MM v[208:211],a[96:99],a[8:11],v[208:211]
 RT a[30:31],v55 offset:2048
 BL v44,s[92:95],s37 offen offset:2048  lds
 MM v[240:243],a[96:99],a[12:15],v[240:243]
 RT a[32:33],v56
 MM v[88:91],a[100:103],a[8:11],v[88:91]
 RT a[34:35],v56 offset:2048
 RT a[36:37],v57
 MM v[120:123],a[100:103],a[12:15],v[120:123]
 RT a[38:39],v57 offset:2048
 MM v[212:215],a[104:107],a[8:11],v[212:215]
 RT a[40:41],v58
 MM v[244:247],a[104:107],a[12:15],v[244:247]
 RT a[42:43],v58 offset:2048
 BL v45,s[92:95],s37 offen offset:3072  lds
 MM v[92:95],a[108:111],a[8:11],v[92:95]
 RT a[44:45],v59
 MM v[124:127],a[108:111],a[12:15],v[124:127]
 RT a[46:47],v59 offset:2048
 MM v[216:219],a[112:115],a[8:11],v[216:219]
 RT a[48:49],v52 offset:256
 s_add_u32 m0,s39,135168
 MM v[248:251],a[112:115],a[12:15],v[248:251]
 RT a[50:51],v52 offset:2304
 BL v46,s[92:95],s37 offen  lds
 MM v[96:99],a[116:119],a[8:11],v[96:99]
 RT a[52:53],v53 offset:256
 MM v[128:131],a[116:119],a[12:15],v[128:131]
 RT a[54:55],v53 offset:2304
 MM v[220:223],a[120:123],a[8:11],v[220:223]
 RT a[56:57],v54 offset:256
 RT a[58:59],v54 offset:2304
 MM v[252:255],a[120:123],a[12:15],v[252:255]
 RT a[60:61],v55 offset:256
 BL v47,s[92:95],s37 offen offset:1024  lds
 MM v[100:103],a[124:127],a[8:11],v[100:103]
 RT a[62:63],v55 offset:2304
 MM v[132:135],a[124:127],a[12:15],v[132:135]
 RT a[64:65],v56 offset:256
 MM v[224:227],a[128:131],a[8:11],v[224:227]
 RT a[66:67],v56 offset:2304
 MM v[72:75],a[128:131],a[12:15],v[72:75]
 RT a[68:69],v57 offset:256
 BL v48,s[92:95],s37 offen offset:2048  lds
 MM v[104:107],a[132:135],a[8:11],v[104:107]
 RT a[70:71],v57 offset:2304
 MM a[144:147],a[132:135],a[12:15],a[144:147]
 RT a[72:73],v58 offset:256
 MM v[228:231],a[136:139],a[8:11],v[228:231]
 RT a[74:75],v58 offset:2304
 MM v[76:79],a[136:139],a[12:15],v[76:79]
 RT a[76:77],v59 offset:256
 RT a[78:79],v59 offset:2304
 MM v[108:111],a[140:143],a[8:11],v[108:111]
 BL v49,s[92:95],s37 offen offset:3072  lds
 s_add_u32 s37,s37,524288
 MM a[148:151],a[140:143],a[12:15],a[148:151]
 s_add_u32 s101,s101,4096
 BS v[152:155],v6,s[16:19],s101 offen sc1
 s_waitcnt lgkmcnt(15)
 MM v[200:203],a[16:19],a[0:3],v[200:203]
 RQ a[8:11],v51 offset:49152
 RQ a[12:15],v51 offset:51200
 MM v[232:235],a[16:19],a[4:7],v[232:235]
 RT a[80:81],v52 offset:16384
 MM v[80:83],a[20:23],a[0:3],v[80:83]
 RT a[82:83],v52 offset:18432
 s_add_u32 m0,s38,32768
 MM v[112:115],a[20:23],a[4:7],v[112:115]
 RT a[84:85],v53 offset:16384
 BL v38,s[88:91],s36 offen  lds
 MM v[204:207],a[24:27],a[0:3],v[204:207]
 RT a[86:87],v53 offset:18432
 RT a[88:89],v54 offset:16384
 MM v[236:239],a[24:27],a[4:7],v[236:239]
 RT a[90:91],v54 offset:18432
 MM v[84:87],a[28:31],a[0:3],v[84:87]
 RT a[92:93],v55 offset:16384
 MM v[116:119],a[28:31],a[4:7],v[116:119]
 RT a[94:95],v55 offset:18432
 BL v39,s[88:91],s36 offen offset:1024  lds
 MM v[208:211],a[32:35],a[0:3],v[208:211]
 RT a[96:97],v56 offset:16384
 RT a[98:99],v56 offset:18432
 MM v[240:243],a[32:35],a[4:7],v[240:243]
 RT a[100:101],v57 offset:16384
 MM v[88:91],a[36:39],a[0:3],v[88:91]
 RT a[102:103],v57 offset:18432
 MM v[120:123],a[36:39],a[4:7],v[120:123]
 RT a[104:105],v58 offset:16384
 MM v[212:215],a[40:43],a[0:3],v[212:215]
 RT a[106:107],v58 offset:18432
 RT a[108:109],v59 offset:16384
 MM v[244:247],a[40:43],a[4:7],v[244:247]
 RT a[110:111],v59 offset:18432
 BL v40,s[88:91],s36 offen offset:2048  lds
 MM v[92:95],a[44:47],a[0:3],v[92:95]
 RT a[112:113],v52 offset:16640
 MM v[124:127],a[44:47],a[4:7],v[124:127]
 RT a[114:115],v52 offset:18688
 s_waitcnt lgkmcnt(15)
 MM v[216:219],a[48:51],a[0:3],v[216:219]
 RT a[116:117],v53 offset:16640
 RT a[118:119],v53 offset:18688
 MM v[248:251],a[48:51],a[4:7],v[248:251]
 RT a[120:121],v54 offset:16640
 MM v[96:99],a[52:55],a[0:3],v[96:99]
 RT a[122:123],v54 offset:18688
 BL v41,s[88:91],s36 offen offset:3072  lds
 MM v[128:131],a[52:55],a[4:7],v[128:131]
 RT a[124:125],v55 offset:16640
 s_add_u32 s36,s36,128
 MM v[220:223],a[56:59],a[0:3],v[220:223]
 RT a[126:127],v55 offset:18688
 RT a[128:129],v56 offset:16640
 MM v[252:255],a[56:59],a[4:7],v[252:255]
 RT a[130:131],v56 offset:18688
 MM v[100:103],a[60:63],a[0:3],v[100:103]
 RT a[132:133],v57 offset:16640
 MM v[132:135],a[60:63],a[4:7],v[132:135]
 RT a[134:135],v57 offset:18688
 BS v[156:159],v6,s[16:19],s101 offen offset:1024 sc1
 MM v[224:227],a[64:67],a[0:3],v[224:227]
 RT a[136:137],v58 offset:16640
 RT a[138:139],v58 offset:18688
 MM v[72:75],a[64:67],a[4:7],v[72:75]
 RT a[140:141],v59 offset:16640
 MM v[104:107],a[68:71],a[0:3],v[104:107]
 RT a[142:143],v59 offset:18688
 MM a[144:147],a[68:71],a[4:7],a[144:147]
 BS v[160:163],v6,s[16:19],s101 offen offset:2048 sc1
 MM v[228:231],a[72:75],a[0:3],v[228:231]
 MM v[76:79],a[72:75],a[4:7],v[76:79]
 MM v[108:111],a[76:79],a[0:3],v[108:111]
 MM a[148:151],a[76:79],a[4:7],a[148:151]
 s_waitcnt vmcnt(23)
 s_waitcnt lgkmcnt(0)
 s_barrier
 MM v[200:203],a[80:83],a[8:11],v[200:203]
 RQ a[0:3],v50
 RQ a[4:7],v50 offset:2048
 s_add_u32 m0,s39,65536
 MM v[232:235],a[80:83],a[12:15],v[232:235]
 RT a[16:17],v52 offset:32768
 BL v42,s[92:95],s37 offen  lds
 MM v[80:83],a[84:87],a[8:11],v[80:83]
 RT a[18:19],v52 offset:34816
 MM v[112:115],a[84:87],a[12:15],v[112:115]
 RT a[20:21],v53 offset:32768
 MM v[204:207],a[88:91],a[8:11],v[204:207]
 RT a[22:23],v53 offset:34816
 BL v43,s[92:95],s37 offen offset:1024  lds
 MM v[236:239],a[88:91],a[12:15],v[236:239]
 RT a[24:25],v54 offset:32768
 MM v[84:87],a[92:95],a[8:11],v[84:87]
 RT a[26:27],v54 offset:34816
 MM v[116:119],a[92:95],a[12:15],v[116:119]
 RT a[28:29],v55 offset:32768
 MM v[208:211],a[96:99],a[8:11],v[208:211]
 RT a[30:31],v55 offset:34816
 BL v44,s[92:95],s37 offen offset:2048  lds
 MM v[240:243],a[96:99],a[12:15],v[240:243]
 RT a[32:33],v56 offset:32768
 MM v[88:91],a[100:103],a[8:11],v[88:91]
 RT a[34:35],v56 offset:34816
 RT a[36:37],v57 offset:32768
 MM v[120:123],a[100:103],a[12:15],v[120:123]
 RT a[38:39],v57 offset:34816
 MM v[212:215],a[104:107],a[8:11],v[212:215]
 RT a[40:41],v58 offset:32768
 MM v[244:247],a[104:107],a[12:15],v[244:247]
 RT a[42:43],v58 offset:34816
 BL v45,s[92:95],s37 offen offset:3072  lds
 MM v[92:95],a[108:111],a[8:11],v[92:95]
 RT a[44:45],v59 offset:32768
 MM v[124:127],a[108:111],a[12:15],v[124:127]
 RT a[46:47],v59 offset:34816
 MM v[216:219],a[112:115],a[8:11],v[216:219]
 RT a[48:49],v52 offset:33024
 s_add_u32 m0,s39,69632
 MM v[248:251],a[112:115],a[12:15],v[248:251]
 RT a[50:51],v52 offset:35072
 BL v46,s[92:95],s37 offen  lds
 MM v[96:99],a[116:119],a[8:11],v[96:99]
 RT a[52:53],v53 offset:33024
 MM v[128:131],a[116:119],a[12:15],v[128:131]
 RT a[54:55],v53 offset:35072
 MM v[220:223],a[120:123],a[8:11],v[220:223]
 RT a[56:57],v54 offset:33024
 RT a[58:59],v54 offset:35072
 MM v[252:255],a[120:123],a[12:15],v[252:255]
 RT a[60:61],v55 offset:33024
 BL v47,s[92:95],s37 offen offset:1024  lds
 MM v[100:103],a[124:127],a[8:11],v[100:103]
 RT a[62:63],v55 offset:35072
 MM v[132:135],a[124:127],a[12:15],v[132:135]
 RT a[64:65],v56 offset:33024
 MM v[224:227],a[128:131],a[8:11],v[224:227]
 RT a[66:67],v56 offset:35072
 MM v[72:75],a[128:131],a[12:15],v[72:75]
 RT a[68:69],v57 offset:33024
 BL v48,s[92:95],s37 offen offset:2048  lds
 MM v[104:107],a[132:135],a[8:11],v[104:107]
 RT a[70:71],v57 offset:35072
 MM a[144:147],a[132:135],a[12:15],a[144:147]
 RT a[72:73],v58 offset:33024
 MM v[228:231],a[136:139],a[8:11],v[228:231]
 RT a[74:75],v58 offset:35072
 MM v[76:79],a[136:139],a[12:15],v[76:79]
 RT a[76:77],v59 offset:33024
 RT a[78:79],v59 offset:35072
 MM v[108:111],a[140:143],a[8:11],v[108:111]
 BL v49,s[92:95],s37 offen offset:3072  lds
 s_add_u32 s37,s37,524288
 MM a[148:151],a[140:143],a[12:15],a[148:151]
 BS v[164:167],v6,s[16:19],s101 offen offset:3072 sc1
 s_mov_b32 s27,0
wzq_chk:
 s_waitcnt vmcnt(30)
 v_cmp_le_u32 vcc,32,v71
 s_nop 1
 s_cmp_eq_u64 vcc,-1
 s_cbranch_scc1 wzq_ok
 s_add_u32 s27,s27,1
 s_cmp_ge_u32 s27,400000
 s_cbranch_scc1 wzq_ok
 s_sleep 1
 global_load_dword v71,v70,s[66:67] sc1
 s_waitcnt vmcnt(0)
 s_branch wzq_chk
wzq_ok:
 s_lshl_b32 s26,s73,2
 s_add_u32 s26,s26,s100
 s_cmp_lg_u32 s35,0
 s_cbranch_scc1 kq_ns
 v_mov_b32 v1,0
 v_mov_b32 v2,1
 s_mov_b64 exec,1
 buffer_store_dword v2,v1,s[0:3],s26 offen sc1
 s_mov_b64 exec,-1
kq_ns:
 s_waitcnt lgkmcnt(15)
 MM v[200:203],a[16:19],a[0:3],v[200:203]
 RQ a[8:11],v51
 RQ a[12:15],v51 offset:2048
 MM v[232:235],a[16:19],a[4:7],v[232:235]
 RT a[80:81],v52 offset:49152
 MM v[80:83],a[20:23],a[0:3],v[80:83]
 RT a[82:83],v52 offset:51200
 s_add_u32 m0,s38,49152
 MM v[112:115],a[20:23],a[4:7],v[112:115]
 RT a[84:85],v53 offset:49152
 BL v38,s[88:91],s36 offen  lds
 MM v[204:207],a[24:27],a[0:3],v[204:207]
 RT a[86:87],v53 offset:51200
 RT a[88:89],v54 offset:49152
 MM v[236:239],a[24:27],a[4:7],v[236:239]
 RT a[90:91],v54 offset:51200
 MM v[84:87],a[28:31],a[0:3],v[84:87]
 RT a[92:93],v55 offset:49152
 MM v[116:119],a[28:31],a[4:7],v[116:119]
 RT a[94:95],v55 offset:51200
 BL v39,s[88:91],s36 offen offset:1024  lds
 MM v[208:211],a[32:35],a[0:3],v[208:211]
 RT a[96:97],v56 offset:49152
 RT a[98:99],v56 offset:51200
 MM v[240:243],a[32:35],a[4:7],v[240:243]
 RT a[100:101],v57 offset:49152
 MM v[88:91],a[36:39],a[0:3],v[88:91]
 RT a[102:103],v57 offset:51200
 MM v[120:123],a[36:39],a[4:7],v[120:123]
 RT a[104:105],v58 offset:49152
 MM v[212:215],a[40:43],a[0:3],v[212:215]
 RT a[106:107],v58 offset:51200
 RT a[108:109],v59 offset:49152
 MM v[244:247],a[40:43],a[4:7],v[244:247]
 RT a[110:111],v59 offset:51200
 BL v40,s[88:91],s36 offen offset:2048  lds
 MM v[92:95],a[44:47],a[0:3],v[92:95]
 RT a[112:113],v52 offset:49408
 MM v[124:127],a[44:47],a[4:7],v[124:127]
 RT a[114:115],v52 offset:51456
 s_waitcnt lgkmcnt(15)
 MM v[216:219],a[48:51],a[0:3],v[216:219]
 RT a[116:117],v53 offset:49408
 RT a[118:119],v53 offset:51456
 MM v[248:251],a[48:51],a[4:7],v[248:251]
 RT a[120:121],v54 offset:49408
 MM v[96:99],a[52:55],a[0:3],v[96:99]
 RT a[122:123],v54 offset:51456
 BL v41,s[88:91],s36 offen offset:3072  lds
 MM v[128:131],a[52:55],a[4:7],v[128:131]
 RT a[124:125],v55 offset:49408
 s_add_u32 s36,s36,128
 MM v[220:223],a[56:59],a[0:3],v[220:223]
 RT a[126:127],v55 offset:51456
 RT a[128:129],v56 offset:49408
 MM v[252:255],a[56:59],a[4:7],v[252:255]
 RT a[130:131],v56 offset:51456
 MM v[100:103],a[60:63],a[0:3],v[100:103]
 RT a[132:133],v57 offset:49408
 MM v[132:135],a[60:63],a[4:7],v[132:135]
 RT a[134:135],v57 offset:51456
 MM v[224:227],a[64:67],a[0:3],v[224:227]
 RT a[136:137],v58 offset:49408
 RT a[138:139],v58 offset:51456
 MM v[72:75],a[64:67],a[4:7],v[72:75]
 RT a[140:141],v59 offset:49408
 MM v[104:107],a[68:71],a[0:3],v[104:107]
 RT a[142:143],v59 offset:51456
 MM a[144:147],a[68:71],a[4:7],a[144:147]
 s_add_u32 s101,s101,4096
 BS v[168:171],v6,s[16:19],s101 offen sc1
 MM v[228:231],a[72:75],a[0:3],v[228:231]
 MM v[76:79],a[72:75],a[4:7],v[76:79]
 MM v[108:111],a[76:79],a[0:3],v[108:111]
 MM a[148:151],a[76:79],a[4:7],a[148:151]
 s_waitcnt vmcnt(21)
 s_waitcnt lgkmcnt(0)
 s_barrier
 MM v[200:203],a[80:83],a[8:11],v[200:203]
 RQ a[0:3],v50 offset:16384
 RQ a[4:7],v50 offset:18432
 s_add_u32 m0,s39,98304
 MM v[232:235],a[80:83],a[12:15],v[232:235]
 RT a[16:17],v60
 BL v42,s[92:95],s37 offen  lds
 MM v[80:83],a[84:87],a[8:11],v[80:83]
 RT a[18:19],v60 offset:2048
 MM v[112:115],a[84:87],a[12:15],v[112:115]
 RT a[20:21],v61
 MM v[204:207],a[88:91],a[8:11],v[204:207]
 RT a[22:23],v61 offset:2048
 MM v[236:239],a[88:91],a[12:15],v[236:239]
 RT a[24:25],v62
 MM v[84:87],a[92:95],a[8:11],v[84:87]
 RT a[26:27],v62 offset:2048
 BL v43,s[92:95],s37 offen offset:1024  lds
 MM v[116:119],a[92:95],a[12:15],v[116:119]
 RT a[28:29],v63
 MM v[208:211],a[96:99],a[8:11],v[208:211]
 RT a[30:31],v63 offset:2048
 MM v[240:243],a[96:99],a[12:15],v[240:243]
 RT a[32:33],v64
 MM v[88:91],a[100:103],a[8:11],v[88:91]
 RT a[34:35],v64 offset:2048
 RT a[36:37],v65
 MM v[120:123],a[100:103],a[12:15],v[120:123]
 RT a[38:39],v65 offset:2048
 MM v[212:215],a[104:107],a[8:11],v[212:215]
 RT a[40:41],v66
 MM v[244:247],a[104:107],a[12:15],v[244:247]
 RT a[42:43],v66 offset:2048
 BL v44,s[92:95],s37 offen offset:2048  lds
 MM v[92:95],a[108:111],a[8:11],v[92:95]
 RT a[44:45],v67
 MM v[124:127],a[108:111],a[12:15],v[124:127]
 RT a[46:47],v67 offset:2048
 MM v[216:219],a[112:115],a[8:11],v[216:219]
 RT a[48:49],v60 offset:256
 MM v[248:251],a[112:115],a[12:15],v[248:251]
 RT a[50:51],v60 offset:2304
 MM v[96:99],a[116:119],a[8:11],v[96:99]
 RT a[52:53],v61 offset:256
 BL v45,s[92:95],s37 offen offset:3072  lds
 MM v[128:131],a[116:119],a[12:15],v[128:131]
 RT a[54:55],v61 offset:2304
 MM v[220:223],a[120:123],a[8:11],v[220:223]
 RT a[56:57],v62 offset:256
 RT a[58:59],v62 offset:2304
 MM v[252:255],a[120:123],a[12:15],v[252:255]
 RT a[60:61],v63 offset:256
 MM v[100:103],a[124:127],a[8:11],v[100:103]
 RT a[62:63],v63 offset:2304
 MM v[132:135],a[124:127],a[12:15],v[132:135]
 RT a[64:65],v64 offset:256
 MM v[224:227],a[128:131],a[8:11],v[224:227]
 RT a[66:67],v64 offset:2304
 s_add_u32 m0,s39,102400
 MM v[72:75],a[128:131],a[12:15],v[72:75]
 RT a[68:69],v65 offset:256
 BL v46,s[92:95],s37 offen  lds
 MM v[104:107],a[132:135],a[8:11],v[104:107]
 RT a[70:71],v65 offset:2304
 MM a[144:147],a[132:135],a[12:15],a[144:147]
 RT a[72:73],v66 offset:256
 MM v[228:231],a[136:139],a[8:11],v[228:231]
 RT a[74:75],v66 offset:2304
 MM v[76:79],a[136:139],a[12:15],v[76:79]
 RT a[76:77],v67 offset:256
 RT a[78:79],v67 offset:2304
 MM v[108:111],a[140:143],a[8:11],v[108:111]
 BS v[172:175],v6,s[16:19],s101 offen offset:1024 sc1
 MM a[148:151],a[140:143],a[12:15],a[148:151]
 v_min_u32 v69,27,v0
 v_lshlrev_b32 v69,2,v69
 v_add_u32 v68,s100,v69
 buffer_load_dword v69,v68,s[0:3],0 offen sc1
 s_waitcnt lgkmcnt(15)
 MM v[200:203],a[16:19],a[0:3],v[200:203]
 RQ a[8:11],v51 offset:16384
 RQ a[12:15],v51 offset:18432
 MM v[232:235],a[16:19],a[4:7],v[232:235]
 RT a[80:81],v60 offset:16384
 BL v47,s[92:95],s37 offen offset:1024  lds
 MM v[80:83],a[20:23],a[0:3],v[80:83]
 RT a[82:83],v60 offset:18432
 MM v[112:115],a[20:23],a[4:7],v[112:115]
 RT a[84:85],v61 offset:16384
 MM v[204:207],a[24:27],a[0:3],v[204:207]
 RT a[86:87],v61 offset:18432
 RT a[88:89],v62 offset:16384
 MM v[236:239],a[24:27],a[4:7],v[236:239]
 RT a[90:91],v62 offset:18432
 MM v[84:87],a[28:31],a[0:3],v[84:87]
 RT a[92:93],v63 offset:16384
 MM v[116:119],a[28:31],a[4:7],v[116:119]
 RT a[94:95],v63 offset:18432
 BL v48,s[92:95],s37 offen offset:2048  lds
 MM v[208:211],a[32:35],a[0:3],v[208:211]
 RT a[96:97],v64 offset:16384
 RT a[98:99],v64 offset:18432
 MM v[240:243],a[32:35],a[4:7],v[240:243]
 RT a[100:101],v65 offset:16384
 MM v[88:91],a[36:39],a[0:3],v[88:91]
 RT a[102:103],v65 offset:18432
 MM v[120:123],a[36:39],a[4:7],v[120:123]
 RT a[104:105],v66 offset:16384
 MM v[212:215],a[40:43],a[0:3],v[212:215]
 RT a[106:107],v66 offset:18432
 RT a[108:109],v67 offset:16384
 MM v[244:247],a[40:43],a[4:7],v[244:247]
 RT a[110:111],v67 offset:18432
 MM v[92:95],a[44:47],a[0:3],v[92:95]
 RT a[112:113],v60 offset:16640
 MM v[124:127],a[44:47],a[4:7],v[124:127]
 RT a[114:115],v60 offset:18688
 BL v49,s[92:95],s37 offen offset:3072  lds
 s_waitcnt lgkmcnt(15)
 MM v[216:219],a[48:51],a[0:3],v[216:219]
 RT a[116:117],v61 offset:16640
 RT a[118:119],v61 offset:18688
 s_add_u32 s37,s37,524288
 MM v[248:251],a[48:51],a[4:7],v[248:251]
 RT a[120:121],v62 offset:16640
 MM v[96:99],a[52:55],a[0:3],v[96:99]
 RT a[122:123],v62 offset:18688
 MM v[128:131],a[52:55],a[4:7],v[128:131]
 RT a[124:125],v63 offset:16640
 MM v[220:223],a[56:59],a[0:3],v[220:223]
 RT a[126:127],v63 offset:18688
 RT a[128:129],v64 offset:16640
 MM v[252:255],a[56:59],a[4:7],v[252:255]
 RT a[130:131],v64 offset:18688
 MM v[100:103],a[60:63],a[0:3],v[100:103]
 RT a[132:133],v65 offset:16640
 MM v[132:135],a[60:63],a[4:7],v[132:135]
 RT a[134:135],v65 offset:18688
 BS v[176:179],v6,s[16:19],s101 offen offset:2048 sc1
 MM v[224:227],a[64:67],a[0:3],v[224:227]
 RT a[136:137],v66 offset:16640
 RT a[138:139],v66 offset:18688
 MM v[72:75],a[64:67],a[4:7],v[72:75]
 RT a[140:141],v67 offset:16640
 MM v[104:107],a[68:71],a[0:3],v[104:107]
 RT a[142:143],v67 offset:18688
 MM a[144:147],a[68:71],a[4:7],a[144:147]
 BS v[180:183],v6,s[16:19],s101 offen offset:3072 sc1
 MM v[228:231],a[72:75],a[0:3],v[228:231]
 MM v[76:79],a[72:75],a[4:7],v[76:79]
 MM v[108:111],a[76:79],a[0:3],v[108:111]
 MM a[148:151],a[76:79],a[4:7],a[148:151]
 s_waitcnt vmcnt(18)
 s_waitcnt lgkmcnt(0)
 s_barrier
 MM v[200:203],a[80:83],a[8:11],v[200:203]
 RQ a[0:3],v50 offset:32768
 RQ a[4:7],v50 offset:34816
 MM v[232:235],a[80:83],a[12:15],v[232:235]
 RT a[16:17],v52
 MM v[80:83],a[84:87],a[8:11],v[80:83]
 RT a[18:19],v52 offset:2048
 MM v[112:115],a[84:87],a[12:15],v[112:115]
 RT a[20:21],v53
 MM v[204:207],a[88:91],a[8:11],v[204:207]
 RT a[22:23],v53 offset:2048
 MM v[236:239],a[88:91],a[12:15],v[236:239]
 RT a[24:25],v54
 MM v[84:87],a[92:95],a[8:11],v[84:87]
 RT a[26:27],v54 offset:2048
 MM v[116:119],a[92:95],a[12:15],v[116:119]
 RT a[28:29],v55
 MM v[208:211],a[96:99],a[8:11],v[208:211]
 RT a[30:31],v55 offset:2048
 MM v[240:243],a[96:99],a[12:15],v[240:243]
 RT a[32:33],v56
 MM v[88:91],a[100:103],a[8:11],v[88:91]
 RT a[34:35],v56 offset:2048
 RT a[36:37],v57
 MM v[120:123],a[100:103],a[12:15],v[120:123]
 RT a[38:39],v57 offset:2048
 MM v[212:215],a[104:107],a[8:11],v[212:215]
 RT a[40:41],v58
 MM v[244:247],a[104:107],a[12:15],v[244:247]
 RT a[42:43],v58 offset:2048
 MM v[92:95],a[108:111],a[8:11],v[92:95]
 RT a[44:45],v59
 MM v[124:127],a[108:111],a[12:15],v[124:127]
 RT a[46:47],v59 offset:2048
 MM v[216:219],a[112:115],a[8:11],v[216:219]
 RT a[48:49],v52 offset:256
 MM v[248:251],a[112:115],a[12:15],v[248:251]
 RT a[50:51],v52 offset:2304
 MM v[96:99],a[116:119],a[8:11],v[96:99]
 RT a[52:53],v53 offset:256
 MM v[128:131],a[116:119],a[12:15],v[128:131]
 RT a[54:55],v53 offset:2304
 MM v[220:223],a[120:123],a[8:11],v[220:223]
 RT a[56:57],v54 offset:256
 RT a[58:59],v54 offset:2304
 MM v[252:255],a[120:123],a[12:15],v[252:255]
 RT a[60:61],v55 offset:256
 MM v[100:103],a[124:127],a[8:11],v[100:103]
 RT a[62:63],v55 offset:2304
 MM v[132:135],a[124:127],a[12:15],v[132:135]
 RT a[64:65],v56 offset:256
 MM v[224:227],a[128:131],a[8:11],v[224:227]
 RT a[66:67],v56 offset:2304
 MM v[72:75],a[128:131],a[12:15],v[72:75]
 RT a[68:69],v57 offset:256
 MM v[104:107],a[132:135],a[8:11],v[104:107]
 RT a[70:71],v57 offset:2304
 MM a[144:147],a[132:135],a[12:15],a[144:147]
 RT a[72:73],v58 offset:256
 MM v[228:231],a[136:139],a[8:11],v[228:231]
 RT a[74:75],v58 offset:2304
 MM v[76:79],a[136:139],a[12:15],v[76:79]
 RT a[76:77],v59 offset:256
 RT a[78:79],v59 offset:2304
 MM v[108:111],a[140:143],a[8:11],v[108:111]
 s_add_u32 s101,s101,4096
 BS v[184:187],v6,s[16:19],s101 offen sc1
 MM a[148:151],a[140:143],a[12:15],a[148:151]
 s_mov_b32 s27,0
wkq_chk:
 s_waitcnt vmcnt(6)
 v_cmp_le_u32 vcc,1,v69
 s_nop 1
 s_cmp_eq_u64 vcc,-1
 s_cbranch_scc1 wkq_ok
 s_add_u32 s27,s27,1
 s_cmp_ge_u32 s27,400000
 s_cbranch_scc1 wkq_ok
 s_sleep 1
 buffer_load_dword v69,v68,s[0:3],0 offen sc1
 s_waitcnt vmcnt(0)
 s_branch wkq_chk
wkq_ok:
 s_waitcnt lgkmcnt(15)
 MM v[200:203],a[16:19],a[0:3],v[200:203]
 RQ a[8:11],v51 offset:32768
 RQ a[12:15],v51 offset:34816
 MM v[232:235],a[16:19],a[4:7],v[232:235]
 RT a[80:81],v52 offset:16384
 MM v[80:83],a[20:23],a[0:3],v[80:83]
 RT a[82:83],v52 offset:18432
 MM v[112:115],a[20:23],a[4:7],v[112:115]
 RT a[84:85],v53 offset:16384
 MM v[204:207],a[24:27],a[0:3],v[204:207]
 RT a[86:87],v53 offset:18432
 RT a[88:89],v54 offset:16384
 MM v[236:239],a[24:27],a[4:7],v[236:239]
 RT a[90:91],v54 offset:18432
 MM v[84:87],a[28:31],a[0:3],v[84:87]
 RT a[92:93],v55 offset:16384
 MM v[116:119],a[28:31],a[4:7],v[116:119]
 RT a[94:95],v55 offset:18432
 MM v[208:211],a[32:35],a[0:3],v[208:211]
 RT a[96:97],v56 offset:16384
 RT a[98:99],v56 offset:18432
 MM v[240:243],a[32:35],a[4:7],v[240:243]
 RT a[100:101],v57 offset:16384
 MM v[88:91],a[36:39],a[0:3],v[88:91]
 RT a[102:103],v57 offset:18432
 MM v[120:123],a[36:39],a[4:7],v[120:123]
 RT a[104:105],v58 offset:16384
 MM v[212:215],a[40:43],a[0:3],v[212:215]
 RT a[106:107],v58 offset:18432
 RT a[108:109],v59 offset:16384
 MM v[244:247],a[40:43],a[4:7],v[244:247]
 RT a[110:111],v59 offset:18432
 MM v[92:95],a[44:47],a[0:3],v[92:95]
 RT a[112:113],v52 offset:16640
 MM v[124:127],a[44:47],a[4:7],v[124:127]
 RT a[114:115],v52 offset:18688
 s_waitcnt lgkmcnt(15)
 MM v[216:219],a[48:51],a[0:3],v[216:219]
 RT a[116:117],v53 offset:16640
 RT a[118:119],v53 offset:18688
 MM v[248:251],a[48:51],a[4:7],v[248:251]
 RT a[120:121],v54 offset:16640
 MM v[96:99],a[52:55],a[0:3],v[96:99]
 RT a[122:123],v54 offset:18688
 MM v[128:131],a[52:55],a[4:7],v[128:131]
 RT a[124:125],v55 offset:16640
 MM v[220:223],a[56:59],a[0:3],v[220:223]
 RT a[126:127],v55 offset:18688
 RT a[128:129],v56 offset:16640
 MM v[252:255],a[56:59],a[4:7],v[252:255]
 RT a[130:131],v56 offset:18688
 MM v[100:103],a[60:63],a[0:3],v[100:103]
 RT a[132:133],v57 offset:16640
 MM v[132:135],a[60:63],a[4:7],v[132:135]
 RT a[134:135],v57 offset:18688
 BS v[188:191],v6,s[16:19],s101 offen offset:1024 sc1
 MM v[224:227],a[64:67],a[0:3],v[224:227]
 RT a[136:137],v58 offset:16640
 RT a[138:139],v58 offset:18688
 MM v[72:75],a[64:67],a[4:7],v[72:75]
 RT a[140:141],v59 offset:16640
 MM v[104:107],a[68:71],a[0:3],v[104:107]
 RT a[142:143],v59 offset:18688
 MM a[144:147],a[68:71],a[4:7],a[144:147]
 BS v[192:195],v6,s[16:19],s101 offen offset:2048 sc1
 MM v[228:231],a[72:75],a[0:3],v[228:231]
 MM v[76:79],a[72:75],a[4:7],v[76:79]
 MM v[108:111],a[76:79],a[0:3],v[108:111]
 MM a[148:151],a[76:79],a[4:7],a[148:151]
 s_waitcnt vmcnt(5)
 s_waitcnt lgkmcnt(0)
 s_barrier
 MM v[200:203],a[80:83],a[8:11],v[200:203]
 RQ a[0:3],v50 offset:49152
 RQ a[4:7],v50 offset:51200
 s_mov_b32 s8,s68
 s_mov_b32 s9,s69
 s_mov_b32 s10,16777216
 s_mov_b32 s11,0x20000
 s_add_u32 s12,s68,16777216
 s_addc_u32 s13,s69,0
 s_mov_b32 s14,16777216
 s_mov_b32 s15,0x20000
 s_lshl_b32 s81,s35,13
 v_add_u32 v2,s81,v6
 v_add_u32 v1,4096,v2
 s_mov_b32 s39,131072
 s_mov_b32 s25,163840
 s_mov_b32 s37,0
 s_lshl_b32 s31,s74,20
 s_lshl_b32 s32,s76,15
 s_add_u32 s20,s31,s32
 s_mov_b32 s21,s20
 s_lshl_b32 s32,s77,15
 s_add_u32 s24,s31,s32
 s_add_u32 s22,s39,s81
 s_mov_b32 s23,s22
 s_add_u32 s23,s23,65536
 s_sub_u32 s34,s23,163840
 s_min_u32 s23,s23,s34
 s_cmp_lt_u32 s20,s24
 s_cselect_b32 s10,16777216,0
 s_cselect_b32 m0,s22,196608
 MM v[232:235],a[80:83],a[12:15],v[232:235]
 RT a[16:17],v52 offset:32768
 BL v2,s[8:11],s20 offen sc1 lds
 MM v[80:83],a[84:87],a[8:11],v[80:83]
 RT a[18:19],v52 offset:34816
 MM v[112:115],a[84:87],a[12:15],v[112:115]
 RT a[20:21],v53 offset:32768
 BL v2,s[8:11],s20 offen offset:1024 sc1 lds
 MM v[204:207],a[88:91],a[8:11],v[204:207]
 RT a[22:23],v53 offset:34816
 MM v[236:239],a[88:91],a[12:15],v[236:239]
 RT a[24:25],v54 offset:32768
 MM v[84:87],a[92:95],a[8:11],v[84:87]
 RT a[26:27],v54 offset:34816
 BL v2,s[8:11],s20 offen offset:2048 sc1 lds
 MM v[116:119],a[92:95],a[12:15],v[116:119]
 RT a[28:29],v55 offset:32768
 MM v[208:211],a[96:99],a[8:11],v[208:211]
 RT a[30:31],v55 offset:34816
 MM v[240:243],a[96:99],a[12:15],v[240:243]
 RT a[32:33],v56 offset:32768
 BL v2,s[8:11],s20 offen offset:3072 sc1 lds
 MM v[88:91],a[100:103],a[8:11],v[88:91]
 RT a[34:35],v56 offset:34816
 RT a[36:37],v57 offset:32768
 MM v[120:123],a[100:103],a[12:15],v[120:123]
 RT a[38:39],v57 offset:34816
 MM v[212:215],a[104:107],a[8:11],v[212:215]
 RT a[40:41],v58 offset:32768
 s_add_u32 m0,m0,4096
 MM v[244:247],a[104:107],a[12:15],v[244:247]
 RT a[42:43],v58 offset:34816
 BL v1,s[8:11],s20 offen sc1 lds
 MM v[92:95],a[108:111],a[8:11],v[92:95]
 RT a[44:45],v59 offset:32768
 MM v[124:127],a[108:111],a[12:15],v[124:127]
 RT a[46:47],v59 offset:34816
 MM v[216:219],a[112:115],a[8:11],v[216:219]
 RT a[48:49],v52 offset:33024
 BL v1,s[8:11],s20 offen offset:1024 sc1 lds
 MM v[248:251],a[112:115],a[12:15],v[248:251]
 RT a[50:51],v52 offset:35072
 MM v[96:99],a[116:119],a[8:11],v[96:99]
 RT a[52:53],v53 offset:33024
 BL v1,s[8:11],s20 offen offset:2048 sc1 lds
 MM v[128:131],a[116:119],a[12:15],v[128:131]
 RT a[54:55],v53 offset:35072
 MM v[220:223],a[120:123],a[8:11],v[220:223]
 RT a[56:57],v54 offset:33024
 RT a[58:59],v54 offset:35072
 MM v[252:255],a[120:123],a[12:15],v[252:255]
 RT a[60:61],v55 offset:33024
 MM v[100:103],a[124:127],a[8:11],v[100:103]
 RT a[62:63],v55 offset:35072
 BL v1,s[8:11],s20 offen offset:3072 sc1 lds
 MM v[132:135],a[124:127],a[12:15],v[132:135]
 RT a[64:65],v56 offset:33024
 s_add_u32 s20,s20,32768
 s_add_u32 s22,s22,32768
 s_sub_u32 s34,s22,163840
 s_min_u32 s22,s22,s34
 MM v[224:227],a[128:131],a[8:11],v[224:227]
 RT a[66:67],v56 offset:35072
 s_cmp_lt_u32 s20,s24
 s_cselect_b32 s10,16777216,0
 s_cselect_b32 m0,s22,196608
 MM v[72:75],a[128:131],a[12:15],v[72:75]
 RT a[68:69],v57 offset:33024
 BL v2,s[8:11],s20 offen sc1 lds
 MM v[104:107],a[132:135],a[8:11],v[104:107]
 RT a[70:71],v57 offset:35072
 MM a[144:147],a[132:135],a[12:15],a[144:147]
 RT a[72:73],v58 offset:33024
 MM v[228:231],a[136:139],a[8:11],v[228:231]
 RT a[74:75],v58 offset:35072
 BL v2,s[8:11],s20 offen offset:1024 sc1 lds
 MM v[76:79],a[136:139],a[12:15],v[76:79]
 RT a[76:77],v59 offset:33024
 RT a[78:79],v59 offset:35072
 MM v[108:111],a[140:143],a[8:11],v[108:111]
 BS v[196:199],v6,s[16:19],s101 offen offset:3072 sc1
 MM a[148:151],a[140:143],a[12:15],a[148:151]
 s_waitcnt lgkmcnt(15)
 MM v[200:203],a[16:19],a[0:3],v[200:203]
 RQ a[8:11],v51 offset:49152
 RQ a[12:15],v51 offset:51200
 MM v[232:235],a[16:19],a[4:7],v[232:235]
 RT a[80:81],v52 offset:49152
 BL v2,s[8:11],s20 offen offset:2048 sc1 lds
 MM v[80:83],a[20:23],a[0:3],v[80:83]
 RT a[82:83],v52 offset:51200
 MM v[112:115],a[20:23],a[4:7],v[112:115]
 RT a[84:85],v53 offset:49152
 BL v2,s[8:11],s20 offen offset:3072 sc1 lds
 MM v[204:207],a[24:27],a[0:3],v[204:207]
 RT a[86:87],v53 offset:51200
 RT a[88:89],v54 offset:49152
 MM v[236:239],a[24:27],a[4:7],v[236:239]
 RT a[90:91],v54 offset:51200
 MM v[84:87],a[28:31],a[0:3],v[84:87]
 RT a[92:93],v55 offset:49152
 s_add_u32 m0,m0,4096
 MM v[116:119],a[28:31],a[4:7],v[116:119]
 RT a[94:95],v55 offset:51200
 BL v1,s[8:11],s20 offen sc1 lds
 MM v[208:211],a[32:35],a[0:3],v[208:211]
 RT a[96:97],v56 offset:49152
 RT a[98:99],v56 offset:51200
 MM v[240:243],a[32:35],a[4:7],v[240:243]
 RT a[100:101],v57 offset:49152
 MM v[88:91],a[36:39],a[0:3],v[88:91]
 RT a[102:103],v57 offset:51200
 MM v[120:123],a[36:39],a[4:7],v[120:123]
 RT a[104:105],v58 offset:49152
 BL v1,s[8:11],s20 offen offset:1024 sc1 lds
 MM v[212:215],a[40:43],a[0:3],v[212:215]
 RT a[106:107],v58 offset:51200
 RT a[108:109],v59 offset:49152
 MM v[244:247],a[40:43],a[4:7],v[244:247]
 RT a[110:111],v59 offset:51200
 MM v[92:95],a[44:47],a[0:3],v[92:95]
 RT a[112:113],v52 offset:49408
 MM v[124:127],a[44:47],a[4:7],v[124:127]
 RT a[114:115],v52 offset:51456
 BL v1,s[8:11],s20 offen offset:2048 sc1 lds
 s_waitcnt lgkmcnt(15)
 MM v[216:219],a[48:51],a[0:3],v[216:219]
 RT a[116:117],v53 offset:49408
 RT a[118:119],v53 offset:51456
 MM v[248:251],a[48:51],a[4:7],v[248:251]
 RT a[120:121],v54 offset:49408
 MM v[96:99],a[52:55],a[0:3],v[96:99]
 RT a[122:123],v54 offset:51456
 MM v[128:131],a[52:55],a[4:7],v[128:131]
 RT a[124:125],v55 offset:49408
 BL v1,s[8:11],s20 offen offset:3072 sc1 lds
 MM v[220:223],a[56:59],a[0:3],v[220:223]
 RT a[126:127],v55 offset:51456
 RT a[128:129],v56 offset:49408
 s_add_u32 s20,s20,32768
 s_add_u32 s22,s22,65536
 s_sub_u32 s34,s22,163840
 s_min_u32 s22,s22,s34
 MM v[252:255],a[56:59],a[4:7],v[252:255]
 RT a[130:131],v56 offset:51456
 MM v[100:103],a[60:63],a[0:3],v[100:103]
 RT a[132:133],v57 offset:49408
 MM v[132:135],a[60:63],a[4:7],v[132:135]
 RT a[134:135],v57 offset:51456
 MM v[224:227],a[64:67],a[0:3],v[224:227]
 RT a[136:137],v58 offset:49408
 RT a[138:139],v58 offset:51456
 MM v[72:75],a[64:67],a[4:7],v[72:75]
 RT a[140:141],v59 offset:49408
 MM v[104:107],a[68:71],a[0:3],v[104:107]
 RT a[142:143],v59 offset:51456
 MM a[144:147],a[68:71],a[4:7],a[144:147]
 MM v[228:231],a[72:75],a[0:3],v[228:231]
 MM v[76:79],a[72:75],a[4:7],v[76:79]
 MM v[108:111],a[76:79],a[0:3],v[108:111]
 MM a[148:151],a[76:79],a[4:7],a[148:151]
 s_waitcnt lgkmcnt(0)
 s_barrier
 MM v[200:203],a[80:83],a[8:11],v[200:203]
 s_cmp_lt_u32 s21,s24
 s_cselect_b32 s14,16777216,0
 s_cselect_b32 m0,s23,196608
 MM v[232:235],a[80:83],a[12:15],v[232:235]
 BL v2,s[12:15],s21 offen sc1 lds
 MM v[80:83],a[84:87],a[8:11],v[80:83]
 MM v[112:115],a[84:87],a[12:15],v[112:115]
 MM v[204:207],a[88:91],a[8:11],v[204:207]
 MM v[236:239],a[88:91],a[12:15],v[236:239]
 MM v[84:87],a[92:95],a[8:11],v[84:87]
 BL v2,s[12:15],s21 offen offset:1024 sc1 lds
 MM v[116:119],a[92:95],a[12:15],v[116:119]
 MM v[208:211],a[96:99],a[8:11],v[208:211]
 MM v[240:243],a[96:99],a[12:15],v[240:243]
 MM v[88:91],a[100:103],a[8:11],v[88:91]
 MM v[120:123],a[100:103],a[12:15],v[120:123]
 MM v[212:215],a[104:107],a[8:11],v[212:215]
 MM v[244:247],a[104:107],a[12:15],v[244:247]
 BL v2,s[12:15],s21 offen offset:2048 sc1 lds
 MM v[92:95],a[108:111],a[8:11],v[92:95]
 MM v[124:127],a[108:111],a[12:15],v[124:127]
 MM v[216:219],a[112:115],a[8:11],v[216:219]
 MM v[248:251],a[112:115],a[12:15],v[248:251]
 MM v[96:99],a[116:119],a[8:11],v[96:99]
 BL v2,s[12:15],s21 offen offset:3072 sc1 lds
 MM v[128:131],a[116:119],a[12:15],v[128:131]
 MM v[220:223],a[120:123],a[8:11],v[220:223]
 MM v[252:255],a[120:123],a[12:15],v[252:255]
 MM v[100:103],a[124:127],a[8:11],v[100:103]
 MM v[132:135],a[124:127],a[12:15],v[132:135]
 MM v[224:227],a[128:131],a[8:11],v[224:227]
 s_add_u32 m0,m0,4096
 MM v[72:75],a[128:131],a[12:15],v[72:75]
 BL v1,s[12:15],s21 offen sc1 lds
 MM v[104:107],a[132:135],a[8:11],v[104:107]
 MM a[144:147],a[132:135],a[12:15],a[144:147]
 MM v[228:231],a[136:139],a[8:11],v[228:231]
 MM v[76:79],a[136:139],a[12:15],v[76:79]
 MM v[108:111],a[140:143],a[8:11],v[108:111]
 MM a[148:151],a[140:143],a[12:15],a[148:151]
 BL v1,s[12:15],s21 offen offset:1024 sc1 lds
 BL v1,s[12:15],s21 offen offset:2048 sc1 lds
 BL v1,s[12:15],s21 offen offset:3072 sc1 lds
 s_add_u32 s21,s21,32768
 s_add_u32 s23,s23,65536
 s_sub_u32 s34,s23,163840
 s_min_u32 s23,s23,s34
 s_add_u32 s16,s68,33554432
 s_addc_u32 s17,s69,0
 s_mov_b32 s18,16777216
 s_mov_b32 s19,0x20000
 s_lshl_b32 s101,s86,2
 s_add_u32 s101,s101,s35
 s_lshl_b32 s101,s101,14
 s_lshl_b32 s26,s74,20
 s_add_u32 s101,s101,s26
 s_cmp_eq_u32 s78,2
 s_cselect_b32 s18,s18,0
 v_mov_b32 v4,0x3db8aa3b
 PM v[200:201],v[200:201],v[4:5] op_sel_hi:[1,0]
 PM v[202:203],v[202:203],v[4:5] op_sel_hi:[1,0]
 PM v[80:81],v[80:81],v[4:5] op_sel_hi:[1,0]
 PM v[82:83],v[82:83],v[4:5] op_sel_hi:[1,0]
 CV v200,v200,v201
 CV v201,v202,v203
 CV v202,v80,v81
 CV v203,v82,v83
 BS v[200:203],v6,s[16:19],s101 offen sc1
 PM v[204:205],v[204:205],v[4:5] op_sel_hi:[1,0]
 PM v[206:207],v[206:207],v[4:5] op_sel_hi:[1,0]
 PM v[84:85],v[84:85],v[4:5] op_sel_hi:[1,0]
 PM v[86:87],v[86:87],v[4:5] op_sel_hi:[1,0]
 CV v204,v204,v205
 CV v205,v206,v207
 CV v206,v84,v85
 CV v207,v86,v87
 BS v[204:207],v6,s[16:19],s101 offen offset:1024 sc1
 PM v[208:209],v[208:209],v[4:5] op_sel_hi:[1,0]
 PM v[210:211],v[210:211],v[4:5] op_sel_hi:[1,0]
 PM v[88:89],v[88:89],v[4:5] op_sel_hi:[1,0]
 PM v[90:91],v[90:91],v[4:5] op_sel_hi:[1,0]
 CV v208,v208,v209
 CV v209,v210,v211
 CV v210,v88,v89
 CV v211,v90,v91
 BS v[208:211],v6,s[16:19],s101 offen offset:2048 sc1
 PM v[212:213],v[212:213],v[4:5] op_sel_hi:[1,0]
 PM v[214:215],v[214:215],v[4:5] op_sel_hi:[1,0]
 PM v[92:93],v[92:93],v[4:5] op_sel_hi:[1,0]
 PM v[94:95],v[94:95],v[4:5] op_sel_hi:[1,0]
 CV v212,v212,v213
 CV v213,v214,v215
 CV v214,v92,v93
 CV v215,v94,v95
 BS v[212:215],v6,s[16:19],s101 offen offset:3072 sc1
 PM v[216:217],v[216:217],v[4:5] op_sel_hi:[1,0]
 PM v[218:219],v[218:219],v[4:5] op_sel_hi:[1,0]
 PM v[96:97],v[96:97],v[4:5] op_sel_hi:[1,0]
 PM v[98:99],v[98:99],v[4:5] op_sel_hi:[1,0]
 CV v216,v216,v217
 CV v217,v218,v219
 CV v218,v96,v97
 CV v219,v98,v99
 s_add_u32 s101,s101,4096
 BS v[216:219],v6,s[16:19],s101 offen sc1
 PM v[220:221],v[220:221],v[4:5] op_sel_hi:[1,0]
 PM v[222:223],v[222:223],v[4:5] op_sel_hi:[1,0]
 PM v[100:101],v[100:101],v[4:5] op_sel_hi:[1,0]
 PM v[102:103],v[102:103],v[4:5] op_sel_hi:[1,0]
 CV v220,v220,v221
 CV v221,v222,v223
 CV v222,v100,v101
 CV v223,v102,v103
 BS v[220:223],v6,s[16:19],s101 offen offset:1024 sc1
 PM v[224:225],v[224:225],v[4:5] op_sel_hi:[1,0]
 PM v[226:227],v[226:227],v[4:5] op_sel_hi:[1,0]
 PM v[104:105],v[104:105],v[4:5] op_sel_hi:[1,0]
 PM v[106:107],v[106:107],v[4:5] op_sel_hi:[1,0]
 CV v224,v224,v225
 CV v225,v226,v227
 CV v226,v104,v105
 CV v227,v106,v107
 BS v[224:227],v6,s[16:19],s101 offen offset:2048 sc1
 PM v[228:229],v[228:229],v[4:5] op_sel_hi:[1,0]
 PM v[230:231],v[230:231],v[4:5] op_sel_hi:[1,0]
 PM v[108:109],v[108:109],v[4:5] op_sel_hi:[1,0]
 PM v[110:111],v[110:111],v[4:5] op_sel_hi:[1,0]
 CV v228,v228,v229
 CV v229,v230,v231
 CV v230,v108,v109
 CV v231,v110,v111
 BS v[228:231],v6,s[16:19],s101 offen offset:3072 sc1
 PM v[232:233],v[232:233],v[4:5] op_sel_hi:[1,0]
 PM v[234:235],v[234:235],v[4:5] op_sel_hi:[1,0]
 PM v[112:113],v[112:113],v[4:5] op_sel_hi:[1,0]
 PM v[114:115],v[114:115],v[4:5] op_sel_hi:[1,0]
 CV v232,v232,v233
 CV v233,v234,v235
 CV v234,v112,v113
 CV v235,v114,v115
 s_add_u32 s101,s101,4096
 BS v[232:235],v6,s[16:19],s101 offen sc1
 PM v[236:237],v[236:237],v[4:5] op_sel_hi:[1,0]
 PM v[238:239],v[238:239],v[4:5] op_sel_hi:[1,0]
 PM v[116:117],v[116:117],v[4:5] op_sel_hi:[1,0]
 PM v[118:119],v[118:119],v[4:5] op_sel_hi:[1,0]
 CV v236,v236,v237
 CV v237,v238,v239
 CV v238,v116,v117
 CV v239,v118,v119
 BS v[236:239],v6,s[16:19],s101 offen offset:1024 sc1
 PM v[240:241],v[240:241],v[4:5] op_sel_hi:[1,0]
 PM v[242:243],v[242:243],v[4:5] op_sel_hi:[1,0]
 PM v[120:121],v[120:121],v[4:5] op_sel_hi:[1,0]
 PM v[122:123],v[122:123],v[4:5] op_sel_hi:[1,0]
 CV v240,v240,v241
 CV v241,v242,v243
 CV v242,v120,v121
 CV v243,v122,v123
 BS v[240:243],v6,s[16:19],s101 offen offset:2048 sc1
 PM v[244:245],v[244:245],v[4:5] op_sel_hi:[1,0]
 PM v[246:247],v[246:247],v[4:5] op_sel_hi:[1,0]
 PM v[124:125],v[124:125],v[4:5] op_sel_hi:[1,0]
 PM v[126:127],v[126:127],v[4:5] op_sel_hi:[1,0]
 CV v244,v244,v245
 CV v245,v246,v247
 CV v246,v124,v125
 CV v247,v126,v127
 BS v[244:247],v6,s[16:19],s101 offen offset:3072 sc1
 PM v[248:249],v[248:249],v[4:5] op_sel_hi:[1,0]
 PM v[250:251],v[250:251],v[4:5] op_sel_hi:[1,0]
 PM v[128:129],v[128:129],v[4:5] op_sel_hi:[1,0]
 PM v[130:131],v[130:131],v[4:5] op_sel_hi:[1,0]
 CV v248,v248,v249
 CV v249,v250,v251
 CV v250,v128,v129
 CV v251,v130,v131
 s_add_u32 s101,s101,4096
 BS v[248:251],v6,s[16:19],s101 offen sc1
 PM v[252:253],v[252:253],v[4:5] op_sel_hi:[1,0]
 PM v[254:255],v[254:255],v[4:5] op_sel_hi:[1,0]
 PM v[132:133],v[132:133],v[4:5] op_sel_hi:[1,0]
 PM v[134:135],v[134:135],v[4:5] op_sel_hi:[1,0]
 CV v252,v252,v253
 CV v253,v254,v255
 CV v254,v132,v133
 CV v255,v134,v135
 BS v[252:255],v6,s[16:19],s101 offen offset:1024 sc1
 AR v8,a144
 AR v9,a145
 AR v10,a146
 AR v11,a147
 PM v[72:73],v[72:73],v[4:5] op_sel_hi:[1,0]
 PM v[74:75],v[74:75],v[4:5] op_sel_hi:[1,0]
 PM v[8:9],v[8:9],v[4:5] op_sel_hi:[1,0]
 PM v[10:11],v[10:11],v[4:5] op_sel_hi:[1,0]
 CV v72,v72,v73
 CV v73,v74,v75
 CV v74,v8,v9
 CV v75,v10,v11
 BS v[72:75],v6,s[16:19],s101 offen offset:2048 sc1
 AR v8,a148
 AR v9,a149
 AR v10,a150
 AR v11,a151
 PM v[76:77],v[76:77],v[4:5] op_sel_hi:[1,0]
 PM v[78:79],v[78:79],v[4:5] op_sel_hi:[1,0]
 PM v[8:9],v[8:9],v[4:5] op_sel_hi:[1,0]
 PM v[10:11],v[10:11],v[4:5] op_sel_hi:[1,0]
 CV v76,v76,v77
 CV v77,v78,v79
 CV v78,v8,v9
 CV v79,v10,v11
 BS v[76:79],v6,s[16:19],s101 offen offset:3072 sc1
 s_lshl_b32 s37,s74,4
 s_add_u32 s37,s37,s97
 s_lshl_b32 s37,s37,2
 s_add_u32 s37,s37,s35
 s_lshl_b32 s37,s37,2
 s_add_u32 s37,s37,8704
 AW a128,v200
 AW a129,v201
 AW a130,v202
 AW a131,v203
 AW a132,v204
 AW a133,v205
 AW a134,v206
 AW a135,v207
 AW a136,v208
 AW a137,v209
 AW a138,v210
 AW a139,v211
 AW a140,v212
 AW a141,v213
 AW a142,v214
 AW a143,v215
 AW a144,v216
 AW a145,v217
 AW a146,v218
 AW a147,v219
 AW a148,v220
 AW a149,v221
 AW a150,v222
 AW a151,v223
 AW a152,v224
 AW a153,v225
 AW a154,v226
 AW a155,v227
 AW a156,v228
 AW a157,v229
 AW a158,v230
 AW a159,v231
 AW a160,v232
 AW a161,v233
 AW a162,v234
 AW a163,v235
 AW a164,v236
 AW a165,v237
 AW a166,v238
 AW a167,v239
 AW a168,v240
 AW a169,v241
 AW a170,v242
 AW a171,v243
 AW a172,v244
 AW a173,v245
 AW a174,v246
 AW a175,v247
 AW a176,v248
 AW a177,v249
 AW a178,v250
 AW a179,v251
 AW a180,v252
 AW a181,v253
 AW a182,v254
 AW a183,v255
 AW a184,v72
 AW a185,v73
 AW a186,v74
 AW a187,v75
 AW a188,v76
 AW a189,v77
 AW a190,v78
 AW a191,v79
 s_waitcnt vmcnt(33)
 s_branch L_seg
L_roleZ:
 s_lshr_b32 s101,s100,5
 s_and_b32 s6,s73,3
 s_add_u32 s101,s101,s6
 s_cmp_lg_u32 s52,224
 s_cbranch_scc1 L_noclr
 s_lshl_b32 s26,s35,12
 v_mov_b32 v72,0
 v_mov_b32 v73,0
 v_mov_b32 v74,0
 v_mov_b32 v75,0
 BS v[72:75],v6,s[0:3],s26 offen sc1
 BS v[72:75],v6,s[0:3],s26 offen offset:1024 sc1
 BS v[72:75],v6,s[0:3],s26 offen offset:2048 sc1
 BS v[72:75],v6,s[0:3],s26 offen offset:3072 sc1
L_noclr:
 s_mov_b32 s92,s54
 s_mov_b32 s93,s55
 s_mov_b32 s94,1605632
 s_mov_b32 s95,0x20000
 s_mov_b32 s37,1792
 v_lshrrev_b32 v1,4,v0
 v_and_b32 v2,15,v0
 v_bfe_u32 v3,v1,0,1
 v_lshlrev_b32 v3,1,v3
 v_xor_b32 v2,v2,v3
 v_bfe_u32 v3,v1,1,1
 v_lshlrev_b32 v3,2,v3
 v_xor_b32 v2,v2,v3
 v_lshlrev_b32 v2,4,v2
 s_mul_i32 s26,s35,57344
 v_mul_u32_u24 v1,3584,v1
 v_add_u32 v1,s26,v1
 v_add_u32 v40,v2,v1
 v_add_u32 v41,13312,v40
 v_xor_b32 v3,128,v2
 v_add_u32 v42,v3,v1
 v_add_u32 v42,26624,v42
 v_add_u32 v43,13312,v42
 s_mul_i32 s39,s35,4096
 s_add_u32 m0,s39,0
 s_nop 0
 BL v40,s[92:95],s37 offen  lds
 BL v41,s[92:95],s37 offen offset:1024  lds
 BL v42,s[92:95],s37 offen offset:2048  lds
 BL v43,s[92:95],s37 offen offset:3072  lds
 s_add_u32 s37,s37,229376
 s_mov_b32 s88,s40
 s_mov_b32 s89,s41
 s_mov_b32 s90,1835008
 s_mov_b32 s91,0x20000
 s_mul_i32 s36,s101,57344
 v_lshrrev_b32 v1,3,v0
 s_mul_i32 s26,s35,14336
 v_mul_u32_u24 v1,896,v1
 v_lshrrev_b32 v2,4,v0
 v_xor_b32 v2,v2,v0
 v_and_b32 v2,7,v2
 v_lshl_add_u32 v1,v2,4,v1
 v_add_u32 v38,s26,v1
 v_xor_b32 v2,64,v38
 v_add_u32 v39,6144,v2
 s_mul_i32 s38,s35,2048
 s_add_u32 m0,s38,106496
 s_nop 0
 BL v38,s[88:91],s36 offen  lds
 BL v39,s[88:91],s36 offen offset:1024  lds
 s_add_u32 s36,s36,128
 s_add_u32 m0,s38,114688
 s_nop 0
 BL v38,s[88:91],s36 offen  lds
 BL v39,s[88:91],s36 offen offset:1024  lds
 s_add_u32 s36,s36,128
 s_add_u32 m0,s38,122880
 s_nop 0
 BL v38,s[88:91],s36 offen  lds
 BL v39,s[88:91],s36 offen offset:1024  lds
 s_add_u32 s36,s36,128
 s_add_u32 m0,s38,131072
 s_nop 0
 BL v38,s[88:91],s36 offen  lds
 BL v39,s[88:91],s36 offen offset:1024  lds
 s_add_u32 s36,s36,128
 s_add_u32 m0,s38,139264
 s_nop 0
 BL v38,s[88:91],s36 offen  lds
 BL v39,s[88:91],s36 offen offset:1024  lds
 s_add_u32 s36,s36,128
 s_add_u32 m0,s38,147456
 s_nop 0
 BL v38,s[88:91],s36 offen  lds
 BL v39,s[88:91],s36 offen offset:1024  lds
 s_add_u32 s36,s36,128
 s_add_u32 m0,s38,155648
 s_nop 0
 BL v38,s[88:91],s36 offen  lds
 BL v39,s[88:91],s36 offen offset:1024  lds
 s_add_u32 s36,s36,128
 s_add_u32 m0,s39,16384
 s_nop 0
 BL v40,s[92:95],s37 offen  lds
 BL v41,s[92:95],s37 offen offset:1024  lds
 BL v42,s[92:95],s37 offen offset:2048  lds
 BL v43,s[92:95],s37 offen offset:3072  lds
 s_add_u32 s37,s37,229376
 s_add_u32 m0,s39,32768
 s_nop 0
 BL v40,s[92:95],s37 offen  lds
 BL v41,s[92:95],s37 offen offset:1024  lds
 BL v42,s[92:95],s37 offen offset:2048  lds
 BL v43,s[92:95],s37 offen offset:3072  lds
 s_add_u32 s37,s37,229376
 s_add_u32 m0,s39,49152
 s_nop 0
 BL v40,s[92:95],s37 offen  lds
 BL v41,s[92:95],s37 offen offset:1024  lds
 BL v42,s[92:95],s37 offen offset:2048  lds
 BL v43,s[92:95],s37 offen offset:3072  lds
 s_add_u32 s37,s37,229376
 s_add_u32 m0,s39,65536
 s_nop 0
 BL v40,s[92:95],s37 offen  lds
 BL v41,s[92:95],s37 offen offset:1024  lds
 BL v42,s[92:95],s37 offen offset:2048  lds
 BL v43,s[92:95],s37 offen offset:3072  lds
 s_add_u32 s37,s37,229376
 s_add_u32 m0,s39,81920
 s_nop 0
 BL v40,s[92:95],s37 offen  lds
 BL v41,s[92:95],s37 offen offset:1024  lds
 BL v42,s[92:95],s37 offen offset:2048  lds
 BL v43,s[92:95],s37 offen offset:3072  lds
 s_add_u32 s37,s37,229376
 s_mov_b32 s4,s54
 s_mov_b32 s5,s55
 s_mov_b32 s6,1605632
 s_mov_b32 s7,0x20000
 s_lshl_b32 s87,s52,2
 s_add_u32 s87,s87,s35
 s_lshl_b32 s87,s87,10
 BL v[68:71],v6,s[4:7],s87 offen
 s_add_u32 s87,s87,1048576
 BL v[68:71],v6,s[4:7],s87 offen
 s_add_u32 s87,s87,1048576
 s_mov_b32 s26,0
 v_and_b32 v1,15,v0
 s_mul_i32 s26,s26,8192
 s_add_u32 s26,s26,106496
 v_lshl_add_u32 v1,v1,7,s26
 v_lshrrev_b32 v2,4,v0
 v_bfe_u32 v3,v0,1,3
 v_xor_b32 v2,v2,v3
 v_lshl_add_u32 v44,v2,4,v1
 v_xor_b32 v45,64,v44
 v_bfe_u32 v1,v0,2,2
 v_lshrrev_b32 v2,4,v0
 v_lshl_add_u32 v2,v2,3,v1
 v_bfe_u32 v4,v2,0,1
 v_bfe_u32 v5,v2,1,1
 v_lshl_or_b32 v4,v5,1,v4
 v_bfe_u32 v5,v2,3,1
 v_lshl_or_b32 v4,v5,2,v4
 v_mul_u32_u24 v2,256,v2
 v_and_b32 v3,3,v0
 v_lshl_add_u32 v2,v3,3,v2
 v_add_u32 v2,0,v2
 s_mov_b32 s26,s35
 s_mul_i32 s26,s26,2
 v_xor_b32 v4,s26,v4
 v_xor_b32 v3,0,v4
 v_lshl_add_u32 v46,v3,5,v2
 v_xor_b32 v3,1,v4
 v_lshl_add_u32 v47,v3,5,v2
 v_add_u32 v50,131072,v46
 v_add_u32 v51,131072,v47
 v_add_u32 v48,65536,v46
 v_add_u32 v49,65536,v47
 v_mov_b32 v58,0xc0135761
 v_mov_b32 v59,0xc0135761
 v_mov_b32 v60,0xbdd2d3e8
 v_mov_b32 v61,0xbdd2d3e8
 v_mov_b32 v224,0
 v_mov_b32 v225,0
 v_mov_b32 v226,0
 v_mov_b32 v227,0
 v_mov_b32 v228,0
 v_mov_b32 v229,0
 v_mov_b32 v230,0
 v_mov_b32 v231,0
 v_mov_b32 v232,0
 v_mov_b32 v233,0
 v_mov_b32 v234,0
 v_mov_b32 v235,0
 v_mov_b32 v236,0
 v_mov_b32 v237,0
 v_mov_b32 v238,0
 v_mov_b32 v239,0
 v_mov_b32 v240,0
 v_mov_b32 v241,0
 v_mov_b32 v242,0
 v_mov_b32 v243,0
 v_mov_b32 v244,0
 v_mov_b32 v245,0
 v_mov_b32 v246,0
 v_mov_b32 v247,0
 v_mov_b32 v248,0
 v_mov_b32 v249,0
 v_mov_b32 v250,0
 v_mov_b32 v251,0
 v_mov_b32 v252,0
 v_mov_b32 v253,0
 v_mov_b32 v254,0
 v_mov_b32 v255,0
 s_waitcnt vmcnt(22)
 s_barrier
 RT a[0:1],v46
 RT a[2:3],v46 offset:1024
 RT a[4:5],v47
 RT a[6:7],v47 offset:1024
 RT a[8:9],v46 offset:8192
 RT a[10:11],v46 offset:9216
 RT a[12:13],v47 offset:8192
 RT a[14:15],v47 offset:9216
 RQ a[32:35],v44
 RQ a[88:91],v44 offset:2048
 RQ a[144:147],v44 offset:4096
 RQ a[200:203],v44 offset:6144
 RQ a[36:39],v45
 RQ a[92:95],v45 offset:2048
 RQ a[148:151],v45 offset:4096
 RQ a[204:207],v45 offset:6144
 RQ a[40:43],v44 offset:8192
 RQ a[96:99],v44 offset:10240
 RQ a[152:155],v44 offset:12288
 RQ a[208:211],v44 offset:14336
 RQ a[44:47],v45 offset:8192
 RQ a[100:103],v45 offset:10240
 RQ a[156:159],v45 offset:12288
 RQ a[212:215],v45 offset:14336
 RQ a[48:51],v44 offset:16384
 RQ a[104:107],v44 offset:18432
 RQ a[160:163],v44 offset:20480
 RQ a[216:219],v44 offset:22528
 RQ a[52:55],v45 offset:16384
 RQ a[108:111],v45 offset:18432
 RQ a[164:167],v45 offset:20480
 RQ a[220:223],v45 offset:22528
 RQ a[56:59],v44 offset:24576
 RQ a[112:115],v44 offset:26624
 RQ a[168:171],v44 offset:28672
 RQ a[224:227],v44 offset:30720
 RQ a[60:63],v45 offset:24576
 RQ a[116:119],v45 offset:26624
 RQ a[172:175],v45 offset:28672
 RQ a[228:231],v45 offset:30720
 RQ a[64:67],v44 offset:32768
 RQ a[120:123],v44 offset:34816
 RQ a[176:179],v44 offset:36864
 RQ a[232:235],v44 offset:38912
 RQ a[68:71],v45 offset:32768
 RQ a[124:127],v45 offset:34816
 RQ a[180:183],v45 offset:36864
 RQ a[236:239],v45 offset:38912
 RQ a[72:75],v44 offset:40960
 RQ a[128:131],v44 offset:43008
 RQ a[184:187],v44 offset:45056
 RQ a[240:243],v44 offset:47104
 RQ a[76:79],v45 offset:40960
 RQ a[132:135],v45 offset:43008
 RQ a[188:191],v45 offset:45056
 RQ a[244:247],v45 offset:47104
 RQ a[80:83],v44 offset:49152
 RQ a[136:139],v44 offset:51200
 RQ a[192:195],v44 offset:53248
 RQ a[248:251],v44 offset:55296
 RQ a[84:87],v45 offset:49152
 RQ a[140:143],v45 offset:51200
 RQ a[196:199],v45 offset:53248
 RQ a[252:255],v45 offset:55296
 s_waitcnt vmcnt(18)
 s_waitcnt lgkmcnt(0)
 s_barrier
 MM v[72:75],a[32:35],a[0:3],0
 RT a[16:17],v46 offset:16384
 s_add_u32 m0,s39,98304
 s_nop 0
 BL v40,s[92:95],s37 offen  lds
 BL v41,s[92:95],s37 offen offset:1024  lds
 MM v[76:79],a[32:35],a[4:7],0
 RT a[18:19],v46 offset:17408
 BL v42,s[92:95],s37 offen offset:2048  lds
 MM v[80:83],a[88:91],a[0:3],0
 RT a[20:21],v47 offset:16384
 BL v43,s[92:95],s37 offen offset:3072  lds
 s_add_u32 s37,s37,4293591296
 s_add_u32 m0,s39,114688
 MM v[84:87],a[88:91],a[4:7],0
 RT a[22:23],v47 offset:17408
 BL v40,s[92:95],s37 offen  lds
 BL v41,s[92:95],s37 offen offset:1024  lds
 MM v[88:91],a[144:147],a[0:3],0
 RT a[24:25],v46 offset:24576
 BL v42,s[92:95],s37 offen offset:2048  lds
 MM v[92:95],a[144:147],a[4:7],0
 RT a[26:27],v46 offset:25600
 BL v43,s[92:95],s37 offen offset:3072  lds
 s_add_u32 s37,s37,229376
 s_add_u32 m0,s39,131072
 MM v[96:99],a[200:203],a[0:3],0
 RT a[28:29],v47 offset:24576
 BL v40,s[92:95],s37 offen  lds
 BL v41,s[92:95],s37 offen offset:1024  lds
 MM v[100:103],a[200:203],a[4:7],0
 RT a[30:31],v47 offset:25600
 BL v42,s[92:95],s37 offen offset:2048  lds
 MM v[72:75],a[36:39],a[8:11],v[72:75]
 BL v43,s[92:95],s37 offen offset:3072  lds
 s_add_u32 s37,s37,229376
 s_add_u32 m0,s39,147456
 MM v[76:79],a[36:39],a[12:15],v[76:79]
 BL v40,s[92:95],s37 offen  lds
 BL v41,s[92:95],s37 offen offset:1024  lds
 MM v[80:83],a[92:95],a[8:11],v[80:83]
 BL v42,s[92:95],s37 offen offset:2048  lds
 MM v[84:87],a[92:95],a[12:15],v[84:87]
 BL v43,s[92:95],s37 offen offset:3072  lds
 s_add_u32 s37,s37,229376
 s_add_u32 m0,s39,0
 MM v[88:91],a[148:151],a[8:11],v[88:91]
 BL v40,s[92:95],s37 offen  lds
 BL v41,s[92:95],s37 offen offset:1024  lds
 MM v[92:95],a[148:151],a[12:15],v[92:95]
 BL v42,s[92:95],s37 offen offset:2048  lds
 MM v[96:99],a[204:207],a[8:11],v[96:99]
 BL v43,s[92:95],s37 offen offset:3072  lds
 s_add_u32 s37,s37,229376
 MM v[100:103],a[204:207],a[12:15],v[100:103]
 s_waitcnt vmcnt(34)
 s_waitcnt lgkmcnt(0)
 s_barrier
 MM v[72:75],a[40:43],a[16:19],v[72:75]
 RT a[0:1],v46 offset:32768
 MM v[76:79],a[40:43],a[20:23],v[76:79]
 RT a[2:3],v46 offset:33792
 MM v[80:83],a[96:99],a[16:19],v[80:83]
 RT a[4:5],v47 offset:32768
 MM v[84:87],a[96:99],a[20:23],v[84:87]
 RT a[6:7],v47 offset:33792
 MM v[88:91],a[152:155],a[16:19],v[88:91]
 RT a[8:9],v46 offset:40960
 MM v[92:95],a[152:155],a[20:23],v[92:95]
 RT a[10:11],v46 offset:41984
 MM v[96:99],a[208:211],a[16:19],v[96:99]
 RT a[12:13],v47 offset:40960
 MM v[100:103],a[208:211],a[20:23],v[100:103]
 RT a[14:15],v47 offset:41984
 s_add_u32 m0,s39,16384
 MM v[72:75],a[44:47],a[24:27],v[72:75]
 BL v40,s[92:95],s37 offen  lds
 MM v[76:79],a[44:47],a[28:31],v[76:79]
 BL v41,s[92:95],s37 offen offset:1024  lds
 MM v[80:83],a[100:103],a[24:27],v[80:83]
 MM v[84:87],a[100:103],a[28:31],v[84:87]
 BL v42,s[92:95],s37 offen offset:2048  lds
 MM v[88:91],a[156:159],a[24:27],v[88:91]
 MM v[92:95],a[156:159],a[28:31],v[92:95]
 BL v43,s[92:95],s37 offen offset:3072  lds
 MM v[96:99],a[212:215],a[24:27],v[96:99]
 s_add_u32 s37,s37,229376
 MM v[100:103],a[212:215],a[28:31],v[100:103]
 s_waitcnt vmcnt(34)
 s_waitcnt lgkmcnt(0)
 s_barrier
 MM v[72:75],a[48:51],a[0:3],v[72:75]
 RT a[16:17],v46 offset:49152
 MM v[76:79],a[48:51],a[4:7],v[76:79]
 RT a[18:19],v46 offset:50176
 MM v[80:83],a[104:107],a[0:3],v[80:83]
 RT a[20:21],v47 offset:49152
 MM v[84:87],a[104:107],a[4:7],v[84:87]
 RT a[22:23],v47 offset:50176
 MM v[88:91],a[160:163],a[0:3],v[88:91]
 RT a[24:25],v46 offset:57344
 MM v[92:95],a[160:163],a[4:7],v[92:95]
 RT a[26:27],v46 offset:58368
 MM v[96:99],a[216:219],a[0:3],v[96:99]
 RT a[28:29],v47 offset:57344
 MM v[100:103],a[216:219],a[4:7],v[100:103]
 RT a[30:31],v47 offset:58368
 s_add_u32 m0,s39,32768
 MM v[72:75],a[52:55],a[8:11],v[72:75]
 BL v40,s[92:95],s37 offen  lds
 MM v[76:79],a[52:55],a[12:15],v[76:79]
 BL v41,s[92:95],s37 offen offset:1024  lds
 MM v[80:83],a[108:111],a[8:11],v[80:83]
 MM v[84:87],a[108:111],a[12:15],v[84:87]
 BL v42,s[92:95],s37 offen offset:2048  lds
 MM v[88:91],a[164:167],a[8:11],v[88:91]
 MM v[92:95],a[164:167],a[12:15],v[92:95]
 BL v43,s[92:95],s37 offen offset:3072  lds
 MM v[96:99],a[220:223],a[8:11],v[96:99]
 s_add_u32 s37,s37,229376
 MM v[100:103],a[220:223],a[12:15],v[100:103]
 s_waitcnt vmcnt(34)
 s_waitcnt lgkmcnt(0)
 s_barrier
 MM v[72:75],a[56:59],a[16:19],v[72:75]
 RT a[0:1],v48
 MM v[76:79],a[56:59],a[20:23],v[76:79]
 RT a[2:3],v48 offset:1024
 MM v[80:83],a[112:115],a[16:19],v[80:83]
 RT a[4:5],v49
 MM v[84:87],a[112:115],a[20:23],v[84:87]
 RT a[6:7],v49 offset:1024
 MM v[88:91],a[168:171],a[16:19],v[88:91]
 RT a[8:9],v48 offset:8192
 MM v[92:95],a[168:171],a[20:23],v[92:95]
 RT a[10:11],v48 offset:9216
 MM v[96:99],a[224:227],a[16:19],v[96:99]
 RT a[12:13],v49 offset:8192
 MM v[100:103],a[224:227],a[20:23],v[100:103]
 RT a[14:15],v49 offset:9216
 s_add_u32 m0,s39,49152
 MM v[72:75],a[60:63],a[24:27],v[72:75]
 BL v40,s[92:95],s37 offen  lds
 MM v[76:79],a[60:63],a[28:31],v[76:79]
 BL v41,s[92:95],s37 offen offset:1024  lds
 MM v[80:83],a[116:119],a[24:27],v[80:83]
 MM v[84:87],a[116:119],a[28:31],v[84:87]
 BL v42,s[92:95],s37 offen offset:2048  lds
 MM v[88:91],a[172:175],a[24:27],v[88:91]
 MM v[92:95],a[172:175],a[28:31],v[92:95]
 BL v43,s[92:95],s37 offen offset:3072  lds
 MM v[96:99],a[228:231],a[24:27],v[96:99]
 s_add_u32 s37,s37,4293591296
 MM v[100:103],a[228:231],a[28:31],v[100:103]
 s_waitcnt vmcnt(34)
 s_waitcnt lgkmcnt(0)
 s_barrier
 MM v[72:75],a[64:67],a[0:3],v[72:75]
 RT a[16:17],v48 offset:16384
 MM v[76:79],a[64:67],a[4:7],v[76:79]
 RT a[18:19],v48 offset:17408
 MM v[80:83],a[120:123],a[0:3],v[80:83]
 RT a[20:21],v49 offset:16384
 MM v[84:87],a[120:123],a[4:7],v[84:87]
 RT a[22:23],v49 offset:17408
 MM v[88:91],a[176:179],a[0:3],v[88:91]
 RT a[24:25],v48 offset:24576
 MM v[92:95],a[176:179],a[4:7],v[92:95]
 RT a[26:27],v48 offset:25600
 MM v[96:99],a[232:235],a[0:3],v[96:99]
 RT a[28:29],v49 offset:24576
 MM v[100:103],a[232:235],a[4:7],v[100:103]
 RT a[30:31],v49 offset:25600
 s_add_u32 m0,s39,65536
 MM v[72:75],a[68:71],a[8:11],v[72:75]
 BL v40,s[92:95],s37 offen  lds
 MM v[76:79],a[68:71],a[12:15],v[76:79]
 BL v41,s[92:95],s37 offen offset:1024  lds
 MM v[80:83],a[124:127],a[8:11],v[80:83]
 MM v[84:87],a[124:127],a[12:15],v[84:87]
 BL v42,s[92:95],s37 offen offset:2048  lds
 MM v[88:91],a[180:183],a[8:11],v[88:91]
 MM v[92:95],a[180:183],a[12:15],v[92:95]
 BL v43,s[92:95],s37 offen offset:3072  lds
 MM v[96:99],a[236:239],a[8:11],v[96:99]
 s_add_u32 s37,s37,229376
 MM v[100:103],a[236:239],a[12:15],v[100:103]
 s_waitcnt vmcnt(32)
 s_waitcnt lgkmcnt(0)
 s_barrier
 MM v[72:75],a[72:75],a[16:19],v[72:75]
 RT a[0:1],v48 offset:32768
 MM v[76:79],a[72:75],a[20:23],v[76:79]
 RT a[2:3],v48 offset:33792
 MM v[80:83],a[128:131],a[16:19],v[80:83]
 RT a[4:5],v49 offset:32768
 MM v[84:87],a[128:131],a[20:23],v[84:87]
 RT a[6:7],v49 offset:33792
 MM v[88:91],a[184:187],a[16:19],v[88:91]
 RT a[8:9],v48 offset:40960
 MM v[92:95],a[184:187],a[20:23],v[92:95]
 RT a[10:11],v48 offset:41984
 MM v[96:99],a[240:243],a[16:19],v[96:99]
 RT a[12:13],v49 offset:40960
 MM v[100:103],a[240:243],a[20:23],v[100:103]
 RT a[14:15],v49 offset:41984
 s_add_u32 m0,s39,81920
 MM v[72:75],a[76:79],a[24:27],v[72:75]
 BL v40,s[92:95],s37 offen  lds
 MM v[76:79],a[76:79],a[28:31],v[76:79]
 BL v41,s[92:95],s37 offen offset:1024  lds
 MM v[80:83],a[132:135],a[24:27],v[80:83]
 MM v[84:87],a[132:135],a[28:31],v[84:87]
 BL v42,s[92:95],s37 offen offset:2048  lds
 MM v[88:91],a[188:191],a[24:27],v[88:91]
 MM v[92:95],a[188:191],a[28:31],v[92:95]
 BL v43,s[92:95],s37 offen offset:3072  lds
 MM v[96:99],a[244:247],a[24:27],v[96:99]
 s_add_u32 s37,s37,229376
 MM v[100:103],a[244:247],a[28:31],v[100:103]
 s_waitcnt vmcnt(32)
 s_waitcnt lgkmcnt(0)
 s_barrier
 MM v[72:75],a[80:83],a[0:3],v[72:75]
 RT a[16:17],v48 offset:49152
 MM v[76:79],a[80:83],a[4:7],v[76:79]
 RT a[18:19],v48 offset:50176
 MM v[80:83],a[136:139],a[0:3],v[80:83]
 RT a[20:21],v49 offset:49152
 MM v[84:87],a[136:139],a[4:7],v[84:87]
 RT a[22:23],v49 offset:50176
 MM v[88:91],a[192:195],a[0:3],v[88:91]
 RT a[24:25],v48 offset:57344
 MM v[92:95],a[192:195],a[4:7],v[92:95]
 RT a[26:27],v48 offset:58368
 MM v[96:99],a[248:251],a[0:3],v[96:99]
 RT a[28:29],v49 offset:57344
 MM v[100:103],a[248:251],a[4:7],v[100:103]
 RT a[30:31],v49 offset:58368
 s_add_u32 m0,s39,98304
 MM v[72:75],a[84:87],a[8:11],v[72:75]
 BL v40,s[92:95],s37 offen  lds
 MM v[76:79],a[84:87],a[12:15],v[76:79]
 BL v41,s[92:95],s37 offen offset:1024  lds
 MM v[80:83],a[140:143],a[8:11],v[80:83]
 MM v[84:87],a[140:143],a[12:15],v[84:87]
 BL v42,s[92:95],s37 offen offset:2048  lds
 MM v[88:91],a[196:199],a[8:11],v[88:91]
 MM v[92:95],a[196:199],a[12:15],v[92:95]
 BL v43,s[92:95],s37 offen offset:3072  lds
 MM v[96:99],a[252:255],a[8:11],v[96:99]
 s_add_u32 s37,s37,229376
 MM v[100:103],a[252:255],a[12:15],v[100:103]
 s_mov_b32 s4,s44
 s_mov_b32 s5,s45
 s_mov_b32 s6,3670016
 s_mov_b32 s7,0x20000
 s_lshl_b32 s87,s52,2
 s_add_u32 s87,s87,s35
 s_lshl_b32 s87,s87,10
 BL v[68:71],v6,s[4:7],s87 offen
 s_add_u32 s87,s87,1048576
 BL v[68:71],v6,s[4:7],s87 offen
 s_add_u32 s87,s87,1048576
 BL v[68:71],v6,s[4:7],s87 offen
 s_add_u32 s87,s87,1048576
 BL v[68:71],v6,s[4:7],s87 offen
 s_add_u32 s87,s87,1048576
 PM v[104:105],v[72:73],v[72:73]
 PM v[106:107],v[74:75],v[74:75]
 PM v[108:109],v[76:77],v[76:77]
 PM v[110:111],v[78:79],v[78:79]
 v_pk_fma_f32 v[104:105],v[104:105],v[60:61],v[58:59]
 v_pk_fma_f32 v[106:107],v[106:107],v[60:61],v[58:59]
 v_pk_fma_f32 v[108:109],v[108:109],v[60:61],v[58:59]
 v_pk_fma_f32 v[110:111],v[110:111],v[60:61],v[58:59]
 PM v[104:105],v[104:105],v[72:73]
 PM v[106:107],v[106:107],v[74:75]
 PM v[108:109],v[108:109],v[76:77]
 PM v[110:111],v[110:111],v[78:79]
 v_exp_f32 v104,v104
 v_exp_f32 v105,v105
 v_exp_f32 v106,v106
 v_exp_f32 v107,v107
 v_exp_f32 v108,v108
 v_exp_f32 v109,v109
 v_exp_f32 v110,v110
 v_exp_f32 v111,v111
 v_pk_add_f32 v[104:105],v[104:105],1.0 op_sel_hi:[1,0]
 v_pk_add_f32 v[106:107],v[106:107],1.0 op_sel_hi:[1,0]
 v_pk_add_f32 v[108:109],v[108:109],1.0 op_sel_hi:[1,0]
 v_pk_add_f32 v[110:111],v[110:111],1.0 op_sel_hi:[1,0]
 v_rcp_f32 v104,v104
 v_rcp_f32 v105,v105
 v_rcp_f32 v106,v106
 v_rcp_f32 v107,v107
 v_rcp_f32 v108,v108
 v_rcp_f32 v109,v109
 v_rcp_f32 v110,v110
 v_rcp_f32 v111,v111
 PM v[72:73],v[72:73],v[104:105]
 PM v[74:75],v[74:75],v[106:107]
 PM v[76:77],v[76:77],v[108:109]
 PM v[78:79],v[78:79],v[110:111]
 v_pk_add_f32 v[224:225],v[224:225],v[72:73]
 v_pk_fma_f32 v[240:241],v[72:73],v[72:73],v[240:241]
 CV v112,v72,v73
 v_pk_add_f32 v[226:227],v[226:227],v[74:75]
 v_pk_fma_f32 v[242:243],v[74:75],v[74:75],v[242:243]
 CV v113,v74,v75
 v_pk_add_f32 v[224:225],v[224:225],v[76:77]
 v_pk_fma_f32 v[240:241],v[76:77],v[76:77],v[240:241]
 CV v116,v76,v77
 v_pk_add_f32 v[226:227],v[226:227],v[78:79]
 v_pk_fma_f32 v[242:243],v[78:79],v[78:79],v[242:243]
 CV v117,v78,v79
 PM v[104:105],v[80:81],v[80:81]
 PM v[106:107],v[82:83],v[82:83]
 PM v[108:109],v[84:85],v[84:85]
 PM v[110:111],v[86:87],v[86:87]
 v_pk_fma_f32 v[104:105],v[104:105],v[60:61],v[58:59]
 v_pk_fma_f32 v[106:107],v[106:107],v[60:61],v[58:59]
 v_pk_fma_f32 v[108:109],v[108:109],v[60:61],v[58:59]
 v_pk_fma_f32 v[110:111],v[110:111],v[60:61],v[58:59]
 PM v[104:105],v[104:105],v[80:81]
 PM v[106:107],v[106:107],v[82:83]
 PM v[108:109],v[108:109],v[84:85]
 PM v[110:111],v[110:111],v[86:87]
 v_exp_f32 v104,v104
 v_exp_f32 v105,v105
 v_exp_f32 v106,v106
 v_exp_f32 v107,v107
 v_exp_f32 v108,v108
 v_exp_f32 v109,v109
 v_exp_f32 v110,v110
 v_exp_f32 v111,v111
 v_pk_add_f32 v[104:105],v[104:105],1.0 op_sel_hi:[1,0]
 v_pk_add_f32 v[106:107],v[106:107],1.0 op_sel_hi:[1,0]
 v_pk_add_f32 v[108:109],v[108:109],1.0 op_sel_hi:[1,0]
 v_pk_add_f32 v[110:111],v[110:111],1.0 op_sel_hi:[1,0]
 v_rcp_f32 v104,v104
 v_rcp_f32 v105,v105
 v_rcp_f32 v106,v106
 v_rcp_f32 v107,v107
 v_rcp_f32 v108,v108
 v_rcp_f32 v109,v109
 v_rcp_f32 v110,v110
 v_rcp_f32 v111,v111
 PM v[80:81],v[80:81],v[104:105]
 PM v[82:83],v[82:83],v[106:107]
 PM v[84:85],v[84:85],v[108:109]
 PM v[86:87],v[86:87],v[110:111]
 v_pk_add_f32 v[228:229],v[228:229],v[80:81]
 v_pk_fma_f32 v[244:245],v[80:81],v[80:81],v[244:245]
 CV v114,v80,v81
 v_pk_add_f32 v[230:231],v[230:231],v[82:83]
 v_pk_fma_f32 v[246:247],v[82:83],v[82:83],v[246:247]
 CV v115,v82,v83
 v_pk_add_f32 v[228:229],v[228:229],v[84:85]
 v_pk_fma_f32 v[244:245],v[84:85],v[84:85],v[244:245]
 CV v118,v84,v85
 v_pk_add_f32 v[230:231],v[230:231],v[86:87]
 v_pk_fma_f32 v[246:247],v[86:87],v[86:87],v[246:247]
 CV v119,v86,v87
 PM v[104:105],v[88:89],v[88:89]
 PM v[106:107],v[90:91],v[90:91]
 PM v[108:109],v[92:93],v[92:93]
 PM v[110:111],v[94:95],v[94:95]
 v_pk_fma_f32 v[104:105],v[104:105],v[60:61],v[58:59]
 v_pk_fma_f32 v[106:107],v[106:107],v[60:61],v[58:59]
 v_pk_fma_f32 v[108:109],v[108:109],v[60:61],v[58:59]
 v_pk_fma_f32 v[110:111],v[110:111],v[60:61],v[58:59]
 PM v[104:105],v[104:105],v[88:89]
 PM v[106:107],v[106:107],v[90:91]
 PM v[108:109],v[108:109],v[92:93]
 PM v[110:111],v[110:111],v[94:95]
 v_exp_f32 v104,v104
 v_exp_f32 v105,v105
 v_exp_f32 v106,v106
 v_exp_f32 v107,v107
 v_exp_f32 v108,v108
 v_exp_f32 v109,v109
 v_exp_f32 v110,v110
 v_exp_f32 v111,v111
 v_pk_add_f32 v[104:105],v[104:105],1.0 op_sel_hi:[1,0]
 v_pk_add_f32 v[106:107],v[106:107],1.0 op_sel_hi:[1,0]
 v_pk_add_f32 v[108:109],v[108:109],1.0 op_sel_hi:[1,0]
 v_pk_add_f32 v[110:111],v[110:111],1.0 op_sel_hi:[1,0]
 v_rcp_f32 v104,v104
 v_rcp_f32 v105,v105
 v_rcp_f32 v106,v106
 v_rcp_f32 v107,v107
 v_rcp_f32 v108,v108
 v_rcp_f32 v109,v109
 v_rcp_f32 v110,v110
 v_rcp_f32 v111,v111
 PM v[88:89],v[88:89],v[104:105]
 PM v[90:91],v[90:91],v[106:107]
 PM v[92:93],v[92:93],v[108:109]
 PM v[94:95],v[94:95],v[110:111]
 v_pk_add_f32 v[232:233],v[232:233],v[88:89]
 v_pk_fma_f32 v[248:249],v[88:89],v[88:89],v[248:249]
 CV v120,v88,v89
 v_pk_add_f32 v[234:235],v[234:235],v[90:91]
 v_pk_fma_f32 v[250:251],v[90:91],v[90:91],v[250:251]
 CV v121,v90,v91
 v_pk_add_f32 v[232:233],v[232:233],v[92:93]
 v_pk_fma_f32 v[248:249],v[92:93],v[92:93],v[248:249]
 CV v124,v92,v93
 v_pk_add_f32 v[234:235],v[234:235],v[94:95]
 v_pk_fma_f32 v[250:251],v[94:95],v[94:95],v[250:251]
 CV v125,v94,v95
 PM v[104:105],v[96:97],v[96:97]
 PM v[106:107],v[98:99],v[98:99]
 PM v[108:109],v[100:101],v[100:101]
 PM v[110:111],v[102:103],v[102:103]
 v_pk_fma_f32 v[104:105],v[104:105],v[60:61],v[58:59]
 v_pk_fma_f32 v[106:107],v[106:107],v[60:61],v[58:59]
 v_pk_fma_f32 v[108:109],v[108:109],v[60:61],v[58:59]
 v_pk_fma_f32 v[110:111],v[110:111],v[60:61],v[58:59]
 PM v[104:105],v[104:105],v[96:97]
 PM v[106:107],v[106:107],v[98:99]
 PM v[108:109],v[108:109],v[100:101]
 PM v[110:111],v[110:111],v[102:103]
 v_exp_f32 v104,v104
 v_exp_f32 v105,v105
 v_exp_f32 v106,v106
 v_exp_f32 v107,v107
 v_exp_f32 v108,v108
 v_exp_f32 v109,v109
 v_exp_f32 v110,v110
 v_exp_f32 v111,v111
 v_pk_add_f32 v[104:105],v[104:105],1.0 op_sel_hi:[1,0]
 v_pk_add_f32 v[106:107],v[106:107],1.0 op_sel_hi:[1,0]
 v_pk_add_f32 v[108:109],v[108:109],1.0 op_sel_hi:[1,0]
 v_pk_add_f32 v[110:111],v[110:111],1.0 op_sel_hi:[1,0]
 v_rcp_f32 v104,v104
 v_rcp_f32 v105,v105
 v_rcp_f32 v106,v106
 v_rcp_f32 v107,v107
 v_rcp_f32 v108,v108
 v_rcp_f32 v109,v109
 v_rcp_f32 v110,v110
 v_rcp_f32 v111,v111
 PM v[96:97],v[96:97],v[104:105]
 PM v[98:99],v[98:99],v[106:107]
 PM v[100:101],v[100:101],v[108:109]
 PM v[102:103],v[102:103],v[110:111]
 v_pk_add_f32 v[236:237],v[236:237],v[96:97]
 v_pk_fma_f32 v[252:253],v[96:97],v[96:97],v[252:253]
 CV v122,v96,v97
 v_pk_add_f32 v[238:239],v[238:239],v[98:99]
 v_pk_fma_f32 v[254:255],v[98:99],v[98:99],v[254:255]
 CV v123,v98,v99
 v_pk_add_f32 v[236:237],v[236:237],v[100:101]
 v_pk_fma_f32 v[252:253],v[100:101],v[100:101],v[252:253]
 CV v126,v100,v101
 v_pk_add_f32 v[238:239],v[238:239],v[102:103]
 v_pk_fma_f32 v[254:255],v[102:103],v[102:103],v[254:255]
 CV v127,v102,v103
 s_waitcnt vmcnt(36)
 s_waitcnt lgkmcnt(0)
 s_barrier
 MM v[72:75],a[32:35],a[16:19],0
 RT a[0:1],v50
 MM v[76:79],a[32:35],a[20:23],0
 RT a[2:3],v50 offset:1024
 MM v[80:83],a[88:91],a[16:19],0
 RT a[4:5],v51
 MM v[84:87],a[88:91],a[20:23],0
 RT a[6:7],v51 offset:1024
 MM v[88:91],a[144:147],a[16:19],0
 RT a[8:9],v50 offset:8192
 MM v[92:95],a[144:147],a[20:23],0
 RT a[10:11],v50 offset:9216
 MM v[96:99],a[200:203],a[16:19],0
 RT a[12:13],v51 offset:8192
 MM v[100:103],a[200:203],a[20:23],0
 RT a[14:15],v51 offset:9216
 s_add_u32 m0,s39,114688
 MM v[72:75],a[36:39],a[24:27],v[72:75]
 BL v40,s[92:95],s37 offen  lds
 MM v[76:79],a[36:39],a[28:31],v[76:79]
 BL v41,s[92:95],s37 offen offset:1024  lds
 MM v[80:83],a[92:95],a[24:27],v[80:83]
 MM v[84:87],a[92:95],a[28:31],v[84:87]
 BL v42,s[92:95],s37 offen offset:2048  lds
 MM v[88:91],a[148:151],a[24:27],v[88:91]
 MM v[92:95],a[148:151],a[28:31],v[92:95]
 BL v43,s[92:95],s37 offen offset:3072  lds
 MM v[96:99],a[204:207],a[24:27],v[96:99]
 s_add_u32 s37,s37,229376
 MM v[100:103],a[204:207],a[28:31],v[100:103]
 s_waitcnt vmcnt(36)
 s_waitcnt lgkmcnt(0)
 s_barrier
 MM v[72:75],a[40:43],a[0:3],v[72:75]
 RT a[16:17],v50 offset:16384
 MM v[76:79],a[40:43],a[4:7],v[76:79]
 RT a[18:19],v50 offset:17408
 MM v[80:83],a[96:99],a[0:3],v[80:83]
 RT a[20:21],v51 offset:16384
 MM v[84:87],a[96:99],a[4:7],v[84:87]
 RT a[22:23],v51 offset:17408
 MM v[88:91],a[152:155],a[0:3],v[88:91]
 RT a[24:25],v50 offset:24576
 MM v[92:95],a[152:155],a[4:7],v[92:95]
 RT a[26:27],v50 offset:25600
 MM v[96:99],a[208:211],a[0:3],v[96:99]
 RT a[28:29],v51 offset:24576
 MM v[100:103],a[208:211],a[4:7],v[100:103]
 RT a[30:31],v51 offset:25600
 s_add_u32 m0,s39,131072
 MM v[72:75],a[44:47],a[8:11],v[72:75]
 BL v40,s[92:95],s37 offen  lds
 MM v[76:79],a[44:47],a[12:15],v[76:79]
 BL v41,s[92:95],s37 offen offset:1024  lds
 MM v[80:83],a[100:103],a[8:11],v[80:83]
 MM v[84:87],a[100:103],a[12:15],v[84:87]
 BL v42,s[92:95],s37 offen offset:2048  lds
 MM v[88:91],a[156:159],a[8:11],v[88:91]
 MM v[92:95],a[156:159],a[12:15],v[92:95]
 BL v43,s[92:95],s37 offen offset:3072  lds
 MM v[96:99],a[212:215],a[8:11],v[96:99]
 s_add_u32 s37,s37,229376
 MM v[100:103],a[212:215],a[12:15],v[100:103]
 s_waitcnt vmcnt(36)
 s_waitcnt lgkmcnt(0)
 s_barrier
 MM v[72:75],a[48:51],a[16:19],v[72:75]
 RT a[0:1],v46
 MM v[76:79],a[48:51],a[20:23],v[76:79]
 RT a[2:3],v46 offset:1024
 MM v[80:83],a[104:107],a[16:19],v[80:83]
 RT a[4:5],v47
 MM v[84:87],a[104:107],a[20:23],v[84:87]
 RT a[6:7],v47 offset:1024
 MM v[88:91],a[160:163],a[16:19],v[88:91]
 RT a[8:9],v46 offset:8192
 MM v[92:95],a[160:163],a[20:23],v[92:95]
 RT a[10:11],v46 offset:9216
 MM v[96:99],a[216:219],a[16:19],v[96:99]
 RT a[12:13],v47 offset:8192
 MM v[100:103],a[216:219],a[20:23],v[100:103]
 RT a[14:15],v47 offset:9216
 s_add_u32 m0,s39,147456
 MM v[72:75],a[52:55],a[24:27],v[72:75]
 BL v40,s[92:95],s37 offen  lds
 MM v[76:79],a[52:55],a[28:31],v[76:79]
 BL v41,s[92:95],s37 offen offset:1024  lds
 MM v[80:83],a[108:111],a[24:27],v[80:83]
 MM v[84:87],a[108:111],a[28:31],v[84:87]
 BL v42,s[92:95],s37 offen offset:2048  lds
 MM v[88:91],a[164:167],a[24:27],v[88:91]
 MM v[92:95],a[164:167],a[28:31],v[92:95]
 BL v43,s[92:95],s37 offen offset:3072  lds
 MM v[96:99],a[220:223],a[24:27],v[96:99]
 s_add_u32 s37,s37,229376
 MM v[100:103],a[220:223],a[28:31],v[100:103]
 s_waitcnt vmcnt(36)
 s_waitcnt lgkmcnt(0)
 s_barrier
 MM v[72:75],a[56:59],a[0:3],v[72:75]
 RT a[16:17],v46 offset:16384
 MM v[76:79],a[56:59],a[4:7],v[76:79]
 RT a[18:19],v46 offset:17408
 MM v[80:83],a[112:115],a[0:3],v[80:83]
 RT a[20:21],v47 offset:16384
 MM v[84:87],a[112:115],a[4:7],v[84:87]
 RT a[22:23],v47 offset:17408
 MM v[88:91],a[168:171],a[0:3],v[88:91]
 RT a[24:25],v46 offset:24576
 MM v[92:95],a[168:171],a[4:7],v[92:95]
 RT a[26:27],v46 offset:25600
 MM v[96:99],a[224:227],a[0:3],v[96:99]
 RT a[28:29],v47 offset:24576
 MM v[100:103],a[224:227],a[4:7],v[100:103]
 RT a[30:31],v47 offset:25600
 s_add_u32 m0,s39,0
 MM v[72:75],a[60:63],a[8:11],v[72:75]
 BL v40,s[92:95],s37 offen  lds
 MM v[76:79],a[60:63],a[12:15],v[76:79]
 BL v41,s[92:95],s37 offen offset:1024  lds
 MM v[80:83],a[116:119],a[8:11],v[80:83]
 MM v[84:87],a[116:119],a[12:15],v[84:87]
 BL v42,s[92:95],s37 offen offset:2048  lds
 MM v[88:91],a[172:175],a[8:11],v[88:91]
 MM v[92:95],a[172:175],a[12:15],v[92:95]
 BL v43,s[92:95],s37 offen offset:3072  lds
 MM v[96:99],a[228:231],a[8:11],v[96:99]
 s_add_u32 s37,s37,4293591296
 MM v[100:103],a[228:231],a[12:15],v[100:103]
 s_waitcnt vmcnt(36)
 s_waitcnt lgkmcnt(0)
 s_barrier
 MM v[72:75],a[64:67],a[16:19],v[72:75]
 RT a[0:1],v46 offset:32768
 MM v[76:79],a[64:67],a[20:23],v[76:79]
 RT a[2:3],v46 offset:33792
 MM v[80:83],a[120:123],a[16:19],v[80:83]
 RT a[4:5],v47 offset:32768
 MM v[84:87],a[120:123],a[20:23],v[84:87]
 RT a[6:7],v47 offset:33792
 MM v[88:91],a[176:179],a[16:19],v[88:91]
 RT a[8:9],v46 offset:40960
 MM v[92:95],a[176:179],a[20:23],v[92:95]
 RT a[10:11],v46 offset:41984
 MM v[96:99],a[232:235],a[16:19],v[96:99]
 RT a[12:13],v47 offset:40960
 MM v[100:103],a[232:235],a[20:23],v[100:103]
 RT a[14:15],v47 offset:41984
 s_add_u32 m0,s39,16384
 MM v[72:75],a[68:71],a[24:27],v[72:75]
 BL v40,s[92:95],s37 offen  lds
 MM v[76:79],a[68:71],a[28:31],v[76:79]
 BL v41,s[92:95],s37 offen offset:1024  lds
 MM v[80:83],a[124:127],a[24:27],v[80:83]
 MM v[84:87],a[124:127],a[28:31],v[84:87]
 BL v42,s[92:95],s37 offen offset:2048  lds
 MM v[88:91],a[180:183],a[24:27],v[88:91]
 MM v[92:95],a[180:183],a[28:31],v[92:95]
 BL v43,s[92:95],s37 offen offset:3072  lds
 MM v[96:99],a[236:239],a[24:27],v[96:99]
 s_add_u32 s37,s37,229376
 MM v[100:103],a[236:239],a[28:31],v[100:103]
 s_waitcnt vmcnt(36)
 s_waitcnt lgkmcnt(0)
 s_barrier
 MM v[72:75],a[72:75],a[0:3],v[72:75]
 RT a[16:17],v46 offset:49152
 MM v[76:79],a[72:75],a[4:7],v[76:79]
 RT a[18:19],v46 offset:50176
 MM v[80:83],a[128:131],a[0:3],v[80:83]
 RT a[20:21],v47 offset:49152
 MM v[84:87],a[128:131],a[4:7],v[84:87]
 RT a[22:23],v47 offset:50176
 MM v[88:91],a[184:187],a[0:3],v[88:91]
 RT a[24:25],v46 offset:57344
 MM v[92:95],a[184:187],a[4:7],v[92:95]
 RT a[26:27],v46 offset:58368
 MM v[96:99],a[240:243],a[0:3],v[96:99]
 RT a[28:29],v47 offset:57344
 MM v[100:103],a[240:243],a[4:7],v[100:103]
 RT a[30:31],v47 offset:58368
 s_add_u32 m0,s39,32768
 MM v[72:75],a[76:79],a[8:11],v[72:75]
 BL v40,s[92:95],s37 offen  lds
 MM v[76:79],a[76:79],a[12:15],v[76:79]
 BL v41,s[92:95],s37 offen offset:1024  lds
 MM v[80:83],a[132:135],a[8:11],v[80:83]
 MM v[84:87],a[132:135],a[12:15],v[84:87]
 BL v42,s[92:95],s37 offen offset:2048  lds
 MM v[88:91],a[188:191],a[8:11],v[88:91]
 MM v[92:95],a[188:191],a[12:15],v[92:95]
 BL v43,s[92:95],s37 offen offset:3072  lds
 MM v[96:99],a[244:247],a[8:11],v[96:99]
 s_add_u32 s37,s37,229376
 MM v[100:103],a[244:247],a[12:15],v[100:103]
 s_waitcnt vmcnt(36)
 s_waitcnt lgkmcnt(0)
 s_barrier
 MM v[72:75],a[80:83],a[16:19],v[72:75]
 RT a[0:1],v48
 MM v[76:79],a[80:83],a[20:23],v[76:79]
 RT a[2:3],v48 offset:1024
 MM v[80:83],a[136:139],a[16:19],v[80:83]
 RT a[4:5],v49
 MM v[84:87],a[136:139],a[20:23],v[84:87]
 RT a[6:7],v49 offset:1024
 MM v[88:91],a[192:195],a[16:19],v[88:91]
 RT a[8:9],v48 offset:8192
 MM v[92:95],a[192:195],a[20:23],v[92:95]
 RT a[10:11],v48 offset:9216
 MM v[96:99],a[248:251],a[16:19],v[96:99]
 RT a[12:13],v49 offset:8192
 MM v[100:103],a[248:251],a[20:23],v[100:103]
 RT a[14:15],v49 offset:9216
 s_add_u32 m0,s39,49152
 MM v[72:75],a[84:87],a[24:27],v[72:75]
 BL v40,s[92:95],s37 offen  lds
 MM v[76:79],a[84:87],a[28:31],v[76:79]
 BL v41,s[92:95],s37 offen offset:1024  lds
 MM v[80:83],a[140:143],a[24:27],v[80:83]
 MM v[84:87],a[140:143],a[28:31],v[84:87]
 BL v42,s[92:95],s37 offen offset:2048  lds
 MM v[88:91],a[196:199],a[24:27],v[88:91]
 MM v[92:95],a[196:199],a[28:31],v[92:95]
 BL v43,s[92:95],s37 offen offset:3072  lds
 MM v[96:99],a[252:255],a[24:27],v[96:99]
 s_add_u32 s37,s37,229376
 MM v[100:103],a[252:255],a[28:31],v[100:103]
 s_mov_b32 s4,s56
 s_mov_b32 s5,s57
 s_mov_b32 s6,8388608
 s_mov_b32 s7,0x20000
 s_lshl_b32 s87,s52,2
 s_add_u32 s87,s87,s35
 s_lshl_b32 s87,s87,10
 BL v[68:71],v6,s[4:7],s87 offen
 s_add_u32 s87,s87,1048576
 BL v[68:71],v6,s[4:7],s87 offen
 s_add_u32 s87,s87,1048576
 BL v[68:71],v6,s[4:7],s87 offen
 s_add_u32 s87,s87,1048576
 BL v[68:71],v6,s[4:7],s87 offen
 s_add_u32 s87,s87,1048576
 BL v[68:71],v6,s[4:7],s87 offen
 s_add_u32 s87,s87,1048576
 BL v[68:71],v6,s[4:7],s87 offen
 s_add_u32 s87,s87,1048576
 BL v[68:71],v6,s[4:7],s87 offen
 s_add_u32 s87,s87,1048576
 BL v[68:71],v6,s[4:7],s87 offen
 s_add_u32 s87,s87,1048576
 PM v[104:105],v[72:73],v[72:73]
 PM v[106:107],v[74:75],v[74:75]
 PM v[108:109],v[76:77],v[76:77]
 PM v[110:111],v[78:79],v[78:79]
 v_pk_fma_f32 v[104:105],v[104:105],v[60:61],v[58:59]
 v_pk_fma_f32 v[106:107],v[106:107],v[60:61],v[58:59]
 v_pk_fma_f32 v[108:109],v[108:109],v[60:61],v[58:59]
 v_pk_fma_f32 v[110:111],v[110:111],v[60:61],v[58:59]
 PM v[104:105],v[104:105],v[72:73]
 PM v[106:107],v[106:107],v[74:75]
 PM v[108:109],v[108:109],v[76:77]
 PM v[110:111],v[110:111],v[78:79]
 v_exp_f32 v104,v104
 v_exp_f32 v105,v105
 v_exp_f32 v106,v106
 v_exp_f32 v107,v107
 v_exp_f32 v108,v108
 v_exp_f32 v109,v109
 v_exp_f32 v110,v110
 v_exp_f32 v111,v111
 v_pk_add_f32 v[104:105],v[104:105],1.0 op_sel_hi:[1,0]
 v_pk_add_f32 v[106:107],v[106:107],1.0 op_sel_hi:[1,0]
 v_pk_add_f32 v[108:109],v[108:109],1.0 op_sel_hi:[1,0]
 v_pk_add_f32 v[110:111],v[110:111],1.0 op_sel_hi:[1,0]
 v_rcp_f32 v104,v104
 v_rcp_f32 v105,v105
 v_rcp_f32 v106,v106
 v_rcp_f32 v107,v107
 v_rcp_f32 v108,v108
 v_rcp_f32 v109,v109
 v_rcp_f32 v110,v110
 v_rcp_f32 v111,v111
 PM v[72:73],v[72:73],v[104:105]
 PM v[74:75],v[74:75],v[106:107]
 PM v[76:77],v[76:77],v[108:109]
 PM v[78:79],v[78:79],v[110:111]
 v_pk_add_f32 v[224:225],v[224:225],v[72:73]
 v_pk_fma_f32 v[240:241],v[72:73],v[72:73],v[240:241]
 CV v128,v72,v73
 v_pk_add_f32 v[226:227],v[226:227],v[74:75]
 v_pk_fma_f32 v[242:243],v[74:75],v[74:75],v[242:243]
 CV v129,v74,v75
 v_pk_add_f32 v[224:225],v[224:225],v[76:77]
 v_pk_fma_f32 v[240:241],v[76:77],v[76:77],v[240:241]
 CV v132,v76,v77
 v_pk_add_f32 v[226:227],v[226:227],v[78:79]
 v_pk_fma_f32 v[242:243],v[78:79],v[78:79],v[242:243]
 CV v133,v78,v79
 PM v[104:105],v[80:81],v[80:81]
 PM v[106:107],v[82:83],v[82:83]
 PM v[108:109],v[84:85],v[84:85]
 PM v[110:111],v[86:87],v[86:87]
 v_pk_fma_f32 v[104:105],v[104:105],v[60:61],v[58:59]
 v_pk_fma_f32 v[106:107],v[106:107],v[60:61],v[58:59]
 v_pk_fma_f32 v[108:109],v[108:109],v[60:61],v[58:59]
 v_pk_fma_f32 v[110:111],v[110:111],v[60:61],v[58:59]
 PM v[104:105],v[104:105],v[80:81]
 PM v[106:107],v[106:107],v[82:83]
 PM v[108:109],v[108:109],v[84:85]
 PM v[110:111],v[110:111],v[86:87]
 v_exp_f32 v104,v104
 v_exp_f32 v105,v105
 v_exp_f32 v106,v106
 v_exp_f32 v107,v107
 v_exp_f32 v108,v108
 v_exp_f32 v109,v109
 v_exp_f32 v110,v110
 v_exp_f32 v111,v111
 v_pk_add_f32 v[104:105],v[104:105],1.0 op_sel_hi:[1,0]
 v_pk_add_f32 v[106:107],v[106:107],1.0 op_sel_hi:[1,0]
 v_pk_add_f32 v[108:109],v[108:109],1.0 op_sel_hi:[1,0]
 v_pk_add_f32 v[110:111],v[110:111],1.0 op_sel_hi:[1,0]
 v_rcp_f32 v104,v104
 v_rcp_f32 v105,v105
 v_rcp_f32 v106,v106
 v_rcp_f32 v107,v107
 v_rcp_f32 v108,v108
 v_rcp_f32 v109,v109
 v_rcp_f32 v110,v110
 v_rcp_f32 v111,v111
 PM v[80:81],v[80:81],v[104:105]
 PM v[82:83],v[82:83],v[106:107]
 PM v[84:85],v[84:85],v[108:109]
 PM v[86:87],v[86:87],v[110:111]
 v_pk_add_f32 v[228:229],v[228:229],v[80:81]
 v_pk_fma_f32 v[244:245],v[80:81],v[80:81],v[244:245]
 CV v130,v80,v81
 v_pk_add_f32 v[230:231],v[230:231],v[82:83]
 v_pk_fma_f32 v[246:247],v[82:83],v[82:83],v[246:247]
 CV v131,v82,v83
 v_pk_add_f32 v[228:229],v[228:229],v[84:85]
 v_pk_fma_f32 v[244:245],v[84:85],v[84:85],v[244:245]
 CV v134,v84,v85
 v_pk_add_f32 v[230:231],v[230:231],v[86:87]
 v_pk_fma_f32 v[246:247],v[86:87],v[86:87],v[246:247]
 CV v135,v86,v87
 PM v[104:105],v[88:89],v[88:89]
 PM v[106:107],v[90:91],v[90:91]
 PM v[108:109],v[92:93],v[92:93]
 PM v[110:111],v[94:95],v[94:95]
 v_pk_fma_f32 v[104:105],v[104:105],v[60:61],v[58:59]
 v_pk_fma_f32 v[106:107],v[106:107],v[60:61],v[58:59]
 v_pk_fma_f32 v[108:109],v[108:109],v[60:61],v[58:59]
 v_pk_fma_f32 v[110:111],v[110:111],v[60:61],v[58:59]
 PM v[104:105],v[104:105],v[88:89]
 PM v[106:107],v[106:107],v[90:91]
 PM v[108:109],v[108:109],v[92:93]
 PM v[110:111],v[110:111],v[94:95]
 v_exp_f32 v104,v104
 v_exp_f32 v105,v105
 v_exp_f32 v106,v106
 v_exp_f32 v107,v107
 v_exp_f32 v108,v108
 v_exp_f32 v109,v109
 v_exp_f32 v110,v110
 v_exp_f32 v111,v111
 v_pk_add_f32 v[104:105],v[104:105],1.0 op_sel_hi:[1,0]
 v_pk_add_f32 v[106:107],v[106:107],1.0 op_sel_hi:[1,0]
 v_pk_add_f32 v[108:109],v[108:109],1.0 op_sel_hi:[1,0]
 v_pk_add_f32 v[110:111],v[110:111],1.0 op_sel_hi:[1,0]
 v_rcp_f32 v104,v104
 v_rcp_f32 v105,v105
 v_rcp_f32 v106,v106
 v_rcp_f32 v107,v107
 v_rcp_f32 v108,v108
 v_rcp_f32 v109,v109
 v_rcp_f32 v110,v110
 v_rcp_f32 v111,v111
 PM v[88:89],v[88:89],v[104:105]
 PM v[90:91],v[90:91],v[106:107]
 PM v[92:93],v[92:93],v[108:109]
 PM v[94:95],v[94:95],v[110:111]
 v_pk_add_f32 v[232:233],v[232:233],v[88:89]
 v_pk_fma_f32 v[248:249],v[88:89],v[88:89],v[248:249]
 CV v136,v88,v89
 v_pk_add_f32 v[234:235],v[234:235],v[90:91]
 v_pk_fma_f32 v[250:251],v[90:91],v[90:91],v[250:251]
 CV v137,v90,v91
 v_pk_add_f32 v[232:233],v[232:233],v[92:93]
 v_pk_fma_f32 v[248:249],v[92:93],v[92:93],v[248:249]
 CV v140,v92,v93
 v_pk_add_f32 v[234:235],v[234:235],v[94:95]
 v_pk_fma_f32 v[250:251],v[94:95],v[94:95],v[250:251]
 CV v141,v94,v95
 PM v[104:105],v[96:97],v[96:97]
 PM v[106:107],v[98:99],v[98:99]
 PM v[108:109],v[100:101],v[100:101]
 PM v[110:111],v[102:103],v[102:103]
 v_pk_fma_f32 v[104:105],v[104:105],v[60:61],v[58:59]
 v_pk_fma_f32 v[106:107],v[106:107],v[60:61],v[58:59]
 v_pk_fma_f32 v[108:109],v[108:109],v[60:61],v[58:59]
 v_pk_fma_f32 v[110:111],v[110:111],v[60:61],v[58:59]
 PM v[104:105],v[104:105],v[96:97]
 PM v[106:107],v[106:107],v[98:99]
 PM v[108:109],v[108:109],v[100:101]
 PM v[110:111],v[110:111],v[102:103]
 v_exp_f32 v104,v104
 v_exp_f32 v105,v105
 v_exp_f32 v106,v106
 v_exp_f32 v107,v107
 v_exp_f32 v108,v108
 v_exp_f32 v109,v109
 v_exp_f32 v110,v110
 v_exp_f32 v111,v111
 v_pk_add_f32 v[104:105],v[104:105],1.0 op_sel_hi:[1,0]
 v_pk_add_f32 v[106:107],v[106:107],1.0 op_sel_hi:[1,0]
 v_pk_add_f32 v[108:109],v[108:109],1.0 op_sel_hi:[1,0]
 v_pk_add_f32 v[110:111],v[110:111],1.0 op_sel_hi:[1,0]
 v_rcp_f32 v104,v104
 v_rcp_f32 v105,v105
 v_rcp_f32 v106,v106
 v_rcp_f32 v107,v107
 v_rcp_f32 v108,v108
 v_rcp_f32 v109,v109
 v_rcp_f32 v110,v110
 v_rcp_f32 v111,v111
 PM v[96:97],v[96:97],v[104:105]
 PM v[98:99],v[98:99],v[106:107]
 PM v[100:101],v[100:101],v[108:109]
 PM v[102:103],v[102:103],v[110:111]
 v_pk_add_f32 v[236:237],v[236:237],v[96:97]
 v_pk_fma_f32 v[252:253],v[96:97],v[96:97],v[252:253]
 CV v138,v96,v97
 v_pk_add_f32 v[238:239],v[238:239],v[98:99]
 v_pk_fma_f32 v[254:255],v[98:99],v[98:99],v[254:255]
 CV v139,v98,v99
 v_pk_add_f32 v[236:237],v[236:237],v[100:101]
 v_pk_fma_f32 v[252:253],v[100:101],v[100:101],v[252:253]
 CV v142,v100,v101
 v_pk_add_f32 v[238:239],v[238:239],v[102:103]
 v_pk_fma_f32 v[254:255],v[102:103],v[102:103],v[254:255]
 CV v143,v102,v103
 s_waitcnt vmcnt(44)
 s_waitcnt lgkmcnt(0)
 s_barrier
 MM v[72:75],a[32:35],a[0:3],0
 RT a[16:17],v48 offset:16384
 MM v[76:79],a[32:35],a[4:7],0
 RT a[18:19],v48 offset:17408
 MM v[80:83],a[88:91],a[0:3],0
 RT a[20:21],v49 offset:16384
 MM v[84:87],a[88:91],a[4:7],0
 RT a[22:23],v49 offset:17408
 MM v[88:91],a[144:147],a[0:3],0
 RT a[24:25],v48 offset:24576
 MM v[92:95],a[144:147],a[4:7],0
 RT a[26:27],v48 offset:25600
 MM v[96:99],a[200:203],a[0:3],0
 RT a[28:29],v49 offset:24576
 MM v[100:103],a[200:203],a[4:7],0
 RT a[30:31],v49 offset:25600
 s_add_u32 m0,s39,65536
 MM v[72:75],a[36:39],a[8:11],v[72:75]
 BL v40,s[92:95],s37 offen  lds
 MM v[76:79],a[36:39],a[12:15],v[76:79]
 BL v41,s[92:95],s37 offen offset:1024  lds
 MM v[80:83],a[92:95],a[8:11],v[80:83]
 MM v[84:87],a[92:95],a[12:15],v[84:87]
 BL v42,s[92:95],s37 offen offset:2048  lds
 MM v[88:91],a[148:151],a[8:11],v[88:91]
 MM v[92:95],a[148:151],a[12:15],v[92:95]
 BL v43,s[92:95],s37 offen offset:3072  lds
 MM v[96:99],a[204:207],a[8:11],v[96:99]
 s_add_u32 s37,s37,229376
 MM v[100:103],a[204:207],a[12:15],v[100:103]
 s_waitcnt vmcnt(44)
 s_waitcnt lgkmcnt(0)
 s_barrier
 MM v[72:75],a[40:43],a[16:19],v[72:75]
 RT a[0:1],v48 offset:32768
 MM v[76:79],a[40:43],a[20:23],v[76:79]
 RT a[2:3],v48 offset:33792
 MM v[80:83],a[96:99],a[16:19],v[80:83]
 RT a[4:5],v49 offset:32768
 MM v[84:87],a[96:99],a[20:23],v[84:87]
 RT a[6:7],v49 offset:33792
 MM v[88:91],a[152:155],a[16:19],v[88:91]
 RT a[8:9],v48 offset:40960
 MM v[92:95],a[152:155],a[20:23],v[92:95]
 RT a[10:11],v48 offset:41984
 MM v[96:99],a[208:211],a[16:19],v[96:99]
 RT a[12:13],v49 offset:40960
 MM v[100:103],a[208:211],a[20:23],v[100:103]
 RT a[14:15],v49 offset:41984
 s_add_u32 m0,s39,81920
 MM v[72:75],a[44:47],a[24:27],v[72:75]
 BL v40,s[92:95],s37 offen  lds
 MM v[76:79],a[44:47],a[28:31],v[76:79]
 BL v41,s[92:95],s37 offen offset:1024  lds
 MM v[80:83],a[100:103],a[24:27],v[80:83]
 MM v[84:87],a[100:103],a[28:31],v[84:87]
 BL v42,s[92:95],s37 offen offset:2048  lds
 MM v[88:91],a[156:159],a[24:27],v[88:91]
 MM v[92:95],a[156:159],a[28:31],v[92:95]
 BL v43,s[92:95],s37 offen offset:3072  lds
 MM v[96:99],a[212:215],a[24:27],v[96:99]
 s_add_u32 s37,s37,229376
 MM v[100:103],a[212:215],a[28:31],v[100:103]
 s_waitcnt vmcnt(40)
 s_waitcnt lgkmcnt(0)
 s_barrier
 MM v[72:75],a[48:51],a[0:3],v[72:75]
 RT a[16:17],v48 offset:49152
 MM v[76:79],a[48:51],a[4:7],v[76:79]
 RT a[18:19],v48 offset:50176
 MM v[80:83],a[104:107],a[0:3],v[80:83]
 RT a[20:21],v49 offset:49152
 MM v[84:87],a[104:107],a[4:7],v[84:87]
 RT a[22:23],v49 offset:50176
 MM v[88:91],a[160:163],a[0:3],v[88:91]
 RT a[24:25],v48 offset:57344
 MM v[92:95],a[160:163],a[4:7],v[92:95]
 RT a[26:27],v48 offset:58368
 MM v[96:99],a[216:219],a[0:3],v[96:99]
 RT a[28:29],v49 offset:57344
 MM v[100:103],a[216:219],a[4:7],v[100:103]
 RT a[30:31],v49 offset:58368
 s_add_u32 m0,s39,98304
 MM v[72:75],a[52:55],a[8:11],v[72:75]
 BL v40,s[92:95],s37 offen  lds
 MM v[76:79],a[52:55],a[12:15],v[76:79]
 BL v41,s[92:95],s37 offen offset:1024  lds
 MM v[80:83],a[108:111],a[8:11],v[80:83]
 MM v[84:87],a[108:111],a[12:15],v[84:87]
 BL v42,s[92:95],s37 offen offset:2048  lds
 MM v[88:91],a[164:167],a[8:11],v[88:91]
 MM v[92:95],a[164:167],a[12:15],v[92:95]
 BL v43,s[92:95],s37 offen offset:3072  lds
 MM v[96:99],a[220:223],a[8:11],v[96:99]
 s_add_u32 s37,s37,229376
 MM v[100:103],a[220:223],a[12:15],v[100:103]
 s_waitcnt vmcnt(40)
 s_waitcnt lgkmcnt(0)
 s_barrier
 MM v[72:75],a[56:59],a[16:19],v[72:75]
 RT a[0:1],v50
 MM v[76:79],a[56:59],a[20:23],v[76:79]
 RT a[2:3],v50 offset:1024
 MM v[80:83],a[112:115],a[16:19],v[80:83]
 RT a[4:5],v51
 MM v[84:87],a[112:115],a[20:23],v[84:87]
 RT a[6:7],v51 offset:1024
 MM v[88:91],a[168:171],a[16:19],v[88:91]
 RT a[8:9],v50 offset:8192
 MM v[92:95],a[168:171],a[20:23],v[92:95]
 RT a[10:11],v50 offset:9216
 MM v[96:99],a[224:227],a[16:19],v[96:99]
 RT a[12:13],v51 offset:8192
 MM v[100:103],a[224:227],a[20:23],v[100:103]
 RT a[14:15],v51 offset:9216
 s_add_u32 m0,s39,114688
 MM v[72:75],a[60:63],a[24:27],v[72:75]
 BL v40,s[92:95],s37 offen  lds
 MM v[76:79],a[60:63],a[28:31],v[76:79]
 BL v41,s[92:95],s37 offen offset:1024  lds
 MM v[80:83],a[116:119],a[24:27],v[80:83]
 MM v[84:87],a[116:119],a[28:31],v[84:87]
 BL v42,s[92:95],s37 offen offset:2048  lds
 MM v[88:91],a[172:175],a[24:27],v[88:91]
 MM v[92:95],a[172:175],a[28:31],v[92:95]
 BL v43,s[92:95],s37 offen offset:3072  lds
 MM v[96:99],a[228:231],a[24:27],v[96:99]
 s_add_u32 s37,s37,4293591296
 MM v[100:103],a[228:231],a[28:31],v[100:103]
 s_waitcnt vmcnt(40)
 s_waitcnt lgkmcnt(0)
 s_barrier
 MM v[72:75],a[64:67],a[0:3],v[72:75]
 RT a[16:17],v50 offset:16384
 MM v[76:79],a[64:67],a[4:7],v[76:79]
 RT a[18:19],v50 offset:17408
 MM v[80:83],a[120:123],a[0:3],v[80:83]
 RT a[20:21],v51 offset:16384
 MM v[84:87],a[120:123],a[4:7],v[84:87]
 RT a[22:23],v51 offset:17408
 MM v[88:91],a[176:179],a[0:3],v[88:91]
 RT a[24:25],v50 offset:24576
 MM v[92:95],a[176:179],a[4:7],v[92:95]
 RT a[26:27],v50 offset:25600
 MM v[96:99],a[232:235],a[0:3],v[96:99]
 RT a[28:29],v51 offset:24576
 MM v[100:103],a[232:235],a[4:7],v[100:103]
 RT a[30:31],v51 offset:25600
 s_add_u32 m0,s39,131072
 MM v[72:75],a[68:71],a[8:11],v[72:75]
 BL v40,s[92:95],s37 offen  lds
 MM v[76:79],a[68:71],a[12:15],v[76:79]
 BL v41,s[92:95],s37 offen offset:1024  lds
 MM v[80:83],a[124:127],a[8:11],v[80:83]
 MM v[84:87],a[124:127],a[12:15],v[84:87]
 BL v42,s[92:95],s37 offen offset:2048  lds
 MM v[88:91],a[180:183],a[8:11],v[88:91]
 MM v[92:95],a[180:183],a[12:15],v[92:95]
 BL v43,s[92:95],s37 offen offset:3072  lds
 MM v[96:99],a[236:239],a[8:11],v[96:99]
 s_add_u32 s37,s37,229376
 MM v[100:103],a[236:239],a[12:15],v[100:103]
 s_waitcnt vmcnt(40)
 s_waitcnt lgkmcnt(0)
 s_barrier
 MM v[72:75],a[72:75],a[16:19],v[72:75]
 RT a[0:1],v46
 MM v[76:79],a[72:75],a[20:23],v[76:79]
 RT a[2:3],v46 offset:1024
 MM v[80:83],a[128:131],a[16:19],v[80:83]
 RT a[4:5],v47
 MM v[84:87],a[128:131],a[20:23],v[84:87]
 RT a[6:7],v47 offset:1024
 MM v[88:91],a[184:187],a[16:19],v[88:91]
 RT a[8:9],v46 offset:8192
 MM v[92:95],a[184:187],a[20:23],v[92:95]
 RT a[10:11],v46 offset:9216
 MM v[96:99],a[240:243],a[16:19],v[96:99]
 RT a[12:13],v47 offset:8192
 MM v[100:103],a[240:243],a[20:23],v[100:103]
 RT a[14:15],v47 offset:9216
 s_add_u32 m0,s39,147456
 MM v[72:75],a[76:79],a[24:27],v[72:75]
 BL v40,s[92:95],s37 offen  lds
 MM v[76:79],a[76:79],a[28:31],v[76:79]
 BL v41,s[92:95],s37 offen offset:1024  lds
 MM v[80:83],a[132:135],a[24:27],v[80:83]
 MM v[84:87],a[132:135],a[28:31],v[84:87]
 BL v42,s[92:95],s37 offen offset:2048  lds
 MM v[88:91],a[188:191],a[24:27],v[88:91]
 MM v[92:95],a[188:191],a[28:31],v[92:95]
 BL v43,s[92:95],s37 offen offset:3072  lds
 MM v[96:99],a[244:247],a[24:27],v[96:99]
 s_add_u32 s37,s37,229376
 MM v[100:103],a[244:247],a[28:31],v[100:103]
 s_waitcnt vmcnt(40)
 s_waitcnt lgkmcnt(0)
 s_barrier
 MM v[72:75],a[80:83],a[0:3],v[72:75]
 RT a[16:17],v46 offset:16384
 MM v[76:79],a[80:83],a[4:7],v[76:79]
 RT a[18:19],v46 offset:17408
 MM v[80:83],a[136:139],a[0:3],v[80:83]
 RT a[20:21],v47 offset:16384
 MM v[84:87],a[136:139],a[4:7],v[84:87]
 RT a[22:23],v47 offset:17408
 MM v[88:91],a[192:195],a[0:3],v[88:91]
 RT a[24:25],v46 offset:24576
 MM v[92:95],a[192:195],a[4:7],v[92:95]
 RT a[26:27],v46 offset:25600
 MM v[96:99],a[248:251],a[0:3],v[96:99]
 RT a[28:29],v47 offset:24576
 MM v[100:103],a[248:251],a[4:7],v[100:103]
 RT a[30:31],v47 offset:25600
 s_add_u32 m0,s39,0
 MM v[72:75],a[84:87],a[8:11],v[72:75]
 BL v40,s[92:95],s37 offen  lds
 MM v[76:79],a[84:87],a[12:15],v[76:79]
 BL v41,s[92:95],s37 offen offset:1024  lds
 MM v[80:83],a[140:143],a[8:11],v[80:83]
 MM v[84:87],a[140:143],a[12:15],v[84:87]
 BL v42,s[92:95],s37 offen offset:2048  lds
 MM v[88:91],a[196:199],a[8:11],v[88:91]
 MM v[92:95],a[196:199],a[12:15],v[92:95]
 BL v43,s[92:95],s37 offen offset:3072  lds
 MM v[96:99],a[252:255],a[8:11],v[96:99]
 s_add_u32 s37,s37,229376
 MM v[100:103],a[252:255],a[12:15],v[100:103]
 PM v[104:105],v[72:73],v[72:73]
 PM v[106:107],v[74:75],v[74:75]
 PM v[108:109],v[76:77],v[76:77]
 PM v[110:111],v[78:79],v[78:79]
 v_pk_fma_f32 v[104:105],v[104:105],v[60:61],v[58:59]
 v_pk_fma_f32 v[106:107],v[106:107],v[60:61],v[58:59]
 v_pk_fma_f32 v[108:109],v[108:109],v[60:61],v[58:59]
 v_pk_fma_f32 v[110:111],v[110:111],v[60:61],v[58:59]
 PM v[104:105],v[104:105],v[72:73]
 PM v[106:107],v[106:107],v[74:75]
 PM v[108:109],v[108:109],v[76:77]
 PM v[110:111],v[110:111],v[78:79]
 v_exp_f32 v104,v104
 v_exp_f32 v105,v105
 v_exp_f32 v106,v106
 v_exp_f32 v107,v107
 v_exp_f32 v108,v108
 v_exp_f32 v109,v109
 v_exp_f32 v110,v110
 v_exp_f32 v111,v111
 v_pk_add_f32 v[104:105],v[104:105],1.0 op_sel_hi:[1,0]
 v_pk_add_f32 v[106:107],v[106:107],1.0 op_sel_hi:[1,0]
 v_pk_add_f32 v[108:109],v[108:109],1.0 op_sel_hi:[1,0]
 v_pk_add_f32 v[110:111],v[110:111],1.0 op_sel_hi:[1,0]
 v_rcp_f32 v104,v104
 v_rcp_f32 v105,v105
 v_rcp_f32 v106,v106
 v_rcp_f32 v107,v107
 v_rcp_f32 v108,v108
 v_rcp_f32 v109,v109
 v_rcp_f32 v110,v110
 v_rcp_f32 v111,v111
 PM v[72:73],v[72:73],v[104:105]
 PM v[74:75],v[74:75],v[106:107]
 PM v[76:77],v[76:77],v[108:109]
 PM v[78:79],v[78:79],v[110:111]
 v_pk_add_f32 v[224:225],v[224:225],v[72:73]
 v_pk_fma_f32 v[240:241],v[72:73],v[72:73],v[240:241]
 CV v144,v72,v73
 v_pk_add_f32 v[226:227],v[226:227],v[74:75]
 v_pk_fma_f32 v[242:243],v[74:75],v[74:75],v[242:243]
 CV v145,v74,v75
 v_pk_add_f32 v[224:225],v[224:225],v[76:77]
 v_pk_fma_f32 v[240:241],v[76:77],v[76:77],v[240:241]
 CV v148,v76,v77
 v_pk_add_f32 v[226:227],v[226:227],v[78:79]
 v_pk_fma_f32 v[242:243],v[78:79],v[78:79],v[242:243]
 CV v149,v78,v79
 PM v[104:105],v[80:81],v[80:81]
 PM v[106:107],v[82:83],v[82:83]
 PM v[108:109],v[84:85],v[84:85]
 PM v[110:111],v[86:87],v[86:87]
 v_pk_fma_f32 v[104:105],v[104:105],v[60:61],v[58:59]
 v_pk_fma_f32 v[106:107],v[106:107],v[60:61],v[58:59]
 v_pk_fma_f32 v[108:109],v[108:109],v[60:61],v[58:59]
 v_pk_fma_f32 v[110:111],v[110:111],v[60:61],v[58:59]
 PM v[104:105],v[104:105],v[80:81]
 PM v[106:107],v[106:107],v[82:83]
 PM v[108:109],v[108:109],v[84:85]
 PM v[110:111],v[110:111],v[86:87]
 v_exp_f32 v104,v104
 v_exp_f32 v105,v105
 v_exp_f32 v106,v106
 v_exp_f32 v107,v107
 v_exp_f32 v108,v108
 v_exp_f32 v109,v109
 v_exp_f32 v110,v110
 v_exp_f32 v111,v111
 v_pk_add_f32 v[104:105],v[104:105],1.0 op_sel_hi:[1,0]
 v_pk_add_f32 v[106:107],v[106:107],1.0 op_sel_hi:[1,0]
 v_pk_add_f32 v[108:109],v[108:109],1.0 op_sel_hi:[1,0]
 v_pk_add_f32 v[110:111],v[110:111],1.0 op_sel_hi:[1,0]
 v_rcp_f32 v104,v104
 v_rcp_f32 v105,v105
 v_rcp_f32 v106,v106
 v_rcp_f32 v107,v107
 v_rcp_f32 v108,v108
 v_rcp_f32 v109,v109
 v_rcp_f32 v110,v110
 v_rcp_f32 v111,v111
 PM v[80:81],v[80:81],v[104:105]
 PM v[82:83],v[82:83],v[106:107]
 PM v[84:85],v[84:85],v[108:109]
 PM v[86:87],v[86:87],v[110:111]
 v_pk_add_f32 v[228:229],v[228:229],v[80:81]
 v_pk_fma_f32 v[244:245],v[80:81],v[80:81],v[244:245]
 CV v146,v80,v81
 v_pk_add_f32 v[230:231],v[230:231],v[82:83]
 v_pk_fma_f32 v[246:247],v[82:83],v[82:83],v[246:247]
 CV v147,v82,v83
 v_pk_add_f32 v[228:229],v[228:229],v[84:85]
 v_pk_fma_f32 v[244:245],v[84:85],v[84:85],v[244:245]
 CV v150,v84,v85
 v_pk_add_f32 v[230:231],v[230:231],v[86:87]
 v_pk_fma_f32 v[246:247],v[86:87],v[86:87],v[246:247]
 CV v151,v86,v87
 PM v[104:105],v[88:89],v[88:89]
 PM v[106:107],v[90:91],v[90:91]
 PM v[108:109],v[92:93],v[92:93]
 PM v[110:111],v[94:95],v[94:95]
 v_pk_fma_f32 v[104:105],v[104:105],v[60:61],v[58:59]
 v_pk_fma_f32 v[106:107],v[106:107],v[60:61],v[58:59]
 v_pk_fma_f32 v[108:109],v[108:109],v[60:61],v[58:59]
 v_pk_fma_f32 v[110:111],v[110:111],v[60:61],v[58:59]
 PM v[104:105],v[104:105],v[88:89]
 PM v[106:107],v[106:107],v[90:91]
 PM v[108:109],v[108:109],v[92:93]
 PM v[110:111],v[110:111],v[94:95]
 v_exp_f32 v104,v104
 v_exp_f32 v105,v105
 v_exp_f32 v106,v106
 v_exp_f32 v107,v107
 v_exp_f32 v108,v108
 v_exp_f32 v109,v109
 v_exp_f32 v110,v110
 v_exp_f32 v111,v111
 v_pk_add_f32 v[104:105],v[104:105],1.0 op_sel_hi:[1,0]
 v_pk_add_f32 v[106:107],v[106:107],1.0 op_sel_hi:[1,0]
 v_pk_add_f32 v[108:109],v[108:109],1.0 op_sel_hi:[1,0]
 v_pk_add_f32 v[110:111],v[110:111],1.0 op_sel_hi:[1,0]
 v_rcp_f32 v104,v104
 v_rcp_f32 v105,v105
 v_rcp_f32 v106,v106
 v_rcp_f32 v107,v107
 v_rcp_f32 v108,v108
 v_rcp_f32 v109,v109
 v_rcp_f32 v110,v110
 v_rcp_f32 v111,v111
 PM v[88:89],v[88:89],v[104:105]
 PM v[90:91],v[90:91],v[106:107]
 PM v[92:93],v[92:93],v[108:109]
 PM v[94:95],v[94:95],v[110:111]
 v_pk_add_f32 v[232:233],v[232:233],v[88:89]
 v_pk_fma_f32 v[248:249],v[88:89],v[88:89],v[248:249]
 CV v152,v88,v89
 v_pk_add_f32 v[234:235],v[234:235],v[90:91]
 v_pk_fma_f32 v[250:251],v[90:91],v[90:91],v[250:251]
 CV v153,v90,v91
 v_pk_add_f32 v[232:233],v[232:233],v[92:93]
 v_pk_fma_f32 v[248:249],v[92:93],v[92:93],v[248:249]
 CV v156,v92,v93
 v_pk_add_f32 v[234:235],v[234:235],v[94:95]
 v_pk_fma_f32 v[250:251],v[94:95],v[94:95],v[250:251]
 CV v157,v94,v95
 PM v[104:105],v[96:97],v[96:97]
 PM v[106:107],v[98:99],v[98:99]
 PM v[108:109],v[100:101],v[100:101]
 PM v[110:111],v[102:103],v[102:103]
 v_pk_fma_f32 v[104:105],v[104:105],v[60:61],v[58:59]
 v_pk_fma_f32 v[106:107],v[106:107],v[60:61],v[58:59]
 v_pk_fma_f32 v[108:109],v[108:109],v[60:61],v[58:59]
 v_pk_fma_f32 v[110:111],v[110:111],v[60:61],v[58:59]
 PM v[104:105],v[104:105],v[96:97]
 PM v[106:107],v[106:107],v[98:99]
 PM v[108:109],v[108:109],v[100:101]
 PM v[110:111],v[110:111],v[102:103]
 v_exp_f32 v104,v104
 v_exp_f32 v105,v105
 v_exp_f32 v106,v106
 v_exp_f32 v107,v107
 v_exp_f32 v108,v108
 v_exp_f32 v109,v109
 v_exp_f32 v110,v110
 v_exp_f32 v111,v111
 v_pk_add_f32 v[104:105],v[104:105],1.0 op_sel_hi:[1,0]
 v_pk_add_f32 v[106:107],v[106:107],1.0 op_sel_hi:[1,0]
 v_pk_add_f32 v[108:109],v[108:109],1.0 op_sel_hi:[1,0]
 v_pk_add_f32 v[110:111],v[110:111],1.0 op_sel_hi:[1,0]
 v_rcp_f32 v104,v104
 v_rcp_f32 v105,v105
 v_rcp_f32 v106,v106
 v_rcp_f32 v107,v107
 v_rcp_f32 v108,v108
 v_rcp_f32 v109,v109
 v_rcp_f32 v110,v110
 v_rcp_f32 v111,v111
 PM v[96:97],v[96:97],v[104:105]
 PM v[98:99],v[98:99],v[106:107]
 PM v[100:101],v[100:101],v[108:109]
 PM v[102:103],v[102:103],v[110:111]
 v_pk_add_f32 v[236:237],v[236:237],v[96:97]
 v_pk_fma_f32 v[252:253],v[96:97],v[96:97],v[252:253]
 CV v154,v96,v97
 v_pk_add_f32 v[238:239],v[238:239],v[98:99]
 v_pk_fma_f32 v[254:255],v[98:99],v[98:99],v[254:255]
 CV v155,v98,v99
 v_pk_add_f32 v[236:237],v[236:237],v[100:101]
 v_pk_fma_f32 v[252:253],v[100:101],v[100:101],v[252:253]
 CV v158,v100,v101
 v_pk_add_f32 v[238:239],v[238:239],v[102:103]
 v_pk_fma_f32 v[254:255],v[102:103],v[102:103],v[254:255]
 CV v159,v102,v103
 s_waitcnt vmcnt(40)
 s_waitcnt lgkmcnt(0)
 s_barrier
 MM v[72:75],a[32:35],a[16:19],0
 RT a[0:1],v46 offset:32768
 MM v[76:79],a[32:35],a[20:23],0
 RT a[2:3],v46 offset:33792
 MM v[80:83],a[88:91],a[16:19],0
 RT a[4:5],v47 offset:32768
 MM v[84:87],a[88:91],a[20:23],0
 RT a[6:7],v47 offset:33792
 MM v[88:91],a[144:147],a[16:19],0
 RT a[8:9],v46 offset:40960
 MM v[92:95],a[144:147],a[20:23],0
 RT a[10:11],v46 offset:41984
 MM v[96:99],a[200:203],a[16:19],0
 RT a[12:13],v47 offset:40960
 MM v[100:103],a[200:203],a[20:23],0
 RT a[14:15],v47 offset:41984
 s_add_u32 m0,s39,16384
 MM v[72:75],a[36:39],a[24:27],v[72:75]
 BL v40,s[92:95],s37 offen  lds
 MM v[76:79],a[36:39],a[28:31],v[76:79]
 BL v41,s[92:95],s37 offen offset:1024  lds
 MM v[80:83],a[92:95],a[24:27],v[80:83]
 MM v[84:87],a[92:95],a[28:31],v[84:87]
 BL v42,s[92:95],s37 offen offset:2048  lds
 MM v[88:91],a[148:151],a[24:27],v[88:91]
 MM v[92:95],a[148:151],a[28:31],v[92:95]
 BL v43,s[92:95],s37 offen offset:3072  lds
 MM v[96:99],a[204:207],a[24:27],v[96:99]
 s_add_u32 s37,s37,229376
 MM v[100:103],a[204:207],a[28:31],v[100:103]
 s_waitcnt vmcnt(40)
 s_waitcnt lgkmcnt(0)
 s_barrier
 MM v[72:75],a[40:43],a[0:3],v[72:75]
 RT a[16:17],v46 offset:49152
 MM v[76:79],a[40:43],a[4:7],v[76:79]
 RT a[18:19],v46 offset:50176
 MM v[80:83],a[96:99],a[0:3],v[80:83]
 RT a[20:21],v47 offset:49152
 MM v[84:87],a[96:99],a[4:7],v[84:87]
 RT a[22:23],v47 offset:50176
 MM v[88:91],a[152:155],a[0:3],v[88:91]
 RT a[24:25],v46 offset:57344
 MM v[92:95],a[152:155],a[4:7],v[92:95]
 RT a[26:27],v46 offset:58368
 MM v[96:99],a[208:211],a[0:3],v[96:99]
 RT a[28:29],v47 offset:57344
 MM v[100:103],a[208:211],a[4:7],v[100:103]
 RT a[30:31],v47 offset:58368
 s_add_u32 m0,s39,32768
 MM v[72:75],a[44:47],a[8:11],v[72:75]
 BL v40,s[92:95],s37 offen  lds
 MM v[76:79],a[44:47],a[12:15],v[76:79]
 BL v41,s[92:95],s37 offen offset:1024  lds
 MM v[80:83],a[100:103],a[8:11],v[80:83]
 MM v[84:87],a[100:103],a[12:15],v[84:87]
 BL v42,s[92:95],s37 offen offset:2048  lds
 MM v[88:91],a[156:159],a[8:11],v[88:91]
 MM v[92:95],a[156:159],a[12:15],v[92:95]
 BL v43,s[92:95],s37 offen offset:3072  lds
 MM v[96:99],a[212:215],a[8:11],v[96:99]
 s_add_u32 s37,s37,229376
 MM v[100:103],a[212:215],a[12:15],v[100:103]
 s_waitcnt vmcnt(32)
 s_waitcnt lgkmcnt(0)
 s_barrier
 MM v[72:75],a[48:51],a[16:19],v[72:75]
 RT a[0:1],v48
 MM v[76:79],a[48:51],a[20:23],v[76:79]
 RT a[2:3],v48 offset:1024
 MM v[80:83],a[104:107],a[16:19],v[80:83]
 RT a[4:5],v49
 MM v[84:87],a[104:107],a[20:23],v[84:87]
 RT a[6:7],v49 offset:1024
 MM v[88:91],a[160:163],a[16:19],v[88:91]
 RT a[8:9],v48 offset:8192
 MM v[92:95],a[160:163],a[20:23],v[92:95]
 RT a[10:11],v48 offset:9216
 MM v[96:99],a[216:219],a[16:19],v[96:99]
 RT a[12:13],v49 offset:8192
 MM v[100:103],a[216:219],a[20:23],v[100:103]
 RT a[14:15],v49 offset:9216
 s_add_u32 m0,s39,49152
 MM v[72:75],a[52:55],a[24:27],v[72:75]
 BL v40,s[92:95],s37 offen  lds
 MM v[76:79],a[52:55],a[28:31],v[76:79]
 BL v41,s[92:95],s37 offen offset:1024  lds
 MM v[80:83],a[108:111],a[24:27],v[80:83]
 MM v[84:87],a[108:111],a[28:31],v[84:87]
 BL v42,s[92:95],s37 offen offset:2048  lds
 MM v[88:91],a[164:167],a[24:27],v[88:91]
 MM v[92:95],a[164:167],a[28:31],v[92:95]
 BL v43,s[92:95],s37 offen offset:3072  lds
 MM v[96:99],a[220:223],a[24:27],v[96:99]
 s_add_u32 s37,s37,229376
 MM v[100:103],a[220:223],a[28:31],v[100:103]
 s_waitcnt vmcnt(32)
 s_waitcnt lgkmcnt(0)
 s_barrier
 MM v[72:75],a[56:59],a[0:3],v[72:75]
 RT a[16:17],v48 offset:16384
 MM v[76:79],a[56:59],a[4:7],v[76:79]
 RT a[18:19],v48 offset:17408
 MM v[80:83],a[112:115],a[0:3],v[80:83]
 RT a[20:21],v49 offset:16384
 MM v[84:87],a[112:115],a[4:7],v[84:87]
 RT a[22:23],v49 offset:17408
 MM v[88:91],a[168:171],a[0:3],v[88:91]
 RT a[24:25],v48 offset:24576
 MM v[92:95],a[168:171],a[4:7],v[92:95]
 RT a[26:27],v48 offset:25600
 MM v[96:99],a[224:227],a[0:3],v[96:99]
 RT a[28:29],v49 offset:24576
 MM v[100:103],a[224:227],a[4:7],v[100:103]
 RT a[30:31],v49 offset:25600
 s_add_u32 m0,s39,65536
 MM v[72:75],a[60:63],a[8:11],v[72:75]
 BL v40,s[92:95],s37 offen  lds
 MM v[76:79],a[60:63],a[12:15],v[76:79]
 BL v41,s[92:95],s37 offen offset:1024  lds
 MM v[80:83],a[116:119],a[8:11],v[80:83]
 MM v[84:87],a[116:119],a[12:15],v[84:87]
 BL v42,s[92:95],s37 offen offset:2048  lds
 MM v[88:91],a[172:175],a[8:11],v[88:91]
 MM v[92:95],a[172:175],a[12:15],v[92:95]
 BL v43,s[92:95],s37 offen offset:3072  lds
 MM v[96:99],a[228:231],a[8:11],v[96:99]
 s_add_u32 s37,s37,4293591296
 MM v[100:103],a[228:231],a[12:15],v[100:103]
 s_waitcnt vmcnt(32)
 s_waitcnt lgkmcnt(0)
 s_barrier
 MM v[72:75],a[64:67],a[16:19],v[72:75]
 RT a[0:1],v48 offset:32768
 MM v[76:79],a[64:67],a[20:23],v[76:79]
 RT a[2:3],v48 offset:33792
 MM v[80:83],a[120:123],a[16:19],v[80:83]
 RT a[4:5],v49 offset:32768
 MM v[84:87],a[120:123],a[20:23],v[84:87]
 RT a[6:7],v49 offset:33792
 MM v[88:91],a[176:179],a[16:19],v[88:91]
 RT a[8:9],v48 offset:40960
 MM v[92:95],a[176:179],a[20:23],v[92:95]
 RT a[10:11],v48 offset:41984
 MM v[96:99],a[232:235],a[16:19],v[96:99]
 RT a[12:13],v49 offset:40960
 MM v[100:103],a[232:235],a[20:23],v[100:103]
 RT a[14:15],v49 offset:41984
 s_add_u32 m0,s39,81920
 MM v[72:75],a[68:71],a[24:27],v[72:75]
 BL v40,s[92:95],s37 offen  lds
 MM v[76:79],a[68:71],a[28:31],v[76:79]
 BL v41,s[92:95],s37 offen offset:1024  lds
 MM v[80:83],a[124:127],a[24:27],v[80:83]
 MM v[84:87],a[124:127],a[28:31],v[84:87]
 BL v42,s[92:95],s37 offen offset:2048  lds
 MM v[88:91],a[180:183],a[24:27],v[88:91]
 MM v[92:95],a[180:183],a[28:31],v[92:95]
 BL v43,s[92:95],s37 offen offset:3072  lds
 MM v[96:99],a[236:239],a[24:27],v[96:99]
 s_add_u32 s37,s37,229376
 MM v[100:103],a[236:239],a[28:31],v[100:103]
 s_waitcnt vmcnt(32)
 s_waitcnt lgkmcnt(0)
 s_barrier
 MM v[72:75],a[72:75],a[0:3],v[72:75]
 RT a[16:17],v48 offset:49152
 MM v[76:79],a[72:75],a[4:7],v[76:79]
 RT a[18:19],v48 offset:50176
 MM v[80:83],a[128:131],a[0:3],v[80:83]
 RT a[20:21],v49 offset:49152
 MM v[84:87],a[128:131],a[4:7],v[84:87]
 RT a[22:23],v49 offset:50176
 MM v[88:91],a[184:187],a[0:3],v[88:91]
 RT a[24:25],v48 offset:57344
 MM v[92:95],a[184:187],a[4:7],v[92:95]
 RT a[26:27],v48 offset:58368
 MM v[96:99],a[240:243],a[0:3],v[96:99]
 RT a[28:29],v49 offset:57344
 MM v[100:103],a[240:243],a[4:7],v[100:103]
 RT a[30:31],v49 offset:58368
 s_add_u32 m0,s39,98304
 MM v[72:75],a[76:79],a[8:11],v[72:75]
 BL v40,s[92:95],s37 offen  lds
 MM v[76:79],a[76:79],a[12:15],v[76:79]
 BL v41,s[92:95],s37 offen offset:1024  lds
 MM v[80:83],a[132:135],a[8:11],v[80:83]
 MM v[84:87],a[132:135],a[12:15],v[84:87]
 BL v42,s[92:95],s37 offen offset:2048  lds
 MM v[88:91],a[188:191],a[8:11],v[88:91]
 MM v[92:95],a[188:191],a[12:15],v[92:95]
 BL v43,s[92:95],s37 offen offset:3072  lds
 MM v[96:99],a[244:247],a[8:11],v[96:99]
 s_add_u32 s37,s37,229376
 MM v[100:103],a[244:247],a[12:15],v[100:103]
 s_waitcnt vmcnt(32)
 s_waitcnt lgkmcnt(0)
 s_barrier
 MM v[72:75],a[80:83],a[16:19],v[72:75]
 RT a[0:1],v50
 MM v[76:79],a[80:83],a[20:23],v[76:79]
 RT a[2:3],v50 offset:1024
 MM v[80:83],a[136:139],a[16:19],v[80:83]
 RT a[4:5],v51
 MM v[84:87],a[136:139],a[20:23],v[84:87]
 RT a[6:7],v51 offset:1024
 MM v[88:91],a[192:195],a[16:19],v[88:91]
 RT a[8:9],v50 offset:8192
 MM v[92:95],a[192:195],a[20:23],v[92:95]
 RT a[10:11],v50 offset:9216
 MM v[96:99],a[248:251],a[16:19],v[96:99]
 RT a[12:13],v51 offset:8192
 MM v[100:103],a[248:251],a[20:23],v[100:103]
 RT a[14:15],v51 offset:9216
 s_add_u32 m0,s39,114688
 MM v[72:75],a[84:87],a[24:27],v[72:75]
 BL v40,s[92:95],s37 offen  lds
 MM v[76:79],a[84:87],a[28:31],v[76:79]
 BL v41,s[92:95],s37 offen offset:1024  lds
 MM v[80:83],a[140:143],a[24:27],v[80:83]
 MM v[84:87],a[140:143],a[28:31],v[84:87]
 BL v42,s[92:95],s37 offen offset:2048  lds
 MM v[88:91],a[196:199],a[24:27],v[88:91]
 MM v[92:95],a[196:199],a[28:31],v[92:95]
 BL v43,s[92:95],s37 offen offset:3072  lds
 MM v[96:99],a[252:255],a[24:27],v[96:99]
 s_add_u32 s37,s37,229376
 MM v[100:103],a[252:255],a[28:31],v[100:103]
 PM v[104:105],v[72:73],v[72:73]
 PM v[106:107],v[74:75],v[74:75]
 PM v[108:109],v[76:77],v[76:77]
 PM v[110:111],v[78:79],v[78:79]
 v_pk_fma_f32 v[104:105],v[104:105],v[60:61],v[58:59]
 v_pk_fma_f32 v[106:107],v[106:107],v[60:61],v[58:59]
 v_pk_fma_f32 v[108:109],v[108:109],v[60:61],v[58:59]
 v_pk_fma_f32 v[110:111],v[110:111],v[60:61],v[58:59]
 PM v[104:105],v[104:105],v[72:73]
 PM v[106:107],v[106:107],v[74:75]
 PM v[108:109],v[108:109],v[76:77]
 PM v[110:111],v[110:111],v[78:79]
 v_exp_f32 v104,v104
 v_exp_f32 v105,v105
 v_exp_f32 v106,v106
 v_exp_f32 v107,v107
 v_exp_f32 v108,v108
 v_exp_f32 v109,v109
 v_exp_f32 v110,v110
 v_exp_f32 v111,v111
 v_pk_add_f32 v[104:105],v[104:105],1.0 op_sel_hi:[1,0]
 v_pk_add_f32 v[106:107],v[106:107],1.0 op_sel_hi:[1,0]
 v_pk_add_f32 v[108:109],v[108:109],1.0 op_sel_hi:[1,0]
 v_pk_add_f32 v[110:111],v[110:111],1.0 op_sel_hi:[1,0]
 v_rcp_f32 v104,v104
 v_rcp_f32 v105,v105
 v_rcp_f32 v106,v106
 v_rcp_f32 v107,v107
 v_rcp_f32 v108,v108
 v_rcp_f32 v109,v109
 v_rcp_f32 v110,v110
 v_rcp_f32 v111,v111
 PM v[72:73],v[72:73],v[104:105]
 PM v[74:75],v[74:75],v[106:107]
 PM v[76:77],v[76:77],v[108:109]
 PM v[78:79],v[78:79],v[110:111]
 v_pk_add_f32 v[224:225],v[224:225],v[72:73]
 v_pk_fma_f32 v[240:241],v[72:73],v[72:73],v[240:241]
 CV v160,v72,v73
 v_pk_add_f32 v[226:227],v[226:227],v[74:75]
 v_pk_fma_f32 v[242:243],v[74:75],v[74:75],v[242:243]
 CV v161,v74,v75
 v_pk_add_f32 v[224:225],v[224:225],v[76:77]
 v_pk_fma_f32 v[240:241],v[76:77],v[76:77],v[240:241]
 CV v164,v76,v77
 v_pk_add_f32 v[226:227],v[226:227],v[78:79]
 v_pk_fma_f32 v[242:243],v[78:79],v[78:79],v[242:243]
 CV v165,v78,v79
 PM v[104:105],v[80:81],v[80:81]
 PM v[106:107],v[82:83],v[82:83]
 PM v[108:109],v[84:85],v[84:85]
 PM v[110:111],v[86:87],v[86:87]
 v_pk_fma_f32 v[104:105],v[104:105],v[60:61],v[58:59]
 v_pk_fma_f32 v[106:107],v[106:107],v[60:61],v[58:59]
 v_pk_fma_f32 v[108:109],v[108:109],v[60:61],v[58:59]
 v_pk_fma_f32 v[110:111],v[110:111],v[60:61],v[58:59]
 PM v[104:105],v[104:105],v[80:81]
 PM v[106:107],v[106:107],v[82:83]
 PM v[108:109],v[108:109],v[84:85]
 PM v[110:111],v[110:111],v[86:87]
 v_exp_f32 v104,v104
 v_exp_f32 v105,v105
 v_exp_f32 v106,v106
 v_exp_f32 v107,v107
 v_exp_f32 v108,v108
 v_exp_f32 v109,v109
 v_exp_f32 v110,v110
 v_exp_f32 v111,v111
 v_pk_add_f32 v[104:105],v[104:105],1.0 op_sel_hi:[1,0]
 v_pk_add_f32 v[106:107],v[106:107],1.0 op_sel_hi:[1,0]
 v_pk_add_f32 v[108:109],v[108:109],1.0 op_sel_hi:[1,0]
 v_pk_add_f32 v[110:111],v[110:111],1.0 op_sel_hi:[1,0]
 v_rcp_f32 v104,v104
 v_rcp_f32 v105,v105
 v_rcp_f32 v106,v106
 v_rcp_f32 v107,v107
 v_rcp_f32 v108,v108
 v_rcp_f32 v109,v109
 v_rcp_f32 v110,v110
 v_rcp_f32 v111,v111
 PM v[80:81],v[80:81],v[104:105]
 PM v[82:83],v[82:83],v[106:107]
 PM v[84:85],v[84:85],v[108:109]
 PM v[86:87],v[86:87],v[110:111]
 v_pk_add_f32 v[228:229],v[228:229],v[80:81]
 v_pk_fma_f32 v[244:245],v[80:81],v[80:81],v[244:245]
 CV v162,v80,v81
 v_pk_add_f32 v[230:231],v[230:231],v[82:83]
 v_pk_fma_f32 v[246:247],v[82:83],v[82:83],v[246:247]
 CV v163,v82,v83
 v_pk_add_f32 v[228:229],v[228:229],v[84:85]
 v_pk_fma_f32 v[244:245],v[84:85],v[84:85],v[244:245]
 CV v166,v84,v85
 v_pk_add_f32 v[230:231],v[230:231],v[86:87]
 v_pk_fma_f32 v[246:247],v[86:87],v[86:87],v[246:247]
 CV v167,v86,v87
 PM v[104:105],v[88:89],v[88:89]
 PM v[106:107],v[90:91],v[90:91]
 PM v[108:109],v[92:93],v[92:93]
 PM v[110:111],v[94:95],v[94:95]
 v_pk_fma_f32 v[104:105],v[104:105],v[60:61],v[58:59]
 v_pk_fma_f32 v[106:107],v[106:107],v[60:61],v[58:59]
 v_pk_fma_f32 v[108:109],v[108:109],v[60:61],v[58:59]
 v_pk_fma_f32 v[110:111],v[110:111],v[60:61],v[58:59]
 PM v[104:105],v[104:105],v[88:89]
 PM v[106:107],v[106:107],v[90:91]
 PM v[108:109],v[108:109],v[92:93]
 PM v[110:111],v[110:111],v[94:95]
 v_exp_f32 v104,v104
 v_exp_f32 v105,v105
 v_exp_f32 v106,v106
 v_exp_f32 v107,v107
 v_exp_f32 v108,v108
 v_exp_f32 v109,v109
 v_exp_f32 v110,v110
 v_exp_f32 v111,v111
 v_pk_add_f32 v[104:105],v[104:105],1.0 op_sel_hi:[1,0]
 v_pk_add_f32 v[106:107],v[106:107],1.0 op_sel_hi:[1,0]
 v_pk_add_f32 v[108:109],v[108:109],1.0 op_sel_hi:[1,0]
 v_pk_add_f32 v[110:111],v[110:111],1.0 op_sel_hi:[1,0]
 v_rcp_f32 v104,v104
 v_rcp_f32 v105,v105
 v_rcp_f32 v106,v106
 v_rcp_f32 v107,v107
 v_rcp_f32 v108,v108
 v_rcp_f32 v109,v109
 v_rcp_f32 v110,v110
 v_rcp_f32 v111,v111
 PM v[88:89],v[88:89],v[104:105]
 PM v[90:91],v[90:91],v[106:107]
 PM v[92:93],v[92:93],v[108:109]
 PM v[94:95],v[94:95],v[110:111]
 v_pk_add_f32 v[232:233],v[232:233],v[88:89]
 v_pk_fma_f32 v[248:249],v[88:89],v[88:89],v[248:249]
 CV v168,v88,v89
 v_pk_add_f32 v[234:235],v[234:235],v[90:91]
 v_pk_fma_f32 v[250:251],v[90:91],v[90:91],v[250:251]
 CV v169,v90,v91
 v_pk_add_f32 v[232:233],v[232:233],v[92:93]
 v_pk_fma_f32 v[248:249],v[92:93],v[92:93],v[248:249]
 CV v172,v92,v93
 v_pk_add_f32 v[234:235],v[234:235],v[94:95]
 v_pk_fma_f32 v[250:251],v[94:95],v[94:95],v[250:251]
 CV v173,v94,v95
 PM v[104:105],v[96:97],v[96:97]
 PM v[106:107],v[98:99],v[98:99]
 PM v[108:109],v[100:101],v[100:101]
 PM v[110:111],v[102:103],v[102:103]
 v_pk_fma_f32 v[104:105],v[104:105],v[60:61],v[58:59]
 v_pk_fma_f32 v[106:107],v[106:107],v[60:61],v[58:59]
 v_pk_fma_f32 v[108:109],v[108:109],v[60:61],v[58:59]
 v_pk_fma_f32 v[110:111],v[110:111],v[60:61],v[58:59]
 PM v[104:105],v[104:105],v[96:97]
 PM v[106:107],v[106:107],v[98:99]
 PM v[108:109],v[108:109],v[100:101]
 PM v[110:111],v[110:111],v[102:103]
 v_exp_f32 v104,v104
 v_exp_f32 v105,v105
 v_exp_f32 v106,v106
 v_exp_f32 v107,v107
 v_exp_f32 v108,v108
 v_exp_f32 v109,v109
 v_exp_f32 v110,v110
 v_exp_f32 v111,v111
 v_pk_add_f32 v[104:105],v[104:105],1.0 op_sel_hi:[1,0]
 v_pk_add_f32 v[106:107],v[106:107],1.0 op_sel_hi:[1,0]
 v_pk_add_f32 v[108:109],v[108:109],1.0 op_sel_hi:[1,0]
 v_pk_add_f32 v[110:111],v[110:111],1.0 op_sel_hi:[1,0]
 v_rcp_f32 v104,v104
 v_rcp_f32 v105,v105
 v_rcp_f32 v106,v106
 v_rcp_f32 v107,v107
 v_rcp_f32 v108,v108
 v_rcp_f32 v109,v109
 v_rcp_f32 v110,v110
 v_rcp_f32 v111,v111
 PM v[96:97],v[96:97],v[104:105]
 PM v[98:99],v[98:99],v[106:107]
 PM v[100:101],v[100:101],v[108:109]
 PM v[102:103],v[102:103],v[110:111]
 v_pk_add_f32 v[236:237],v[236:237],v[96:97]
 v_pk_fma_f32 v[252:253],v[96:97],v[96:97],v[252:253]
 CV v170,v96,v97
 v_pk_add_f32 v[238:239],v[238:239],v[98:99]
 v_pk_fma_f32 v[254:255],v[98:99],v[98:99],v[254:255]
 CV v171,v98,v99
 v_pk_add_f32 v[236:237],v[236:237],v[100:101]
 v_pk_fma_f32 v[252:253],v[100:101],v[100:101],v[252:253]
 CV v174,v100,v101
 v_pk_add_f32 v[238:239],v[238:239],v[102:103]
 v_pk_fma_f32 v[254:255],v[102:103],v[102:103],v[254:255]
 CV v175,v102,v103
 s_waitcnt vmcnt(32)
 s_waitcnt lgkmcnt(0)
 s_barrier
 MM v[72:75],a[32:35],a[0:3],0
 RT a[16:17],v50 offset:16384
 MM v[76:79],a[32:35],a[4:7],0
 RT a[18:19],v50 offset:17408
 MM v[80:83],a[88:91],a[0:3],0
 RT a[20:21],v51 offset:16384
 MM v[84:87],a[88:91],a[4:7],0
 RT a[22:23],v51 offset:17408
 MM v[88:91],a[144:147],a[0:3],0
 RT a[24:25],v50 offset:24576
 MM v[92:95],a[144:147],a[4:7],0
 RT a[26:27],v50 offset:25600
 MM v[96:99],a[200:203],a[0:3],0
 RT a[28:29],v51 offset:24576
 MM v[100:103],a[200:203],a[4:7],0
 RT a[30:31],v51 offset:25600
 s_add_u32 m0,s39,131072
 MM v[72:75],a[36:39],a[8:11],v[72:75]
 BL v40,s[92:95],s37 offen  lds
 MM v[76:79],a[36:39],a[12:15],v[76:79]
 BL v41,s[92:95],s37 offen offset:1024  lds
 MM v[80:83],a[92:95],a[8:11],v[80:83]
 MM v[84:87],a[92:95],a[12:15],v[84:87]
 BL v42,s[92:95],s37 offen offset:2048  lds
 MM v[88:91],a[148:151],a[8:11],v[88:91]
 MM v[92:95],a[148:151],a[12:15],v[92:95]
 BL v43,s[92:95],s37 offen offset:3072  lds
 MM v[96:99],a[204:207],a[8:11],v[96:99]
 s_add_u32 s37,s37,229376
 MM v[100:103],a[204:207],a[12:15],v[100:103]
 s_waitcnt vmcnt(32)
 s_waitcnt lgkmcnt(0)
 s_barrier
 MM v[72:75],a[40:43],a[16:19],v[72:75]
 RT a[0:1],v46
 MM v[76:79],a[40:43],a[20:23],v[76:79]
 RT a[2:3],v46 offset:1024
 MM v[80:83],a[96:99],a[16:19],v[80:83]
 RT a[4:5],v47
 MM v[84:87],a[96:99],a[20:23],v[84:87]
 RT a[6:7],v47 offset:1024
 MM v[88:91],a[152:155],a[16:19],v[88:91]
 RT a[8:9],v46 offset:8192
 MM v[92:95],a[152:155],a[20:23],v[92:95]
 RT a[10:11],v46 offset:9216
 MM v[96:99],a[208:211],a[16:19],v[96:99]
 RT a[12:13],v47 offset:8192
 MM v[100:103],a[208:211],a[20:23],v[100:103]
 RT a[14:15],v47 offset:9216
 s_add_u32 m0,s39,147456
 MM v[72:75],a[44:47],a[24:27],v[72:75]
 BL v40,s[92:95],s37 offen  lds
 MM v[76:79],a[44:47],a[28:31],v[76:79]
 BL v41,s[92:95],s37 offen offset:1024  lds
 MM v[80:83],a[100:103],a[24:27],v[80:83]
 MM v[84:87],a[100:103],a[28:31],v[84:87]
 BL v42,s[92:95],s37 offen offset:2048  lds
 MM v[88:91],a[156:159],a[24:27],v[88:91]
 MM v[92:95],a[156:159],a[28:31],v[92:95]
 BL v43,s[92:95],s37 offen offset:3072  lds
 MM v[96:99],a[212:215],a[24:27],v[96:99]
 s_add_u32 s37,s37,229376
 MM v[100:103],a[212:215],a[28:31],v[100:103]
 s_waitcnt vmcnt(32)
 s_waitcnt lgkmcnt(0)
 s_barrier
 MM v[72:75],a[48:51],a[0:3],v[72:75]
 RT a[16:17],v46 offset:16384
 MM v[76:79],a[48:51],a[4:7],v[76:79]
 RT a[18:19],v46 offset:17408
 MM v[80:83],a[104:107],a[0:3],v[80:83]
 RT a[20:21],v47 offset:16384
 MM v[84:87],a[104:107],a[4:7],v[84:87]
 RT a[22:23],v47 offset:17408
 MM v[88:91],a[160:163],a[0:3],v[88:91]
 RT a[24:25],v46 offset:24576
 MM v[92:95],a[160:163],a[4:7],v[92:95]
 RT a[26:27],v46 offset:25600
 MM v[96:99],a[216:219],a[0:3],v[96:99]
 RT a[28:29],v47 offset:24576
 MM v[100:103],a[216:219],a[4:7],v[100:103]
 RT a[30:31],v47 offset:25600
 s_add_u32 m0,s39,0
 MM v[72:75],a[52:55],a[8:11],v[72:75]
 BL v40,s[92:95],s37 offen  lds
 MM v[76:79],a[52:55],a[12:15],v[76:79]
 BL v41,s[92:95],s37 offen offset:1024  lds
 MM v[80:83],a[108:111],a[8:11],v[80:83]
 MM v[84:87],a[108:111],a[12:15],v[84:87]
 BL v42,s[92:95],s37 offen offset:2048  lds
 MM v[88:91],a[164:167],a[8:11],v[88:91]
 MM v[92:95],a[164:167],a[12:15],v[92:95]
 BL v43,s[92:95],s37 offen offset:3072  lds
 MM v[96:99],a[220:223],a[8:11],v[96:99]
 s_add_u32 s37,s37,229376
 MM v[100:103],a[220:223],a[12:15],v[100:103]
 s_waitcnt vmcnt(32)
 s_waitcnt lgkmcnt(0)
 s_barrier
 MM v[72:75],a[56:59],a[16:19],v[72:75]
 RT a[0:1],v46 offset:32768
 MM v[76:79],a[56:59],a[20:23],v[76:79]
 RT a[2:3],v46 offset:33792
 MM v[80:83],a[112:115],a[16:19],v[80:83]
 RT a[4:5],v47 offset:32768
 MM v[84:87],a[112:115],a[20:23],v[84:87]
 RT a[6:7],v47 offset:33792
 MM v[88:91],a[168:171],a[16:19],v[88:91]
 RT a[8:9],v46 offset:40960
 MM v[92:95],a[168:171],a[20:23],v[92:95]
 RT a[10:11],v46 offset:41984
 MM v[96:99],a[224:227],a[16:19],v[96:99]
 RT a[12:13],v47 offset:40960
 MM v[100:103],a[224:227],a[20:23],v[100:103]
 RT a[14:15],v47 offset:41984
 s_add_u32 m0,s39,16384
 MM v[72:75],a[60:63],a[24:27],v[72:75]
 BL v40,s[92:95],s37 offen  lds
 MM v[76:79],a[60:63],a[28:31],v[76:79]
 BL v41,s[92:95],s37 offen offset:1024  lds
 MM v[80:83],a[116:119],a[24:27],v[80:83]
 MM v[84:87],a[116:119],a[28:31],v[84:87]
 BL v42,s[92:95],s37 offen offset:2048  lds
 MM v[88:91],a[172:175],a[24:27],v[88:91]
 MM v[92:95],a[172:175],a[28:31],v[92:95]
 BL v43,s[92:95],s37 offen offset:3072  lds
 MM v[96:99],a[228:231],a[24:27],v[96:99]
 s_add_u32 s37,s37,4293591296
 MM v[100:103],a[228:231],a[28:31],v[100:103]
 s_waitcnt vmcnt(32)
 s_waitcnt lgkmcnt(0)
 s_barrier
 MM v[72:75],a[64:67],a[0:3],v[72:75]
 RT a[16:17],v46 offset:49152
 MM v[76:79],a[64:67],a[4:7],v[76:79]
 RT a[18:19],v46 offset:50176
 MM v[80:83],a[120:123],a[0:3],v[80:83]
 RT a[20:21],v47 offset:49152
 MM v[84:87],a[120:123],a[4:7],v[84:87]
 RT a[22:23],v47 offset:50176
 MM v[88:91],a[176:179],a[0:3],v[88:91]
 RT a[24:25],v46 offset:57344
 MM v[92:95],a[176:179],a[4:7],v[92:95]
 RT a[26:27],v46 offset:58368
 MM v[96:99],a[232:235],a[0:3],v[96:99]
 RT a[28:29],v47 offset:57344
 MM v[100:103],a[232:235],a[4:7],v[100:103]
 RT a[30:31],v47 offset:58368
 s_add_u32 m0,s39,32768
 MM v[72:75],a[68:71],a[8:11],v[72:75]
 BL v40,s[92:95],s37 offen  lds
 MM v[76:79],a[68:71],a[12:15],v[76:79]
 BL v41,s[92:95],s37 offen offset:1024  lds
 MM v[80:83],a[124:127],a[8:11],v[80:83]
 MM v[84:87],a[124:127],a[12:15],v[84:87]
 BL v42,s[92:95],s37 offen offset:2048  lds
 MM v[88:91],a[180:183],a[8:11],v[88:91]
 MM v[92:95],a[180:183],a[12:15],v[92:95]
 BL v43,s[92:95],s37 offen offset:3072  lds
 MM v[96:99],a[236:239],a[8:11],v[96:99]
 s_add_u32 s37,s37,229376
 MM v[100:103],a[236:239],a[12:15],v[100:103]
 s_waitcnt vmcnt(32)
 s_waitcnt lgkmcnt(0)
 s_barrier
 MM v[72:75],a[72:75],a[16:19],v[72:75]
 RT a[0:1],v48
 MM v[76:79],a[72:75],a[20:23],v[76:79]
 RT a[2:3],v48 offset:1024
 MM v[80:83],a[128:131],a[16:19],v[80:83]
 RT a[4:5],v49
 MM v[84:87],a[128:131],a[20:23],v[84:87]
 RT a[6:7],v49 offset:1024
 MM v[88:91],a[184:187],a[16:19],v[88:91]
 RT a[8:9],v48 offset:8192
 MM v[92:95],a[184:187],a[20:23],v[92:95]
 RT a[10:11],v48 offset:9216
 MM v[96:99],a[240:243],a[16:19],v[96:99]
 RT a[12:13],v49 offset:8192
 MM v[100:103],a[240:243],a[20:23],v[100:103]
 RT a[14:15],v49 offset:9216
 s_add_u32 m0,s39,49152
 MM v[72:75],a[76:79],a[24:27],v[72:75]
 BL v40,s[92:95],s37 offen  lds
 MM v[76:79],a[76:79],a[28:31],v[76:79]
 BL v41,s[92:95],s37 offen offset:1024  lds
 MM v[80:83],a[132:135],a[24:27],v[80:83]
 MM v[84:87],a[132:135],a[28:31],v[84:87]
 BL v42,s[92:95],s37 offen offset:2048  lds
 MM v[88:91],a[188:191],a[24:27],v[88:91]
 MM v[92:95],a[188:191],a[28:31],v[92:95]
 BL v43,s[92:95],s37 offen offset:3072  lds
 MM v[96:99],a[244:247],a[24:27],v[96:99]
 s_add_u32 s37,s37,229376
 MM v[100:103],a[244:247],a[28:31],v[100:103]
 s_waitcnt vmcnt(32)
 s_waitcnt lgkmcnt(0)
 s_barrier
 MM v[72:75],a[80:83],a[0:3],v[72:75]
 RT a[16:17],v48 offset:16384
 MM v[76:79],a[80:83],a[4:7],v[76:79]
 RT a[18:19],v48 offset:17408
 MM v[80:83],a[136:139],a[0:3],v[80:83]
 RT a[20:21],v49 offset:16384
 MM v[84:87],a[136:139],a[4:7],v[84:87]
 RT a[22:23],v49 offset:17408
 MM v[88:91],a[192:195],a[0:3],v[88:91]
 RT a[24:25],v48 offset:24576
 MM v[92:95],a[192:195],a[4:7],v[92:95]
 RT a[26:27],v48 offset:25600
 MM v[96:99],a[248:251],a[0:3],v[96:99]
 RT a[28:29],v49 offset:24576
 MM v[100:103],a[248:251],a[4:7],v[100:103]
 RT a[30:31],v49 offset:25600
 s_add_u32 m0,s39,65536
 MM v[72:75],a[84:87],a[8:11],v[72:75]
 BL v40,s[92:95],s37 offen  lds
 MM v[76:79],a[84:87],a[12:15],v[76:79]
 BL v41,s[92:95],s37 offen offset:1024  lds
 MM v[80:83],a[140:143],a[8:11],v[80:83]
 MM v[84:87],a[140:143],a[12:15],v[84:87]
 BL v42,s[92:95],s37 offen offset:2048  lds
 MM v[88:91],a[196:199],a[8:11],v[88:91]
 MM v[92:95],a[196:199],a[12:15],v[92:95]
 BL v43,s[92:95],s37 offen offset:3072  lds
 MM v[96:99],a[252:255],a[8:11],v[96:99]
 s_add_u32 s37,s37,229376
 MM v[100:103],a[252:255],a[12:15],v[100:103]
 PM v[104:105],v[72:73],v[72:73]
 PM v[106:107],v[74:75],v[74:75]
 PM v[108:109],v[76:77],v[76:77]
 PM v[110:111],v[78:79],v[78:79]
 v_pk_fma_f32 v[104:105],v[104:105],v[60:61],v[58:59]
 v_pk_fma_f32 v[106:107],v[106:107],v[60:61],v[58:59]
 v_pk_fma_f32 v[108:109],v[108:109],v[60:61],v[58:59]
 v_pk_fma_f32 v[110:111],v[110:111],v[60:61],v[58:59]
 PM v[104:105],v[104:105],v[72:73]
 PM v[106:107],v[106:107],v[74:75]
 PM v[108:109],v[108:109],v[76:77]
 PM v[110:111],v[110:111],v[78:79]
 v_exp_f32 v104,v104
 v_exp_f32 v105,v105
 v_exp_f32 v106,v106
 v_exp_f32 v107,v107
 v_exp_f32 v108,v108
 v_exp_f32 v109,v109
 v_exp_f32 v110,v110
 v_exp_f32 v111,v111
 v_pk_add_f32 v[104:105],v[104:105],1.0 op_sel_hi:[1,0]
 v_pk_add_f32 v[106:107],v[106:107],1.0 op_sel_hi:[1,0]
 v_pk_add_f32 v[108:109],v[108:109],1.0 op_sel_hi:[1,0]
 v_pk_add_f32 v[110:111],v[110:111],1.0 op_sel_hi:[1,0]
 v_rcp_f32 v104,v104
 v_rcp_f32 v105,v105
 v_rcp_f32 v106,v106
 v_rcp_f32 v107,v107
 v_rcp_f32 v108,v108
 v_rcp_f32 v109,v109
 v_rcp_f32 v110,v110
 v_rcp_f32 v111,v111
 PM v[72:73],v[72:73],v[104:105]
 PM v[74:75],v[74:75],v[106:107]
 PM v[76:77],v[76:77],v[108:109]
 PM v[78:79],v[78:79],v[110:111]
 v_pk_add_f32 v[224:225],v[224:225],v[72:73]
 v_pk_fma_f32 v[240:241],v[72:73],v[72:73],v[240:241]
 CV v176,v72,v73
 v_pk_add_f32 v[226:227],v[226:227],v[74:75]
 v_pk_fma_f32 v[242:243],v[74:75],v[74:75],v[242:243]
 CV v177,v74,v75
 v_pk_add_f32 v[224:225],v[224:225],v[76:77]
 v_pk_fma_f32 v[240:241],v[76:77],v[76:77],v[240:241]
 CV v180,v76,v77
 v_pk_add_f32 v[226:227],v[226:227],v[78:79]
 v_pk_fma_f32 v[242:243],v[78:79],v[78:79],v[242:243]
 CV v181,v78,v79
 PM v[104:105],v[80:81],v[80:81]
 PM v[106:107],v[82:83],v[82:83]
 PM v[108:109],v[84:85],v[84:85]
 PM v[110:111],v[86:87],v[86:87]
 v_pk_fma_f32 v[104:105],v[104:105],v[60:61],v[58:59]
 v_pk_fma_f32 v[106:107],v[106:107],v[60:61],v[58:59]
 v_pk_fma_f32 v[108:109],v[108:109],v[60:61],v[58:59]
 v_pk_fma_f32 v[110:111],v[110:111],v[60:61],v[58:59]
 PM v[104:105],v[104:105],v[80:81]
 PM v[106:107],v[106:107],v[82:83]
 PM v[108:109],v[108:109],v[84:85]
 PM v[110:111],v[110:111],v[86:87]
 v_exp_f32 v104,v104
 v_exp_f32 v105,v105
 v_exp_f32 v106,v106
 v_exp_f32 v107,v107
 v_exp_f32 v108,v108
 v_exp_f32 v109,v109
 v_exp_f32 v110,v110
 v_exp_f32 v111,v111
 v_pk_add_f32 v[104:105],v[104:105],1.0 op_sel_hi:[1,0]
 v_pk_add_f32 v[106:107],v[106:107],1.0 op_sel_hi:[1,0]
 v_pk_add_f32 v[108:109],v[108:109],1.0 op_sel_hi:[1,0]
 v_pk_add_f32 v[110:111],v[110:111],1.0 op_sel_hi:[1,0]
 v_rcp_f32 v104,v104
 v_rcp_f32 v105,v105
 v_rcp_f32 v106,v106
 v_rcp_f32 v107,v107
 v_rcp_f32 v108,v108
 v_rcp_f32 v109,v109
 v_rcp_f32 v110,v110
 v_rcp_f32 v111,v111
 PM v[80:81],v[80:81],v[104:105]
 PM v[82:83],v[82:83],v[106:107]
 PM v[84:85],v[84:85],v[108:109]
 PM v[86:87],v[86:87],v[110:111]
 v_pk_add_f32 v[228:229],v[228:229],v[80:81]
 v_pk_fma_f32 v[244:245],v[80:81],v[80:81],v[244:245]
 CV v178,v80,v81
 v_pk_add_f32 v[230:231],v[230:231],v[82:83]
 v_pk_fma_f32 v[246:247],v[82:83],v[82:83],v[246:247]
 CV v179,v82,v83
 v_pk_add_f32 v[228:229],v[228:229],v[84:85]
 v_pk_fma_f32 v[244:245],v[84:85],v[84:85],v[244:245]
 CV v182,v84,v85
 v_pk_add_f32 v[230:231],v[230:231],v[86:87]
 v_pk_fma_f32 v[246:247],v[86:87],v[86:87],v[246:247]
 CV v183,v86,v87
 PM v[104:105],v[88:89],v[88:89]
 PM v[106:107],v[90:91],v[90:91]
 PM v[108:109],v[92:93],v[92:93]
 PM v[110:111],v[94:95],v[94:95]
 v_pk_fma_f32 v[104:105],v[104:105],v[60:61],v[58:59]
 v_pk_fma_f32 v[106:107],v[106:107],v[60:61],v[58:59]
 v_pk_fma_f32 v[108:109],v[108:109],v[60:61],v[58:59]
 v_pk_fma_f32 v[110:111],v[110:111],v[60:61],v[58:59]
 PM v[104:105],v[104:105],v[88:89]
 PM v[106:107],v[106:107],v[90:91]
 PM v[108:109],v[108:109],v[92:93]
 PM v[110:111],v[110:111],v[94:95]
 v_exp_f32 v104,v104
 v_exp_f32 v105,v105
 v_exp_f32 v106,v106
 v_exp_f32 v107,v107
 v_exp_f32 v108,v108
 v_exp_f32 v109,v109
 v_exp_f32 v110,v110
 v_exp_f32 v111,v111
 v_pk_add_f32 v[104:105],v[104:105],1.0 op_sel_hi:[1,0]
 v_pk_add_f32 v[106:107],v[106:107],1.0 op_sel_hi:[1,0]
 v_pk_add_f32 v[108:109],v[108:109],1.0 op_sel_hi:[1,0]
 v_pk_add_f32 v[110:111],v[110:111],1.0 op_sel_hi:[1,0]
 v_rcp_f32 v104,v104
 v_rcp_f32 v105,v105
 v_rcp_f32 v106,v106
 v_rcp_f32 v107,v107
 v_rcp_f32 v108,v108
 v_rcp_f32 v109,v109
 v_rcp_f32 v110,v110
 v_rcp_f32 v111,v111
 PM v[88:89],v[88:89],v[104:105]
 PM v[90:91],v[90:91],v[106:107]
 PM v[92:93],v[92:93],v[108:109]
 PM v[94:95],v[94:95],v[110:111]
 v_pk_add_f32 v[232:233],v[232:233],v[88:89]
 v_pk_fma_f32 v[248:249],v[88:89],v[88:89],v[248:249]
 CV v184,v88,v89
 v_pk_add_f32 v[234:235],v[234:235],v[90:91]
 v_pk_fma_f32 v[250:251],v[90:91],v[90:91],v[250:251]
 CV v185,v90,v91
 v_pk_add_f32 v[232:233],v[232:233],v[92:93]
 v_pk_fma_f32 v[248:249],v[92:93],v[92:93],v[248:249]
 CV v188,v92,v93
 v_pk_add_f32 v[234:235],v[234:235],v[94:95]
 v_pk_fma_f32 v[250:251],v[94:95],v[94:95],v[250:251]
 CV v189,v94,v95
 PM v[104:105],v[96:97],v[96:97]
 PM v[106:107],v[98:99],v[98:99]
 PM v[108:109],v[100:101],v[100:101]
 PM v[110:111],v[102:103],v[102:103]
 v_pk_fma_f32 v[104:105],v[104:105],v[60:61],v[58:59]
 v_pk_fma_f32 v[106:107],v[106:107],v[60:61],v[58:59]
 v_pk_fma_f32 v[108:109],v[108:109],v[60:61],v[58:59]
 v_pk_fma_f32 v[110:111],v[110:111],v[60:61],v[58:59]
 PM v[104:105],v[104:105],v[96:97]
 PM v[106:107],v[106:107],v[98:99]
 PM v[108:109],v[108:109],v[100:101]
 PM v[110:111],v[110:111],v[102:103]
 v_exp_f32 v104,v104
 v_exp_f32 v105,v105
 v_exp_f32 v106,v106
 v_exp_f32 v107,v107
 v_exp_f32 v108,v108
 v_exp_f32 v109,v109
 v_exp_f32 v110,v110
 v_exp_f32 v111,v111
 v_pk_add_f32 v[104:105],v[104:105],1.0 op_sel_hi:[1,0]
 v_pk_add_f32 v[106:107],v[106:107],1.0 op_sel_hi:[1,0]
 v_pk_add_f32 v[108:109],v[108:109],1.0 op_sel_hi:[1,0]
 v_pk_add_f32 v[110:111],v[110:111],1.0 op_sel_hi:[1,0]
 v_rcp_f32 v104,v104
 v_rcp_f32 v105,v105
 v_rcp_f32 v106,v106
 v_rcp_f32 v107,v107
 v_rcp_f32 v108,v108
 v_rcp_f32 v109,v109
 v_rcp_f32 v110,v110
 v_rcp_f32 v111,v111
 PM v[96:97],v[96:97],v[104:105]
 PM v[98:99],v[98:99],v[106:107]
 PM v[100:101],v[100:101],v[108:109]
 PM v[102:103],v[102:103],v[110:111]
 v_pk_add_f32 v[236:237],v[236:237],v[96:97]
 v_pk_fma_f32 v[252:253],v[96:97],v[96:97],v[252:253]
 CV v186,v96,v97
 v_pk_add_f32 v[238:239],v[238:239],v[98:99]
 v_pk_fma_f32 v[254:255],v[98:99],v[98:99],v[254:255]
 CV v187,v98,v99
 v_pk_add_f32 v[236:237],v[236:237],v[100:101]
 v_pk_fma_f32 v[252:253],v[100:101],v[100:101],v[252:253]
 CV v190,v100,v101
 v_pk_add_f32 v[238:239],v[238:239],v[102:103]
 v_pk_fma_f32 v[254:255],v[102:103],v[102:103],v[254:255]
 CV v191,v102,v103
 s_waitcnt vmcnt(32)
 s_waitcnt lgkmcnt(0)
 s_barrier
 MM v[72:75],a[32:35],a[16:19],0
 RT a[0:1],v48 offset:32768
 MM v[76:79],a[32:35],a[20:23],0
 RT a[2:3],v48 offset:33792
 MM v[80:83],a[88:91],a[16:19],0
 RT a[4:5],v49 offset:32768
 MM v[84:87],a[88:91],a[20:23],0
 RT a[6:7],v49 offset:33792
 MM v[88:91],a[144:147],a[16:19],0
 RT a[8:9],v48 offset:40960
 MM v[92:95],a[144:147],a[20:23],0
 RT a[10:11],v48 offset:41984
 MM v[96:99],a[200:203],a[16:19],0
 RT a[12:13],v49 offset:40960
 MM v[100:103],a[200:203],a[20:23],0
 RT a[14:15],v49 offset:41984
 s_add_u32 m0,s39,81920
 MM v[72:75],a[36:39],a[24:27],v[72:75]
 BL v40,s[92:95],s37 offen  lds
 MM v[76:79],a[36:39],a[28:31],v[76:79]
 BL v41,s[92:95],s37 offen offset:1024  lds
 MM v[80:83],a[92:95],a[24:27],v[80:83]
 MM v[84:87],a[92:95],a[28:31],v[84:87]
 BL v42,s[92:95],s37 offen offset:2048  lds
 MM v[88:91],a[148:151],a[24:27],v[88:91]
 MM v[92:95],a[148:151],a[28:31],v[92:95]
 BL v43,s[92:95],s37 offen offset:3072  lds
 MM v[96:99],a[204:207],a[24:27],v[96:99]
 s_add_u32 s37,s37,229376
 MM v[100:103],a[204:207],a[28:31],v[100:103]
 s_waitcnt vmcnt(32)
 s_waitcnt lgkmcnt(0)
 s_barrier
 MM v[72:75],a[40:43],a[0:3],v[72:75]
 RT a[16:17],v48 offset:49152
 MM v[76:79],a[40:43],a[4:7],v[76:79]
 RT a[18:19],v48 offset:50176
 MM v[80:83],a[96:99],a[0:3],v[80:83]
 RT a[20:21],v49 offset:49152
 MM v[84:87],a[96:99],a[4:7],v[84:87]
 RT a[22:23],v49 offset:50176
 MM v[88:91],a[152:155],a[0:3],v[88:91]
 RT a[24:25],v48 offset:57344
 MM v[92:95],a[152:155],a[4:7],v[92:95]
 RT a[26:27],v48 offset:58368
 MM v[96:99],a[208:211],a[0:3],v[96:99]
 RT a[28:29],v49 offset:57344
 MM v[100:103],a[208:211],a[4:7],v[100:103]
 RT a[30:31],v49 offset:58368
 s_add_u32 m0,s39,98304
 MM v[72:75],a[44:47],a[8:11],v[72:75]
 BL v40,s[92:95],s37 offen  lds
 MM v[76:79],a[44:47],a[12:15],v[76:79]
 BL v41,s[92:95],s37 offen offset:1024  lds
 MM v[80:83],a[100:103],a[8:11],v[80:83]
 MM v[84:87],a[100:103],a[12:15],v[84:87]
 BL v42,s[92:95],s37 offen offset:2048  lds
 MM v[88:91],a[156:159],a[8:11],v[88:91]
 MM v[92:95],a[156:159],a[12:15],v[92:95]
 BL v43,s[92:95],s37 offen offset:3072  lds
 MM v[96:99],a[212:215],a[8:11],v[96:99]
 s_add_u32 s37,s37,229376
 MM v[100:103],a[212:215],a[12:15],v[100:103]
 s_waitcnt vmcnt(32)
 s_waitcnt lgkmcnt(0)
 s_barrier
 MM v[72:75],a[48:51],a[16:19],v[72:75]
 RT a[0:1],v50
 MM v[76:79],a[48:51],a[20:23],v[76:79]
 RT a[2:3],v50 offset:1024
 MM v[80:83],a[104:107],a[16:19],v[80:83]
 RT a[4:5],v51
 MM v[84:87],a[104:107],a[20:23],v[84:87]
 RT a[6:7],v51 offset:1024
 MM v[88:91],a[160:163],a[16:19],v[88:91]
 RT a[8:9],v50 offset:8192
 MM v[92:95],a[160:163],a[20:23],v[92:95]
 RT a[10:11],v50 offset:9216
 MM v[96:99],a[216:219],a[16:19],v[96:99]
 RT a[12:13],v51 offset:8192
 MM v[100:103],a[216:219],a[20:23],v[100:103]
 RT a[14:15],v51 offset:9216
 s_add_u32 m0,s39,114688
 MM v[72:75],a[52:55],a[24:27],v[72:75]
 BL v40,s[92:95],s37 offen  lds
 MM v[76:79],a[52:55],a[28:31],v[76:79]
 BL v41,s[92:95],s37 offen offset:1024  lds
 MM v[80:83],a[108:111],a[24:27],v[80:83]
 MM v[84:87],a[108:111],a[28:31],v[84:87]
 BL v42,s[92:95],s37 offen offset:2048  lds
 MM v[88:91],a[164:167],a[24:27],v[88:91]
 MM v[92:95],a[164:167],a[28:31],v[92:95]
 BL v43,s[92:95],s37 offen offset:3072  lds
 MM v[96:99],a[220:223],a[24:27],v[96:99]
 s_add_u32 s37,s37,229376
 MM v[100:103],a[220:223],a[28:31],v[100:103]
 s_waitcnt vmcnt(32)
 s_waitcnt lgkmcnt(0)
 s_barrier
 MM v[72:75],a[56:59],a[0:3],v[72:75]
 RT a[16:17],v50 offset:16384
 MM v[76:79],a[56:59],a[4:7],v[76:79]
 RT a[18:19],v50 offset:17408
 MM v[80:83],a[112:115],a[0:3],v[80:83]
 RT a[20:21],v51 offset:16384
 MM v[84:87],a[112:115],a[4:7],v[84:87]
 RT a[22:23],v51 offset:17408
 MM v[88:91],a[168:171],a[0:3],v[88:91]
 RT a[24:25],v50 offset:24576
 MM v[92:95],a[168:171],a[4:7],v[92:95]
 RT a[26:27],v50 offset:25600
 MM v[96:99],a[224:227],a[0:3],v[96:99]
 RT a[28:29],v51 offset:24576
 MM v[100:103],a[224:227],a[4:7],v[100:103]
 RT a[30:31],v51 offset:25600
 s_add_u32 m0,s39,131072
 MM v[72:75],a[60:63],a[8:11],v[72:75]
 BL v40,s[92:95],s37 offen  lds
 MM v[76:79],a[60:63],a[12:15],v[76:79]
 BL v41,s[92:95],s37 offen offset:1024  lds
 MM v[80:83],a[116:119],a[8:11],v[80:83]
 MM v[84:87],a[116:119],a[12:15],v[84:87]
 BL v42,s[92:95],s37 offen offset:2048  lds
 MM v[88:91],a[172:175],a[8:11],v[88:91]
 MM v[92:95],a[172:175],a[12:15],v[92:95]
 BL v43,s[92:95],s37 offen offset:3072  lds
 MM v[96:99],a[228:231],a[8:11],v[96:99]
 s_add_u32 s37,s37,4293591296
 MM v[100:103],a[228:231],a[12:15],v[100:103]
 s_waitcnt vmcnt(32)
 s_waitcnt lgkmcnt(0)
 s_barrier
 MM v[72:75],a[64:67],a[16:19],v[72:75]
 RT a[0:1],v46
 MM v[76:79],a[64:67],a[20:23],v[76:79]
 RT a[2:3],v46 offset:1024
 MM v[80:83],a[120:123],a[16:19],v[80:83]
 RT a[4:5],v47
 MM v[84:87],a[120:123],a[20:23],v[84:87]
 RT a[6:7],v47 offset:1024
 MM v[88:91],a[176:179],a[16:19],v[88:91]
 RT a[8:9],v46 offset:8192
 MM v[92:95],a[176:179],a[20:23],v[92:95]
 RT a[10:11],v46 offset:9216
 MM v[96:99],a[232:235],a[16:19],v[96:99]
 RT a[12:13],v47 offset:8192
 MM v[100:103],a[232:235],a[20:23],v[100:103]
 RT a[14:15],v47 offset:9216
 MM v[72:75],a[68:71],a[24:27],v[72:75]
 MM v[76:79],a[68:71],a[28:31],v[76:79]
 MM v[80:83],a[124:127],a[24:27],v[80:83]
 MM v[84:87],a[124:127],a[28:31],v[84:87]
 MM v[88:91],a[180:183],a[24:27],v[88:91]
 MM v[92:95],a[180:183],a[28:31],v[92:95]
 MM v[96:99],a[236:239],a[24:27],v[96:99]
 MM v[100:103],a[236:239],a[28:31],v[100:103]
 s_waitcnt vmcnt(28)
 s_waitcnt lgkmcnt(0)
 s_barrier
 MM v[72:75],a[72:75],a[0:3],v[72:75]
 RT a[16:17],v46 offset:16384
 MM v[76:79],a[72:75],a[4:7],v[76:79]
 RT a[18:19],v46 offset:17408
 MM v[80:83],a[128:131],a[0:3],v[80:83]
 RT a[20:21],v47 offset:16384
 MM v[84:87],a[128:131],a[4:7],v[84:87]
 RT a[22:23],v47 offset:17408
 MM v[88:91],a[184:187],a[0:3],v[88:91]
 RT a[24:25],v46 offset:24576
 MM v[92:95],a[184:187],a[4:7],v[92:95]
 RT a[26:27],v46 offset:25600
 MM v[96:99],a[240:243],a[0:3],v[96:99]
 RT a[28:29],v47 offset:24576
 MM v[100:103],a[240:243],a[4:7],v[100:103]
 RT a[30:31],v47 offset:25600
 MM v[72:75],a[76:79],a[8:11],v[72:75]
 MM v[76:79],a[76:79],a[12:15],v[76:79]
 MM v[80:83],a[132:135],a[8:11],v[80:83]
 MM v[84:87],a[132:135],a[12:15],v[84:87]
 MM v[88:91],a[188:191],a[8:11],v[88:91]
 MM v[92:95],a[188:191],a[12:15],v[92:95]
 MM v[96:99],a[244:247],a[8:11],v[96:99]
 MM v[100:103],a[244:247],a[12:15],v[100:103]
 s_waitcnt vmcnt(24)
 s_waitcnt lgkmcnt(0)
 s_barrier
 MM v[72:75],a[80:83],a[16:19],v[72:75]
 RT a[0:1],v46 offset:32768
 MM v[76:79],a[80:83],a[20:23],v[76:79]
 RT a[2:3],v46 offset:33792
 MM v[80:83],a[136:139],a[16:19],v[80:83]
 RT a[4:5],v47 offset:32768
 MM v[84:87],a[136:139],a[20:23],v[84:87]
 RT a[6:7],v47 offset:33792
 MM v[88:91],a[192:195],a[16:19],v[88:91]
 RT a[8:9],v46 offset:40960
 MM v[92:95],a[192:195],a[20:23],v[92:95]
 RT a[10:11],v46 offset:41984
 MM v[96:99],a[248:251],a[16:19],v[96:99]
 RT a[12:13],v47 offset:40960
 MM v[100:103],a[248:251],a[20:23],v[100:103]
 RT a[14:15],v47 offset:41984
 s_mov_b32 s8,s42
 s_mov_b32 s9,s43
 s_mov_b32 s10,4194304
 s_mov_b32 s11,0x20000
 s_lshl_b32 s20,s70,19
 v_lshrrev_b32 v1,3,v0
 s_mul_i32 s26,s35,131072
 v_mul_u32_u24 v1,2048,v1
 v_lshrrev_b32 v2,4,v0
 v_xor_b32 v2,v2,v0
 v_and_b32 v2,7,v2
 v_lshl_add_u32 v1,v2,4,v1
 v_add_u32 v8,s26,v1
 v_xor_b32 v2,64,v8
 v_add_u32 v9,15360,v2
 v_add_u32 v10,30720,v8
 v_add_u32 v11,30720,v9
 v_add_u32 v12,65536,v8
 v_add_u32 v13,65536,v9
 v_add_u32 v14,96256,v8
 v_add_u32 v15,96256,v9
 s_mul_i32 s22,s35,8192
 s_add_u32 m0,s22,0
 MM v[72:75],a[84:87],a[24:27],v[72:75]
 BL v8,s[8:11],s20 offen  lds
 MM v[76:79],a[84:87],a[28:31],v[76:79]
 BL v9,s[8:11],s20 offen offset:1024  lds
 MM v[80:83],a[140:143],a[24:27],v[80:83]
 BL v10,s[8:11],s20 offen offset:2048  lds
 MM v[84:87],a[140:143],a[28:31],v[84:87]
 BL v11,s[8:11],s20 offen offset:3072  lds
 s_add_u32 m0,s22,4096
 MM v[88:91],a[196:199],a[24:27],v[88:91]
 BL v12,s[8:11],s20 offen  lds
 MM v[92:95],a[196:199],a[28:31],v[92:95]
 BL v13,s[8:11],s20 offen offset:1024  lds
 MM v[96:99],a[252:255],a[24:27],v[96:99]
 MM v[100:103],a[252:255],a[28:31],v[100:103]
 PM v[104:105],v[72:73],v[72:73]
 PM v[106:107],v[74:75],v[74:75]
 PM v[108:109],v[76:77],v[76:77]
 PM v[110:111],v[78:79],v[78:79]
 v_pk_fma_f32 v[104:105],v[104:105],v[60:61],v[58:59]
 v_pk_fma_f32 v[106:107],v[106:107],v[60:61],v[58:59]
 v_pk_fma_f32 v[108:109],v[108:109],v[60:61],v[58:59]
 v_pk_fma_f32 v[110:111],v[110:111],v[60:61],v[58:59]
 PM v[104:105],v[104:105],v[72:73]
 PM v[106:107],v[106:107],v[74:75]
 PM v[108:109],v[108:109],v[76:77]
 PM v[110:111],v[110:111],v[78:79]
 v_exp_f32 v104,v104
 v_exp_f32 v105,v105
 v_exp_f32 v106,v106
 v_exp_f32 v107,v107
 v_exp_f32 v108,v108
 v_exp_f32 v109,v109
 v_exp_f32 v110,v110
 v_exp_f32 v111,v111
 v_pk_add_f32 v[104:105],v[104:105],1.0 op_sel_hi:[1,0]
 v_pk_add_f32 v[106:107],v[106:107],1.0 op_sel_hi:[1,0]
 v_pk_add_f32 v[108:109],v[108:109],1.0 op_sel_hi:[1,0]
 v_pk_add_f32 v[110:111],v[110:111],1.0 op_sel_hi:[1,0]
 v_rcp_f32 v104,v104
 v_rcp_f32 v105,v105
 v_rcp_f32 v106,v106
 v_rcp_f32 v107,v107
 v_rcp_f32 v108,v108
 v_rcp_f32 v109,v109
 v_rcp_f32 v110,v110
 v_rcp_f32 v111,v111
 PM v[72:73],v[72:73],v[104:105]
 PM v[74:75],v[74:75],v[106:107]
 PM v[76:77],v[76:77],v[108:109]
 PM v[78:79],v[78:79],v[110:111]
 v_pk_add_f32 v[224:225],v[224:225],v[72:73]
 v_pk_fma_f32 v[240:241],v[72:73],v[72:73],v[240:241]
 CV v192,v72,v73
 v_pk_add_f32 v[226:227],v[226:227],v[74:75]
 v_pk_fma_f32 v[242:243],v[74:75],v[74:75],v[242:243]
 CV v193,v74,v75
 v_pk_add_f32 v[224:225],v[224:225],v[76:77]
 v_pk_fma_f32 v[240:241],v[76:77],v[76:77],v[240:241]
 CV v196,v76,v77
 v_pk_add_f32 v[226:227],v[226:227],v[78:79]
 v_pk_fma_f32 v[242:243],v[78:79],v[78:79],v[242:243]
 CV v197,v78,v79
 PM v[104:105],v[80:81],v[80:81]
 PM v[106:107],v[82:83],v[82:83]
 PM v[108:109],v[84:85],v[84:85]
 PM v[110:111],v[86:87],v[86:87]
 v_pk_fma_f32 v[104:105],v[104:105],v[60:61],v[58:59]
 v_pk_fma_f32 v[106:107],v[106:107],v[60:61],v[58:59]
 v_pk_fma_f32 v[108:109],v[108:109],v[60:61],v[58:59]
 v_pk_fma_f32 v[110:111],v[110:111],v[60:61],v[58:59]
 PM v[104:105],v[104:105],v[80:81]
 PM v[106:107],v[106:107],v[82:83]
 PM v[108:109],v[108:109],v[84:85]
 PM v[110:111],v[110:111],v[86:87]
 v_exp_f32 v104,v104
 v_exp_f32 v105,v105
 v_exp_f32 v106,v106
 v_exp_f32 v107,v107
 v_exp_f32 v108,v108
 v_exp_f32 v109,v109
 v_exp_f32 v110,v110
 v_exp_f32 v111,v111
 v_pk_add_f32 v[104:105],v[104:105],1.0 op_sel_hi:[1,0]
 v_pk_add_f32 v[106:107],v[106:107],1.0 op_sel_hi:[1,0]
 v_pk_add_f32 v[108:109],v[108:109],1.0 op_sel_hi:[1,0]
 v_pk_add_f32 v[110:111],v[110:111],1.0 op_sel_hi:[1,0]
 v_rcp_f32 v104,v104
 v_rcp_f32 v105,v105
 v_rcp_f32 v106,v106
 v_rcp_f32 v107,v107
 v_rcp_f32 v108,v108
 v_rcp_f32 v109,v109
 v_rcp_f32 v110,v110
 v_rcp_f32 v111,v111
 PM v[80:81],v[80:81],v[104:105]
 PM v[82:83],v[82:83],v[106:107]
 PM v[84:85],v[84:85],v[108:109]
 PM v[86:87],v[86:87],v[110:111]
 v_pk_add_f32 v[228:229],v[228:229],v[80:81]
 v_pk_fma_f32 v[244:245],v[80:81],v[80:81],v[244:245]
 CV v194,v80,v81
 v_pk_add_f32 v[230:231],v[230:231],v[82:83]
 v_pk_fma_f32 v[246:247],v[82:83],v[82:83],v[246:247]
 CV v195,v82,v83
 v_pk_add_f32 v[228:229],v[228:229],v[84:85]
 v_pk_fma_f32 v[244:245],v[84:85],v[84:85],v[244:245]
 CV v198,v84,v85
 v_pk_add_f32 v[230:231],v[230:231],v[86:87]
 v_pk_fma_f32 v[246:247],v[86:87],v[86:87],v[246:247]
 CV v199,v86,v87
 PM v[104:105],v[88:89],v[88:89]
 PM v[106:107],v[90:91],v[90:91]
 PM v[108:109],v[92:93],v[92:93]
 PM v[110:111],v[94:95],v[94:95]
 v_pk_fma_f32 v[104:105],v[104:105],v[60:61],v[58:59]
 v_pk_fma_f32 v[106:107],v[106:107],v[60:61],v[58:59]
 v_pk_fma_f32 v[108:109],v[108:109],v[60:61],v[58:59]
 v_pk_fma_f32 v[110:111],v[110:111],v[60:61],v[58:59]
 PM v[104:105],v[104:105],v[88:89]
 PM v[106:107],v[106:107],v[90:91]
 PM v[108:109],v[108:109],v[92:93]
 PM v[110:111],v[110:111],v[94:95]
 v_exp_f32 v104,v104
 v_exp_f32 v105,v105
 v_exp_f32 v106,v106
 v_exp_f32 v107,v107
 v_exp_f32 v108,v108
 v_exp_f32 v109,v109
 v_exp_f32 v110,v110
 v_exp_f32 v111,v111
 v_pk_add_f32 v[104:105],v[104:105],1.0 op_sel_hi:[1,0]
 v_pk_add_f32 v[106:107],v[106:107],1.0 op_sel_hi:[1,0]
 v_pk_add_f32 v[108:109],v[108:109],1.0 op_sel_hi:[1,0]
 v_pk_add_f32 v[110:111],v[110:111],1.0 op_sel_hi:[1,0]
 v_rcp_f32 v104,v104
 v_rcp_f32 v105,v105
 v_rcp_f32 v106,v106
 v_rcp_f32 v107,v107
 v_rcp_f32 v108,v108
 v_rcp_f32 v109,v109
 v_rcp_f32 v110,v110
 v_rcp_f32 v111,v111
 PM v[88:89],v[88:89],v[104:105]
 PM v[90:91],v[90:91],v[106:107]
 PM v[92:93],v[92:93],v[108:109]
 PM v[94:95],v[94:95],v[110:111]
 v_pk_add_f32 v[232:233],v[232:233],v[88:89]
 v_pk_fma_f32 v[248:249],v[88:89],v[88:89],v[248:249]
 CV v200,v88,v89
 v_pk_add_f32 v[234:235],v[234:235],v[90:91]
 v_pk_fma_f32 v[250:251],v[90:91],v[90:91],v[250:251]
 CV v201,v90,v91
 v_pk_add_f32 v[232:233],v[232:233],v[92:93]
 v_pk_fma_f32 v[248:249],v[92:93],v[92:93],v[248:249]
 CV v204,v92,v93
 v_pk_add_f32 v[234:235],v[234:235],v[94:95]
 v_pk_fma_f32 v[250:251],v[94:95],v[94:95],v[250:251]
 CV v205,v94,v95
 PM v[104:105],v[96:97],v[96:97]
 PM v[106:107],v[98:99],v[98:99]
 PM v[108:109],v[100:101],v[100:101]
 PM v[110:111],v[102:103],v[102:103]
 v_pk_fma_f32 v[104:105],v[104:105],v[60:61],v[58:59]
 v_pk_fma_f32 v[106:107],v[106:107],v[60:61],v[58:59]
 v_pk_fma_f32 v[108:109],v[108:109],v[60:61],v[58:59]
 v_pk_fma_f32 v[110:111],v[110:111],v[60:61],v[58:59]
 PM v[104:105],v[104:105],v[96:97]
 PM v[106:107],v[106:107],v[98:99]
 PM v[108:109],v[108:109],v[100:101]
 PM v[110:111],v[110:111],v[102:103]
 v_exp_f32 v104,v104
 v_exp_f32 v105,v105
 v_exp_f32 v106,v106
 v_exp_f32 v107,v107
 v_exp_f32 v108,v108
 v_exp_f32 v109,v109
 v_exp_f32 v110,v110
 v_exp_f32 v111,v111
 v_pk_add_f32 v[104:105],v[104:105],1.0 op_sel_hi:[1,0]
 v_pk_add_f32 v[106:107],v[106:107],1.0 op_sel_hi:[1,0]
 v_pk_add_f32 v[108:109],v[108:109],1.0 op_sel_hi:[1,0]
 v_pk_add_f32 v[110:111],v[110:111],1.0 op_sel_hi:[1,0]
 v_rcp_f32 v104,v104
 v_rcp_f32 v105,v105
 v_rcp_f32 v106,v106
 v_rcp_f32 v107,v107
 v_rcp_f32 v108,v108
 v_rcp_f32 v109,v109
 v_rcp_f32 v110,v110
 v_rcp_f32 v111,v111
 PM v[96:97],v[96:97],v[104:105]
 PM v[98:99],v[98:99],v[106:107]
 PM v[100:101],v[100:101],v[108:109]
 PM v[102:103],v[102:103],v[110:111]
 v_pk_add_f32 v[236:237],v[236:237],v[96:97]
 v_pk_fma_f32 v[252:253],v[96:97],v[96:97],v[252:253]
 CV v202,v96,v97
 v_pk_add_f32 v[238:239],v[238:239],v[98:99]
 v_pk_fma_f32 v[254:255],v[98:99],v[98:99],v[254:255]
 CV v203,v98,v99
 v_pk_add_f32 v[236:237],v[236:237],v[100:101]
 v_pk_fma_f32 v[252:253],v[100:101],v[100:101],v[252:253]
 CV v206,v100,v101
 v_pk_add_f32 v[238:239],v[238:239],v[102:103]
 v_pk_fma_f32 v[254:255],v[102:103],v[102:103],v[254:255]
 CV v207,v102,v103
 s_waitcnt vmcnt(26)
 s_waitcnt lgkmcnt(0)
 s_barrier
 MM v[72:75],a[32:35],a[0:3],0
 RT a[16:17],v46 offset:49152
 MM v[76:79],a[32:35],a[4:7],0
 RT a[18:19],v46 offset:50176
 MM v[80:83],a[88:91],a[0:3],0
 RT a[20:21],v47 offset:49152
 MM v[84:87],a[88:91],a[4:7],0
 RT a[22:23],v47 offset:50176
 MM v[88:91],a[144:147],a[0:3],0
 RT a[24:25],v46 offset:57344
 MM v[92:95],a[144:147],a[4:7],0
 RT a[26:27],v46 offset:58368
 MM v[96:99],a[200:203],a[0:3],0
 RT a[28:29],v47 offset:57344
 MM v[100:103],a[200:203],a[4:7],0
 RT a[30:31],v47 offset:58368
 MM v[72:75],a[36:39],a[8:11],v[72:75]
 BL v14,s[8:11],s20 offen offset:2048  lds
 MM v[76:79],a[36:39],a[12:15],v[76:79]
 MM v[80:83],a[92:95],a[8:11],v[80:83]
 MM v[84:87],a[92:95],a[12:15],v[84:87]
 BL v15,s[8:11],s20 offen offset:3072  lds
 MM v[88:91],a[148:151],a[8:11],v[88:91]
 s_add_u32 s20,s20,128
 MM v[92:95],a[148:151],a[12:15],v[92:95]
 s_add_u32 s22,s22,32768
 MM v[96:99],a[204:207],a[8:11],v[96:99]
 s_sub_u32 s34,s22,98304
 s_min_u32 s22,s22,s34
 MM v[100:103],a[204:207],a[12:15],v[100:103]
 s_waitcnt vmcnt(24)
 s_waitcnt lgkmcnt(0)
 s_barrier
 MM v[72:75],a[40:43],a[16:19],v[72:75]
 RT a[0:1],v48
 MM v[76:79],a[40:43],a[20:23],v[76:79]
 RT a[2:3],v48 offset:1024
 MM v[80:83],a[96:99],a[16:19],v[80:83]
 RT a[4:5],v49
 MM v[84:87],a[96:99],a[20:23],v[84:87]
 RT a[6:7],v49 offset:1024
 MM v[88:91],a[152:155],a[16:19],v[88:91]
 RT a[8:9],v48 offset:8192
 MM v[92:95],a[152:155],a[20:23],v[92:95]
 RT a[10:11],v48 offset:9216
 MM v[96:99],a[208:211],a[16:19],v[96:99]
 RT a[12:13],v49 offset:8192
 MM v[100:103],a[208:211],a[20:23],v[100:103]
 RT a[14:15],v49 offset:9216
 s_add_u32 m0,s22,0
 MM v[72:75],a[44:47],a[24:27],v[72:75]
 BL v8,s[8:11],s20 offen  lds
 MM v[76:79],a[44:47],a[28:31],v[76:79]
 BL v9,s[8:11],s20 offen offset:1024  lds
 MM v[80:83],a[100:103],a[24:27],v[80:83]
 BL v10,s[8:11],s20 offen offset:2048  lds
 MM v[84:87],a[100:103],a[28:31],v[84:87]
 BL v11,s[8:11],s20 offen offset:3072  lds
 s_add_u32 m0,s22,4096
 MM v[88:91],a[156:159],a[24:27],v[88:91]
 BL v12,s[8:11],s20 offen  lds
 MM v[92:95],a[156:159],a[28:31],v[92:95]
 BL v13,s[8:11],s20 offen offset:1024  lds
 MM v[96:99],a[212:215],a[24:27],v[96:99]
 MM v[100:103],a[212:215],a[28:31],v[100:103]
 s_waitcnt vmcnt(26)
 s_waitcnt lgkmcnt(0)
 s_barrier
 MM v[72:75],a[48:51],a[0:3],v[72:75]
 RT a[16:17],v48 offset:16384
 MM v[76:79],a[48:51],a[4:7],v[76:79]
 RT a[18:19],v48 offset:17408
 MM v[80:83],a[104:107],a[0:3],v[80:83]
 RT a[20:21],v49 offset:16384
 MM v[84:87],a[104:107],a[4:7],v[84:87]
 RT a[22:23],v49 offset:17408
 MM v[88:91],a[160:163],a[0:3],v[88:91]
 RT a[24:25],v48 offset:24576
 MM v[92:95],a[160:163],a[4:7],v[92:95]
 RT a[26:27],v48 offset:25600
 MM v[96:99],a[216:219],a[0:3],v[96:99]
 RT a[28:29],v49 offset:24576
 MM v[100:103],a[216:219],a[4:7],v[100:103]
 RT a[30:31],v49 offset:25600
 MM v[72:75],a[52:55],a[8:11],v[72:75]
 BL v14,s[8:11],s20 offen offset:2048  lds
 MM v[76:79],a[52:55],a[12:15],v[76:79]
 MM v[80:83],a[108:111],a[8:11],v[80:83]
 MM v[84:87],a[108:111],a[12:15],v[84:87]
 BL v15,s[8:11],s20 offen offset:3072  lds
 MM v[88:91],a[164:167],a[8:11],v[88:91]
 s_add_u32 s20,s20,128
 MM v[92:95],a[164:167],a[12:15],v[92:95]
 s_add_u32 s22,s22,32768
 MM v[96:99],a[220:223],a[8:11],v[96:99]
 s_sub_u32 s34,s22,98304
 s_min_u32 s22,s22,s34
 MM v[100:103],a[220:223],a[12:15],v[100:103]
 s_waitcnt vmcnt(24)
 s_waitcnt lgkmcnt(0)
 s_barrier
 MM v[72:75],a[56:59],a[16:19],v[72:75]
 RT a[0:1],v48 offset:32768
 MM v[76:79],a[56:59],a[20:23],v[76:79]
 RT a[2:3],v48 offset:33792
 MM v[80:83],a[112:115],a[16:19],v[80:83]
 RT a[4:5],v49 offset:32768
 MM v[84:87],a[112:115],a[20:23],v[84:87]
 RT a[6:7],v49 offset:33792
 MM v[88:91],a[168:171],a[16:19],v[88:91]
 RT a[8:9],v48 offset:40960
 MM v[92:95],a[168:171],a[20:23],v[92:95]
 RT a[10:11],v48 offset:41984
 MM v[96:99],a[224:227],a[16:19],v[96:99]
 RT a[12:13],v49 offset:40960
 MM v[100:103],a[224:227],a[20:23],v[100:103]
 RT a[14:15],v49 offset:41984
 MM v[72:75],a[60:63],a[24:27],v[72:75]
 MM v[76:79],a[60:63],a[28:31],v[76:79]
 MM v[80:83],a[116:119],a[24:27],v[80:83]
 MM v[84:87],a[116:119],a[28:31],v[84:87]
 MM v[88:91],a[172:175],a[24:27],v[88:91]
 MM v[92:95],a[172:175],a[28:31],v[92:95]
 MM v[96:99],a[228:231],a[24:27],v[96:99]
 MM v[100:103],a[228:231],a[28:31],v[100:103]
 s_waitcnt vmcnt(20)
 s_waitcnt lgkmcnt(0)
 s_barrier
 MM v[72:75],a[64:67],a[0:3],v[72:75]
 RT a[16:17],v48 offset:49152
 MM v[76:79],a[64:67],a[4:7],v[76:79]
 RT a[18:19],v48 offset:50176
 MM v[80:83],a[120:123],a[0:3],v[80:83]
 RT a[20:21],v49 offset:49152
 MM v[84:87],a[120:123],a[4:7],v[84:87]
 RT a[22:23],v49 offset:50176
 MM v[88:91],a[176:179],a[0:3],v[88:91]
 RT a[24:25],v48 offset:57344
 MM v[92:95],a[176:179],a[4:7],v[92:95]
 RT a[26:27],v48 offset:58368
 MM v[96:99],a[232:235],a[0:3],v[96:99]
 RT a[28:29],v49 offset:57344
 MM v[100:103],a[232:235],a[4:7],v[100:103]
 RT a[30:31],v49 offset:58368
 MM v[72:75],a[68:71],a[8:11],v[72:75]
 MM v[76:79],a[68:71],a[12:15],v[76:79]
 MM v[80:83],a[124:127],a[8:11],v[80:83]
 MM v[84:87],a[124:127],a[12:15],v[84:87]
 MM v[88:91],a[180:183],a[8:11],v[88:91]
 MM v[92:95],a[180:183],a[12:15],v[92:95]
 MM v[96:99],a[236:239],a[8:11],v[96:99]
 MM v[100:103],a[236:239],a[12:15],v[100:103]
 s_waitcnt vmcnt(16)
 s_waitcnt lgkmcnt(0)
 s_barrier
 MM v[72:75],a[72:75],a[16:19],v[72:75]
 RT a[0:1],v50
 MM v[76:79],a[72:75],a[20:23],v[76:79]
 RT a[2:3],v50 offset:1024
 MM v[80:83],a[128:131],a[16:19],v[80:83]
 RT a[4:5],v51
 MM v[84:87],a[128:131],a[20:23],v[84:87]
 RT a[6:7],v51 offset:1024
 MM v[88:91],a[184:187],a[16:19],v[88:91]
 RT a[8:9],v50 offset:8192
 MM v[92:95],a[184:187],a[20:23],v[92:95]
 RT a[10:11],v50 offset:9216
 MM v[96:99],a[240:243],a[16:19],v[96:99]
 RT a[12:13],v51 offset:8192
 MM v[100:103],a[240:243],a[20:23],v[100:103]
 RT a[14:15],v51 offset:9216
 s_cmp_eq_u32 s72,0
 s_cselect_b32 s12,s46,s48
 s_cselect_b32 s13,s47,s49
 s_mov_b32 s14,8388608
 s_mov_b32 s15,0x20000
 s_lshl_b32 s21,s71,9
 v_lshrrev_b32 v1,5,v0
 v_and_b32 v2,31,v0
 v_bfe_u32 v3,v1,0,1
 v_lshlrev_b32 v3,1,v3
 v_xor_b32 v2,v2,v3
 v_lshlrev_b32 v2,4,v2
 s_mul_i32 s26,s35,131072
 v_mul_u32_u24 v1,8192,v1
 v_add_u32 v1,s26,v1
 v_add_u32 v16,v2,v1
 v_xor_b32 v3,64,v2
 v_add_u32 v17,v3,v1
 v_add_u32 v17,15360,v17
 v_add_u32 v18,30720,v16
 v_add_u32 v19,30720,v17
 v_xor_b32 v3,128,v2
 v_add_u32 v20,v3,v1
 v_add_u32 v20,65536,v20
 v_xor_b32 v3,192,v2
 v_add_u32 v21,v3,v1
 v_add_u32 v21,80896,v21
 v_add_u32 v22,30720,v20
 v_add_u32 v23,30720,v21
 s_mul_i32 s23,s35,8192
 s_add_u32 m0,s23,98304
 MM v[72:75],a[76:79],a[24:27],v[72:75]
 BL v16,s[12:15],s21 offen  lds
 MM v[76:79],a[76:79],a[28:31],v[76:79]
 BL v17,s[12:15],s21 offen offset:1024  lds
 MM v[80:83],a[132:135],a[24:27],v[80:83]
 BL v18,s[12:15],s21 offen offset:2048  lds
 MM v[84:87],a[132:135],a[28:31],v[84:87]
 BL v19,s[12:15],s21 offen offset:3072  lds
 s_add_u32 m0,s23,102400
 MM v[88:91],a[188:191],a[24:27],v[88:91]
 BL v20,s[12:15],s21 offen  lds
 MM v[92:95],a[188:191],a[28:31],v[92:95]
 BL v21,s[12:15],s21 offen offset:1024  lds
 MM v[96:99],a[244:247],a[24:27],v[96:99]
 MM v[100:103],a[244:247],a[28:31],v[100:103]
 s_waitcnt lgkmcnt(0)
 s_barrier
 MM v[72:75],a[80:83],a[0:3],v[72:75]
 MM v[76:79],a[80:83],a[4:7],v[76:79]
 MM v[80:83],a[136:139],a[0:3],v[80:83]
 MM v[84:87],a[136:139],a[4:7],v[84:87]
 MM v[88:91],a[192:195],a[0:3],v[88:91]
 MM v[92:95],a[192:195],a[4:7],v[92:95]
 MM v[96:99],a[248:251],a[0:3],v[96:99]
 MM v[100:103],a[248:251],a[4:7],v[100:103]
 MM v[72:75],a[84:87],a[8:11],v[72:75]
 BL v22,s[12:15],s21 offen offset:2048  lds
 MM v[76:79],a[84:87],a[12:15],v[76:79]
 MM v[80:83],a[140:143],a[8:11],v[80:83]
 MM v[84:87],a[140:143],a[12:15],v[84:87]
 BL v23,s[12:15],s21 offen offset:3072  lds
 MM v[88:91],a[196:199],a[8:11],v[88:91]
 s_add_u32 s21,s21,524288
 MM v[92:95],a[196:199],a[12:15],v[92:95]
 s_add_u32 s23,s23,32768
 MM v[96:99],a[252:255],a[8:11],v[96:99]
 s_sub_u32 s34,s23,65536
 s_min_u32 s23,s23,s34
 MM v[100:103],a[252:255],a[12:15],v[100:103]
 s_add_u32 m0,s23,98304
 s_nop 0
 BL v16,s[12:15],s21 offen  lds
 BL v17,s[12:15],s21 offen offset:1024  lds
 BL v18,s[12:15],s21 offen offset:2048  lds
 BL v19,s[12:15],s21 offen offset:3072  lds
 s_add_u32 m0,s23,102400
 s_nop 0
 BL v20,s[12:15],s21 offen  lds
 BL v21,s[12:15],s21 offen offset:1024  lds
 BL v22,s[12:15],s21 offen offset:2048  lds
 BL v23,s[12:15],s21 offen offset:3072  lds
 s_add_u32 s21,s21,524288
 s_add_u32 s23,s23,32768
 s_sub_u32 s34,s23,65536
 s_min_u32 s23,s23,s34
 s_add_u32 m0,s22,0
 s_nop 0
 BL v8,s[8:11],s20 offen  lds
 BL v9,s[8:11],s20 offen offset:1024  lds
 PM v[104:105],v[72:73],v[72:73]
 PM v[106:107],v[74:75],v[74:75]
 PM v[108:109],v[76:77],v[76:77]
 PM v[110:111],v[78:79],v[78:79]
 v_pk_fma_f32 v[104:105],v[104:105],v[60:61],v[58:59]
 v_pk_fma_f32 v[106:107],v[106:107],v[60:61],v[58:59]
 v_pk_fma_f32 v[108:109],v[108:109],v[60:61],v[58:59]
 v_pk_fma_f32 v[110:111],v[110:111],v[60:61],v[58:59]
 PM v[104:105],v[104:105],v[72:73]
 PM v[106:107],v[106:107],v[74:75]
 PM v[108:109],v[108:109],v[76:77]
 PM v[110:111],v[110:111],v[78:79]
 v_exp_f32 v104,v104
 v_exp_f32 v105,v105
 v_exp_f32 v106,v106
 v_exp_f32 v107,v107
 v_exp_f32 v108,v108
 v_exp_f32 v109,v109
 v_exp_f32 v110,v110
 v_exp_f32 v111,v111
 v_pk_add_f32 v[104:105],v[104:105],1.0 op_sel_hi:[1,0]
 v_pk_add_f32 v[106:107],v[106:107],1.0 op_sel_hi:[1,0]
 v_pk_add_f32 v[108:109],v[108:109],1.0 op_sel_hi:[1,0]
 v_pk_add_f32 v[110:111],v[110:111],1.0 op_sel_hi:[1,0]
 v_rcp_f32 v104,v104
 v_rcp_f32 v105,v105
 v_rcp_f32 v106,v106
 v_rcp_f32 v107,v107
 v_rcp_f32 v108,v108
 v_rcp_f32 v109,v109
 v_rcp_f32 v110,v110
 v_rcp_f32 v111,v111
 PM v[72:73],v[72:73],v[104:105]
 PM v[74:75],v[74:75],v[106:107]
 PM v[76:77],v[76:77],v[108:109]
 PM v[78:79],v[78:79],v[110:111]
 v_pk_add_f32 v[224:225],v[224:225],v[72:73]
 v_pk_fma_f32 v[240:241],v[72:73],v[72:73],v[240:241]
 CV v208,v72,v73
 v_pk_add_f32 v[226:227],v[226:227],v[74:75]
 v_pk_fma_f32 v[242:243],v[74:75],v[74:75],v[242:243]
 CV v209,v74,v75
 v_pk_add_f32 v[224:225],v[224:225],v[76:77]
 v_pk_fma_f32 v[240:241],v[76:77],v[76:77],v[240:241]
 CV v212,v76,v77
 v_pk_add_f32 v[226:227],v[226:227],v[78:79]
 v_pk_fma_f32 v[242:243],v[78:79],v[78:79],v[242:243]
 CV v213,v78,v79
 PM v[104:105],v[80:81],v[80:81]
 PM v[106:107],v[82:83],v[82:83]
 PM v[108:109],v[84:85],v[84:85]
 PM v[110:111],v[86:87],v[86:87]
 v_pk_fma_f32 v[104:105],v[104:105],v[60:61],v[58:59]
 v_pk_fma_f32 v[106:107],v[106:107],v[60:61],v[58:59]
 v_pk_fma_f32 v[108:109],v[108:109],v[60:61],v[58:59]
 v_pk_fma_f32 v[110:111],v[110:111],v[60:61],v[58:59]
 PM v[104:105],v[104:105],v[80:81]
 PM v[106:107],v[106:107],v[82:83]
 PM v[108:109],v[108:109],v[84:85]
 PM v[110:111],v[110:111],v[86:87]
 v_exp_f32 v104,v104
 v_exp_f32 v105,v105
 v_exp_f32 v106,v106
 v_exp_f32 v107,v107
 v_exp_f32 v108,v108
 v_exp_f32 v109,v109
 v_exp_f32 v110,v110
 v_exp_f32 v111,v111
 v_pk_add_f32 v[104:105],v[104:105],1.0 op_sel_hi:[1,0]
 v_pk_add_f32 v[106:107],v[106:107],1.0 op_sel_hi:[1,0]
 v_pk_add_f32 v[108:109],v[108:109],1.0 op_sel_hi:[1,0]
 v_pk_add_f32 v[110:111],v[110:111],1.0 op_sel_hi:[1,0]
 v_rcp_f32 v104,v104
 v_rcp_f32 v105,v105
 v_rcp_f32 v106,v106
 v_rcp_f32 v107,v107
 v_rcp_f32 v108,v108
 v_rcp_f32 v109,v109
 v_rcp_f32 v110,v110
 v_rcp_f32 v111,v111
 PM v[80:81],v[80:81],v[104:105]
 PM v[82:83],v[82:83],v[106:107]
 PM v[84:85],v[84:85],v[108:109]
 PM v[86:87],v[86:87],v[110:111]
 v_pk_add_f32 v[228:229],v[228:229],v[80:81]
 v_pk_fma_f32 v[244:245],v[80:81],v[80:81],v[244:245]
 CV v210,v80,v81
 v_pk_add_f32 v[230:231],v[230:231],v[82:83]
 v_pk_fma_f32 v[246:247],v[82:83],v[82:83],v[246:247]
 CV v211,v82,v83
 v_pk_add_f32 v[228:229],v[228:229],v[84:85]
 v_pk_fma_f32 v[244:245],v[84:85],v[84:85],v[244:245]
 CV v214,v84,v85
 v_pk_add_f32 v[230:231],v[230:231],v[86:87]
 v_pk_fma_f32 v[246:247],v[86:87],v[86:87],v[246:247]
 CV v215,v86,v87
 PM v[104:105],v[88:89],v[88:89]
 PM v[106:107],v[90:91],v[90:91]
 PM v[108:109],v[92:93],v[92:93]
 PM v[110:111],v[94:95],v[94:95]
 v_pk_fma_f32 v[104:105],v[104:105],v[60:61],v[58:59]
 v_pk_fma_f32 v[106:107],v[106:107],v[60:61],v[58:59]
 v_pk_fma_f32 v[108:109],v[108:109],v[60:61],v[58:59]
 v_pk_fma_f32 v[110:111],v[110:111],v[60:61],v[58:59]
 PM v[104:105],v[104:105],v[88:89]
 PM v[106:107],v[106:107],v[90:91]
 PM v[108:109],v[108:109],v[92:93]
 PM v[110:111],v[110:111],v[94:95]
 v_exp_f32 v104,v104
 v_exp_f32 v105,v105
 v_exp_f32 v106,v106
 v_exp_f32 v107,v107
 v_exp_f32 v108,v108
 v_exp_f32 v109,v109
 v_exp_f32 v110,v110
 v_exp_f32 v111,v111
 v_pk_add_f32 v[104:105],v[104:105],1.0 op_sel_hi:[1,0]
 v_pk_add_f32 v[106:107],v[106:107],1.0 op_sel_hi:[1,0]
 v_pk_add_f32 v[108:109],v[108:109],1.0 op_sel_hi:[1,0]
 v_pk_add_f32 v[110:111],v[110:111],1.0 op_sel_hi:[1,0]
 v_rcp_f32 v104,v104
 v_rcp_f32 v105,v105
 v_rcp_f32 v106,v106
 v_rcp_f32 v107,v107
 v_rcp_f32 v108,v108
 v_rcp_f32 v109,v109
 v_rcp_f32 v110,v110
 v_rcp_f32 v111,v111
 PM v[88:89],v[88:89],v[104:105]
 PM v[90:91],v[90:91],v[106:107]
 PM v[92:93],v[92:93],v[108:109]
 PM v[94:95],v[94:95],v[110:111]
 v_pk_add_f32 v[232:233],v[232:233],v[88:89]
 v_pk_fma_f32 v[248:249],v[88:89],v[88:89],v[248:249]
 CV v216,v88,v89
 v_pk_add_f32 v[234:235],v[234:235],v[90:91]
 v_pk_fma_f32 v[250:251],v[90:91],v[90:91],v[250:251]
 CV v217,v90,v91
 v_pk_add_f32 v[232:233],v[232:233],v[92:93]
 v_pk_fma_f32 v[248:249],v[92:93],v[92:93],v[248:249]
 CV v220,v92,v93
 v_pk_add_f32 v[234:235],v[234:235],v[94:95]
 v_pk_fma_f32 v[250:251],v[94:95],v[94:95],v[250:251]
 CV v221,v94,v95
 PM v[104:105],v[96:97],v[96:97]
 PM v[106:107],v[98:99],v[98:99]
 PM v[108:109],v[100:101],v[100:101]
 PM v[110:111],v[102:103],v[102:103]
 v_pk_fma_f32 v[104:105],v[104:105],v[60:61],v[58:59]
 v_pk_fma_f32 v[106:107],v[106:107],v[60:61],v[58:59]
 v_pk_fma_f32 v[108:109],v[108:109],v[60:61],v[58:59]
 v_pk_fma_f32 v[110:111],v[110:111],v[60:61],v[58:59]
 PM v[104:105],v[104:105],v[96:97]
 PM v[106:107],v[106:107],v[98:99]
 PM v[108:109],v[108:109],v[100:101]
 PM v[110:111],v[110:111],v[102:103]
 v_exp_f32 v104,v104
 v_exp_f32 v105,v105
 v_exp_f32 v106,v106
 v_exp_f32 v107,v107
 v_exp_f32 v108,v108
 v_exp_f32 v109,v109
 v_exp_f32 v110,v110
 v_exp_f32 v111,v111
 v_pk_add_f32 v[104:105],v[104:105],1.0 op_sel_hi:[1,0]
 v_pk_add_f32 v[106:107],v[106:107],1.0 op_sel_hi:[1,0]
 v_pk_add_f32 v[108:109],v[108:109],1.0 op_sel_hi:[1,0]
 v_pk_add_f32 v[110:111],v[110:111],1.0 op_sel_hi:[1,0]
 v_rcp_f32 v104,v104
 v_rcp_f32 v105,v105
 v_rcp_f32 v106,v106
 v_rcp_f32 v107,v107
 v_rcp_f32 v108,v108
 v_rcp_f32 v109,v109
 v_rcp_f32 v110,v110
 v_rcp_f32 v111,v111
 PM v[96:97],v[96:97],v[104:105]
 PM v[98:99],v[98:99],v[106:107]
 PM v[100:101],v[100:101],v[108:109]
 PM v[102:103],v[102:103],v[110:111]
 v_pk_add_f32 v[236:237],v[236:237],v[96:97]
 v_pk_fma_f32 v[252:253],v[96:97],v[96:97],v[252:253]
 CV v218,v96,v97
 v_pk_add_f32 v[238:239],v[238:239],v[98:99]
 v_pk_fma_f32 v[254:255],v[98:99],v[98:99],v[254:255]
 CV v219,v98,v99
 v_pk_add_f32 v[236:237],v[236:237],v[100:101]
 v_pk_fma_f32 v[252:253],v[100:101],v[100:101],v[252:253]
 CV v222,v100,v101
 v_pk_add_f32 v[238:239],v[238:239],v[102:103]
 v_pk_fma_f32 v[254:255],v[102:103],v[102:103],v[254:255]
 CV v223,v102,v103
 v_add_f32_dpp v224,v224,v224 row_ror:8 row_mask:0xf bank_mask:0xf
 v_add_f32_dpp v225,v225,v225 row_ror:8 row_mask:0xf bank_mask:0xf
 v_add_f32_dpp v226,v226,v226 row_ror:8 row_mask:0xf bank_mask:0xf
 v_add_f32_dpp v227,v227,v227 row_ror:8 row_mask:0xf bank_mask:0xf
 v_add_f32_dpp v228,v228,v228 row_ror:8 row_mask:0xf bank_mask:0xf
 v_add_f32_dpp v229,v229,v229 row_ror:8 row_mask:0xf bank_mask:0xf
 v_add_f32_dpp v230,v230,v230 row_ror:8 row_mask:0xf bank_mask:0xf
 v_add_f32_dpp v231,v231,v231 row_ror:8 row_mask:0xf bank_mask:0xf
 v_add_f32_dpp v232,v232,v232 row_ror:8 row_mask:0xf bank_mask:0xf
 v_add_f32_dpp v233,v233,v233 row_ror:8 row_mask:0xf bank_mask:0xf
 v_add_f32_dpp v234,v234,v234 row_ror:8 row_mask:0xf bank_mask:0xf
 v_add_f32_dpp v235,v235,v235 row_ror:8 row_mask:0xf bank_mask:0xf
 v_add_f32_dpp v236,v236,v236 row_ror:8 row_mask:0xf bank_mask:0xf
 v_add_f32_dpp v237,v237,v237 row_ror:8 row_mask:0xf bank_mask:0xf
 v_add_f32_dpp v238,v238,v238 row_ror:8 row_mask:0xf bank_mask:0xf
 v_add_f32_dpp v239,v239,v239 row_ror:8 row_mask:0xf bank_mask:0xf
 v_add_f32_dpp v240,v240,v240 row_ror:8 row_mask:0xf bank_mask:0xf
 v_add_f32_dpp v241,v241,v241 row_ror:8 row_mask:0xf bank_mask:0xf
 v_add_f32_dpp v242,v242,v242 row_ror:8 row_mask:0xf bank_mask:0xf
 v_add_f32_dpp v243,v243,v243 row_ror:8 row_mask:0xf bank_mask:0xf
 v_add_f32_dpp v244,v244,v244 row_ror:8 row_mask:0xf bank_mask:0xf
 v_add_f32_dpp v245,v245,v245 row_ror:8 row_mask:0xf bank_mask:0xf
 v_add_f32_dpp v246,v246,v246 row_ror:8 row_mask:0xf bank_mask:0xf
 v_add_f32_dpp v247,v247,v247 row_ror:8 row_mask:0xf bank_mask:0xf
 v_add_f32_dpp v248,v248,v248 row_ror:8 row_mask:0xf bank_mask:0xf
 v_add_f32_dpp v249,v249,v249 row_ror:8 row_mask:0xf bank_mask:0xf
 v_add_f32_dpp v250,v250,v250 row_ror:8 row_mask:0xf bank_mask:0xf
 v_add_f32_dpp v251,v251,v251 row_ror:8 row_mask:0xf bank_mask:0xf
 v_add_f32_dpp v252,v252,v252 row_ror:8 row_mask:0xf bank_mask:0xf
 v_add_f32_dpp v253,v253,v253 row_ror:8 row_mask:0xf bank_mask:0xf
 v_add_f32_dpp v254,v254,v254 row_ror:8 row_mask:0xf bank_mask:0xf
 v_add_f32_dpp v255,v255,v255 row_ror:8 row_mask:0xf bank_mask:0xf
 v_add_f32_dpp v224,v224,v224 row_ror:4 row_mask:0xf bank_mask:0xf
 v_add_f32_dpp v225,v225,v225 row_ror:4 row_mask:0xf bank_mask:0xf
 v_add_f32_dpp v226,v226,v226 row_ror:4 row_mask:0xf bank_mask:0xf
 v_add_f32_dpp v227,v227,v227 row_ror:4 row_mask:0xf bank_mask:0xf
 v_add_f32_dpp v228,v228,v228 row_ror:4 row_mask:0xf bank_mask:0xf
 v_add_f32_dpp v229,v229,v229 row_ror:4 row_mask:0xf bank_mask:0xf
 v_add_f32_dpp v230,v230,v230 row_ror:4 row_mask:0xf bank_mask:0xf
 v_add_f32_dpp v231,v231,v231 row_ror:4 row_mask:0xf bank_mask:0xf
 v_add_f32_dpp v232,v232,v232 row_ror:4 row_mask:0xf bank_mask:0xf
 v_add_f32_dpp v233,v233,v233 row_ror:4 row_mask:0xf bank_mask:0xf
 v_add_f32_dpp v234,v234,v234 row_ror:4 row_mask:0xf bank_mask:0xf
 v_add_f32_dpp v235,v235,v235 row_ror:4 row_mask:0xf bank_mask:0xf
 v_add_f32_dpp v236,v236,v236 row_ror:4 row_mask:0xf bank_mask:0xf
 v_add_f32_dpp v237,v237,v237 row_ror:4 row_mask:0xf bank_mask:0xf
 v_add_f32_dpp v238,v238,v238 row_ror:4 row_mask:0xf bank_mask:0xf
 v_add_f32_dpp v239,v239,v239 row_ror:4 row_mask:0xf bank_mask:0xf
 v_add_f32_dpp v240,v240,v240 row_ror:4 row_mask:0xf bank_mask:0xf
 v_add_f32_dpp v241,v241,v241 row_ror:4 row_mask:0xf bank_mask:0xf
 v_add_f32_dpp v242,v242,v242 row_ror:4 row_mask:0xf bank_mask:0xf
 v_add_f32_dpp v243,v243,v243 row_ror:4 row_mask:0xf bank_mask:0xf
 v_add_f32_dpp v244,v244,v244 row_ror:4 row_mask:0xf bank_mask:0xf
 v_add_f32_dpp v245,v245,v245 row_ror:4 row_mask:0xf bank_mask:0xf
 v_add_f32_dpp v246,v246,v246 row_ror:4 row_mask:0xf bank_mask:0xf
 v_add_f32_dpp v247,v247,v247 row_ror:4 row_mask:0xf bank_mask:0xf
 v_add_f32_dpp v248,v248,v248 row_ror:4 row_mask:0xf bank_mask:0xf
 v_add_f32_dpp v249,v249,v249 row_ror:4 row_mask:0xf bank_mask:0xf
 v_add_f32_dpp v250,v250,v250 row_ror:4 row_mask:0xf bank_mask:0xf
 v_add_f32_dpp v251,v251,v251 row_ror:4 row_mask:0xf bank_mask:0xf
 v_add_f32_dpp v252,v252,v252 row_ror:4 row_mask:0xf bank_mask:0xf
 v_add_f32_dpp v253,v253,v253 row_ror:4 row_mask:0xf bank_mask:0xf
 v_add_f32_dpp v254,v254,v254 row_ror:4 row_mask:0xf bank_mask:0xf
 v_add_f32_dpp v255,v255,v255 row_ror:4 row_mask:0xf bank_mask:0xf
 v_add_f32_dpp v224,v224,v224 row_ror:2 row_mask:0xf bank_mask:0xf
 v_add_f32_dpp v225,v225,v225 row_ror:2 row_mask:0xf bank_mask:0xf
 v_add_f32_dpp v226,v226,v226 row_ror:2 row_mask:0xf bank_mask:0xf
 v_add_f32_dpp v227,v227,v227 row_ror:2 row_mask:0xf bank_mask:0xf
 v_add_f32_dpp v228,v228,v228 row_ror:2 row_mask:0xf bank_mask:0xf
 v_add_f32_dpp v229,v229,v229 row_ror:2 row_mask:0xf bank_mask:0xf
 v_add_f32_dpp v230,v230,v230 row_ror:2 row_mask:0xf bank_mask:0xf
 v_add_f32_dpp v231,v231,v231 row_ror:2 row_mask:0xf bank_mask:0xf
 v_add_f32_dpp v232,v232,v232 row_ror:2 row_mask:0xf bank_mask:0xf
 v_add_f32_dpp v233,v233,v233 row_ror:2 row_mask:0xf bank_mask:0xf
 v_add_f32_dpp v234,v234,v234 row_ror:2 row_mask:0xf bank_mask:0xf
 v_add_f32_dpp v235,v235,v235 row_ror:2 row_mask:0xf bank_mask:0xf
 v_add_f32_dpp v236,v236,v236 row_ror:2 row_mask:0xf bank_mask:0xf
 v_add_f32_dpp v237,v237,v237 row_ror:2 row_mask:0xf bank_mask:0xf
 v_add_f32_dpp v238,v238,v238 row_ror:2 row_mask:0xf bank_mask:0xf
 v_add_f32_dpp v239,v239,v239 row_ror:2 row_mask:0xf bank_mask:0xf
 v_add_f32_dpp v240,v240,v240 row_ror:2 row_mask:0xf bank_mask:0xf
 v_add_f32_dpp v241,v241,v241 row_ror:2 row_mask:0xf bank_mask:0xf
 v_add_f32_dpp v242,v242,v242 row_ror:2 row_mask:0xf bank_mask:0xf
 v_add_f32_dpp v243,v243,v243 row_ror:2 row_mask:0xf bank_mask:0xf
 v_add_f32_dpp v244,v244,v244 row_ror:2 row_mask:0xf bank_mask:0xf
 v_add_f32_dpp v245,v245,v245 row_ror:2 row_mask:0xf bank_mask:0xf
 v_add_f32_dpp v246,v246,v246 row_ror:2 row_mask:0xf bank_mask:0xf
 v_add_f32_dpp v247,v247,v247 row_ror:2 row_mask:0xf bank_mask:0xf
 v_add_f32_dpp v248,v248,v248 row_ror:2 row_mask:0xf bank_mask:0xf
 v_add_f32_dpp v249,v249,v249 row_ror:2 row_mask:0xf bank_mask:0xf
 v_add_f32_dpp v250,v250,v250 row_ror:2 row_mask:0xf bank_mask:0xf
 v_add_f32_dpp v251,v251,v251 row_ror:2 row_mask:0xf bank_mask:0xf
 v_add_f32_dpp v252,v252,v252 row_ror:2 row_mask:0xf bank_mask:0xf
 v_add_f32_dpp v253,v253,v253 row_ror:2 row_mask:0xf bank_mask:0xf
 v_add_f32_dpp v254,v254,v254 row_ror:2 row_mask:0xf bank_mask:0xf
 v_add_f32_dpp v255,v255,v255 row_ror:2 row_mask:0xf bank_mask:0xf
 v_add_f32_dpp v224,v224,v224 row_ror:1 row_mask:0xf bank_mask:0xf
 v_add_f32_dpp v225,v225,v225 row_ror:1 row_mask:0xf bank_mask:0xf
 v_add_f32_dpp v226,v226,v226 row_ror:1 row_mask:0xf bank_mask:0xf
 v_add_f32_dpp v227,v227,v227 row_ror:1 row_mask:0xf bank_mask:0xf
 v_add_f32_dpp v228,v228,v228 row_ror:1 row_mask:0xf bank_mask:0xf
 v_add_f32_dpp v229,v229,v229 row_ror:1 row_mask:0xf bank_mask:0xf
 v_add_f32_dpp v230,v230,v230 row_ror:1 row_mask:0xf bank_mask:0xf
 v_add_f32_dpp v231,v231,v231 row_ror:1 row_mask:0xf bank_mask:0xf
 v_add_f32_dpp v232,v232,v232 row_ror:1 row_mask:0xf bank_mask:0xf
 v_add_f32_dpp v233,v233,v233 row_ror:1 row_mask:0xf bank_mask:0xf
 v_add_f32_dpp v234,v234,v234 row_ror:1 row_mask:0xf bank_mask:0xf
 v_add_f32_dpp v235,v235,v235 row_ror:1 row_mask:0xf bank_mask:0xf
 v_add_f32_dpp v236,v236,v236 row_ror:1 row_mask:0xf bank_mask:0xf
 v_add_f32_dpp v237,v237,v237 row_ror:1 row_mask:0xf bank_mask:0xf
 v_add_f32_dpp v238,v238,v238 row_ror:1 row_mask:0xf bank_mask:0xf
 v_add_f32_dpp v239,v239,v239 row_ror:1 row_mask:0xf bank_mask:0xf
 v_add_f32_dpp v240,v240,v240 row_ror:1 row_mask:0xf bank_mask:0xf
 v_add_f32_dpp v241,v241,v241 row_ror:1 row_mask:0xf bank_mask:0xf
 v_add_f32_dpp v242,v242,v242 row_ror:1 row_mask:0xf bank_mask:0xf
 v_add_f32_dpp v243,v243,v243 row_ror:1 row_mask:0xf bank_mask:0xf
 v_add_f32_dpp v244,v244,v244 row_ror:1 row_mask:0xf bank_mask:0xf
 v_add_f32_dpp v245,v245,v245 row_ror:1 row_mask:0xf bank_mask:0xf
 v_add_f32_dpp v246,v246,v246 row_ror:1 row_mask:0xf bank_mask:0xf
 v_add_f32_dpp v247,v247,v247 row_ror:1 row_mask:0xf bank_mask:0xf
 v_add_f32_dpp v248,v248,v248 row_ror:1 row_mask:0xf bank_mask:0xf
 v_add_f32_dpp v249,v249,v249 row_ror:1 row_mask:0xf bank_mask:0xf
 v_add_f32_dpp v250,v250,v250 row_ror:1 row_mask:0xf bank_mask:0xf
 v_add_f32_dpp v251,v251,v251 row_ror:1 row_mask:0xf bank_mask:0xf
 v_add_f32_dpp v252,v252,v252 row_ror:1 row_mask:0xf bank_mask:0xf
 v_add_f32_dpp v253,v253,v253 row_ror:1 row_mask:0xf bank_mask:0xf
 v_add_f32_dpp v254,v254,v254 row_ror:1 row_mask:0xf bank_mask:0xf
 v_add_f32_dpp v255,v255,v255 row_ror:1 row_mask:0xf bank_mask:0xf
 v_lshrrev_b32 v2,4,v0
 v_lshlrev_b32 v2,4,v2
 v_add_u32 v2,71680,v2
 s_lshl_b32 s26,s35,9
 v_add_u32 v3,s26,v2
 ds_write_b128 v3,v[224:227]
 ds_write_b128 v3,v[228:231] offset:64
 ds_write_b128 v3,v[232:235] offset:128
 ds_write_b128 v3,v[236:239] offset:192
 ds_write_b128 v3,v[240:243] offset:256
 ds_write_b128 v3,v[244:247] offset:320
 ds_write_b128 v3,v[248:251] offset:384
 ds_write_b128 v3,v[252:255] offset:448
 s_waitcnt lgkmcnt(0)
 s_barrier
 RQ v[224:227],v2
 RQ v[228:231],v2 offset:64
 RQ v[232:235],v2 offset:128
 RQ v[236:239],v2 offset:192
 RQ v[240:243],v2 offset:256
 RQ v[244:247],v2 offset:320
 RQ v[248:251],v2 offset:384
 RQ v[252:255],v2 offset:448
 RQ v[72:75],v2 offset:512
 RQ v[76:79],v2 offset:576
 RQ v[80:83],v2 offset:640
 RQ v[84:87],v2 offset:704
 RQ v[88:91],v2 offset:768
 RQ v[92:95],v2 offset:832
 RQ v[96:99],v2 offset:896
 RQ v[100:103],v2 offset:960
 s_waitcnt lgkmcnt(7)
 v_pk_add_f32 v[224:225],v[224:225],v[72:73]
 v_pk_add_f32 v[226:227],v[226:227],v[74:75]
 s_waitcnt lgkmcnt(6)
 v_pk_add_f32 v[228:229],v[228:229],v[76:77]
 v_pk_add_f32 v[230:231],v[230:231],v[78:79]
 s_waitcnt lgkmcnt(5)
 v_pk_add_f32 v[232:233],v[232:233],v[80:81]
 v_pk_add_f32 v[234:235],v[234:235],v[82:83]
 s_waitcnt lgkmcnt(4)
 v_pk_add_f32 v[236:237],v[236:237],v[84:85]
 v_pk_add_f32 v[238:239],v[238:239],v[86:87]
 s_waitcnt lgkmcnt(3)
 v_pk_add_f32 v[240:241],v[240:241],v[88:89]
 v_pk_add_f32 v[242:243],v[242:243],v[90:91]
 s_waitcnt lgkmcnt(2)
 v_pk_add_f32 v[244:245],v[244:245],v[92:93]
 v_pk_add_f32 v[246:247],v[246:247],v[94:95]
 s_waitcnt lgkmcnt(1)
 v_pk_add_f32 v[248:249],v[248:249],v[96:97]
 v_pk_add_f32 v[250:251],v[250:251],v[98:99]
 s_waitcnt lgkmcnt(0)
 v_pk_add_f32 v[252:253],v[252:253],v[100:101]
 v_pk_add_f32 v[254:255],v[254:255],v[102:103]
 RQ v[72:75],v2 offset:1024
 RQ v[76:79],v2 offset:1088
 RQ v[80:83],v2 offset:1152
 RQ v[84:87],v2 offset:1216
 RQ v[88:91],v2 offset:1280
 RQ v[92:95],v2 offset:1344
 RQ v[96:99],v2 offset:1408
 RQ v[100:103],v2 offset:1472
 s_waitcnt lgkmcnt(7)
 v_pk_add_f32 v[224:225],v[224:225],v[72:73]
 v_pk_add_f32 v[226:227],v[226:227],v[74:75]
 s_waitcnt lgkmcnt(6)
 v_pk_add_f32 v[228:229],v[228:229],v[76:77]
 v_pk_add_f32 v[230:231],v[230:231],v[78:79]
 s_waitcnt lgkmcnt(5)
 v_pk_add_f32 v[232:233],v[232:233],v[80:81]
 v_pk_add_f32 v[234:235],v[234:235],v[82:83]
 s_waitcnt lgkmcnt(4)
 v_pk_add_f32 v[236:237],v[236:237],v[84:85]
 v_pk_add_f32 v[238:239],v[238:239],v[86:87]
 s_waitcnt lgkmcnt(3)
 v_pk_add_f32 v[240:241],v[240:241],v[88:89]
 v_pk_add_f32 v[242:243],v[242:243],v[90:91]
 s_waitcnt lgkmcnt(2)
 v_pk_add_f32 v[244:245],v[244:245],v[92:93]
 v_pk_add_f32 v[246:247],v[246:247],v[94:95]
 s_waitcnt lgkmcnt(1)
 v_pk_add_f32 v[248:249],v[248:249],v[96:97]
 v_pk_add_f32 v[250:251],v[250:251],v[98:99]
 s_waitcnt lgkmcnt(0)
 v_pk_add_f32 v[252:253],v[252:253],v[100:101]
 v_pk_add_f32 v[254:255],v[254:255],v[102:103]
 RQ v[72:75],v2 offset:1536
 RQ v[76:79],v2 offset:1600
 RQ v[80:83],v2 offset:1664
 RQ v[84:87],v2 offset:1728
 RQ v[88:91],v2 offset:1792
 RQ v[92:95],v2 offset:1856
 RQ v[96:99],v2 offset:1920
 RQ v[100:103],v2 offset:1984
 s_waitcnt lgkmcnt(7)
 v_pk_add_f32 v[224:225],v[224:225],v[72:73]
 v_pk_add_f32 v[226:227],v[226:227],v[74:75]
 s_waitcnt lgkmcnt(6)
 v_pk_add_f32 v[228:229],v[228:229],v[76:77]
 v_pk_add_f32 v[230:231],v[230:231],v[78:79]
 s_waitcnt lgkmcnt(5)
 v_pk_add_f32 v[232:233],v[232:233],v[80:81]
 v_pk_add_f32 v[234:235],v[234:235],v[82:83]
 s_waitcnt lgkmcnt(4)
 v_pk_add_f32 v[236:237],v[236:237],v[84:85]
 v_pk_add_f32 v[238:239],v[238:239],v[86:87]
 s_waitcnt lgkmcnt(3)
 v_pk_add_f32 v[240:241],v[240:241],v[88:89]
 v_pk_add_f32 v[242:243],v[242:243],v[90:91]
 s_waitcnt lgkmcnt(2)
 v_pk_add_f32 v[244:245],v[244:245],v[92:93]
 v_pk_add_f32 v[246:247],v[246:247],v[94:95]
 s_waitcnt lgkmcnt(1)
 v_pk_add_f32 v[248:249],v[248:249],v[96:97]
 v_pk_add_f32 v[250:251],v[250:251],v[98:99]
 s_waitcnt lgkmcnt(0)
 v_pk_add_f32 v[252:253],v[252:253],v[100:101]
 v_pk_add_f32 v[254:255],v[254:255],v[102:103]
 v_mul_f32 v224,0x3a924925,v224
 v_mul_f32 v225,0x3a924925,v225
 v_mul_f32 v226,0x3a924925,v226
 v_mul_f32 v227,0x3a924925,v227
 v_mul_f32 v228,0x3a924925,v228
 v_mul_f32 v229,0x3a924925,v229
 v_mul_f32 v230,0x3a924925,v230
 v_mul_f32 v231,0x3a924925,v231
 v_mul_f32 v232,0x3a924925,v232
 v_mul_f32 v233,0x3a924925,v233
 v_mul_f32 v234,0x3a924925,v234
 v_mul_f32 v235,0x3a924925,v235
 v_mul_f32 v236,0x3a924925,v236
 v_mul_f32 v237,0x3a924925,v237
 v_mul_f32 v238,0x3a924925,v238
 v_mul_f32 v239,0x3a924925,v239
 v_mul_f32 v240,0x3a924925,v240
 v_mul_f32 v241,0x3a924925,v241
 v_mul_f32 v242,0x3a924925,v242
 v_mul_f32 v243,0x3a924925,v243
 v_mul_f32 v244,0x3a924925,v244
 v_mul_f32 v245,0x3a924925,v245
 v_mul_f32 v246,0x3a924925,v246
 v_mul_f32 v247,0x3a924925,v247
 v_mul_f32 v248,0x3a924925,v248
 v_mul_f32 v249,0x3a924925,v249
 v_mul_f32 v250,0x3a924925,v250
 v_mul_f32 v251,0x3a924925,v251
 v_mul_f32 v252,0x3a924925,v252
 v_mul_f32 v253,0x3a924925,v253
 v_mul_f32 v254,0x3a924925,v254
 v_mul_f32 v255,0x3a924925,v255
 v_fma_f32 v240,-v224,v224,v240
 v_fma_f32 v241,-v225,v225,v241
 v_fma_f32 v242,-v226,v226,v242
 v_fma_f32 v243,-v227,v227,v243
 v_fma_f32 v244,-v228,v228,v244
 v_fma_f32 v245,-v229,v229,v245
 v_fma_f32 v246,-v230,v230,v246
 v_fma_f32 v247,-v231,v231,v247
 v_fma_f32 v248,-v232,v232,v248
 v_fma_f32 v249,-v233,v233,v249
 v_fma_f32 v250,-v234,v234,v250
 v_fma_f32 v251,-v235,v235,v251
 v_fma_f32 v252,-v236,v236,v252
 v_fma_f32 v253,-v237,v237,v253
 v_fma_f32 v254,-v238,v238,v254
 v_fma_f32 v255,-v239,v239,v255
 v_max_f32 v240,0,v240
 v_max_f32 v241,0,v241
 v_max_f32 v242,0,v242
 v_max_f32 v243,0,v243
 v_max_f32 v244,0,v244
 v_max_f32 v245,0,v245
 v_max_f32 v246,0,v246
 v_max_f32 v247,0,v247
 v_max_f32 v248,0,v248
 v_max_f32 v249,0,v249
 v_max_f32 v250,0,v250
 v_max_f32 v251,0,v251
 v_max_f32 v252,0,v252
 v_max_f32 v253,0,v253
 v_max_f32 v254,0,v254
 v_max_f32 v255,0,v255
 v_add_f32 v240,0x3727c5ac,v240
 v_add_f32 v241,0x3727c5ac,v241
 v_add_f32 v242,0x3727c5ac,v242
 v_add_f32 v243,0x3727c5ac,v243
 v_add_f32 v244,0x3727c5ac,v244
 v_add_f32 v245,0x3727c5ac,v245
 v_add_f32 v246,0x3727c5ac,v246
 v_add_f32 v247,0x3727c5ac,v247
 v_add_f32 v248,0x3727c5ac,v248
 v_add_f32 v249,0x3727c5ac,v249
 v_add_f32 v250,0x3727c5ac,v250
 v_add_f32 v251,0x3727c5ac,v251
 v_add_f32 v252,0x3727c5ac,v252
 v_add_f32 v253,0x3727c5ac,v253
 v_add_f32 v254,0x3727c5ac,v254
 v_add_f32 v255,0x3727c5ac,v255
 v_rsq_f32 v240,v240
 v_rsq_f32 v241,v241
 v_rsq_f32 v242,v242
 v_rsq_f32 v243,v243
 v_rsq_f32 v244,v244
 v_rsq_f32 v245,v245
 v_rsq_f32 v246,v246
 v_rsq_f32 v247,v247
 v_rsq_f32 v248,v248
 v_rsq_f32 v249,v249
 v_rsq_f32 v250,v250
 v_rsq_f32 v251,v251
 v_rsq_f32 v252,v252
 v_rsq_f32 v253,v253
 v_rsq_f32 v254,v254
 v_rsq_f32 v255,v255
 v_mul_f32 v224,-v224,v240
 v_mul_f32 v225,-v225,v241
 v_mul_f32 v226,-v226,v242
 v_mul_f32 v227,-v227,v243
 v_mul_f32 v228,-v228,v244
 v_mul_f32 v229,-v229,v245
 v_mul_f32 v230,-v230,v246
 v_mul_f32 v231,-v231,v247
 v_mul_f32 v232,-v232,v248
 v_mul_f32 v233,-v233,v249
 v_mul_f32 v234,-v234,v250
 v_mul_f32 v235,-v235,v251
 v_mul_f32 v236,-v236,v252
 v_mul_f32 v237,-v237,v253
 v_mul_f32 v238,-v238,v254
 v_mul_f32 v239,-v239,v255
 s_add_u32 s16,s68,71303168
 s_addc_u32 s17,s69,0
 s_mov_b32 s18,3670016
 s_mov_b32 s19,0x20000
 v_and_b32 v1,15,v0
 v_bfe_u32 v2,v0,5,1
 v_bfe_u32 v3,v0,4,1
 v_lshl_add_u32 v2,v3,1,v2
 v_lshl_add_u32 v2,v2,4,v1
 v_lshlrev_b32 v5,4,v2
 s_mul_i32 s84,s101,114688
 s_lshl_b32 s85,s35,11
 s_add_u32 s84,s84,s85
 v_lshlrev_b32 v72,16,v112
 v_and_b32 v73,0xffff0000,v112
 v_lshlrev_b32 v74,16,v113
 v_and_b32 v75,0xffff0000,v113
 v_lshlrev_b32 v76,16,v114
 v_and_b32 v77,0xffff0000,v114
 v_lshlrev_b32 v78,16,v115
 v_and_b32 v79,0xffff0000,v115
 v_pk_fma_f32 v[72:73],v[72:73],v[240:241],v[224:225]
 v_pk_fma_f32 v[74:75],v[74:75],v[242:243],v[226:227]
 v_pk_fma_f32 v[76:77],v[76:77],v[244:245],v[228:229]
 v_pk_fma_f32 v[78:79],v[78:79],v[246:247],v[230:231]
 CV v112,v72,v73
 CV v113,v74,v75
 CV v114,v76,v77
 CV v115,v78,v79
 s_nop 0
 v_permlane16_swap_b32 v112,v114
 s_nop 0
 v_permlane16_swap_b32 v113,v115
 BS v[112:115],v5,s[16:19],s84 offen sc1
 v_lshlrev_b32 v80,16,v116
 v_and_b32 v81,0xffff0000,v116
 v_lshlrev_b32 v82,16,v117
 v_and_b32 v83,0xffff0000,v117
 v_lshlrev_b32 v84,16,v118
 v_and_b32 v85,0xffff0000,v118
 v_lshlrev_b32 v86,16,v119
 v_and_b32 v87,0xffff0000,v119
 v_pk_fma_f32 v[80:81],v[80:81],v[240:241],v[224:225]
 v_pk_fma_f32 v[82:83],v[82:83],v[242:243],v[226:227]
 v_pk_fma_f32 v[84:85],v[84:85],v[244:245],v[228:229]
 v_pk_fma_f32 v[86:87],v[86:87],v[246:247],v[230:231]
 CV v116,v80,v81
 CV v117,v82,v83
 CV v118,v84,v85
 CV v119,v86,v87
 s_nop 0
 v_permlane16_swap_b32 v116,v118
 s_nop 0
 v_permlane16_swap_b32 v117,v119
 BS v[116:119],v5,s[16:19],s84 offen offset:1024 sc1
 v_lshlrev_b32 v88,16,v120
 v_and_b32 v89,0xffff0000,v120
 v_lshlrev_b32 v90,16,v121
 v_and_b32 v91,0xffff0000,v121
 v_lshlrev_b32 v92,16,v122
 v_and_b32 v93,0xffff0000,v122
 v_lshlrev_b32 v94,16,v123
 v_and_b32 v95,0xffff0000,v123
 v_pk_fma_f32 v[88:89],v[88:89],v[248:249],v[232:233]
 v_pk_fma_f32 v[90:91],v[90:91],v[250:251],v[234:235]
 v_pk_fma_f32 v[92:93],v[92:93],v[252:253],v[236:237]
 v_pk_fma_f32 v[94:95],v[94:95],v[254:255],v[238:239]
 CV v120,v88,v89
 CV v121,v90,v91
 CV v122,v92,v93
 CV v123,v94,v95
 s_nop 0
 v_permlane16_swap_b32 v120,v122
 s_nop 0
 v_permlane16_swap_b32 v121,v123
 s_add_u32 s85,s84,57344
 BS v[120:123],v5,s[16:19],s85 offen sc1
 v_lshlrev_b32 v96,16,v124
 v_and_b32 v97,0xffff0000,v124
 v_lshlrev_b32 v98,16,v125
 v_and_b32 v99,0xffff0000,v125
 v_lshlrev_b32 v100,16,v126
 v_and_b32 v101,0xffff0000,v126
 v_lshlrev_b32 v102,16,v127
 v_and_b32 v103,0xffff0000,v127
 v_pk_fma_f32 v[96:97],v[96:97],v[248:249],v[232:233]
 v_pk_fma_f32 v[98:99],v[98:99],v[250:251],v[234:235]
 v_pk_fma_f32 v[100:101],v[100:101],v[252:253],v[236:237]
 v_pk_fma_f32 v[102:103],v[102:103],v[254:255],v[238:239]
 CV v124,v96,v97
 CV v125,v98,v99
 CV v126,v100,v101
 CV v127,v102,v103
 s_nop 0
 v_permlane16_swap_b32 v124,v126
 s_nop 0
 v_permlane16_swap_b32 v125,v127
 s_add_u32 s85,s84,57344
 BS v[124:127],v5,s[16:19],s85 offen offset:1024 sc1
 v_lshlrev_b32 v72,16,v128
 v_and_b32 v73,0xffff0000,v128
 v_lshlrev_b32 v74,16,v129
 v_and_b32 v75,0xffff0000,v129
 v_lshlrev_b32 v76,16,v130
 v_and_b32 v77,0xffff0000,v130
 v_lshlrev_b32 v78,16,v131
 v_and_b32 v79,0xffff0000,v131
 v_pk_fma_f32 v[72:73],v[72:73],v[240:241],v[224:225]
 v_pk_fma_f32 v[74:75],v[74:75],v[242:243],v[226:227]
 v_pk_fma_f32 v[76:77],v[76:77],v[244:245],v[228:229]
 v_pk_fma_f32 v[78:79],v[78:79],v[246:247],v[230:231]
 CV v128,v72,v73
 CV v129,v74,v75
 CV v130,v76,v77
 CV v131,v78,v79
 s_nop 0
 v_permlane16_swap_b32 v128,v130
 s_nop 0
 v_permlane16_swap_b32 v129,v131
 s_add_u32 s85,s84,8192
 BS v[128:131],v5,s[16:19],s85 offen sc1
 v_lshlrev_b32 v80,16,v132
 v_and_b32 v81,0xffff0000,v132
 v_lshlrev_b32 v82,16,v133
 v_and_b32 v83,0xffff0000,v133
 v_lshlrev_b32 v84,16,v134
 v_and_b32 v85,0xffff0000,v134
 v_lshlrev_b32 v86,16,v135
 v_and_b32 v87,0xffff0000,v135
 v_pk_fma_f32 v[80:81],v[80:81],v[240:241],v[224:225]
 v_pk_fma_f32 v[82:83],v[82:83],v[242:243],v[226:227]
 v_pk_fma_f32 v[84:85],v[84:85],v[244:245],v[228:229]
 v_pk_fma_f32 v[86:87],v[86:87],v[246:247],v[230:231]
 CV v132,v80,v81
 CV v133,v82,v83
 CV v134,v84,v85
 CV v135,v86,v87
 s_nop 0
 v_permlane16_swap_b32 v132,v134
 s_nop 0
 v_permlane16_swap_b32 v133,v135
 s_add_u32 s85,s84,8192
 BS v[132:135],v5,s[16:19],s85 offen offset:1024 sc1
 v_lshlrev_b32 v88,16,v136
 v_and_b32 v89,0xffff0000,v136
 v_lshlrev_b32 v90,16,v137
 v_and_b32 v91,0xffff0000,v137
 v_lshlrev_b32 v92,16,v138
 v_and_b32 v93,0xffff0000,v138
 v_lshlrev_b32 v94,16,v139
 v_and_b32 v95,0xffff0000,v139
 v_pk_fma_f32 v[88:89],v[88:89],v[248:249],v[232:233]
 v_pk_fma_f32 v[90:91],v[90:91],v[250:251],v[234:235]
 v_pk_fma_f32 v[92:93],v[92:93],v[252:253],v[236:237]
 v_pk_fma_f32 v[94:95],v[94:95],v[254:255],v[238:239]
 CV v136,v88,v89
 CV v137,v90,v91
 CV v138,v92,v93
 CV v139,v94,v95
 s_nop 0
 v_permlane16_swap_b32 v136,v138
 s_nop 0
 v_permlane16_swap_b32 v137,v139
 s_add_u32 s85,s84,65536
 BS v[136:139],v5,s[16:19],s85 offen sc1
 v_lshlrev_b32 v96,16,v140
 v_and_b32 v97,0xffff0000,v140
 v_lshlrev_b32 v98,16,v141
 v_and_b32 v99,0xffff0000,v141
 v_lshlrev_b32 v100,16,v142
 v_and_b32 v101,0xffff0000,v142
 v_lshlrev_b32 v102,16,v143
 v_and_b32 v103,0xffff0000,v143
 v_pk_fma_f32 v[96:97],v[96:97],v[248:249],v[232:233]
 v_pk_fma_f32 v[98:99],v[98:99],v[250:251],v[234:235]
 v_pk_fma_f32 v[100:101],v[100:101],v[252:253],v[236:237]
 v_pk_fma_f32 v[102:103],v[102:103],v[254:255],v[238:239]
 CV v140,v96,v97
 CV v141,v98,v99
 CV v142,v100,v101
 CV v143,v102,v103
 s_nop 0
 v_permlane16_swap_b32 v140,v142
 s_nop 0
 v_permlane16_swap_b32 v141,v143
 s_add_u32 s85,s84,65536
 BS v[140:143],v5,s[16:19],s85 offen offset:1024 sc1
 v_lshlrev_b32 v72,16,v144
 v_and_b32 v73,0xffff0000,v144
 v_lshlrev_b32 v74,16,v145
 v_and_b32 v75,0xffff0000,v145
 v_lshlrev_b32 v76,16,v146
 v_and_b32 v77,0xffff0000,v146
 v_lshlrev_b32 v78,16,v147
 v_and_b32 v79,0xffff0000,v147
 v_pk_fma_f32 v[72:73],v[72:73],v[240:241],v[224:225]
 v_pk_fma_f32 v[74:75],v[74:75],v[242:243],v[226:227]
 v_pk_fma_f32 v[76:77],v[76:77],v[244:245],v[228:229]
 v_pk_fma_f32 v[78:79],v[78:79],v[246:247],v[230:231]
 CV v144,v72,v73
 CV v145,v74,v75
 CV v146,v76,v77
 CV v147,v78,v79
 s_nop 0
 v_permlane16_swap_b32 v144,v146
 s_nop 0
 v_permlane16_swap_b32 v145,v147
 s_add_u32 s85,s84,16384
 BS v[144:147],v5,s[16:19],s85 offen sc1
 v_lshlrev_b32 v80,16,v148
 v_and_b32 v81,0xffff0000,v148
 v_lshlrev_b32 v82,16,v149
 v_and_b32 v83,0xffff0000,v149
 v_lshlrev_b32 v84,16,v150
 v_and_b32 v85,0xffff0000,v150
 v_lshlrev_b32 v86,16,v151
 v_and_b32 v87,0xffff0000,v151
 v_pk_fma_f32 v[80:81],v[80:81],v[240:241],v[224:225]
 v_pk_fma_f32 v[82:83],v[82:83],v[242:243],v[226:227]
 v_pk_fma_f32 v[84:85],v[84:85],v[244:245],v[228:229]
 v_pk_fma_f32 v[86:87],v[86:87],v[246:247],v[230:231]
 CV v148,v80,v81
 CV v149,v82,v83
 CV v150,v84,v85
 CV v151,v86,v87
 s_nop 0
 v_permlane16_swap_b32 v148,v150
 s_nop 0
 v_permlane16_swap_b32 v149,v151
 s_add_u32 s85,s84,16384
 BS v[148:151],v5,s[16:19],s85 offen offset:1024 sc1
 v_lshlrev_b32 v88,16,v152
 v_and_b32 v89,0xffff0000,v152
 v_lshlrev_b32 v90,16,v153
 v_and_b32 v91,0xffff0000,v153
 v_lshlrev_b32 v92,16,v154
 v_and_b32 v93,0xffff0000,v154
 v_lshlrev_b32 v94,16,v155
 v_and_b32 v95,0xffff0000,v155
 v_pk_fma_f32 v[88:89],v[88:89],v[248:249],v[232:233]
 v_pk_fma_f32 v[90:91],v[90:91],v[250:251],v[234:235]
 v_pk_fma_f32 v[92:93],v[92:93],v[252:253],v[236:237]
 v_pk_fma_f32 v[94:95],v[94:95],v[254:255],v[238:239]
 CV v152,v88,v89
 CV v153,v90,v91
 CV v154,v92,v93
 CV v155,v94,v95
 s_nop 0
 v_permlane16_swap_b32 v152,v154
 s_nop 0
 v_permlane16_swap_b32 v153,v155
 s_add_u32 s85,s84,73728
 BS v[152:155],v5,s[16:19],s85 offen sc1
 v_lshlrev_b32 v96,16,v156
 v_and_b32 v97,0xffff0000,v156
 v_lshlrev_b32 v98,16,v157
 v_and_b32 v99,0xffff0000,v157
 v_lshlrev_b32 v100,16,v158
 v_and_b32 v101,0xffff0000,v158
 v_lshlrev_b32 v102,16,v159
 v_and_b32 v103,0xffff0000,v159
 v_pk_fma_f32 v[96:97],v[96:97],v[248:249],v[232:233]
 v_pk_fma_f32 v[98:99],v[98:99],v[250:251],v[234:235]
 v_pk_fma_f32 v[100:101],v[100:101],v[252:253],v[236:237]
 v_pk_fma_f32 v[102:103],v[102:103],v[254:255],v[238:239]
 CV v156,v96,v97
 CV v157,v98,v99
 CV v158,v100,v101
 CV v159,v102,v103
 s_nop 0
 v_permlane16_swap_b32 v156,v158
 s_nop 0
 v_permlane16_swap_b32 v157,v159
 s_add_u32 s85,s84,73728
 BS v[156:159],v5,s[16:19],s85 offen offset:1024 sc1
 v_lshlrev_b32 v72,16,v160
 v_and_b32 v73,0xffff0000,v160
 v_lshlrev_b32 v74,16,v161
 v_and_b32 v75,0xffff0000,v161
 v_lshlrev_b32 v76,16,v162
 v_and_b32 v77,0xffff0000,v162
 v_lshlrev_b32 v78,16,v163
 v_and_b32 v79,0xffff0000,v163
 v_pk_fma_f32 v[72:73],v[72:73],v[240:241],v[224:225]
 v_pk_fma_f32 v[74:75],v[74:75],v[242:243],v[226:227]
 v_pk_fma_f32 v[76:77],v[76:77],v[244:245],v[228:229]
 v_pk_fma_f32 v[78:79],v[78:79],v[246:247],v[230:231]
 CV v160,v72,v73
 CV v161,v74,v75
 CV v162,v76,v77
 CV v163,v78,v79
 s_nop 0
 v_permlane16_swap_b32 v160,v162
 s_nop 0
 v_permlane16_swap_b32 v161,v163
 s_add_u32 s85,s84,24576
 BS v[160:163],v5,s[16:19],s85 offen sc1
 v_lshlrev_b32 v80,16,v164
 v_and_b32 v81,0xffff0000,v164
 v_lshlrev_b32 v82,16,v165
 v_and_b32 v83,0xffff0000,v165
 v_lshlrev_b32 v84,16,v166
 v_and_b32 v85,0xffff0000,v166
 v_lshlrev_b32 v86,16,v167
 v_and_b32 v87,0xffff0000,v167
 v_pk_fma_f32 v[80:81],v[80:81],v[240:241],v[224:225]
 v_pk_fma_f32 v[82:83],v[82:83],v[242:243],v[226:227]
 v_pk_fma_f32 v[84:85],v[84:85],v[244:245],v[228:229]
 v_pk_fma_f32 v[86:87],v[86:87],v[246:247],v[230:231]
 CV v164,v80,v81
 CV v165,v82,v83
 CV v166,v84,v85
 CV v167,v86,v87
 s_nop 0
 v_permlane16_swap_b32 v164,v166
 s_nop 0
 v_permlane16_swap_b32 v165,v167
 s_add_u32 s85,s84,24576
 BS v[164:167],v5,s[16:19],s85 offen offset:1024 sc1
 v_lshlrev_b32 v88,16,v168
 v_and_b32 v89,0xffff0000,v168
 v_lshlrev_b32 v90,16,v169
 v_and_b32 v91,0xffff0000,v169
 v_lshlrev_b32 v92,16,v170
 v_and_b32 v93,0xffff0000,v170
 v_lshlrev_b32 v94,16,v171
 v_and_b32 v95,0xffff0000,v171
 v_pk_fma_f32 v[88:89],v[88:89],v[248:249],v[232:233]
 v_pk_fma_f32 v[90:91],v[90:91],v[250:251],v[234:235]
 v_pk_fma_f32 v[92:93],v[92:93],v[252:253],v[236:237]
 v_pk_fma_f32 v[94:95],v[94:95],v[254:255],v[238:239]
 CV v168,v88,v89
 CV v169,v90,v91
 CV v170,v92,v93
 CV v171,v94,v95
 s_nop 0
 v_permlane16_swap_b32 v168,v170
 s_nop 0
 v_permlane16_swap_b32 v169,v171
 s_add_u32 s85,s84,81920
 BS v[168:171],v5,s[16:19],s85 offen sc1
 v_lshlrev_b32 v96,16,v172
 v_and_b32 v97,0xffff0000,v172
 v_lshlrev_b32 v98,16,v173
 v_and_b32 v99,0xffff0000,v173
 v_lshlrev_b32 v100,16,v174
 v_and_b32 v101,0xffff0000,v174
 v_lshlrev_b32 v102,16,v175
 v_and_b32 v103,0xffff0000,v175
 v_pk_fma_f32 v[96:97],v[96:97],v[248:249],v[232:233]
 v_pk_fma_f32 v[98:99],v[98:99],v[250:251],v[234:235]
 v_pk_fma_f32 v[100:101],v[100:101],v[252:253],v[236:237]
 v_pk_fma_f32 v[102:103],v[102:103],v[254:255],v[238:239]
 CV v172,v96,v97
 CV v173,v98,v99
 CV v174,v100,v101
 CV v175,v102,v103
 s_nop 0
 v_permlane16_swap_b32 v172,v174
 s_nop 0
 v_permlane16_swap_b32 v173,v175
 s_add_u32 s85,s84,81920
 BS v[172:175],v5,s[16:19],s85 offen offset:1024 sc1
 v_lshlrev_b32 v72,16,v176
 v_and_b32 v73,0xffff0000,v176
 v_lshlrev_b32 v74,16,v177
 v_and_b32 v75,0xffff0000,v177
 v_lshlrev_b32 v76,16,v178
 v_and_b32 v77,0xffff0000,v178
 v_lshlrev_b32 v78,16,v179
 v_and_b32 v79,0xffff0000,v179
 v_pk_fma_f32 v[72:73],v[72:73],v[240:241],v[224:225]
 v_pk_fma_f32 v[74:75],v[74:75],v[242:243],v[226:227]
 v_pk_fma_f32 v[76:77],v[76:77],v[244:245],v[228:229]
 v_pk_fma_f32 v[78:79],v[78:79],v[246:247],v[230:231]
 CV v176,v72,v73
 CV v177,v74,v75
 CV v178,v76,v77
 CV v179,v78,v79
 s_nop 0
 v_permlane16_swap_b32 v176,v178
 s_nop 0
 v_permlane16_swap_b32 v177,v179
 s_add_u32 s85,s84,32768
 BS v[176:179],v5,s[16:19],s85 offen sc1
 v_lshlrev_b32 v80,16,v180
 v_and_b32 v81,0xffff0000,v180
 v_lshlrev_b32 v82,16,v181
 v_and_b32 v83,0xffff0000,v181
 v_lshlrev_b32 v84,16,v182
 v_and_b32 v85,0xffff0000,v182
 v_lshlrev_b32 v86,16,v183
 v_and_b32 v87,0xffff0000,v183
 v_pk_fma_f32 v[80:81],v[80:81],v[240:241],v[224:225]
 v_pk_fma_f32 v[82:83],v[82:83],v[242:243],v[226:227]
 v_pk_fma_f32 v[84:85],v[84:85],v[244:245],v[228:229]
 v_pk_fma_f32 v[86:87],v[86:87],v[246:247],v[230:231]
 CV v180,v80,v81
 CV v181,v82,v83
 CV v182,v84,v85
 CV v183,v86,v87
 s_nop 0
 v_permlane16_swap_b32 v180,v182
 s_nop 0
 v_permlane16_swap_b32 v181,v183
 s_add_u32 s85,s84,32768
 BS v[180:183],v5,s[16:19],s85 offen offset:1024 sc1
 v_lshlrev_b32 v88,16,v184
 v_and_b32 v89,0xffff0000,v184
 v_lshlrev_b32 v90,16,v185
 v_and_b32 v91,0xffff0000,v185
 v_lshlrev_b32 v92,16,v186
 v_and_b32 v93,0xffff0000,v186
 v_lshlrev_b32 v94,16,v187
 v_and_b32 v95,0xffff0000,v187
 v_pk_fma_f32 v[88:89],v[88:89],v[248:249],v[232:233]
 v_pk_fma_f32 v[90:91],v[90:91],v[250:251],v[234:235]
 v_pk_fma_f32 v[92:93],v[92:93],v[252:253],v[236:237]
 v_pk_fma_f32 v[94:95],v[94:95],v[254:255],v[238:239]
 CV v184,v88,v89
 CV v185,v90,v91
 CV v186,v92,v93
 CV v187,v94,v95
 s_nop 0
 v_permlane16_swap_b32 v184,v186
 s_nop 0
 v_permlane16_swap_b32 v185,v187
 s_add_u32 s85,s84,90112
 BS v[184:187],v5,s[16:19],s85 offen sc1
 v_lshlrev_b32 v96,16,v188
 v_and_b32 v97,0xffff0000,v188
 v_lshlrev_b32 v98,16,v189
 v_and_b32 v99,0xffff0000,v189
 v_lshlrev_b32 v100,16,v190
 v_and_b32 v101,0xffff0000,v190
 v_lshlrev_b32 v102,16,v191
 v_and_b32 v103,0xffff0000,v191
 v_pk_fma_f32 v[96:97],v[96:97],v[248:249],v[232:233]
 v_pk_fma_f32 v[98:99],v[98:99],v[250:251],v[234:235]
 v_pk_fma_f32 v[100:101],v[100:101],v[252:253],v[236:237]
 v_pk_fma_f32 v[102:103],v[102:103],v[254:255],v[238:239]
 CV v188,v96,v97
 CV v189,v98,v99
 CV v190,v100,v101
 CV v191,v102,v103
 s_nop 0
 v_permlane16_swap_b32 v188,v190
 s_nop 0
 v_permlane16_swap_b32 v189,v191
 s_add_u32 s85,s84,90112
 BS v[188:191],v5,s[16:19],s85 offen offset:1024 sc1
 v_lshlrev_b32 v72,16,v192
 v_and_b32 v73,0xffff0000,v192
 v_lshlrev_b32 v74,16,v193
 v_and_b32 v75,0xffff0000,v193
 v_lshlrev_b32 v76,16,v194
 v_and_b32 v77,0xffff0000,v194
 v_lshlrev_b32 v78,16,v195
 v_and_b32 v79,0xffff0000,v195
 v_pk_fma_f32 v[72:73],v[72:73],v[240:241],v[224:225]
 v_pk_fma_f32 v[74:75],v[74:75],v[242:243],v[226:227]
 v_pk_fma_f32 v[76:77],v[76:77],v[244:245],v[228:229]
 v_pk_fma_f32 v[78:79],v[78:79],v[246:247],v[230:231]
 CV v192,v72,v73
 CV v193,v74,v75
 CV v194,v76,v77
 CV v195,v78,v79
 s_nop 0
 v_permlane16_swap_b32 v192,v194
 s_nop 0
 v_permlane16_swap_b32 v193,v195
 s_add_u32 s85,s84,40960
 BS v[192:195],v5,s[16:19],s85 offen sc1
 v_lshlrev_b32 v80,16,v196
 v_and_b32 v81,0xffff0000,v196
 v_lshlrev_b32 v82,16,v197
 v_and_b32 v83,0xffff0000,v197
 v_lshlrev_b32 v84,16,v198
 v_and_b32 v85,0xffff0000,v198
 v_lshlrev_b32 v86,16,v199
 v_and_b32 v87,0xffff0000,v199
 v_pk_fma_f32 v[80:81],v[80:81],v[240:241],v[224:225]
 v_pk_fma_f32 v[82:83],v[82:83],v[242:243],v[226:227]
 v_pk_fma_f32 v[84:85],v[84:85],v[244:245],v[228:229]
 v_pk_fma_f32 v[86:87],v[86:87],v[246:247],v[230:231]
 CV v196,v80,v81
 CV v197,v82,v83
 CV v198,v84,v85
 CV v199,v86,v87
 s_nop 0
 v_permlane16_swap_b32 v196,v198
 s_nop 0
 v_permlane16_swap_b32 v197,v199
 s_add_u32 s85,s84,40960
 BS v[196:199],v5,s[16:19],s85 offen offset:1024 sc1
 v_lshlrev_b32 v88,16,v200
 v_and_b32 v89,0xffff0000,v200
 v_lshlrev_b32 v90,16,v201
 v_and_b32 v91,0xffff0000,v201
 v_lshlrev_b32 v92,16,v202
 v_and_b32 v93,0xffff0000,v202
 v_lshlrev_b32 v94,16,v203
 v_and_b32 v95,0xffff0000,v203
 v_pk_fma_f32 v[88:89],v[88:89],v[248:249],v[232:233]
 v_pk_fma_f32 v[90:91],v[90:91],v[250:251],v[234:235]
 v_pk_fma_f32 v[92:93],v[92:93],v[252:253],v[236:237]
 v_pk_fma_f32 v[94:95],v[94:95],v[254:255],v[238:239]
 CV v200,v88,v89
 CV v201,v90,v91
 CV v202,v92,v93
 CV v203,v94,v95
 s_nop 0
 v_permlane16_swap_b32 v200,v202
 s_nop 0
 v_permlane16_swap_b32 v201,v203
 s_add_u32 s85,s84,98304
 BS v[200:203],v5,s[16:19],s85 offen sc1
 v_lshlrev_b32 v96,16,v204
 v_and_b32 v97,0xffff0000,v204
 v_lshlrev_b32 v98,16,v205
 v_and_b32 v99,0xffff0000,v205
 v_lshlrev_b32 v100,16,v206
 v_and_b32 v101,0xffff0000,v206
 v_lshlrev_b32 v102,16,v207
 v_and_b32 v103,0xffff0000,v207
 v_pk_fma_f32 v[96:97],v[96:97],v[248:249],v[232:233]
 v_pk_fma_f32 v[98:99],v[98:99],v[250:251],v[234:235]
 v_pk_fma_f32 v[100:101],v[100:101],v[252:253],v[236:237]
 v_pk_fma_f32 v[102:103],v[102:103],v[254:255],v[238:239]
 CV v204,v96,v97
 CV v205,v98,v99
 CV v206,v100,v101
 CV v207,v102,v103
 s_nop 0
 v_permlane16_swap_b32 v204,v206
 s_nop 0
 v_permlane16_swap_b32 v205,v207
 s_add_u32 s85,s84,98304
 BS v[204:207],v5,s[16:19],s85 offen offset:1024 sc1
 v_lshlrev_b32 v72,16,v208
 v_and_b32 v73,0xffff0000,v208
 v_lshlrev_b32 v74,16,v209
 v_and_b32 v75,0xffff0000,v209
 v_lshlrev_b32 v76,16,v210
 v_and_b32 v77,0xffff0000,v210
 v_lshlrev_b32 v78,16,v211
 v_and_b32 v79,0xffff0000,v211
 v_pk_fma_f32 v[72:73],v[72:73],v[240:241],v[224:225]
 v_pk_fma_f32 v[74:75],v[74:75],v[242:243],v[226:227]
 v_pk_fma_f32 v[76:77],v[76:77],v[244:245],v[228:229]
 v_pk_fma_f32 v[78:79],v[78:79],v[246:247],v[230:231]
 CV v208,v72,v73
 CV v209,v74,v75
 CV v210,v76,v77
 CV v211,v78,v79
 s_nop 0
 v_permlane16_swap_b32 v208,v210
 s_nop 0
 v_permlane16_swap_b32 v209,v211
 s_add_u32 s85,s84,49152
 BS v[208:211],v5,s[16:19],s85 offen sc1
 v_lshlrev_b32 v80,16,v212
 v_and_b32 v81,0xffff0000,v212
 v_lshlrev_b32 v82,16,v213
 v_and_b32 v83,0xffff0000,v213
 v_lshlrev_b32 v84,16,v214
 v_and_b32 v85,0xffff0000,v214
 v_lshlrev_b32 v86,16,v215
 v_and_b32 v87,0xffff0000,v215
 v_pk_fma_f32 v[80:81],v[80:81],v[240:241],v[224:225]
 v_pk_fma_f32 v[82:83],v[82:83],v[242:243],v[226:227]
 v_pk_fma_f32 v[84:85],v[84:85],v[244:245],v[228:229]
 v_pk_fma_f32 v[86:87],v[86:87],v[246:247],v[230:231]
 CV v212,v80,v81
 CV v213,v82,v83
 CV v214,v84,v85
 CV v215,v86,v87
 s_nop 0
 v_permlane16_swap_b32 v212,v214
 s_nop 0
 v_permlane16_swap_b32 v213,v215
 s_add_u32 s85,s84,49152
 BS v[212:215],v5,s[16:19],s85 offen offset:1024 sc1
 v_lshlrev_b32 v88,16,v216
 v_and_b32 v89,0xffff0000,v216
 v_lshlrev_b32 v90,16,v217
 v_and_b32 v91,0xffff0000,v217
 v_lshlrev_b32 v92,16,v218
 v_and_b32 v93,0xffff0000,v218
 v_lshlrev_b32 v94,16,v219
 v_and_b32 v95,0xffff0000,v219
 v_pk_fma_f32 v[88:89],v[88:89],v[248:249],v[232:233]
 v_pk_fma_f32 v[90:91],v[90:91],v[250:251],v[234:235]
 v_pk_fma_f32 v[92:93],v[92:93],v[252:253],v[236:237]
 v_pk_fma_f32 v[94:95],v[94:95],v[254:255],v[238:239]
 CV v216,v88,v89
 CV v217,v90,v91
 CV v218,v92,v93
 CV v219,v94,v95
 s_nop 0
 v_permlane16_swap_b32 v216,v218
 s_nop 0
 v_permlane16_swap_b32 v217,v219
 s_add_u32 s85,s84,106496
 BS v[216:219],v5,s[16:19],s85 offen sc1
 v_lshlrev_b32 v96,16,v220
 v_and_b32 v97,0xffff0000,v220
 v_lshlrev_b32 v98,16,v221
 v_and_b32 v99,0xffff0000,v221
 v_lshlrev_b32 v100,16,v222
 v_and_b32 v101,0xffff0000,v222
 v_lshlrev_b32 v102,16,v223
 v_and_b32 v103,0xffff0000,v223
 v_pk_fma_f32 v[96:97],v[96:97],v[248:249],v[232:233]
 v_pk_fma_f32 v[98:99],v[98:99],v[250:251],v[234:235]
 v_pk_fma_f32 v[100:101],v[100:101],v[252:253],v[236:237]
 v_pk_fma_f32 v[102:103],v[102:103],v[254:255],v[238:239]
 CV v220,v96,v97
 CV v221,v98,v99
 CV v222,v100,v101
 CV v223,v102,v103
 s_nop 0
 v_permlane16_swap_b32 v220,v222
 s_nop 0
 v_permlane16_swap_b32 v221,v223
 s_add_u32 s85,s84,106496
 BS v[220:223],v5,s[16:19],s85 offen offset:1024 sc1
 s_lshl_b32 s26,s70,2
 s_add_u32 s26,s26,s35
 s_lshl_b32 s26,s26,14
 v_lshrrev_b32 v1,5,v0
 v_lshlrev_b32 v1,13,v1
 v_and_b32 v2,31,v0
 v_lshl_add_u32 v1,v2,4,v1
 v_add_u32 v36,s26,v1
 s_waitcnt vmcnt(0)
 s_barrier
 s_cmp_lg_u32 s35,0
 s_cbranch_scc1 z2_ns
 v_mov_b32 v1,0
 v_mov_b32 v2,1
 s_mov_b64 exec,1
 global_atomic_add v1,v2,s[66:67]
 s_mov_b64 exec,-1
z2_ns:
 s_branch L_kv
kv0_hk:
 s_cmp_lg_u32 s28,4
 s_cbranch_scc1 kv0_n4
 s_mov_b32 s4,s56
 s_mov_b32 s5,s57
 s_mov_b32 s6,8388608
 s_mov_b32 s7,0x20000
 s_lshl_b32 s87,s52,2
 s_add_u32 s87,s87,s35
 s_lshl_b32 s87,s87,10
 s_branch kv0
kv0_n4:
 s_cmp_lg_u32 s28,12
 s_cbranch_scc1 kv0_n12
 s_mov_b32 s6,0
 s_branch kv0
kv0_n12:
 s_branch kv0_x
kv1_hk:
 s_cmp_lg_u32 s28,4
 s_cbranch_scc1 kv1_n4
 s_mov_b32 s4,s56
 s_mov_b32 s5,s57
 s_mov_b32 s6,8388608
 s_mov_b32 s7,0x20000
 s_lshl_b32 s87,s52,2
 s_add_u32 s87,s87,s35
 s_lshl_b32 s87,s87,10
 s_branch kv1
kv1_n4:
 s_cmp_lg_u32 s28,12
 s_cbranch_scc1 kv1_n12
 s_mov_b32 s6,0
 s_branch kv1
kv1_n12:
 s_branch kv1_x
kv0_g:
 s_waitcnt lgkmcnt(0)
 MM v[200:203],a[64:67],a[0:3],v[200:203]
 RQ a[32:35],v25
 s_mov_b32 s88,s40
 MM v[72:75],a[68:71],a[0:3],v[72:75]
 s_add_u32 s31,s24,32768
 s_sub_u32 s33,s31,98304
 MM v[204:207],a[72:75],a[0:3],v[204:207]
 RT a[96:97],v26 offset:16384
 s_mov_b32 s89,s41
 MM v[76:79],a[76:79],a[0:3],v[76:79]
 s_min_u32 s33,s31,s33
 s_sub_u32 s31,s33,s24
 MM v[208:211],a[80:83],a[0:3],v[208:211]
 RT a[98:99],v26 offset:18432
 s_mov_b32 s90,1835008
 MM v[80:83],a[84:87],a[0:3],v[80:83]
 BL v10,s[8:11],s20 offen offset:2048  lds
 s_mov_b32 s24,s33
 MM v[212:215],a[88:91],a[0:3],v[212:215]
 RT a[100:101],v27 offset:16384
 s_mov_b32 s91,0x20000
 MM v[84:87],a[92:95],a[0:3],v[84:87]
 s_add_u32 s32,s25,32768
 s_sub_u32 s33,s32,65536
 MM v[216:219],a[64:67],a[4:7],v[216:219]
 RT a[102:103],v27 offset:18432
 s_mul_i32 s36,s82,114688
 MM v[88:91],a[68:71],a[4:7],v[88:91]
 s_min_u32 s33,s32,s33
 s_sub_u32 s32,s33,s25
 MM v[220:223],a[72:75],a[4:7],v[220:223]
 RT a[104:105],v28 offset:16384
 v_lshrrev_b32 v1,3,v0
 MM v[92:95],a[76:79],a[4:7],v[92:95]
 BL v11,s[8:11],s20 offen offset:3072  lds
 s_mov_b32 s25,s33
 MM v[224:227],a[80:83],a[4:7],v[224:227]
 RT a[106:107],v28 offset:18432
 s_mul_i32 s26,s35,28672
 MM v[96:99],a[84:87],a[4:7],v[96:99]
 v_mul_u32_u24 v1,896,v1
 v_lshrrev_b32 v2,4,v0
 MM v[228:231],a[88:91],a[4:7],v[228:231]
 RT a[108:109],v29 offset:16384
 v_xor_b32 v2,v2,v0
 MM v[100:103],a[92:95],a[4:7],v[100:103]
 v_and_b32 v2,7,v2
 MM v[232:235],a[64:67],a[8:11],v[232:235]
 RT a[110:111],v29 offset:18432
 v_lshl_add_u32 v1,v2,4,v1
 MM v[104:107],a[68:71],a[8:11],v[104:107]
 v_add_u32 v38,s26,v1
 MM v[236:239],a[72:75],a[8:11],v[236:239]
 RT a[112:113],v30 offset:16384
 s_add_u32 m0,s22,4096
 MM v[108:111],a[76:79],a[8:11],v[108:111]
 BL v12,s[8:11],s20 offen  lds
 MM v[240:243],a[80:83],a[8:11],v[240:243]
 RT a[114:115],v30 offset:18432
 v_xor_b32 v2,64,v38
 MM v[112:115],a[84:87],a[8:11],v[112:115]
 v_add_u32 v39,6144,v2
 MM v[244:247],a[88:91],a[8:11],v[244:247]
 RT a[116:117],v31 offset:16384
 v_add_u32 v40,12288,v38
 MM v[116:119],a[92:95],a[8:11],v[116:119]
 v_add_u32 v41,12288,v39
 MM v[248:251],a[64:67],a[12:15],v[248:251]
 RT a[118:119],v31 offset:18432
 MM v[120:123],a[68:71],a[12:15],v[120:123]
 BL v13,s[8:11],s20 offen offset:1024  lds
 MM v[252:255],a[72:75],a[12:15],v[252:255]
 RT a[120:121],v32 offset:16384
 s_mul_i32 s38,s35,4096
 MM v[124:127],a[76:79],a[12:15],v[124:127]
 s_mov_b32 s92,s54
 MM v[128:131],a[80:83],a[12:15],v[128:131]
 RT a[122:123],v32 offset:18432
 s_mov_b32 s93,s55
 MM v[132:135],a[84:87],a[12:15],v[132:135]
 s_mov_b32 s94,1605632
 MM v[136:139],a[88:91],a[12:15],v[136:139]
 RT a[124:125],v33 offset:16384
 MM v[140:143],a[92:95],a[12:15],v[140:143]
 s_mov_b32 s95,0x20000
 MM v[144:147],a[64:67],a[16:19],v[144:147]
 RT a[126:127],v33 offset:18432
 s_lshl_b32 s37,s83,8
 MM v[148:151],a[68:71],a[16:19],v[148:151]
 BL v14,s[8:11],s20 offen offset:2048  lds
 MM v[152:155],a[72:75],a[16:19],v[152:155]
 RQ a[36:39],v25 offset:2048
 v_lshrrev_b32 v1,4,v0
 MM v[156:159],a[76:79],a[16:19],v[156:159]
 v_and_b32 v2,15,v0
 MM v[160:163],a[80:83],a[16:19],v[160:163]
 RQ a[40:43],v25 offset:4096
 v_bfe_u32 v3,v1,0,1
 MM v[164:167],a[84:87],a[16:19],v[164:167]
 MM v[168:171],a[88:91],a[16:19],v[168:171]
 RQ a[44:47],v25 offset:6144
 v_lshlrev_b32 v3,1,v3
 MM v[172:175],a[92:95],a[16:19],v[172:175]
 BL v15,s[8:11],s20 offen offset:3072  lds
 MM v[176:179],a[64:67],a[20:23],v[176:179]
 RQ a[48:51],v25 offset:8192
 s_add_u32 s20,s20,128
 MM v[180:183],a[68:71],a[20:23],v[180:183]
 s_add_u32 s22,s22,32768
 v_xor_b32 v2,v2,v3
 MM v[184:187],a[72:75],a[20:23],v[184:187]
 RQ a[52:55],v25 offset:10240
 s_sub_u32 s34,s22,98304
 s_min_u32 s22,s22,s34
 MM v[188:191],a[76:79],a[20:23],v[188:191]
 v_bfe_u32 v3,v1,1,1
 v_lshlrev_b32 v3,2,v3
 MM v[192:195],a[80:83],a[20:23],v[192:195]
 RQ a[56:59],v25 offset:12288
 v_xor_b32 v2,v2,v3
 MM v[196:199],a[84:87],a[20:23],v[196:199]
 v_lshlrev_b32 v2,4,v2
 MM a[184:187],a[88:91],a[20:23],a[184:187]
 RQ a[60:63],v25 offset:14336
 MM a[188:191],a[92:95],a[20:23],a[188:191]
 v_add_u32 v24,s31,v24
 s_mul_i32 s26,s35,57344
 MM a[192:195],a[64:67],a[24:27],a[192:195]
 v_add_u32 v25,s31,v25
 v_mul_u32_u24 v1,3584,v1
 MM a[196:199],a[68:71],a[24:27],a[196:199]
 MM a[200:203],a[72:75],a[24:27],a[200:203]
 v_add_u32 v26,s32,v26
 v_add_u32 v1,s26,v1
 MM a[204:207],a[76:79],a[24:27],a[204:207]
 v_add_u32 v42,v2,v1
 MM a[208:211],a[80:83],a[24:27],a[208:211]
 v_add_u32 v27,s32,v27
 MM a[212:215],a[84:87],a[24:27],a[212:215]
 v_add_u32 v28,s32,v28
 v_add_u32 v43,13312,v42
 MM a[216:219],a[88:91],a[24:27],a[216:219]
 v_xor_b32 v3,128,v2
 MM a[220:223],a[92:95],a[24:27],a[220:223]
 v_add_u32 v29,s32,v29
 MM a[224:227],a[64:67],a[28:31],a[224:227]
 v_add_u32 v44,v3,v1
 MM a[228:231],a[68:71],a[28:31],a[228:231]
 v_add_u32 v30,s32,v30
 v_add_u32 v44,26624,v44
 MM a[232:235],a[72:75],a[28:31],a[232:235]
 v_add_u32 v31,s32,v31
 MM a[236:239],a[76:79],a[28:31],a[236:239]
 v_add_u32 v45,13312,v44
 MM a[240:243],a[80:83],a[28:31],a[240:243]
 v_add_u32 v32,s32,v32
 s_mul_i32 s39,s35,4096
 MM a[244:247],a[84:87],a[28:31],a[244:247]
 MM a[248:251],a[88:91],a[28:31],a[248:251]
 v_add_u32 v33,s32,v33
 MM a[252:255],a[92:95],a[28:31],a[252:255]
 s_waitcnt vmcnt(10)
 s_waitcnt lgkmcnt(0)
 s_barrier
 MM v[200:203],a[96:99],a[32:35],v[200:203]
 RQ a[0:3],v24
 s_add_u32 m0,s23,98304
 MM v[72:75],a[100:103],a[32:35],v[72:75]
 BL v16,s[12:15],s21 offen  lds
 MM v[204:207],a[104:107],a[32:35],v[204:207]
 RT a[64:65],v26
 MM v[76:79],a[108:111],a[32:35],v[76:79]
 MM v[208:211],a[112:115],a[32:35],v[208:211]
 RT a[66:67],v26 offset:2048
 MM v[80:83],a[116:119],a[32:35],v[80:83]
 MM v[212:215],a[120:123],a[32:35],v[212:215]
 RT a[68:69],v27
 MM v[84:87],a[124:127],a[32:35],v[84:87]
 BL v17,s[12:15],s21 offen offset:1024  lds
 MM v[216:219],a[96:99],a[36:39],v[216:219]
 RT a[70:71],v27 offset:2048
 MM v[88:91],a[100:103],a[36:39],v[88:91]
 MM v[220:223],a[104:107],a[36:39],v[220:223]
 RT a[72:73],v28
 MM v[92:95],a[108:111],a[36:39],v[92:95]
 MM v[224:227],a[112:115],a[36:39],v[224:227]
 RT a[74:75],v28 offset:2048
 MM v[96:99],a[116:119],a[36:39],v[96:99]
 MM v[228:231],a[120:123],a[36:39],v[228:231]
 RT a[76:77],v29
 MM v[100:103],a[124:127],a[36:39],v[100:103]
 BL v18,s[12:15],s21 offen offset:2048  lds
 MM v[232:235],a[96:99],a[40:43],v[232:235]
 RT a[78:79],v29 offset:2048
 MM v[104:107],a[100:103],a[40:43],v[104:107]
 MM v[236:239],a[104:107],a[40:43],v[236:239]
 RT a[80:81],v30
 MM v[108:111],a[108:111],a[40:43],v[108:111]
 MM v[240:243],a[112:115],a[40:43],v[240:243]
 RT a[82:83],v30 offset:2048
 MM v[112:115],a[116:119],a[40:43],v[112:115]
 MM v[244:247],a[120:123],a[40:43],v[244:247]
 RT a[84:85],v31
 MM v[116:119],a[124:127],a[40:43],v[116:119]
 BL v19,s[12:15],s21 offen offset:3072  lds
 MM v[248:251],a[96:99],a[44:47],v[248:251]
 RT a[86:87],v31 offset:2048
 MM v[120:123],a[100:103],a[44:47],v[120:123]
 MM v[252:255],a[104:107],a[44:47],v[252:255]
 RT a[88:89],v32
 MM v[124:127],a[108:111],a[44:47],v[124:127]
 MM v[128:131],a[112:115],a[44:47],v[128:131]
 RT a[90:91],v32 offset:2048
 MM v[132:135],a[116:119],a[44:47],v[132:135]
 MM v[136:139],a[120:123],a[44:47],v[136:139]
 RT a[92:93],v33
 s_add_u32 m0,s23,102400
 MM v[140:143],a[124:127],a[44:47],v[140:143]
 BL v20,s[12:15],s21 offen  lds
 MM v[144:147],a[96:99],a[48:51],v[144:147]
 RT a[94:95],v33 offset:2048
 MM v[148:151],a[100:103],a[48:51],v[148:151]
 MM v[152:155],a[104:107],a[48:51],v[152:155]
 RQ a[4:7],v24 offset:2048
 MM v[156:159],a[108:111],a[48:51],v[156:159]
 MM v[160:163],a[112:115],a[48:51],v[160:163]
 RQ a[8:11],v24 offset:4096
 MM v[164:167],a[116:119],a[48:51],v[164:167]
 MM v[168:171],a[120:123],a[48:51],v[168:171]
 RQ a[12:15],v24 offset:6144
 MM v[172:175],a[124:127],a[48:51],v[172:175]
 BL v21,s[12:15],s21 offen offset:1024  lds
 MM v[176:179],a[96:99],a[52:55],v[176:179]
 RQ a[16:19],v24 offset:8192
 MM v[180:183],a[100:103],a[52:55],v[180:183]
 MM v[184:187],a[104:107],a[52:55],v[184:187]
 RQ a[20:23],v24 offset:10240
 MM v[188:191],a[108:111],a[52:55],v[188:191]
 MM v[192:195],a[112:115],a[52:55],v[192:195]
 RQ a[24:27],v24 offset:12288
 MM v[196:199],a[116:119],a[52:55],v[196:199]
 MM a[184:187],a[120:123],a[52:55],a[184:187]
 RQ a[28:31],v24 offset:14336
 MM a[188:191],a[124:127],a[52:55],a[188:191]
 BL v22,s[12:15],s21 offen offset:2048  lds
 MM a[192:195],a[96:99],a[56:59],a[192:195]
 MM a[196:199],a[100:103],a[56:59],a[196:199]
 MM a[200:203],a[104:107],a[56:59],a[200:203]
 MM a[204:207],a[108:111],a[56:59],a[204:207]
 BL v23,s[12:15],s21 offen offset:3072  lds
 MM a[208:211],a[112:115],a[56:59],a[208:211]
 s_add_u32 s21,s21,524288
 MM a[212:215],a[116:119],a[56:59],a[212:215]
 s_add_u32 s23,s23,32768
 s_sub_u32 s34,s23,65536
 s_min_u32 s23,s23,s34
 MM a[216:219],a[120:123],a[56:59],a[216:219]
 s_add_u32 m0,s38,32768
 MM a[220:223],a[124:127],a[56:59],a[220:223]
 BL v38,s[88:91],s36 offen  lds
 MM a[224:227],a[96:99],a[60:63],a[224:227]
 MM a[228:231],a[100:103],a[60:63],a[228:231]
 MM a[232:235],a[104:107],a[60:63],a[232:235]
 MM a[236:239],a[108:111],a[60:63],a[236:239]
 BL v39,s[88:91],s36 offen offset:1024  lds
 MM a[240:243],a[112:115],a[60:63],a[240:243]
 MM a[244:247],a[116:119],a[60:63],a[244:247]
 MM a[248:251],a[120:123],a[60:63],a[248:251]
 MM a[252:255],a[124:127],a[60:63],a[252:255]
 BL v40,s[88:91],s36 offen offset:2048  lds
 s_waitcnt lgkmcnt(0)
 MM v[200:203],a[64:67],a[0:3],v[200:203]
 RQ a[32:35],v25
 s_and_b32 s26,s35,1
 MM v[72:75],a[68:71],a[0:3],v[72:75]
 s_add_u32 s31,s24,32768
 s_sub_u32 s33,s31,98304
 MM v[204:207],a[72:75],a[0:3],v[204:207]
 RT a[96:97],v26 offset:16384
 v_and_b32 v1,15,v0
 MM v[76:79],a[76:79],a[0:3],v[76:79]
 s_min_u32 s33,s31,s33
 s_sub_u32 s31,s33,s24
 MM v[208:211],a[80:83],a[0:3],v[208:211]
 RT a[98:99],v26 offset:18432
 s_mul_i32 s26,s26,8192
 MM v[80:83],a[84:87],a[0:3],v[80:83]
 s_mov_b32 s24,s33
 MM v[212:215],a[88:91],a[0:3],v[212:215]
 RT a[100:101],v27 offset:16384
 v_lshl_add_u32 v1,v1,7,s26
 MM v[84:87],a[92:95],a[0:3],v[84:87]
 BL v41,s[88:91],s36 offen offset:3072  lds
 s_add_u32 s32,s25,32768
 s_sub_u32 s33,s32,65536
 MM v[216:219],a[64:67],a[4:7],v[216:219]
 RT a[102:103],v27 offset:18432
 s_add_u32 s36,s36,128
 MM v[88:91],a[68:71],a[4:7],v[88:91]
 s_min_u32 s33,s32,s33
 s_sub_u32 s32,s33,s25
 MM v[220:223],a[72:75],a[4:7],v[220:223]
 RT a[104:105],v28 offset:16384
 v_lshrrev_b32 v2,4,v0
 MM v[92:95],a[76:79],a[4:7],v[92:95]
 s_mov_b32 s25,s33
 v_bfe_u32 v3,v0,1,3
 MM v[224:227],a[80:83],a[4:7],v[224:227]
 RT a[106:107],v28 offset:18432
 v_xor_b32 v2,v2,v3
 MM v[96:99],a[84:87],a[4:7],v[96:99]
 MM v[228:231],a[88:91],a[4:7],v[228:231]
 RT a[108:109],v29 offset:16384
 s_add_u32 m0,s38,49152
 MM v[100:103],a[92:95],a[4:7],v[100:103]
 BL v38,s[88:91],s36 offen  lds
 MM v[232:235],a[64:67],a[8:11],v[232:235]
 RT a[110:111],v29 offset:18432
 v_lshl_add_u32 v46,v2,4,v1
 MM v[104:107],a[68:71],a[8:11],v[104:107]
 v_xor_b32 v47,64,v46
 MM v[236:239],a[72:75],a[8:11],v[236:239]
 RT a[112:113],v30 offset:16384
 MM v[108:111],a[76:79],a[8:11],v[108:111]
 v_add_u32 v48,65536,v46
 MM v[240:243],a[80:83],a[8:11],v[240:243]
 RT a[114:115],v30 offset:18432
 MM v[112:115],a[84:87],a[8:11],v[112:115]
 v_add_u32 v49,65536,v47
 MM v[244:247],a[88:91],a[8:11],v[244:247]
 RT a[116:117],v31 offset:16384
 MM v[116:119],a[92:95],a[8:11],v[116:119]
 BL v39,s[88:91],s36 offen offset:1024  lds
 MM v[248:251],a[64:67],a[12:15],v[248:251]
 RT a[118:119],v31 offset:18432
 v_bfe_u32 v1,v0,2,2
 MM v[120:123],a[68:71],a[12:15],v[120:123]
 v_lshrrev_b32 v2,4,v0
 MM v[252:255],a[72:75],a[12:15],v[252:255]
 RT a[120:121],v32 offset:16384
 MM v[124:127],a[76:79],a[12:15],v[124:127]
 v_lshl_add_u32 v2,v2,3,v1
 MM v[128:131],a[80:83],a[12:15],v[128:131]
 RT a[122:123],v32 offset:18432
 MM v[132:135],a[84:87],a[12:15],v[132:135]
 v_bfe_u32 v4,v2,0,1
 MM v[136:139],a[88:91],a[12:15],v[136:139]
 RT a[124:125],v33 offset:16384
 MM v[140:143],a[92:95],a[12:15],v[140:143]
 BL v40,s[88:91],s36 offen offset:2048  lds
 MM v[144:147],a[64:67],a[16:19],v[144:147]
 RT a[126:127],v33 offset:18432
 v_bfe_u32 v5,v2,1,1
 MM v[148:151],a[68:71],a[16:19],v[148:151]
 MM v[152:155],a[72:75],a[16:19],v[152:155]
 RQ a[36:39],v25 offset:2048
 v_lshl_or_b32 v4,v5,1,v4
 MM v[156:159],a[76:79],a[16:19],v[156:159]
 MM v[160:163],a[80:83],a[16:19],v[160:163]
 RQ a[40:43],v25 offset:4096
 v_bfe_u32 v5,v2,3,1
 MM v[164:167],a[84:87],a[16:19],v[164:167]
 MM v[168:171],a[88:91],a[16:19],v[168:171]
 RQ a[44:47],v25 offset:6144
 v_lshl_or_b32 v4,v5,2,v4
 MM v[172:175],a[92:95],a[16:19],v[172:175]
 BL v41,s[88:91],s36 offen offset:3072  lds
 MM v[176:179],a[64:67],a[20:23],v[176:179]
 RQ a[48:51],v25 offset:8192
 s_add_u32 s36,s36,128
 MM v[180:183],a[68:71],a[20:23],v[180:183]
 v_mul_u32_u24 v2,256,v2
 MM v[184:187],a[72:75],a[20:23],v[184:187]
 RQ a[52:55],v25 offset:10240
 v_and_b32 v3,3,v0
 MM v[188:191],a[76:79],a[20:23],v[188:191]
 MM v[192:195],a[80:83],a[20:23],v[192:195]
 RQ a[56:59],v25 offset:12288
 v_lshl_add_u32 v2,v3,3,v2
 MM v[196:199],a[84:87],a[20:23],v[196:199]
 MM a[184:187],a[88:91],a[20:23],a[184:187]
 RQ a[60:63],v25 offset:14336
 v_add_u32 v2,81920,v2
 MM a[188:191],a[92:95],a[20:23],a[188:191]
 v_add_u32 v24,s31,v24
 MM a[192:195],a[64:67],a[24:27],a[192:195]
 v_add_u32 v25,s31,v25
 MM a[196:199],a[68:71],a[24:27],a[196:199]
 s_lshr_b32 s26,s35,1
 MM a[200:203],a[72:75],a[24:27],a[200:203]
 v_add_u32 v26,s32,v26
 MM a[204:207],a[76:79],a[24:27],a[204:207]
 s_mul_i32 s26,s26,4
 MM a[208:211],a[80:83],a[24:27],a[208:211]
 v_add_u32 v27,s32,v27
 MM a[212:215],a[84:87],a[24:27],a[212:215]
 v_add_u32 v28,s32,v28
 v_xor_b32 v4,s26,v4
 MM a[216:219],a[88:91],a[24:27],a[216:219]
 MM a[220:223],a[92:95],a[24:27],a[220:223]
 v_add_u32 v29,s32,v29
 v_xor_b32 v3,0,v4
 MM a[224:227],a[64:67],a[28:31],a[224:227]
 MM a[228:231],a[68:71],a[28:31],a[228:231]
 v_add_u32 v30,s32,v30
 v_lshl_add_u32 v50,v3,5,v2
 MM a[232:235],a[72:75],a[28:31],a[232:235]
 v_add_u32 v31,s32,v31
 MM a[236:239],a[76:79],a[28:31],a[236:239]
 v_xor_b32 v3,1,v4
 MM a[240:243],a[80:83],a[28:31],a[240:243]
 v_add_u32 v32,s32,v32
 MM a[244:247],a[84:87],a[28:31],a[244:247]
 v_lshl_add_u32 v51,v3,5,v2
 MM a[248:251],a[88:91],a[28:31],a[248:251]
 v_add_u32 v33,s32,v33
 MM a[252:255],a[92:95],a[28:31],a[252:255]
 s_waitcnt vmcnt(8)
 s_waitcnt lgkmcnt(0)
 s_barrier
 MM v[200:203],a[96:99],a[32:35],v[200:203]
 RQ a[0:3],v24
 s_add_u32 m0,s39,81920
 MM v[72:75],a[100:103],a[32:35],v[72:75]
 BL v42,s[92:95],s37 offen sc1 lds
 MM v[204:207],a[104:107],a[32:35],v[204:207]
 RT a[64:65],v26
 v_xor_b32 v3,2,v4
 MM v[76:79],a[108:111],a[32:35],v[76:79]
 v_lshl_add_u32 v52,v3,5,v2
 MM v[208:211],a[112:115],a[32:35],v[208:211]
 RT a[66:67],v26 offset:2048
 v_xor_b32 v3,3,v4
 MM v[80:83],a[116:119],a[32:35],v[80:83]
 MM v[212:215],a[120:123],a[32:35],v[212:215]
 RT a[68:69],v27
 v_lshl_add_u32 v53,v3,5,v2
 MM v[84:87],a[124:127],a[32:35],v[84:87]
 BL v43,s[92:95],s37 offen offset:1024 sc1 lds
 MM v[216:219],a[96:99],a[36:39],v[216:219]
 RT a[70:71],v27 offset:2048
 v_add_u32 v54,65536,v50
 MM v[88:91],a[100:103],a[36:39],v[88:91]
 MM v[220:223],a[104:107],a[36:39],v[220:223]
 RT a[72:73],v28
 v_add_u32 v55,65536,v51
 MM v[92:95],a[108:111],a[36:39],v[92:95]
 MM v[224:227],a[112:115],a[36:39],v[224:227]
 RT a[74:75],v28 offset:2048
 v_add_u32 v56,65536,v52
 MM v[96:99],a[116:119],a[36:39],v[96:99]
 MM v[228:231],a[120:123],a[36:39],v[228:231]
 RT a[76:77],v29
 v_add_u32 v57,65536,v53
 MM v[100:103],a[124:127],a[36:39],v[100:103]
 BL v44,s[92:95],s37 offen offset:2048 sc1 lds
 MM v[232:235],a[96:99],a[40:43],v[232:235]
 RT a[78:79],v29 offset:2048
 MM v[104:107],a[100:103],a[40:43],v[104:107]
 v_lshrrev_b32 v1,3,v0
 MM v[236:239],a[104:107],a[40:43],v[236:239]
 RT a[80:81],v30
 MM v[108:111],a[108:111],a[40:43],v[108:111]
 s_mul_i32 s26,s35,131072
 MM v[240:243],a[112:115],a[40:43],v[240:243]
 RT a[82:83],v30 offset:2048
 MM v[112:115],a[116:119],a[40:43],v[112:115]
 v_mul_u32_u24 v1,4096,v1
 MM v[244:247],a[120:123],a[40:43],v[244:247]
 RT a[84:85],v31
 MM v[116:119],a[124:127],a[40:43],v[116:119]
 BL v45,s[92:95],s37 offen offset:3072 sc1 lds
 MM v[248:251],a[96:99],a[44:47],v[248:251]
 RT a[86:87],v31 offset:2048
 s_add_u32 s37,s37,229376
 MM v[120:123],a[100:103],a[44:47],v[120:123]
 v_lshrrev_b32 v2,4,v0
 v_xor_b32 v2,v2,v0
 MM v[252:255],a[104:107],a[44:47],v[252:255]
 RT a[88:89],v32
 MM v[124:127],a[108:111],a[44:47],v[124:127]
 v_and_b32 v2,7,v2
 MM v[128:131],a[112:115],a[44:47],v[128:131]
 RT a[90:91],v32 offset:2048
 MM v[132:135],a[116:119],a[44:47],v[132:135]
 v_lshl_add_u32 v1,v2,4,v1
 MM v[136:139],a[120:123],a[44:47],v[136:139]
 RT a[92:93],v33
 s_add_u32 m0,s39,98304
 MM v[140:143],a[124:127],a[44:47],v[140:143]
 BL v42,s[92:95],s37 offen sc1 lds
 MM v[144:147],a[96:99],a[48:51],v[144:147]
 RT a[94:95],v33 offset:2048
 v_add_u32 v58,s26,v1
 MM v[148:151],a[100:103],a[48:51],v[148:151]
 MM v[152:155],a[104:107],a[48:51],v[152:155]
 RQ a[4:7],v24 offset:2048
 v_xor_b32 v2,64,v58
 MM v[156:159],a[108:111],a[48:51],v[156:159]
 MM v[160:163],a[112:115],a[48:51],v[160:163]
 RQ a[8:11],v24 offset:4096
 v_add_u32 v59,31744,v2
 MM v[164:167],a[116:119],a[48:51],v[164:167]
 MM v[168:171],a[120:123],a[48:51],v[168:171]
 RQ a[12:15],v24 offset:6144
 v_add_u32 v60,63488,v58
 MM v[172:175],a[124:127],a[48:51],v[172:175]
 BL v43,s[92:95],s37 offen offset:1024 sc1 lds
 MM v[176:179],a[96:99],a[52:55],v[176:179]
 RQ a[16:19],v24 offset:8192
 v_add_u32 v61,63488,v59
 MM v[180:183],a[100:103],a[52:55],v[180:183]
 MM v[184:187],a[104:107],a[52:55],v[184:187]
 RQ a[20:23],v24 offset:10240
 s_lshr_b32 s26,s35,1
 MM v[188:191],a[108:111],a[52:55],v[188:191]
 MM v[192:195],a[112:115],a[52:55],v[192:195]
 RQ a[24:27],v24 offset:12288
 s_mul_i32 s27,s26,57344
 MM v[196:199],a[116:119],a[52:55],v[196:199]
 MM a[184:187],a[120:123],a[52:55],a[184:187]
 RQ a[28:31],v24 offset:14336
 s_lshl_b32 s26,s26,12
 MM a[188:191],a[124:127],a[52:55],a[188:191]
 BL v44,s[92:95],s37 offen offset:2048 sc1 lds
 MM a[192:195],a[96:99],a[56:59],a[192:195]
 MM a[196:199],a[100:103],a[56:59],a[196:199]
 s_add_u32 s26,s26,81920
 MM a[200:203],a[104:107],a[56:59],a[200:203]
 MM a[204:207],a[108:111],a[56:59],a[204:207]
 BL v45,s[92:95],s37 offen offset:3072 sc1 lds
 MM a[208:211],a[112:115],a[56:59],a[208:211]
 s_add_u32 s37,s37,229376
 v_add_u32 v63,s26,v6
 MM a[212:215],a[116:119],a[56:59],a[212:215]
 v_add_u32 v64,65536,v63
 MM a[216:219],a[120:123],a[56:59],a[216:219]
 s_add_u32 m0,s38,65536
 MM a[220:223],a[124:127],a[56:59],a[220:223]
 BL v38,s[88:91],s36 offen  lds
 MM a[224:227],a[96:99],a[60:63],a[224:227]
 s_and_b32 s26,s35,1
 MM a[228:231],a[100:103],a[60:63],a[228:231]
 s_lshl_b32 s26,s26,12
 MM a[232:235],a[104:107],a[60:63],a[232:235]
 MM a[236:239],a[108:111],a[60:63],a[236:239]
 BL v39,s[88:91],s36 offen offset:1024  lds
 MM a[240:243],a[112:115],a[60:63],a[240:243]
 s_add_u32 s26,s26,s27
 MM a[244:247],a[116:119],a[60:63],a[244:247]
 v_add_u32 v62,s26,v6
 MM a[248:251],a[120:123],a[60:63],a[248:251]
 MM a[252:255],a[124:127],a[60:63],a[252:255]
 BL v40,s[88:91],s36 offen offset:2048  lds
 s_waitcnt lgkmcnt(0)
 MM v[200:203],a[64:67],a[0:3],v[200:203]
 RQ a[32:35],v25
 MM v[72:75],a[68:71],a[0:3],v[72:75]
 s_mov_b32 s4,s62
 s_mov_b32 s5,s63
 s_mov_b32 s6,896
 s_mov_b32 s7,0x20000
 v_lshrrev_b32 v1,4,v0
 v_lshlrev_b32 v1,4,v1
 BL a[128:131],v1,s[4:7],0 offen
 BL a[132:135],v1,s[4:7],0 offen offset:64
 BL a[136:139],v1,s[4:7],0 offen offset:128
 BL a[140:143],v1,s[4:7],0 offen offset:192
 BL a[144:147],v1,s[4:7],0 offen offset:256
 BL a[148:151],v1,s[4:7],0 offen offset:320
 MM v[204:207],a[72:75],a[0:3],v[204:207]
 RT a[96:97],v26 offset:16384
 MM v[76:79],a[76:79],a[0:3],v[76:79]
 MM v[208:211],a[80:83],a[0:3],v[208:211]
 RT a[98:99],v26 offset:18432
 MM v[80:83],a[84:87],a[0:3],v[80:83]
 MM v[212:215],a[88:91],a[0:3],v[212:215]
 RT a[100:101],v27 offset:16384
 MM v[84:87],a[92:95],a[0:3],v[84:87]
 BL v41,s[88:91],s36 offen offset:3072  lds
 MM v[216:219],a[64:67],a[4:7],v[216:219]
 RT a[102:103],v27 offset:18432
 s_add_u32 s36,s36,128
 MM v[88:91],a[68:71],a[4:7],v[88:91]
 MM v[220:223],a[72:75],a[4:7],v[220:223]
 RT a[104:105],v28 offset:16384
 MM v[92:95],a[76:79],a[4:7],v[92:95]
 MM v[224:227],a[80:83],a[4:7],v[224:227]
 RT a[106:107],v28 offset:18432
 MM v[96:99],a[84:87],a[4:7],v[96:99]
 MM v[228:231],a[88:91],a[4:7],v[228:231]
 RT a[108:109],v29 offset:16384
 s_add_u32 m0,s39,114688
 MM v[100:103],a[92:95],a[4:7],v[100:103]
 BL v42,s[92:95],s37 offen sc1 lds
 MM v[232:235],a[64:67],a[8:11],v[232:235]
 RT a[110:111],v29 offset:18432
 MM v[104:107],a[68:71],a[8:11],v[104:107]
 MM v[236:239],a[72:75],a[8:11],v[236:239]
 RT a[112:113],v30 offset:16384
 MM v[108:111],a[76:79],a[8:11],v[108:111]
 MM v[240:243],a[80:83],a[8:11],v[240:243]
 RT a[114:115],v30 offset:18432
 MM v[112:115],a[84:87],a[8:11],v[112:115]
 MM v[244:247],a[88:91],a[8:11],v[244:247]
 RT a[116:117],v31 offset:16384
 MM v[116:119],a[92:95],a[8:11],v[116:119]
 BL v43,s[92:95],s37 offen offset:1024 sc1 lds
 MM v[248:251],a[64:67],a[12:15],v[248:251]
 RT a[118:119],v31 offset:18432
 MM v[120:123],a[68:71],a[12:15],v[120:123]
 MM v[252:255],a[72:75],a[12:15],v[252:255]
 RT a[120:121],v32 offset:16384
 MM v[124:127],a[76:79],a[12:15],v[124:127]
 MM v[128:131],a[80:83],a[12:15],v[128:131]
 RT a[122:123],v32 offset:18432
 MM v[132:135],a[84:87],a[12:15],v[132:135]
 MM v[136:139],a[88:91],a[12:15],v[136:139]
 RT a[124:125],v33 offset:16384
 MM v[140:143],a[92:95],a[12:15],v[140:143]
 BL v44,s[92:95],s37 offen offset:2048 sc1 lds
 MM v[144:147],a[64:67],a[16:19],v[144:147]
 RT a[126:127],v33 offset:18432
 MM v[148:151],a[68:71],a[16:19],v[148:151]
 MM v[152:155],a[72:75],a[16:19],v[152:155]
 RQ a[36:39],v25 offset:2048
 MM v[156:159],a[76:79],a[16:19],v[156:159]
 MM v[160:163],a[80:83],a[16:19],v[160:163]
 RQ a[40:43],v25 offset:4096
 MM v[164:167],a[84:87],a[16:19],v[164:167]
 MM v[168:171],a[88:91],a[16:19],v[168:171]
 RQ a[44:47],v25 offset:6144
 MM v[172:175],a[92:95],a[16:19],v[172:175]
 BL v45,s[92:95],s37 offen offset:3072 sc1 lds
 MM v[176:179],a[64:67],a[20:23],v[176:179]
 RQ a[48:51],v25 offset:8192
 s_add_u32 s37,s37,229376
 MM v[180:183],a[68:71],a[20:23],v[180:183]
 MM v[184:187],a[72:75],a[20:23],v[184:187]
 RQ a[52:55],v25 offset:10240
 MM v[188:191],a[76:79],a[20:23],v[188:191]
 MM v[192:195],a[80:83],a[20:23],v[192:195]
 RQ a[56:59],v25 offset:12288
 MM v[196:199],a[84:87],a[20:23],v[196:199]
 MM a[184:187],a[88:91],a[20:23],a[184:187]
 RQ a[60:63],v25 offset:14336
 MM a[188:191],a[92:95],a[20:23],a[188:191]
 MM a[192:195],a[64:67],a[24:27],a[192:195]
 MM a[196:199],a[68:71],a[24:27],a[196:199]
 MM a[200:203],a[72:75],a[24:27],a[200:203]
 MM a[204:207],a[76:79],a[24:27],a[204:207]
 MM a[208:211],a[80:83],a[24:27],a[208:211]
 MM a[212:215],a[84:87],a[24:27],a[212:215]
 MM a[216:219],a[88:91],a[24:27],a[216:219]
 MM a[220:223],a[92:95],a[24:27],a[220:223]
 MM a[224:227],a[64:67],a[28:31],a[224:227]
 MM a[228:231],a[68:71],a[28:31],a[228:231]
 MM a[232:235],a[72:75],a[28:31],a[232:235]
 MM a[236:239],a[76:79],a[28:31],a[236:239]
 MM a[240:243],a[80:83],a[28:31],a[240:243]
 MM a[244:247],a[84:87],a[28:31],a[244:247]
 MM a[248:251],a[88:91],a[28:31],a[248:251]
 MM a[252:255],a[92:95],a[28:31],a[252:255]
 s_waitcnt lgkmcnt(0)
 s_barrier
 MM v[200:203],a[96:99],a[32:35],v[200:203]
 s_add_u32 m0,s38,0
 MM v[72:75],a[100:103],a[32:35],v[72:75]
 BL v38,s[88:91],s36 offen  lds
 MM v[204:207],a[104:107],a[32:35],v[204:207]
 MM v[76:79],a[108:111],a[32:35],v[76:79]
 MM v[208:211],a[112:115],a[32:35],v[208:211]
 MM v[80:83],a[116:119],a[32:35],v[80:83]
 MM v[212:215],a[120:123],a[32:35],v[212:215]
 MM v[84:87],a[124:127],a[32:35],v[84:87]
 BL v39,s[88:91],s36 offen offset:1024  lds
 MM v[216:219],a[96:99],a[36:39],v[216:219]
 MM v[88:91],a[100:103],a[36:39],v[88:91]
 MM v[220:223],a[104:107],a[36:39],v[220:223]
 MM v[92:95],a[108:111],a[36:39],v[92:95]
 MM v[224:227],a[112:115],a[36:39],v[224:227]
 MM v[96:99],a[116:119],a[36:39],v[96:99]
 MM v[228:231],a[120:123],a[36:39],v[228:231]
 MM v[100:103],a[124:127],a[36:39],v[100:103]
 BL v40,s[88:91],s36 offen offset:2048  lds
 MM v[232:235],a[96:99],a[40:43],v[232:235]
 MM v[104:107],a[100:103],a[40:43],v[104:107]
 MM v[236:239],a[104:107],a[40:43],v[236:239]
 MM v[108:111],a[108:111],a[40:43],v[108:111]
 MM v[240:243],a[112:115],a[40:43],v[240:243]
 MM v[112:115],a[116:119],a[40:43],v[112:115]
 MM v[244:247],a[120:123],a[40:43],v[244:247]
 MM v[116:119],a[124:127],a[40:43],v[116:119]
 BL v41,s[88:91],s36 offen offset:3072  lds
 MM v[248:251],a[96:99],a[44:47],v[248:251]
 s_add_u32 s36,s36,128
 MM v[120:123],a[100:103],a[44:47],v[120:123]
 MM v[252:255],a[104:107],a[44:47],v[252:255]
 MM v[124:127],a[108:111],a[44:47],v[124:127]
 MM v[128:131],a[112:115],a[44:47],v[128:131]
 MM v[132:135],a[116:119],a[44:47],v[132:135]
 MM v[136:139],a[120:123],a[44:47],v[136:139]
 s_add_u32 m0,s39,131072
 MM v[140:143],a[124:127],a[44:47],v[140:143]
 BL v42,s[92:95],s37 offen sc1 lds
 MM v[144:147],a[96:99],a[48:51],v[144:147]
 MM v[148:151],a[100:103],a[48:51],v[148:151]
 MM v[152:155],a[104:107],a[48:51],v[152:155]
 MM v[156:159],a[108:111],a[48:51],v[156:159]
 MM v[160:163],a[112:115],a[48:51],v[160:163]
 MM v[164:167],a[116:119],a[48:51],v[164:167]
 MM v[168:171],a[120:123],a[48:51],v[168:171]
 MM v[172:175],a[124:127],a[48:51],v[172:175]
 BL v43,s[92:95],s37 offen offset:1024 sc1 lds
 MM v[176:179],a[96:99],a[52:55],v[176:179]
 MM v[180:183],a[100:103],a[52:55],v[180:183]
 MM v[184:187],a[104:107],a[52:55],v[184:187]
 MM v[188:191],a[108:111],a[52:55],v[188:191]
 MM v[192:195],a[112:115],a[52:55],v[192:195]
 MM v[196:199],a[116:119],a[52:55],v[196:199]
 MM a[184:187],a[120:123],a[52:55],a[184:187]
 MM a[188:191],a[124:127],a[52:55],a[188:191]
 BL v44,s[92:95],s37 offen offset:2048 sc1 lds
 MM a[192:195],a[96:99],a[56:59],a[192:195]
 MM a[196:199],a[100:103],a[56:59],a[196:199]
 MM a[200:203],a[104:107],a[56:59],a[200:203]
 MM a[204:207],a[108:111],a[56:59],a[204:207]
 BL v45,s[92:95],s37 offen offset:3072 sc1 lds
 MM a[208:211],a[112:115],a[56:59],a[208:211]
 s_add_u32 s37,s37,229376
 MM a[212:215],a[116:119],a[56:59],a[212:215]
 MM a[216:219],a[120:123],a[56:59],a[216:219]
 s_add_u32 m0,s38,16384
 MM a[220:223],a[124:127],a[56:59],a[220:223]
 BL v38,s[88:91],s36 offen  lds
 MM a[224:227],a[96:99],a[60:63],a[224:227]
 MM a[228:231],a[100:103],a[60:63],a[228:231]
 MM a[232:235],a[104:107],a[60:63],a[232:235]
 MM a[236:239],a[108:111],a[60:63],a[236:239]
 BL v39,s[88:91],s36 offen offset:1024  lds
 MM a[240:243],a[112:115],a[60:63],a[240:243]
 MM a[244:247],a[116:119],a[60:63],a[244:247]
 MM a[248:251],a[120:123],a[60:63],a[248:251]
 MM a[252:255],a[124:127],a[60:63],a[252:255]
 BL v40,s[88:91],s36 offen offset:2048  lds
 BL v41,s[88:91],s36 offen offset:3072  lds
 s_add_u32 s36,s36,128
 s_add_u32 m0,s39,147456
 s_nop 0
 BL v42,s[92:95],s37 offen sc1 lds
 BL v43,s[92:95],s37 offen offset:1024 sc1 lds
 BL v44,s[92:95],s37 offen offset:2048 sc1 lds
 BL v45,s[92:95],s37 offen offset:3072 sc1 lds
 s_add_u32 s37,s37,229376
 s_mov_b32 s16,s68
 s_mov_b32 s17,s69
 s_mov_b32 s18,33554432
 s_mov_b32 s19,0x20000
 s_and_b32 s85,s35,1
 s_lshl_b32 s84,s70,1
 s_add_u32 s84,s84,s85
 s_lshl_b32 s84,s84,16
 s_lshr_b32 s85,s35,1
 s_lshl_b32 s85,s85,12
 s_add_u32 s84,s84,s85
 s_lshl_b32 s85,s71,20
 s_add_u32 s84,s84,s85
 s_mov_b32 s29,4096
 s_mov_b32 s30,4096
 AR v12,a184
 AR v13,a185
 AR v14,a186
 AR v15,a187
 AR v16,a188
 AR v17,a189
 AR v18,a190
 AR v19,a191
 CV v8,v12,v13
 CV v9,v14,v15
 CV v10,v16,v17
 CV v11,v18,v19
 s_add_u32 s85,s84,40960
 BS v[8:11],v6,s[16:19],s85 offen offset:3072 sc1
 AR v24,a192
 AR v25,a193
 AR v26,a194
 AR v27,a195
 AR v28,a196
 AR v29,a197
 AR v30,a198
 AR v31,a199
 CV v20,v24,v25
 CV v21,v26,v27
 CV v22,v28,v29
 CV v23,v30,v31
 s_add_u32 s85,s84,49152
 BS v[20:23],v6,s[16:19],s85 offen sc1
 AR v12,a200
 AR v13,a201
 AR v14,a202
 AR v15,a203
 AR v16,a204
 AR v17,a205
 AR v18,a206
 AR v19,a207
 CV v8,v12,v13
 CV v9,v14,v15
 CV v10,v16,v17
 CV v11,v18,v19
 s_add_u32 s85,s84,49152
 BS v[8:11],v6,s[16:19],s85 offen offset:1024 sc1
 AR v24,a208
 AR v25,a209
 AR v26,a210
 AR v27,a211
 AR v28,a212
 AR v29,a213
 AR v30,a214
 AR v31,a215
 CV v20,v24,v25
 CV v21,v26,v27
 CV v22,v28,v29
 CV v23,v30,v31
 s_add_u32 s85,s84,49152
 BS v[20:23],v6,s[16:19],s85 offen offset:2048 sc1
 AR v12,a216
 AR v13,a217
 AR v14,a218
 AR v15,a219
 AR v16,a220
 AR v17,a221
 AR v18,a222
 AR v19,a223
 CV v8,v12,v13
 CV v9,v14,v15
 CV v10,v16,v17
 CV v11,v18,v19
 s_add_u32 s85,s84,49152
 BS v[8:11],v6,s[16:19],s85 offen offset:3072 sc1
 AR v24,a224
 AR v25,a225
 AR v26,a226
 AR v27,a227
 AR v28,a228
 AR v29,a229
 AR v30,a230
 AR v31,a231
 CV v20,v24,v25
 CV v21,v26,v27
 CV v22,v28,v29
 CV v23,v30,v31
 s_add_u32 s85,s84,57344
 BS v[20:23],v6,s[16:19],s85 offen sc1
 AR v12,a232
 AR v13,a233
 AR v14,a234
 AR v15,a235
 AR v16,a236
 AR v17,a237
 AR v18,a238
 AR v19,a239
 CV v8,v12,v13
 CV v9,v14,v15
 CV v10,v16,v17
 CV v11,v18,v19
 s_add_u32 s85,s84,57344
 BS v[8:11],v6,s[16:19],s85 offen offset:1024 sc1
 AR v24,a240
 AR v25,a241
 AR v26,a242
 AR v27,a243
 AR v28,a244
 AR v29,a245
 AR v30,a246
 AR v31,a247
 CV v20,v24,v25
 CV v21,v26,v27
 CV v22,v28,v29
 CV v23,v30,v31
 s_add_u32 s85,s84,57344
 BS v[20:23],v6,s[16:19],s85 offen offset:2048 sc1
 AR v12,a248
 AR v13,a249
 AR v14,a250
 AR v15,a251
 AR v16,a252
 AR v17,a253
 AR v18,a254
 AR v19,a255
 CV v8,v12,v13
 CV v9,v14,v15
 CV v10,v16,v17
 CV v11,v18,v19
 s_add_u32 s85,s84,57344
 BS v[8:11],v6,s[16:19],s85 offen offset:3072 sc1
 CV v128,v128,v129
 CV v129,v130,v131
 CV v130,v132,v133
 CV v131,v134,v135
 AW a152,v128
 AW a153,v129
 AW a154,v130
 AW a155,v131
 CV v136,v136,v137
 CV v137,v138,v139
 CV v138,v140,v141
 CV v139,v142,v143
 AW a156,v136
 AW a157,v137
 AW a158,v138
 AW a159,v139
 CV v144,v144,v145
 CV v145,v146,v147
 CV v146,v148,v149
 CV v147,v150,v151
 AW a160,v144
 AW a161,v145
 AW a162,v146
 AW a163,v147
 CV v152,v152,v153
 CV v153,v154,v155
 CV v154,v156,v157
 CV v155,v158,v159
 AW a164,v152
 AW a165,v153
 AW a166,v154
 AW a167,v155
 CV v160,v160,v161
 CV v161,v162,v163
 CV v162,v164,v165
 CV v163,v166,v167
 AW a168,v160
 AW a169,v161
 AW a170,v162
 AW a171,v163
 CV v168,v168,v169
 CV v169,v170,v171
 CV v170,v172,v173
 CV v171,v174,v175
 AW a172,v168
 AW a173,v169
 AW a174,v170
 AW a175,v171
 CV v176,v176,v177
 CV v177,v178,v179
 CV v178,v180,v181
 CV v179,v182,v183
 AW a176,v176
 AW a177,v177
 AW a178,v178
 AW a179,v179
 CV v184,v184,v185
 CV v185,v186,v187
 CV v186,v188,v189
 CV v187,v190,v191
 AW a180,v184
 AW a181,v185
 AW a182,v186
 AW a183,v187
 CV v192,v192,v193
 CV v193,v194,v195
 CV v194,v196,v197
 CV v195,v198,v199
 AW a184,v192
 AW a185,v193
 AW a186,v194
 AW a187,v195
 CV v200,v200,v201
 CV v201,v202,v203
 CV v202,v72,v73
 CV v203,v74,v75
 CV v204,v204,v205
 CV v205,v206,v207
 CV v206,v76,v77
 CV v207,v78,v79
 CV v208,v208,v209
 CV v209,v210,v211
 CV v210,v80,v81
 CV v211,v82,v83
 CV v212,v212,v213
 CV v213,v214,v215
 CV v214,v84,v85
 CV v215,v86,v87
 CV v216,v216,v217
 CV v217,v218,v219
 CV v218,v88,v89
 CV v219,v90,v91
 CV v220,v220,v221
 CV v221,v222,v223
 CV v222,v92,v93
 CV v223,v94,v95
 CV v224,v224,v225
 CV v225,v226,v227
 CV v226,v96,v97
 CV v227,v98,v99
 CV v228,v228,v229
 CV v229,v230,v231
 CV v230,v100,v101
 CV v231,v102,v103
 CV v232,v232,v233
 CV v233,v234,v235
 CV v234,v104,v105
 CV v235,v106,v107
 CV v236,v236,v237
 CV v237,v238,v239
 CV v238,v108,v109
 CV v239,v110,v111
 CV v240,v240,v241
 CV v241,v242,v243
 CV v242,v112,v113
 CV v243,v114,v115
 CV v244,v244,v245
 CV v245,v246,v247
 CV v246,v116,v117
 CV v247,v118,v119
 CV v248,v248,v249
 CV v249,v250,v251
 CV v250,v120,v121
 CV v251,v122,v123
 CV v252,v252,v253
 CV v253,v254,v255
 CV v254,v124,v125
 CV v255,v126,v127
 s_branch L_g
kv1_g:
 s_waitcnt lgkmcnt(0)
 MM v[200:203],a[0:3],a[64:67],v[200:203]
 RQ a[32:35],v25
 s_mov_b32 s88,s40
 MM v[204:207],a[0:3],a[68:71],v[204:207]
 s_add_u32 s31,s24,32768
 s_sub_u32 s33,s31,98304
 MM v[208:211],a[0:3],a[72:75],v[208:211]
 RT a[96:97],v26 offset:16384
 s_mov_b32 s89,s41
 MM v[212:215],a[0:3],a[76:79],v[212:215]
 s_min_u32 s33,s31,s33
 s_sub_u32 s31,s33,s24
 MM v[216:219],a[0:3],a[80:83],v[216:219]
 RT a[98:99],v26 offset:18432
 s_mov_b32 s90,1835008
 MM v[220:223],a[0:3],a[84:87],v[220:223]
 BL v10,s[8:11],s20 offen offset:2048  lds
 s_mov_b32 s24,s33
 MM v[224:227],a[0:3],a[88:91],v[224:227]
 RT a[100:101],v27 offset:16384
 s_mov_b32 s91,0x20000
 MM v[228:231],a[0:3],a[92:95],v[228:231]
 s_add_u32 s32,s25,32768
 s_sub_u32 s33,s32,65536
 MM v[72:75],a[4:7],a[64:67],v[72:75]
 RT a[102:103],v27 offset:18432
 s_mul_i32 s36,s82,114688
 MM v[76:79],a[4:7],a[68:71],v[76:79]
 s_min_u32 s33,s32,s33
 s_sub_u32 s32,s33,s25
 MM v[80:83],a[4:7],a[72:75],v[80:83]
 RT a[104:105],v28 offset:16384
 v_lshrrev_b32 v1,3,v0
 MM v[84:87],a[4:7],a[76:79],v[84:87]
 BL v11,s[8:11],s20 offen offset:3072  lds
 s_mov_b32 s25,s33
 MM v[88:91],a[4:7],a[80:83],v[88:91]
 RT a[106:107],v28 offset:18432
 s_mul_i32 s26,s35,28672
 MM v[92:95],a[4:7],a[84:87],v[92:95]
 v_mul_u32_u24 v1,896,v1
 v_lshrrev_b32 v2,4,v0
 MM v[96:99],a[4:7],a[88:91],v[96:99]
 RT a[108:109],v29 offset:16384
 v_xor_b32 v2,v2,v0
 MM v[100:103],a[4:7],a[92:95],v[100:103]
 v_and_b32 v2,7,v2
 MM v[232:235],a[8:11],a[64:67],v[232:235]
 RT a[110:111],v29 offset:18432
 v_lshl_add_u32 v1,v2,4,v1
 MM v[236:239],a[8:11],a[68:71],v[236:239]
 v_add_u32 v38,s26,v1
 MM v[240:243],a[8:11],a[72:75],v[240:243]
 RT a[112:113],v30 offset:16384
 s_add_u32 m0,s22,4096
 MM v[244:247],a[8:11],a[76:79],v[244:247]
 BL v12,s[8:11],s20 offen  lds
 MM v[248:251],a[8:11],a[80:83],v[248:251]
 RT a[114:115],v30 offset:18432
 v_xor_b32 v2,64,v38
 MM v[252:255],a[8:11],a[84:87],v[252:255]
 v_add_u32 v39,6144,v2
 MM v[128:131],a[8:11],a[88:91],v[128:131]
 RT a[116:117],v31 offset:16384
 v_add_u32 v40,12288,v38
 MM v[136:139],a[8:11],a[92:95],v[136:139]
 v_add_u32 v41,12288,v39
 MM v[104:107],a[12:15],a[64:67],v[104:107]
 RT a[118:119],v31 offset:18432
 MM v[108:111],a[12:15],a[68:71],v[108:111]
 BL v13,s[8:11],s20 offen offset:1024  lds
 MM v[112:115],a[12:15],a[72:75],v[112:115]
 RT a[120:121],v32 offset:16384
 s_mul_i32 s38,s35,4096
 MM v[116:119],a[12:15],a[76:79],v[116:119]
 s_mov_b32 s92,s54
 MM v[120:123],a[12:15],a[80:83],v[120:123]
 RT a[122:123],v32 offset:18432
 s_mov_b32 s93,s55
 MM v[124:127],a[12:15],a[84:87],v[124:127]
 s_mov_b32 s94,1605632
 MM v[132:135],a[12:15],a[88:91],v[132:135]
 RT a[124:125],v33 offset:16384
 MM v[140:143],a[12:15],a[92:95],v[140:143]
 s_mov_b32 s95,0x20000
 MM v[144:147],a[16:19],a[64:67],v[144:147]
 RT a[126:127],v33 offset:18432
 s_lshl_b32 s37,s83,8
 MM v[152:155],a[16:19],a[68:71],v[152:155]
 BL v14,s[8:11],s20 offen offset:2048  lds
 MM v[160:163],a[16:19],a[72:75],v[160:163]
 RQ a[36:39],v25 offset:2048
 v_lshrrev_b32 v1,4,v0
 MM v[168:171],a[16:19],a[76:79],v[168:171]
 v_and_b32 v2,15,v0
 MM v[176:179],a[16:19],a[80:83],v[176:179]
 RQ a[40:43],v25 offset:4096
 v_bfe_u32 v3,v1,0,1
 MM v[184:187],a[16:19],a[84:87],v[184:187]
 MM v[192:195],a[16:19],a[88:91],v[192:195]
 RQ a[44:47],v25 offset:6144
 v_lshlrev_b32 v3,1,v3
 MM a[184:187],a[16:19],a[92:95],a[184:187]
 BL v15,s[8:11],s20 offen offset:3072  lds
 MM v[148:151],a[20:23],a[64:67],v[148:151]
 RQ a[48:51],v25 offset:8192
 s_add_u32 s20,s20,128
 MM v[156:159],a[20:23],a[68:71],v[156:159]
 s_add_u32 s22,s22,32768
 v_xor_b32 v2,v2,v3
 MM v[164:167],a[20:23],a[72:75],v[164:167]
 RQ a[52:55],v25 offset:10240
 s_sub_u32 s34,s22,98304
 s_min_u32 s22,s22,s34
 MM v[172:175],a[20:23],a[76:79],v[172:175]
 v_bfe_u32 v3,v1,1,1
 v_lshlrev_b32 v3,2,v3
 MM v[180:183],a[20:23],a[80:83],v[180:183]
 RQ a[56:59],v25 offset:12288
 v_xor_b32 v2,v2,v3
 MM v[188:191],a[20:23],a[84:87],v[188:191]
 v_lshlrev_b32 v2,4,v2
 MM v[196:199],a[20:23],a[88:91],v[196:199]
 RQ a[60:63],v25 offset:14336
 MM a[188:191],a[20:23],a[92:95],a[188:191]
 v_add_u32 v24,s31,v24
 s_mul_i32 s26,s35,57344
 MM a[192:195],a[24:27],a[64:67],a[192:195]
 v_add_u32 v25,s31,v25
 v_mul_u32_u24 v1,3584,v1
 MM a[200:203],a[24:27],a[68:71],a[200:203]
 MM a[208:211],a[24:27],a[72:75],a[208:211]
 v_add_u32 v26,s32,v26
 v_add_u32 v1,s26,v1
 MM a[216:219],a[24:27],a[76:79],a[216:219]
 v_add_u32 v42,v2,v1
 MM a[224:227],a[24:27],a[80:83],a[224:227]
 v_add_u32 v27,s32,v27
 MM a[232:235],a[24:27],a[84:87],a[232:235]
 v_add_u32 v28,s32,v28
 v_add_u32 v43,13312,v42
 MM a[240:243],a[24:27],a[88:91],a[240:243]
 v_xor_b32 v3,128,v2
 MM a[248:251],a[24:27],a[92:95],a[248:251]
 v_add_u32 v29,s32,v29
 MM a[196:199],a[28:31],a[64:67],a[196:199]
 v_add_u32 v44,v3,v1
 MM a[204:207],a[28:31],a[68:71],a[204:207]
 v_add_u32 v30,s32,v30
 v_add_u32 v44,26624,v44
 MM a[212:215],a[28:31],a[72:75],a[212:215]
 v_add_u32 v31,s32,v31
 MM a[220:223],a[28:31],a[76:79],a[220:223]
 v_add_u32 v45,13312,v44
 MM a[228:231],a[28:31],a[80:83],a[228:231]
 v_add_u32 v32,s32,v32
 s_mul_i32 s39,s35,4096
 MM a[236:239],a[28:31],a[84:87],a[236:239]
 MM a[244:247],a[28:31],a[88:91],a[244:247]
 v_add_u32 v33,s32,v33
 MM a[252:255],a[28:31],a[92:95],a[252:255]
 s_waitcnt vmcnt(10)
 s_waitcnt lgkmcnt(0)
 s_barrier
 MM v[200:203],a[32:35],a[96:99],v[200:203]
 RQ a[0:3],v24
 s_add_u32 m0,s23,98304
 MM v[204:207],a[32:35],a[100:103],v[204:207]
 BL v16,s[12:15],s21 offen  lds
 MM v[208:211],a[32:35],a[104:107],v[208:211]
 RT a[64:65],v26
 MM v[212:215],a[32:35],a[108:111],v[212:215]
 MM v[216:219],a[32:35],a[112:115],v[216:219]
 RT a[66:67],v26 offset:2048
 MM v[220:223],a[32:35],a[116:119],v[220:223]
 MM v[224:227],a[32:35],a[120:123],v[224:227]
 RT a[68:69],v27
 MM v[228:231],a[32:35],a[124:127],v[228:231]
 BL v17,s[12:15],s21 offen offset:1024  lds
 MM v[72:75],a[36:39],a[96:99],v[72:75]
 RT a[70:71],v27 offset:2048
 MM v[76:79],a[36:39],a[100:103],v[76:79]
 MM v[80:83],a[36:39],a[104:107],v[80:83]
 RT a[72:73],v28
 MM v[84:87],a[36:39],a[108:111],v[84:87]
 MM v[88:91],a[36:39],a[112:115],v[88:91]
 RT a[74:75],v28 offset:2048
 MM v[92:95],a[36:39],a[116:119],v[92:95]
 MM v[96:99],a[36:39],a[120:123],v[96:99]
 RT a[76:77],v29
 MM v[100:103],a[36:39],a[124:127],v[100:103]
 BL v18,s[12:15],s21 offen offset:2048  lds
 MM v[232:235],a[40:43],a[96:99],v[232:235]
 RT a[78:79],v29 offset:2048
 MM v[236:239],a[40:43],a[100:103],v[236:239]
 MM v[240:243],a[40:43],a[104:107],v[240:243]
 RT a[80:81],v30
 MM v[244:247],a[40:43],a[108:111],v[244:247]
 MM v[248:251],a[40:43],a[112:115],v[248:251]
 RT a[82:83],v30 offset:2048
 MM v[252:255],a[40:43],a[116:119],v[252:255]
 MM v[128:131],a[40:43],a[120:123],v[128:131]
 RT a[84:85],v31
 MM v[136:139],a[40:43],a[124:127],v[136:139]
 BL v19,s[12:15],s21 offen offset:3072  lds
 MM v[104:107],a[44:47],a[96:99],v[104:107]
 RT a[86:87],v31 offset:2048
 MM v[108:111],a[44:47],a[100:103],v[108:111]
 MM v[112:115],a[44:47],a[104:107],v[112:115]
 RT a[88:89],v32
 MM v[116:119],a[44:47],a[108:111],v[116:119]
 MM v[120:123],a[44:47],a[112:115],v[120:123]
 RT a[90:91],v32 offset:2048
 MM v[124:127],a[44:47],a[116:119],v[124:127]
 MM v[132:135],a[44:47],a[120:123],v[132:135]
 RT a[92:93],v33
 s_add_u32 m0,s23,102400
 MM v[140:143],a[44:47],a[124:127],v[140:143]
 BL v20,s[12:15],s21 offen  lds
 MM v[144:147],a[48:51],a[96:99],v[144:147]
 RT a[94:95],v33 offset:2048
 MM v[152:155],a[48:51],a[100:103],v[152:155]
 MM v[160:163],a[48:51],a[104:107],v[160:163]
 RQ a[4:7],v24 offset:2048
 MM v[168:171],a[48:51],a[108:111],v[168:171]
 MM v[176:179],a[48:51],a[112:115],v[176:179]
 RQ a[8:11],v24 offset:4096
 MM v[184:187],a[48:51],a[116:119],v[184:187]
 MM v[192:195],a[48:51],a[120:123],v[192:195]
 RQ a[12:15],v24 offset:6144
 MM a[184:187],a[48:51],a[124:127],a[184:187]
 BL v21,s[12:15],s21 offen offset:1024  lds
 MM v[148:151],a[52:55],a[96:99],v[148:151]
 RQ a[16:19],v24 offset:8192
 MM v[156:159],a[52:55],a[100:103],v[156:159]
 MM v[164:167],a[52:55],a[104:107],v[164:167]
 RQ a[20:23],v24 offset:10240
 MM v[172:175],a[52:55],a[108:111],v[172:175]
 MM v[180:183],a[52:55],a[112:115],v[180:183]
 RQ a[24:27],v24 offset:12288
 MM v[188:191],a[52:55],a[116:119],v[188:191]
 MM v[196:199],a[52:55],a[120:123],v[196:199]
 RQ a[28:31],v24 offset:14336
 MM a[188:191],a[52:55],a[124:127],a[188:191]
 BL v22,s[12:15],s21 offen offset:2048  lds
 MM a[192:195],a[56:59],a[96:99],a[192:195]
 MM a[200:203],a[56:59],a[100:103],a[200:203]
 MM a[208:211],a[56:59],a[104:107],a[208:211]
 MM a[216:219],a[56:59],a[108:111],a[216:219]
 BL v23,s[12:15],s21 offen offset:3072  lds
 MM a[224:227],a[56:59],a[112:115],a[224:227]
 s_add_u32 s21,s21,524288
 MM a[232:235],a[56:59],a[116:119],a[232:235]
 s_add_u32 s23,s23,32768
 s_sub_u32 s34,s23,65536
 s_min_u32 s23,s23,s34
 MM a[240:243],a[56:59],a[120:123],a[240:243]
 s_add_u32 m0,s38,32768
 MM a[248:251],a[56:59],a[124:127],a[248:251]
 BL v38,s[88:91],s36 offen  lds
 MM a[196:199],a[60:63],a[96:99],a[196:199]
 MM a[204:207],a[60:63],a[100:103],a[204:207]
 MM a[212:215],a[60:63],a[104:107],a[212:215]
 MM a[220:223],a[60:63],a[108:111],a[220:223]
 BL v39,s[88:91],s36 offen offset:1024  lds
 MM a[228:231],a[60:63],a[112:115],a[228:231]
 MM a[236:239],a[60:63],a[116:119],a[236:239]
 MM a[244:247],a[60:63],a[120:123],a[244:247]
 MM a[252:255],a[60:63],a[124:127],a[252:255]
 BL v40,s[88:91],s36 offen offset:2048  lds
 s_waitcnt lgkmcnt(0)
 MM v[200:203],a[0:3],a[64:67],v[200:203]
 RQ a[32:35],v25
 s_and_b32 s26,s35,1
 MM v[204:207],a[0:3],a[68:71],v[204:207]
 s_add_u32 s31,s24,32768
 s_sub_u32 s33,s31,98304
 MM v[208:211],a[0:3],a[72:75],v[208:211]
 RT a[96:97],v26 offset:16384
 v_and_b32 v1,15,v0
 MM v[212:215],a[0:3],a[76:79],v[212:215]
 s_min_u32 s33,s31,s33
 s_sub_u32 s31,s33,s24
 MM v[216:219],a[0:3],a[80:83],v[216:219]
 RT a[98:99],v26 offset:18432
 s_mul_i32 s26,s26,8192
 MM v[220:223],a[0:3],a[84:87],v[220:223]
 s_mov_b32 s24,s33
 MM v[224:227],a[0:3],a[88:91],v[224:227]
 RT a[100:101],v27 offset:16384
 v_lshl_add_u32 v1,v1,7,s26
 MM v[228:231],a[0:3],a[92:95],v[228:231]
 BL v41,s[88:91],s36 offen offset:3072  lds
 s_add_u32 s32,s25,32768
 s_sub_u32 s33,s32,65536
 MM v[72:75],a[4:7],a[64:67],v[72:75]
 RT a[102:103],v27 offset:18432
 s_add_u32 s36,s36,128
 MM v[76:79],a[4:7],a[68:71],v[76:79]
 s_min_u32 s33,s32,s33
 s_sub_u32 s32,s33,s25
 MM v[80:83],a[4:7],a[72:75],v[80:83]
 RT a[104:105],v28 offset:16384
 v_lshrrev_b32 v2,4,v0
 MM v[84:87],a[4:7],a[76:79],v[84:87]
 s_mov_b32 s25,s33
 v_bfe_u32 v3,v0,1,3
 MM v[88:91],a[4:7],a[80:83],v[88:91]
 RT a[106:107],v28 offset:18432
 v_xor_b32 v2,v2,v3
 MM v[92:95],a[4:7],a[84:87],v[92:95]
 MM v[96:99],a[4:7],a[88:91],v[96:99]
 RT a[108:109],v29 offset:16384
 s_add_u32 m0,s38,49152
 MM v[100:103],a[4:7],a[92:95],v[100:103]
 BL v38,s[88:91],s36 offen  lds
 MM v[232:235],a[8:11],a[64:67],v[232:235]
 RT a[110:111],v29 offset:18432
 v_lshl_add_u32 v46,v2,4,v1
 MM v[236:239],a[8:11],a[68:71],v[236:239]
 v_xor_b32 v47,64,v46
 MM v[240:243],a[8:11],a[72:75],v[240:243]
 RT a[112:113],v30 offset:16384
 MM v[244:247],a[8:11],a[76:79],v[244:247]
 v_add_u32 v48,65536,v46
 MM v[248:251],a[8:11],a[80:83],v[248:251]
 RT a[114:115],v30 offset:18432
 MM v[252:255],a[8:11],a[84:87],v[252:255]
 v_add_u32 v49,65536,v47
 MM v[128:131],a[8:11],a[88:91],v[128:131]
 RT a[116:117],v31 offset:16384
 MM v[136:139],a[8:11],a[92:95],v[136:139]
 BL v39,s[88:91],s36 offen offset:1024  lds
 MM v[104:107],a[12:15],a[64:67],v[104:107]
 RT a[118:119],v31 offset:18432
 v_bfe_u32 v1,v0,2,2
 MM v[108:111],a[12:15],a[68:71],v[108:111]
 v_lshrrev_b32 v2,4,v0
 MM v[112:115],a[12:15],a[72:75],v[112:115]
 RT a[120:121],v32 offset:16384
 MM v[116:119],a[12:15],a[76:79],v[116:119]
 v_lshl_add_u32 v2,v2,3,v1
 MM v[120:123],a[12:15],a[80:83],v[120:123]
 RT a[122:123],v32 offset:18432
 MM v[124:127],a[12:15],a[84:87],v[124:127]
 v_bfe_u32 v4,v2,0,1
 MM v[132:135],a[12:15],a[88:91],v[132:135]
 RT a[124:125],v33 offset:16384
 MM v[140:143],a[12:15],a[92:95],v[140:143]
 BL v40,s[88:91],s36 offen offset:2048  lds
 MM v[144:147],a[16:19],a[64:67],v[144:147]
 RT a[126:127],v33 offset:18432
 v_bfe_u32 v5,v2,1,1
 MM v[152:155],a[16:19],a[68:71],v[152:155]
 MM v[160:163],a[16:19],a[72:75],v[160:163]
 RQ a[36:39],v25 offset:2048
 v_lshl_or_b32 v4,v5,1,v4
 MM v[168:171],a[16:19],a[76:79],v[168:171]
 MM v[176:179],a[16:19],a[80:83],v[176:179]
 RQ a[40:43],v25 offset:4096
 v_bfe_u32 v5,v2,3,1
 MM v[184:187],a[16:19],a[84:87],v[184:187]
 MM v[192:195],a[16:19],a[88:91],v[192:195]
 RQ a[44:47],v25 offset:6144
 v_lshl_or_b32 v4,v5,2,v4
 MM a[184:187],a[16:19],a[92:95],a[184:187]
 BL v41,s[88:91],s36 offen offset:3072  lds
 MM v[148:151],a[20:23],a[64:67],v[148:151]
 RQ a[48:51],v25 offset:8192
 s_add_u32 s36,s36,128
 MM v[156:159],a[20:23],a[68:71],v[156:159]
 v_mul_u32_u24 v2,256,v2
 MM v[164:167],a[20:23],a[72:75],v[164:167]
 RQ a[52:55],v25 offset:10240
 v_and_b32 v3,3,v0
 MM v[172:175],a[20:23],a[76:79],v[172:175]
 MM v[180:183],a[20:23],a[80:83],v[180:183]
 RQ a[56:59],v25 offset:12288
 v_lshl_add_u32 v2,v3,3,v2
 MM v[188:191],a[20:23],a[84:87],v[188:191]
 MM v[196:199],a[20:23],a[88:91],v[196:199]
 RQ a[60:63],v25 offset:14336
 v_add_u32 v2,81920,v2
 MM a[188:191],a[20:23],a[92:95],a[188:191]
 v_add_u32 v24,s31,v24
 MM a[192:195],a[24:27],a[64:67],a[192:195]
 v_add_u32 v25,s31,v25
 MM a[200:203],a[24:27],a[68:71],a[200:203]
 s_lshr_b32 s26,s35,1
 MM a[208:211],a[24:27],a[72:75],a[208:211]
 v_add_u32 v26,s32,v26
 MM a[216:219],a[24:27],a[76:79],a[216:219]
 s_mul_i32 s26,s26,4
 MM a[224:227],a[24:27],a[80:83],a[224:227]
 v_add_u32 v27,s32,v27
 MM a[232:235],a[24:27],a[84:87],a[232:235]
 v_add_u32 v28,s32,v28
 v_xor_b32 v4,s26,v4
 MM a[240:243],a[24:27],a[88:91],a[240:243]
 MM a[248:251],a[24:27],a[92:95],a[248:251]
 v_add_u32 v29,s32,v29
 v_xor_b32 v3,0,v4
 MM a[196:199],a[28:31],a[64:67],a[196:199]
 MM a[204:207],a[28:31],a[68:71],a[204:207]
 v_add_u32 v30,s32,v30
 v_lshl_add_u32 v50,v3,5,v2
 MM a[212:215],a[28:31],a[72:75],a[212:215]
 v_add_u32 v31,s32,v31
 MM a[220:223],a[28:31],a[76:79],a[220:223]
 v_xor_b32 v3,1,v4
 MM a[228:231],a[28:31],a[80:83],a[228:231]
 v_add_u32 v32,s32,v32
 MM a[236:239],a[28:31],a[84:87],a[236:239]
 v_lshl_add_u32 v51,v3,5,v2
 MM a[244:247],a[28:31],a[88:91],a[244:247]
 v_add_u32 v33,s32,v33
 MM a[252:255],a[28:31],a[92:95],a[252:255]
 s_waitcnt vmcnt(8)
 s_waitcnt lgkmcnt(0)
 s_barrier
 MM v[200:203],a[32:35],a[96:99],v[200:203]
 RQ a[0:3],v24
 s_add_u32 m0,s39,81920
 MM v[204:207],a[32:35],a[100:103],v[204:207]
 BL v42,s[92:95],s37 offen sc1 lds
 MM v[208:211],a[32:35],a[104:107],v[208:211]
 RT a[64:65],v26
 v_xor_b32 v3,2,v4
 MM v[212:215],a[32:35],a[108:111],v[212:215]
 v_lshl_add_u32 v52,v3,5,v2
 MM v[216:219],a[32:35],a[112:115],v[216:219]
 RT a[66:67],v26 offset:2048
 v_xor_b32 v3,3,v4
 MM v[220:223],a[32:35],a[116:119],v[220:223]
 MM v[224:227],a[32:35],a[120:123],v[224:227]
 RT a[68:69],v27
 v_lshl_add_u32 v53,v3,5,v2
 MM v[228:231],a[32:35],a[124:127],v[228:231]
 BL v43,s[92:95],s37 offen offset:1024 sc1 lds
 MM v[72:75],a[36:39],a[96:99],v[72:75]
 RT a[70:71],v27 offset:2048
 v_add_u32 v54,65536,v50
 MM v[76:79],a[36:39],a[100:103],v[76:79]
 MM v[80:83],a[36:39],a[104:107],v[80:83]
 RT a[72:73],v28
 v_add_u32 v55,65536,v51
 MM v[84:87],a[36:39],a[108:111],v[84:87]
 MM v[88:91],a[36:39],a[112:115],v[88:91]
 RT a[74:75],v28 offset:2048
 v_add_u32 v56,65536,v52
 MM v[92:95],a[36:39],a[116:119],v[92:95]
 MM v[96:99],a[36:39],a[120:123],v[96:99]
 RT a[76:77],v29
 v_add_u32 v57,65536,v53
 MM v[100:103],a[36:39],a[124:127],v[100:103]
 BL v44,s[92:95],s37 offen offset:2048 sc1 lds
 MM v[232:235],a[40:43],a[96:99],v[232:235]
 RT a[78:79],v29 offset:2048
 MM v[236:239],a[40:43],a[100:103],v[236:239]
 v_lshrrev_b32 v1,3,v0
 MM v[240:243],a[40:43],a[104:107],v[240:243]
 RT a[80:81],v30
 MM v[244:247],a[40:43],a[108:111],v[244:247]
 s_mul_i32 s26,s35,131072
 MM v[248:251],a[40:43],a[112:115],v[248:251]
 RT a[82:83],v30 offset:2048
 MM v[252:255],a[40:43],a[116:119],v[252:255]
 v_mul_u32_u24 v1,4096,v1
 MM v[128:131],a[40:43],a[120:123],v[128:131]
 RT a[84:85],v31
 MM v[136:139],a[40:43],a[124:127],v[136:139]
 BL v45,s[92:95],s37 offen offset:3072 sc1 lds
 MM v[104:107],a[44:47],a[96:99],v[104:107]
 RT a[86:87],v31 offset:2048
 s_add_u32 s37,s37,229376
 MM v[108:111],a[44:47],a[100:103],v[108:111]
 v_lshrrev_b32 v2,4,v0
 v_xor_b32 v2,v2,v0
 MM v[112:115],a[44:47],a[104:107],v[112:115]
 RT a[88:89],v32
 MM v[116:119],a[44:47],a[108:111],v[116:119]
 v_and_b32 v2,7,v2
 MM v[120:123],a[44:47],a[112:115],v[120:123]
 RT a[90:91],v32 offset:2048
 MM v[124:127],a[44:47],a[116:119],v[124:127]
 v_lshl_add_u32 v1,v2,4,v1
 MM v[132:135],a[44:47],a[120:123],v[132:135]
 RT a[92:93],v33
 s_add_u32 m0,s39,98304
 MM v[140:143],a[44:47],a[124:127],v[140:143]
 BL v42,s[92:95],s37 offen sc1 lds
 MM v[144:147],a[48:51],a[96:99],v[144:147]
 RT a[94:95],v33 offset:2048
 v_add_u32 v58,s26,v1
 MM v[152:155],a[48:51],a[100:103],v[152:155]
 MM v[160:163],a[48:51],a[104:107],v[160:163]
 RQ a[4:7],v24 offset:2048
 v_xor_b32 v2,64,v58
 MM v[168:171],a[48:51],a[108:111],v[168:171]
 MM v[176:179],a[48:51],a[112:115],v[176:179]
 RQ a[8:11],v24 offset:4096
 v_add_u32 v59,31744,v2
 MM v[184:187],a[48:51],a[116:119],v[184:187]
 MM v[192:195],a[48:51],a[120:123],v[192:195]
 RQ a[12:15],v24 offset:6144
 v_add_u32 v60,63488,v58
 MM a[184:187],a[48:51],a[124:127],a[184:187]
 BL v43,s[92:95],s37 offen offset:1024 sc1 lds
 MM v[148:151],a[52:55],a[96:99],v[148:151]
 RQ a[16:19],v24 offset:8192
 v_add_u32 v61,63488,v59
 MM v[156:159],a[52:55],a[100:103],v[156:159]
 MM v[164:167],a[52:55],a[104:107],v[164:167]
 RQ a[20:23],v24 offset:10240
 s_lshr_b32 s26,s35,1
 MM v[172:175],a[52:55],a[108:111],v[172:175]
 MM v[180:183],a[52:55],a[112:115],v[180:183]
 RQ a[24:27],v24 offset:12288
 s_mul_i32 s27,s26,57344
 MM v[188:191],a[52:55],a[116:119],v[188:191]
 MM v[196:199],a[52:55],a[120:123],v[196:199]
 RQ a[28:31],v24 offset:14336
 s_lshl_b32 s26,s26,12
 MM a[188:191],a[52:55],a[124:127],a[188:191]
 BL v44,s[92:95],s37 offen offset:2048 sc1 lds
 MM a[192:195],a[56:59],a[96:99],a[192:195]
 MM a[200:203],a[56:59],a[100:103],a[200:203]
 s_add_u32 s26,s26,81920
 MM a[208:211],a[56:59],a[104:107],a[208:211]
 MM a[216:219],a[56:59],a[108:111],a[216:219]
 BL v45,s[92:95],s37 offen offset:3072 sc1 lds
 MM a[224:227],a[56:59],a[112:115],a[224:227]
 s_add_u32 s37,s37,229376
 v_add_u32 v63,s26,v6
 MM a[232:235],a[56:59],a[116:119],a[232:235]
 v_add_u32 v64,65536,v63
 MM a[240:243],a[56:59],a[120:123],a[240:243]
 s_add_u32 m0,s38,65536
 MM a[248:251],a[56:59],a[124:127],a[248:251]
 BL v38,s[88:91],s36 offen  lds
 MM a[196:199],a[60:63],a[96:99],a[196:199]
 s_and_b32 s26,s35,1
 MM a[204:207],a[60:63],a[100:103],a[204:207]
 s_lshl_b32 s26,s26,12
 MM a[212:215],a[60:63],a[104:107],a[212:215]
 MM a[220:223],a[60:63],a[108:111],a[220:223]
 BL v39,s[88:91],s36 offen offset:1024  lds
 MM a[228:231],a[60:63],a[112:115],a[228:231]
 s_add_u32 s26,s26,s27
 MM a[236:239],a[60:63],a[116:119],a[236:239]
 v_add_u32 v62,s26,v6
 MM a[244:247],a[60:63],a[120:123],a[244:247]
 MM a[252:255],a[60:63],a[124:127],a[252:255]
 BL v40,s[88:91],s36 offen offset:2048  lds
 s_waitcnt lgkmcnt(0)
 MM v[200:203],a[0:3],a[64:67],v[200:203]
 RQ a[32:35],v25
 MM v[204:207],a[0:3],a[68:71],v[204:207]
 s_mov_b32 s4,s62
 s_mov_b32 s5,s63
 s_mov_b32 s6,896
 s_mov_b32 s7,0x20000
 v_lshrrev_b32 v1,4,v0
 v_lshlrev_b32 v1,4,v1
 BL a[128:131],v1,s[4:7],0 offen
 BL a[132:135],v1,s[4:7],0 offen offset:64
 BL a[136:139],v1,s[4:7],0 offen offset:128
 BL a[140:143],v1,s[4:7],0 offen offset:192
 BL a[144:147],v1,s[4:7],0 offen offset:256
 BL a[148:151],v1,s[4:7],0 offen offset:320
 MM v[208:211],a[0:3],a[72:75],v[208:211]
 RT a[96:97],v26 offset:16384
 MM v[212:215],a[0:3],a[76:79],v[212:215]
 MM v[216:219],a[0:3],a[80:83],v[216:219]
 RT a[98:99],v26 offset:18432
 MM v[220:223],a[0:3],a[84:87],v[220:223]
 MM v[224:227],a[0:3],a[88:91],v[224:227]
 RT a[100:101],v27 offset:16384
 MM v[228:231],a[0:3],a[92:95],v[228:231]
 BL v41,s[88:91],s36 offen offset:3072  lds
 MM v[72:75],a[4:7],a[64:67],v[72:75]
 RT a[102:103],v27 offset:18432
 s_add_u32 s36,s36,128
 MM v[76:79],a[4:7],a[68:71],v[76:79]
 MM v[80:83],a[4:7],a[72:75],v[80:83]
 RT a[104:105],v28 offset:16384
 MM v[84:87],a[4:7],a[76:79],v[84:87]
 MM v[88:91],a[4:7],a[80:83],v[88:91]
 RT a[106:107],v28 offset:18432
 MM v[92:95],a[4:7],a[84:87],v[92:95]
 MM v[96:99],a[4:7],a[88:91],v[96:99]
 RT a[108:109],v29 offset:16384
 s_add_u32 m0,s39,114688
 MM v[100:103],a[4:7],a[92:95],v[100:103]
 BL v42,s[92:95],s37 offen sc1 lds
 MM v[232:235],a[8:11],a[64:67],v[232:235]
 RT a[110:111],v29 offset:18432
 MM v[236:239],a[8:11],a[68:71],v[236:239]
 MM v[240:243],a[8:11],a[72:75],v[240:243]
 RT a[112:113],v30 offset:16384
 MM v[244:247],a[8:11],a[76:79],v[244:247]
 MM v[248:251],a[8:11],a[80:83],v[248:251]
 RT a[114:115],v30 offset:18432
 MM v[252:255],a[8:11],a[84:87],v[252:255]
 MM v[128:131],a[8:11],a[88:91],v[128:131]
 RT a[116:117],v31 offset:16384
 MM v[136:139],a[8:11],a[92:95],v[136:139]
 BL v43,s[92:95],s37 offen offset:1024 sc1 lds
 MM v[104:107],a[12:15],a[64:67],v[104:107]
 RT a[118:119],v31 offset:18432
 MM v[108:111],a[12:15],a[68:71],v[108:111]
 MM v[112:115],a[12:15],a[72:75],v[112:115]
 RT a[120:121],v32 offset:16384
 MM v[116:119],a[12:15],a[76:79],v[116:119]
 MM v[120:123],a[12:15],a[80:83],v[120:123]
 RT a[122:123],v32 offset:18432
 MM v[124:127],a[12:15],a[84:87],v[124:127]
 MM v[132:135],a[12:15],a[88:91],v[132:135]
 RT a[124:125],v33 offset:16384
 MM v[140:143],a[12:15],a[92:95],v[140:143]
 BL v44,s[92:95],s37 offen offset:2048 sc1 lds
 MM v[144:147],a[16:19],a[64:67],v[144:147]
 RT a[126:127],v33 offset:18432
 MM v[152:155],a[16:19],a[68:71],v[152:155]
 MM v[160:163],a[16:19],a[72:75],v[160:163]
 RQ a[36:39],v25 offset:2048
 MM v[168:171],a[16:19],a[76:79],v[168:171]
 MM v[176:179],a[16:19],a[80:83],v[176:179]
 RQ a[40:43],v25 offset:4096
 MM v[184:187],a[16:19],a[84:87],v[184:187]
 MM v[192:195],a[16:19],a[88:91],v[192:195]
 RQ a[44:47],v25 offset:6144
 MM a[184:187],a[16:19],a[92:95],a[184:187]
 BL v45,s[92:95],s37 offen offset:3072 sc1 lds
 MM v[148:151],a[20:23],a[64:67],v[148:151]
 RQ a[48:51],v25 offset:8192
 s_add_u32 s37,s37,229376
 MM v[156:159],a[20:23],a[68:71],v[156:159]
 MM v[164:167],a[20:23],a[72:75],v[164:167]
 RQ a[52:55],v25 offset:10240
 MM v[172:175],a[20:23],a[76:79],v[172:175]
 MM v[180:183],a[20:23],a[80:83],v[180:183]
 RQ a[56:59],v25 offset:12288
 MM v[188:191],a[20:23],a[84:87],v[188:191]
 MM v[196:199],a[20:23],a[88:91],v[196:199]
 RQ a[60:63],v25 offset:14336
 MM a[188:191],a[20:23],a[92:95],a[188:191]
 MM a[192:195],a[24:27],a[64:67],a[192:195]
 MM a[200:203],a[24:27],a[68:71],a[200:203]
 MM a[208:211],a[24:27],a[72:75],a[208:211]
 MM a[216:219],a[24:27],a[76:79],a[216:219]
 MM a[224:227],a[24:27],a[80:83],a[224:227]
 MM a[232:235],a[24:27],a[84:87],a[232:235]
 MM a[240:243],a[24:27],a[88:91],a[240:243]
 MM a[248:251],a[24:27],a[92:95],a[248:251]
 MM a[196:199],a[28:31],a[64:67],a[196:199]
 MM a[204:207],a[28:31],a[68:71],a[204:207]
 MM a[212:215],a[28:31],a[72:75],a[212:215]
 MM a[220:223],a[28:31],a[76:79],a[220:223]
 MM a[228:231],a[28:31],a[80:83],a[228:231]
 MM a[236:239],a[28:31],a[84:87],a[236:239]
 MM a[244:247],a[28:31],a[88:91],a[244:247]
 MM a[252:255],a[28:31],a[92:95],a[252:255]
 s_waitcnt lgkmcnt(0)
 s_barrier
 MM v[200:203],a[32:35],a[96:99],v[200:203]
 s_add_u32 m0,s38,0
 MM v[204:207],a[32:35],a[100:103],v[204:207]
 BL v38,s[88:91],s36 offen  lds
 MM v[208:211],a[32:35],a[104:107],v[208:211]
 MM v[212:215],a[32:35],a[108:111],v[212:215]
 MM v[216:219],a[32:35],a[112:115],v[216:219]
 MM v[220:223],a[32:35],a[116:119],v[220:223]
 MM v[224:227],a[32:35],a[120:123],v[224:227]
 MM v[228:231],a[32:35],a[124:127],v[228:231]
 BL v39,s[88:91],s36 offen offset:1024  lds
 MM v[72:75],a[36:39],a[96:99],v[72:75]
 MM v[76:79],a[36:39],a[100:103],v[76:79]
 MM v[80:83],a[36:39],a[104:107],v[80:83]
 MM v[84:87],a[36:39],a[108:111],v[84:87]
 MM v[88:91],a[36:39],a[112:115],v[88:91]
 MM v[92:95],a[36:39],a[116:119],v[92:95]
 MM v[96:99],a[36:39],a[120:123],v[96:99]
 MM v[100:103],a[36:39],a[124:127],v[100:103]
 BL v40,s[88:91],s36 offen offset:2048  lds
 MM v[232:235],a[40:43],a[96:99],v[232:235]
 MM v[236:239],a[40:43],a[100:103],v[236:239]
 MM v[240:243],a[40:43],a[104:107],v[240:243]
 MM v[244:247],a[40:43],a[108:111],v[244:247]
 MM v[248:251],a[40:43],a[112:115],v[248:251]
 MM v[252:255],a[40:43],a[116:119],v[252:255]
 MM v[128:131],a[40:43],a[120:123],v[128:131]
 MM v[136:139],a[40:43],a[124:127],v[136:139]
 BL v41,s[88:91],s36 offen offset:3072  lds
 MM v[104:107],a[44:47],a[96:99],v[104:107]
 s_add_u32 s36,s36,128
 MM v[108:111],a[44:47],a[100:103],v[108:111]
 MM v[112:115],a[44:47],a[104:107],v[112:115]
 MM v[116:119],a[44:47],a[108:111],v[116:119]
 MM v[120:123],a[44:47],a[112:115],v[120:123]
 MM v[124:127],a[44:47],a[116:119],v[124:127]
 MM v[132:135],a[44:47],a[120:123],v[132:135]
 s_add_u32 m0,s39,131072
 MM v[140:143],a[44:47],a[124:127],v[140:143]
 BL v42,s[92:95],s37 offen sc1 lds
 MM v[144:147],a[48:51],a[96:99],v[144:147]
 MM v[152:155],a[48:51],a[100:103],v[152:155]
 MM v[160:163],a[48:51],a[104:107],v[160:163]
 MM v[168:171],a[48:51],a[108:111],v[168:171]
 MM v[176:179],a[48:51],a[112:115],v[176:179]
 MM v[184:187],a[48:51],a[116:119],v[184:187]
 MM v[192:195],a[48:51],a[120:123],v[192:195]
 MM a[184:187],a[48:51],a[124:127],a[184:187]
 BL v43,s[92:95],s37 offen offset:1024 sc1 lds
 MM v[148:151],a[52:55],a[96:99],v[148:151]
 MM v[156:159],a[52:55],a[100:103],v[156:159]
 MM v[164:167],a[52:55],a[104:107],v[164:167]
 MM v[172:175],a[52:55],a[108:111],v[172:175]
 MM v[180:183],a[52:55],a[112:115],v[180:183]
 MM v[188:191],a[52:55],a[116:119],v[188:191]
 MM v[196:199],a[52:55],a[120:123],v[196:199]
 MM a[188:191],a[52:55],a[124:127],a[188:191]
 BL v44,s[92:95],s37 offen offset:2048 sc1 lds
 MM a[192:195],a[56:59],a[96:99],a[192:195]
 MM a[200:203],a[56:59],a[100:103],a[200:203]
 MM a[208:211],a[56:59],a[104:107],a[208:211]
 MM a[216:219],a[56:59],a[108:111],a[216:219]
 BL v45,s[92:95],s37 offen offset:3072 sc1 lds
 MM a[224:227],a[56:59],a[112:115],a[224:227]
 s_add_u32 s37,s37,229376
 MM a[232:235],a[56:59],a[116:119],a[232:235]
 MM a[240:243],a[56:59],a[120:123],a[240:243]
 s_add_u32 m0,s38,16384
 MM a[248:251],a[56:59],a[124:127],a[248:251]
 BL v38,s[88:91],s36 offen  lds
 MM a[196:199],a[60:63],a[96:99],a[196:199]
 MM a[204:207],a[60:63],a[100:103],a[204:207]
 MM a[212:215],a[60:63],a[104:107],a[212:215]
 MM a[220:223],a[60:63],a[108:111],a[220:223]
 BL v39,s[88:91],s36 offen offset:1024  lds
 MM a[228:231],a[60:63],a[112:115],a[228:231]
 MM a[236:239],a[60:63],a[116:119],a[236:239]
 MM a[244:247],a[60:63],a[120:123],a[244:247]
 MM a[252:255],a[60:63],a[124:127],a[252:255]
 BL v40,s[88:91],s36 offen offset:2048  lds
 BL v41,s[88:91],s36 offen offset:3072  lds
 s_add_u32 s36,s36,128
 s_add_u32 m0,s39,147456
 s_nop 0
 BL v42,s[92:95],s37 offen sc1 lds
 BL v43,s[92:95],s37 offen offset:1024 sc1 lds
 BL v44,s[92:95],s37 offen offset:2048 sc1 lds
 BL v45,s[92:95],s37 offen offset:3072 sc1 lds
 s_add_u32 s37,s37,229376
 s_mov_b32 s16,s68
 s_mov_b32 s17,s69
 s_mov_b32 s18,33554432
 s_mov_b32 s19,0x20000
 s_and_b32 s85,s35,1
 s_lshl_b32 s84,s70,1
 s_add_u32 s84,s84,s85
 s_lshl_b32 s84,s84,16
 s_lshr_b32 s85,s35,1
 s_lshl_b32 s85,s85,13
 s_add_u32 s84,s84,s85
 s_lshl_b32 s85,s71,20
 s_add_u32 s84,s84,s85
 s_add_u32 s84,s84,16777216
 s_mov_b32 s29,0
 s_mov_b32 s30,8192
 AR v12,a184
 AR v13,a185
 AR v14,a186
 AR v15,a187
 AR v16,a188
 AR v17,a189
 AR v18,a190
 AR v19,a191
 CV v8,v12,v13
 CV v9,v14,v15
 CV v10,v16,v17
 CV v11,v18,v19
 s_add_u32 s85,s84,36864
 BS v[8:11],v6,s[16:19],s85 offen offset:3072 sc1
 AR v24,a192
 AR v25,a193
 AR v26,a194
 AR v27,a195
 AR v28,a196
 AR v29,a197
 AR v30,a198
 AR v31,a199
 CV v20,v24,v25
 CV v21,v26,v27
 CV v22,v28,v29
 CV v23,v30,v31
 s_add_u32 s85,s84,49152
 BS v[20:23],v6,s[16:19],s85 offen sc1
 AR v12,a200
 AR v13,a201
 AR v14,a202
 AR v15,a203
 AR v16,a204
 AR v17,a205
 AR v18,a206
 AR v19,a207
 CV v8,v12,v13
 CV v9,v14,v15
 CV v10,v16,v17
 CV v11,v18,v19
 s_add_u32 s85,s84,49152
 BS v[8:11],v6,s[16:19],s85 offen offset:1024 sc1
 AR v24,a208
 AR v25,a209
 AR v26,a210
 AR v27,a211
 AR v28,a212
 AR v29,a213
 AR v30,a214
 AR v31,a215
 CV v20,v24,v25
 CV v21,v26,v27
 CV v22,v28,v29
 CV v23,v30,v31
 s_add_u32 s85,s84,49152
 BS v[20:23],v6,s[16:19],s85 offen offset:2048 sc1
 AR v12,a216
 AR v13,a217
 AR v14,a218
 AR v15,a219
 AR v16,a220
 AR v17,a221
 AR v18,a222
 AR v19,a223
 CV v8,v12,v13
 CV v9,v14,v15
 CV v10,v16,v17
 CV v11,v18,v19
 s_add_u32 s85,s84,49152
 BS v[8:11],v6,s[16:19],s85 offen offset:3072 sc1
 AR v24,a224
 AR v25,a225
 AR v26,a226
 AR v27,a227
 AR v28,a228
 AR v29,a229
 AR v30,a230
 AR v31,a231
 CV v20,v24,v25
 CV v21,v26,v27
 CV v22,v28,v29
 CV v23,v30,v31
 s_add_u32 s85,s84,53248
 BS v[20:23],v6,s[16:19],s85 offen sc1
 AR v12,a232
 AR v13,a233
 AR v14,a234
 AR v15,a235
 AR v16,a236
 AR v17,a237
 AR v18,a238
 AR v19,a239
 CV v8,v12,v13
 CV v9,v14,v15
 CV v10,v16,v17
 CV v11,v18,v19
 s_add_u32 s85,s84,53248
 BS v[8:11],v6,s[16:19],s85 offen offset:1024 sc1
 AR v24,a240
 AR v25,a241
 AR v26,a242
 AR v27,a243
 AR v28,a244
 AR v29,a245
 AR v30,a246
 AR v31,a247
 CV v20,v24,v25
 CV v21,v26,v27
 CV v22,v28,v29
 CV v23,v30,v31
 s_add_u32 s85,s84,53248
 BS v[20:23],v6,s[16:19],s85 offen offset:2048 sc1
 AR v12,a248
 AR v13,a249
 AR v14,a250
 AR v15,a251
 AR v16,a252
 AR v17,a253
 AR v18,a254
 AR v19,a255
 CV v8,v12,v13
 CV v9,v14,v15
 CV v10,v16,v17
 CV v11,v18,v19
 s_add_u32 s85,s84,53248
 BS v[8:11],v6,s[16:19],s85 offen offset:3072 sc1
 CV v128,v128,v129
 CV v129,v130,v131
 CV v130,v132,v133
 CV v131,v134,v135
 AW a152,v128
 AW a153,v129
 AW a154,v130
 AW a155,v131
 CV v136,v136,v137
 CV v137,v138,v139
 CV v138,v140,v141
 CV v139,v142,v143
 AW a156,v136
 AW a157,v137
 AW a158,v138
 AW a159,v139
 CV v144,v144,v145
 CV v145,v146,v147
 CV v146,v148,v149
 CV v147,v150,v151
 AW a160,v144
 AW a161,v145
 AW a162,v146
 AW a163,v147
 CV v152,v152,v153
 CV v153,v154,v155
 CV v154,v156,v157
 CV v155,v158,v159
 AW a164,v152
 AW a165,v153
 AW a166,v154
 AW a167,v155
 CV v160,v160,v161
 CV v161,v162,v163
 CV v162,v164,v165
 CV v163,v166,v167
 AW a168,v160
 AW a169,v161
 AW a170,v162
 AW a171,v163
 CV v168,v168,v169
 CV v169,v170,v171
 CV v170,v172,v173
 CV v171,v174,v175
 AW a172,v168
 AW a173,v169
 AW a174,v170
 AW a175,v171
 CV v176,v176,v177
 CV v177,v178,v179
 CV v178,v180,v181
 CV v179,v182,v183
 AW a176,v176
 AW a177,v177
 AW a178,v178
 AW a179,v179
 CV v184,v184,v185
 CV v185,v186,v187
 CV v186,v188,v189
 CV v187,v190,v191
 AW a180,v184
 AW a181,v185
 AW a182,v186
 AW a183,v187
 CV v192,v192,v193
 CV v193,v194,v195
 CV v194,v196,v197
 CV v195,v198,v199
 AW a184,v192
 AW a185,v193
 AW a186,v194
 AW a187,v195
 CV v200,v200,v201
 CV v201,v202,v203
 CV v202,v72,v73
 CV v203,v74,v75
 CV v204,v204,v205
 CV v205,v206,v207
 CV v206,v76,v77
 CV v207,v78,v79
 CV v208,v208,v209
 CV v209,v210,v211
 CV v210,v80,v81
 CV v211,v82,v83
 CV v212,v212,v213
 CV v213,v214,v215
 CV v214,v84,v85
 CV v215,v86,v87
 CV v216,v216,v217
 CV v217,v218,v219
 CV v218,v88,v89
 CV v219,v90,v91
 CV v220,v220,v221
 CV v221,v222,v223
 CV v222,v92,v93
 CV v223,v94,v95
 CV v224,v224,v225
 CV v225,v226,v227
 CV v226,v96,v97
 CV v227,v98,v99
 CV v228,v228,v229
 CV v229,v230,v231
 CV v230,v100,v101
 CV v231,v102,v103
 CV v232,v232,v233
 CV v233,v234,v235
 CV v234,v104,v105
 CV v235,v106,v107
 CV v236,v236,v237
 CV v237,v238,v239
 CV v238,v108,v109
 CV v239,v110,v111
 CV v240,v240,v241
 CV v241,v242,v243
 CV v242,v112,v113
 CV v243,v114,v115
 CV v244,v244,v245
 CV v245,v246,v247
 CV v246,v116,v117
 CV v247,v118,v119
 CV v248,v248,v249
 CV v249,v250,v251
 CV v250,v120,v121
 CV v251,v122,v123
 CV v252,v252,v253
 CV v253,v254,v255
 CV v254,v124,v125
 CV v255,v126,v127
 s_branch L_g
L_g:
 s_and_b32 s26,s82,1
 s_mul_i32 s26,s26,57344
 s_lshl_b32 s27,s35,11
 s_add_u32 s26,s26,s27
 v_lshlrev_b32 v1,7,v0
 v_add_u32 v1,s26,v1
 v_mov_b32 v2,0x80000000
 v_cmp_gt_u32 vcc,16,v0
 s_nop 1
 v_cndmask_b32 v65,v2,v1,vcc
 s_lshl_b32 s26,s83,2
 s_add_u32 s26,s26,s35
 s_mul_i32 s26,s26,5
 v_add_u32 v1,s26,v0
 v_min_u32 v1,127,v1
 v_lshlrev_b32 v1,12,v1
 v_cmp_gt_u32 vcc,5,v0
 s_nop 1
 v_cndmask_b32 v66,v2,v1,vcc
 s_mov_b32 s4,s62
 s_mov_b32 s5,s63
 s_mov_b32 s6,896
 s_mov_b32 s7,0x20000
 v_lshrrev_b32 v1,4,v0
 v_lshlrev_b32 v1,4,v1
 BL a[188:191],v1,s[4:7],0 offen offset:384
 BL a[192:195],v1,s[4:7],0 offen offset:448
 BL a[196:199],v1,s[4:7],0 offen offset:512
 BL a[200:203],v1,s[4:7],0 offen offset:576
 BL a[204:207],v1,s[4:7],0 offen offset:640
 BL a[208:211],v1,s[4:7],0 offen offset:704
 BL a[212:215],v1,s[4:7],0 offen offset:768
 BL a[216:219],v1,s[4:7],0 offen offset:832
 s_mov_b32 s4,s58
 s_mov_b32 s5,s59
 s_mov_b32 s6,4096
 s_mov_b32 s7,0x20000
 s_and_b32 s27,s35,1
 v_and_b32 v1,15,v0
 s_lshl_b32 s26,s82,7
 s_lshl_b32 s27,s27,6
 s_add_u32 s26,s26,s27
 v_add_lshl_u32 v1,s26,v1,1
 buffer_load_ushort v24,v1,s[4:7],0 offen
 buffer_load_ushort v25,v1,s[4:7],0 offen offset:32
 buffer_load_ushort v26,v1,s[4:7],0 offen offset:64
 buffer_load_ushort v27,v1,s[4:7],0 offen offset:96
 s_waitcnt vmcnt(55)
 s_barrier
 RQ a[0:3],v46 offset:32768
 RT a[64:65],v50
 RT a[66:67],v50 offset:1024
 RT a[68:69],v51
 RT a[70:71],v51 offset:1024
 RT a[72:73],v52
 RT a[74:75],v52 offset:1024
 RT a[76:77],v53
 RT a[78:79],v53 offset:1024
 RQ a[4:7],v46 offset:34816
 RQ a[8:11],v46 offset:36864
 RQ a[12:15],v46 offset:38912
 RQ a[16:19],v47 offset:32768
 RT a[80:81],v50 offset:8192
 RT a[82:83],v50 offset:9216
 RT a[84:85],v51 offset:8192
 RT a[86:87],v51 offset:9216
 RT a[88:89],v52 offset:8192
 RT a[90:91],v52 offset:9216
 RT a[92:93],v53 offset:8192
 RT a[94:95],v53 offset:9216
 RQ a[20:23],v47 offset:34816
 RQ a[24:27],v47 offset:36864
 RQ a[28:31],v47 offset:38912
 s_waitcnt vmcnt(51)
 s_waitcnt lgkmcnt(0)
 s_barrier
 MM v[72:75],a[64:67],a[0:3],0
 RQ a[32:35],v46 offset:49152
 s_waitcnt vmcnt(47)
 MM v[8:11],a[128:131],a[0:3],0
 s_add_u32 m0,s39,81920
 s_nop 0
 BL v42,s[92:95],s37 offen sc1 lds
 MM v[76:79],a[68:71],a[0:3],0
 RT a[96:97],v50 offset:16384
 MM v[80:83],a[72:75],a[0:3],0
 RT a[98:99],v50 offset:17408
 MM v[84:87],a[76:79],a[0:3],0
 RT a[100:101],v51 offset:16384
 MM v[12:15],a[128:131],a[4:7],0
 BL v43,s[92:95],s37 offen offset:1024 sc1 lds
 MM v[88:91],a[64:67],a[4:7],0
 RT a[102:103],v51 offset:17408
 MM v[92:95],a[68:71],a[4:7],0
 RT a[104:105],v52 offset:16384
 MM v[96:99],a[72:75],a[4:7],0
 RT a[106:107],v52 offset:17408
 MM v[100:103],a[76:79],a[4:7],0
 RT a[108:109],v53 offset:16384
 MM v[16:19],a[128:131],a[8:11],0
 BL v44,s[92:95],s37 offen offset:2048 sc1 lds
 MM v[104:107],a[64:67],a[8:11],0
 RT a[110:111],v53 offset:17408
 MM v[108:111],a[68:71],a[8:11],0
 RQ a[36:39],v46 offset:51200
 MM v[112:115],a[72:75],a[8:11],0
 RQ a[40:43],v46 offset:53248
 MM v[116:119],a[76:79],a[8:11],0
 RQ a[44:47],v46 offset:55296
 MM v[20:23],a[128:131],a[12:15],0
 BL v45,s[92:95],s37 offen offset:3072 sc1 lds
 MM v[120:123],a[64:67],a[12:15],0
 RQ a[48:51],v47 offset:49152
 s_add_u32 s37,s37,229376
 MM v[124:127],a[68:71],a[12:15],0
 RT a[112:113],v50 offset:24576
 MM v[128:131],a[72:75],a[12:15],0
 RT a[114:115],v50 offset:25600
 s_add_u32 m0,s38,32768
 MM v[132:135],a[76:79],a[12:15],0
 RT a[116:117],v51 offset:24576
 s_waitcnt vmcnt(50)
 MM v[8:11],a[132:135],a[16:19],v[8:11]
 BL v38,s[88:91],s36 offen  lds
 MM v[72:75],a[80:83],a[16:19],v[72:75]
 RT a[118:119],v51 offset:25600
 MM v[76:79],a[84:87],a[16:19],v[76:79]
 RT a[120:121],v52 offset:24576
 MM v[80:83],a[88:91],a[16:19],v[80:83]
 RT a[122:123],v52 offset:25600
 MM v[12:15],a[132:135],a[20:23],v[12:15]
 BS v[200:203],v6,s[16:19],s84 offen sc1
 MM v[84:87],a[92:95],a[16:19],v[84:87]
 RT a[124:125],v53 offset:24576
 MM v[16:19],a[132:135],a[24:27],v[16:19]
 BL v39,s[88:91],s36 offen offset:1024  lds
 MM v[88:91],a[80:83],a[20:23],v[88:91]
 RT a[126:127],v53 offset:25600
 MM v[92:95],a[84:87],a[20:23],v[92:95]
 RQ a[52:55],v47 offset:51200
 MM v[96:99],a[88:91],a[20:23],v[96:99]
 RQ a[56:59],v47 offset:53248
 MM v[100:103],a[92:95],a[20:23],v[100:103]
 RQ a[60:63],v47 offset:55296
 MM v[20:23],a[132:135],a[28:31],v[20:23]
 BL v40,s[88:91],s36 offen offset:2048  lds
 MM v[104:107],a[80:83],a[24:27],v[104:107]
 BS v[204:207],v6,s[16:19],s84 offen offset:1024 sc1
 MM v[108:111],a[84:87],a[24:27],v[108:111]
 MM v[112:115],a[88:91],a[24:27],v[112:115]
 MM v[116:119],a[92:95],a[24:27],v[116:119]
 BL v41,s[88:91],s36 offen offset:3072  lds
 MM v[120:123],a[80:83],a[28:31],v[120:123]
 s_add_u32 s36,s36,128
 MM v[124:127],a[84:87],a[28:31],v[124:127]
 MM v[128:131],a[88:91],a[28:31],v[128:131]
 MM v[132:135],a[92:95],a[28:31],v[132:135]
 s_waitcnt vmcnt(47)
 s_waitcnt lgkmcnt(0)
 s_barrier
 MM v[72:75],a[96:99],a[32:35],v[72:75]
 RQ a[0:3],v48
 MM v[8:11],a[136:139],a[32:35],v[8:11]
 s_add_u32 m0,s39,98304
 s_nop 0
 BL v42,s[92:95],s37 offen sc1 lds
 MM v[76:79],a[100:103],a[32:35],v[76:79]
 RT a[64:65],v50 offset:32768
 MM v[80:83],a[104:107],a[32:35],v[80:83]
 RT a[66:67],v50 offset:33792
 MM v[84:87],a[108:111],a[32:35],v[84:87]
 RT a[68:69],v51 offset:32768
 MM v[12:15],a[136:139],a[36:39],v[12:15]
 BL v43,s[92:95],s37 offen offset:1024 sc1 lds
 MM v[88:91],a[96:99],a[36:39],v[88:91]
 RT a[70:71],v51 offset:33792
 MM v[92:95],a[100:103],a[36:39],v[92:95]
 RT a[72:73],v52 offset:32768
 MM v[96:99],a[104:107],a[36:39],v[96:99]
 RT a[74:75],v52 offset:33792
 MM v[100:103],a[108:111],a[36:39],v[100:103]
 RT a[76:77],v53 offset:32768
 MM v[16:19],a[136:139],a[40:43],v[16:19]
 BL v44,s[92:95],s37 offen offset:2048 sc1 lds
 MM v[104:107],a[96:99],a[40:43],v[104:107]
 RT a[78:79],v53 offset:33792
 MM v[108:111],a[100:103],a[40:43],v[108:111]
 RQ a[4:7],v48 offset:2048
 MM v[112:115],a[104:107],a[40:43],v[112:115]
 RQ a[8:11],v48 offset:4096
 MM v[116:119],a[108:111],a[40:43],v[116:119]
 RQ a[12:15],v48 offset:6144
 MM v[20:23],a[136:139],a[44:47],v[20:23]
 BL v45,s[92:95],s37 offen offset:3072 sc1 lds
 MM v[120:123],a[96:99],a[44:47],v[120:123]
 RQ a[16:19],v49
 s_add_u32 s37,s37,229376
 MM v[124:127],a[100:103],a[44:47],v[124:127]
 RT a[80:81],v50 offset:40960
 MM v[128:131],a[104:107],a[44:47],v[128:131]
 RT a[82:83],v50 offset:41984
 s_add_u32 m0,s38,49152
 MM v[132:135],a[108:111],a[44:47],v[132:135]
 RT a[84:85],v51 offset:40960
 MM v[8:11],a[140:143],a[48:51],v[8:11]
 BL v38,s[88:91],s36 offen  lds
 MM v[72:75],a[112:115],a[48:51],v[72:75]
 RT a[86:87],v51 offset:41984
 MM v[76:79],a[116:119],a[48:51],v[76:79]
 RT a[88:89],v52 offset:40960
 MM v[80:83],a[120:123],a[48:51],v[80:83]
 RT a[90:91],v52 offset:41984
 MM v[12:15],a[140:143],a[52:55],v[12:15]
 BS v[208:211],v6,s[16:19],s84 offen offset:2048 sc1
 MM v[84:87],a[124:127],a[48:51],v[84:87]
 RT a[92:93],v53 offset:40960
 MM v[16:19],a[140:143],a[56:59],v[16:19]
 BL v39,s[88:91],s36 offen offset:1024  lds
 MM v[88:91],a[112:115],a[52:55],v[88:91]
 RT a[94:95],v53 offset:41984
 MM v[92:95],a[116:119],a[52:55],v[92:95]
 RQ a[20:23],v49 offset:2048
 MM v[96:99],a[120:123],a[52:55],v[96:99]
 RQ a[24:27],v49 offset:4096
 MM v[100:103],a[124:127],a[52:55],v[100:103]
 RQ a[28:31],v49 offset:6144
 MM v[20:23],a[140:143],a[60:63],v[20:23]
 BL v40,s[88:91],s36 offen offset:2048  lds
 MM v[104:107],a[112:115],a[56:59],v[104:107]
 BS v[212:215],v6,s[16:19],s84 offen offset:3072 sc1
 MM v[108:111],a[116:119],a[56:59],v[108:111]
 MM v[112:115],a[120:123],a[56:59],v[112:115]
 MM v[116:119],a[124:127],a[56:59],v[116:119]
 BL v41,s[88:91],s36 offen offset:3072  lds
 MM v[120:123],a[112:115],a[60:63],v[120:123]
 s_add_u32 s36,s36,128
 MM v[124:127],a[116:119],a[60:63],v[124:127]
 MM v[128:131],a[120:123],a[60:63],v[128:131]
 MM v[132:135],a[124:127],a[60:63],v[132:135]
 s_waitcnt vmcnt(49)
 s_waitcnt lgkmcnt(0)
 s_barrier
 MM v[72:75],a[64:67],a[0:3],v[72:75]
 RQ a[32:35],v46
 MM v[76:79],a[68:71],a[0:3],v[76:79]
 RT a[96:97],v50 offset:49152
 MM v[80:83],a[72:75],a[0:3],v[80:83]
 RT a[98:99],v50 offset:50176
 MM v[84:87],a[76:79],a[0:3],v[84:87]
 RT a[100:101],v51 offset:49152
 MM v[88:91],a[64:67],a[4:7],v[88:91]
 RT a[102:103],v51 offset:50176
 MM v[92:95],a[68:71],a[4:7],v[92:95]
 RT a[104:105],v52 offset:49152
 MM v[96:99],a[72:75],a[4:7],v[96:99]
 RT a[106:107],v52 offset:50176
 MM v[100:103],a[76:79],a[4:7],v[100:103]
 RT a[108:109],v53 offset:49152
 MM v[104:107],a[64:67],a[8:11],v[104:107]
 RT a[110:111],v53 offset:50176
 MM v[108:111],a[68:71],a[8:11],v[108:111]
 RQ a[36:39],v46 offset:2048
 MM v[112:115],a[72:75],a[8:11],v[112:115]
 RQ a[40:43],v46 offset:4096
 MM v[116:119],a[76:79],a[8:11],v[116:119]
 RQ a[44:47],v46 offset:6144
 MM v[120:123],a[64:67],a[12:15],v[120:123]
 RQ a[48:51],v47
 MM v[124:127],a[68:71],a[12:15],v[124:127]
 RT a[112:113],v50 offset:57344
 MM v[128:131],a[72:75],a[12:15],v[128:131]
 RT a[114:115],v50 offset:58368
 MM v[132:135],a[76:79],a[12:15],v[132:135]
 RT a[116:117],v51 offset:57344
 MM v[72:75],a[80:83],a[16:19],v[72:75]
 RT a[118:119],v51 offset:58368
 MM v[76:79],a[84:87],a[16:19],v[76:79]
 RT a[120:121],v52 offset:57344
 MM v[80:83],a[88:91],a[16:19],v[80:83]
 RT a[122:123],v52 offset:58368
 s_add_u32 s84,s84,4096
 MM v[8:11],a[144:147],a[0:3],v[8:11]
 s_add_u32 s84,s84,s29
 BS v[216:219],v6,s[16:19],s84 offen sc1
 MM v[84:87],a[92:95],a[16:19],v[84:87]
 RT a[124:125],v53 offset:57344
 MM v[88:91],a[80:83],a[20:23],v[88:91]
 RT a[126:127],v53 offset:58368
 MM v[92:95],a[84:87],a[20:23],v[92:95]
 RQ a[52:55],v47 offset:2048
 MM v[96:99],a[88:91],a[20:23],v[96:99]
 RQ a[56:59],v47 offset:4096
 MM v[100:103],a[92:95],a[20:23],v[100:103]
 RQ a[60:63],v47 offset:6144
 s_mov_b32 s88,s56
 s_mov_b32 s89,s57
 MM v[12:15],a[144:147],a[4:7],v[12:15]
 s_mov_b32 s90,8388608
 s_mov_b32 s91,0x20000
 s_lshl_b32 s36,s82,19
 s_add_u32 m0,s38,65536
 MM v[104:107],a[80:83],a[24:27],v[104:107]
 BL v58,s[88:91],s36 offen  lds
 MM v[108:111],a[84:87],a[24:27],v[108:111]
 BL v59,s[88:91],s36 offen offset:1024  lds
 MM v[112:115],a[88:91],a[24:27],v[112:115]
 BS v[220:223],v6,s[16:19],s84 offen offset:1024 sc1
 MM v[116:119],a[92:95],a[24:27],v[116:119]
 BL v60,s[88:91],s36 offen offset:2048  lds
 MM v[120:123],a[80:83],a[28:31],v[120:123]
 MM v[124:127],a[84:87],a[28:31],v[124:127]
 BL v61,s[88:91],s36 offen offset:3072  lds
 MM v[128:131],a[88:91],a[28:31],v[128:131]
 s_add_u32 s36,s36,128
 MM v[132:135],a[92:95],a[28:31],v[132:135]
 MM v[16:19],a[144:147],a[8:11],v[16:19]
 MM v[20:23],a[144:147],a[12:15],v[20:23]
 MM v[8:11],a[148:151],a[16:19],v[8:11]
 MM v[12:15],a[148:151],a[20:23],v[12:15]
 MM v[16:19],a[148:151],a[24:27],v[16:19]
 MM v[20:23],a[148:151],a[28:31],v[20:23]
 s_waitcnt vmcnt(47)
 s_waitcnt lgkmcnt(0)
 s_barrier
 MM v[72:75],a[96:99],a[32:35],v[72:75]
 RQ a[0:3],v46 offset:16384
 MM v[76:79],a[100:103],a[32:35],v[76:79]
 RT a[64:65],v54
 MM v[80:83],a[104:107],a[32:35],v[80:83]
 RT a[66:67],v54 offset:1024
 MM v[84:87],a[108:111],a[32:35],v[84:87]
 RT a[68:69],v55
 MM v[88:91],a[96:99],a[36:39],v[88:91]
 RT a[70:71],v55 offset:1024
 MM v[92:95],a[100:103],a[36:39],v[92:95]
 RT a[72:73],v56
 MM v[96:99],a[104:107],a[36:39],v[96:99]
 RT a[74:75],v56 offset:1024
 MM v[100:103],a[108:111],a[36:39],v[100:103]
 RT a[76:77],v57
 MM v[104:107],a[96:99],a[40:43],v[104:107]
 RT a[78:79],v57 offset:1024
 MM v[108:111],a[100:103],a[40:43],v[108:111]
 RQ a[4:7],v46 offset:18432
 MM v[112:115],a[104:107],a[40:43],v[112:115]
 RQ a[8:11],v46 offset:20480
 MM v[116:119],a[108:111],a[40:43],v[116:119]
 RQ a[12:15],v46 offset:22528
 MM v[120:123],a[96:99],a[44:47],v[120:123]
 RQ a[16:19],v47 offset:16384
 MM v[124:127],a[100:103],a[44:47],v[124:127]
 RT a[80:81],v54 offset:8192
 MM v[128:131],a[104:107],a[44:47],v[128:131]
 RT a[82:83],v54 offset:9216
 MM v[132:135],a[108:111],a[44:47],v[132:135]
 RT a[84:85],v55 offset:8192
 MM v[72:75],a[112:115],a[48:51],v[72:75]
 RT a[86:87],v55 offset:9216
 MM v[76:79],a[116:119],a[48:51],v[76:79]
 RT a[88:89],v56 offset:8192
 MM v[80:83],a[120:123],a[48:51],v[80:83]
 RT a[90:91],v56 offset:9216
 s_waitcnt vmcnt(37)
 MM v[8:11],a[188:191],a[32:35],v[8:11]
 BS v[224:227],v6,s[16:19],s84 offen offset:2048 sc1
 MM v[84:87],a[124:127],a[48:51],v[84:87]
 RT a[92:93],v57 offset:8192
 MM v[88:91],a[112:115],a[52:55],v[88:91]
 RT a[94:95],v57 offset:9216
 MM v[92:95],a[116:119],a[52:55],v[92:95]
 RQ a[20:23],v47 offset:18432
 MM v[96:99],a[120:123],a[52:55],v[96:99]
 RQ a[24:27],v47 offset:20480
 MM v[100:103],a[124:127],a[52:55],v[100:103]
 RQ a[28:31],v47 offset:22528
 s_add_u32 m0,s38,0
 MM v[104:107],a[112:115],a[56:59],v[104:107]
 BL v58,s[88:91],s36 offen  lds
 MM v[108:111],a[116:119],a[56:59],v[108:111]
 BL v59,s[88:91],s36 offen offset:1024  lds
 MM v[112:115],a[120:123],a[56:59],v[112:115]
 BS v[228:231],v6,s[16:19],s84 offen offset:3072 sc1
 MM v[116:119],a[124:127],a[56:59],v[116:119]
 BL v60,s[88:91],s36 offen offset:2048  lds
 MM v[120:123],a[112:115],a[60:63],v[120:123]
 MM v[124:127],a[116:119],a[60:63],v[124:127]
 BL v61,s[88:91],s36 offen offset:3072  lds
 MM v[128:131],a[120:123],a[60:63],v[128:131]
 s_add_u32 s36,s36,128
 MM v[132:135],a[124:127],a[60:63],v[132:135]
 MM v[12:15],a[188:191],a[36:39],v[12:15]
 MM v[16:19],a[188:191],a[40:43],v[16:19]
 MM v[20:23],a[188:191],a[44:47],v[20:23]
 s_waitcnt vmcnt(42)
 MM v[8:11],a[192:195],a[48:51],v[8:11]
 MM v[12:15],a[192:195],a[52:55],v[12:15]
 MM v[16:19],a[192:195],a[56:59],v[16:19]
 MM v[20:23],a[192:195],a[60:63],v[20:23]
 s_waitcnt vmcnt(22)
 s_waitcnt lgkmcnt(0)
 s_barrier
 MM v[72:75],a[64:67],a[0:3],v[72:75]
 RQ a[32:35],v46 offset:32768
 MM v[76:79],a[68:71],a[0:3],v[76:79]
 RT a[96:97],v50
 MM v[80:83],a[72:75],a[0:3],v[80:83]
 RT a[98:99],v50 offset:1024
 MM v[84:87],a[76:79],a[0:3],v[84:87]
 RT a[100:101],v51
 MM v[88:91],a[64:67],a[4:7],v[88:91]
 RT a[102:103],v51 offset:1024
 MM v[92:95],a[68:71],a[4:7],v[92:95]
 RT a[104:105],v52
 MM v[96:99],a[72:75],a[4:7],v[96:99]
 RT a[106:107],v52 offset:1024
 MM v[100:103],a[76:79],a[4:7],v[100:103]
 RT a[108:109],v53
 MM v[104:107],a[64:67],a[8:11],v[104:107]
 RT a[110:111],v53 offset:1024
 MM v[108:111],a[68:71],a[8:11],v[108:111]
 RQ a[36:39],v46 offset:34816
 MM v[112:115],a[72:75],a[8:11],v[112:115]
 RQ a[40:43],v46 offset:36864
 MM v[116:119],a[76:79],a[8:11],v[116:119]
 RQ a[44:47],v46 offset:38912
 MM v[120:123],a[64:67],a[12:15],v[120:123]
 RQ a[48:51],v47 offset:32768
 MM v[124:127],a[68:71],a[12:15],v[124:127]
 RT a[112:113],v50 offset:8192
 MM v[128:131],a[72:75],a[12:15],v[128:131]
 RT a[114:115],v50 offset:9216
 MM v[132:135],a[76:79],a[12:15],v[132:135]
 RT a[116:117],v51 offset:8192
 MM v[72:75],a[80:83],a[16:19],v[72:75]
 RT a[118:119],v51 offset:9216
 MM v[76:79],a[84:87],a[16:19],v[76:79]
 RT a[120:121],v52 offset:8192
 MM v[80:83],a[88:91],a[16:19],v[80:83]
 RT a[122:123],v52 offset:9216
 s_add_u32 s84,s84,4096
 MM v[8:11],a[196:199],a[0:3],v[8:11]
 s_add_u32 s84,s84,s30
 BS v[232:235],v6,s[16:19],s84 offen sc1
 MM v[84:87],a[92:95],a[16:19],v[84:87]
 RT a[124:125],v53 offset:8192
 MM v[88:91],a[80:83],a[20:23],v[88:91]
 RT a[126:127],v53 offset:9216
 MM v[92:95],a[84:87],a[20:23],v[92:95]
 RQ a[52:55],v47 offset:34816
 MM v[96:99],a[88:91],a[20:23],v[96:99]
 RQ a[56:59],v47 offset:36864
 MM v[100:103],a[92:95],a[20:23],v[100:103]
 RQ a[60:63],v47 offset:38912
 s_add_u32 m0,s38,16384
 MM v[104:107],a[80:83],a[24:27],v[104:107]
 BL v58,s[88:91],s36 offen  lds
 MM v[108:111],a[84:87],a[24:27],v[108:111]
 BL v59,s[88:91],s36 offen offset:1024  lds
 MM v[112:115],a[88:91],a[24:27],v[112:115]
 BS v[236:239],v6,s[16:19],s84 offen offset:1024 sc1
 MM v[116:119],a[92:95],a[24:27],v[116:119]
 BL v60,s[88:91],s36 offen offset:2048  lds
 MM v[120:123],a[80:83],a[28:31],v[120:123]
 MM v[124:127],a[84:87],a[28:31],v[124:127]
 BL v61,s[88:91],s36 offen offset:3072  lds
 MM v[128:131],a[88:91],a[28:31],v[128:131]
 s_add_u32 s36,s36,128
 MM v[132:135],a[92:95],a[28:31],v[132:135]
 MM v[12:15],a[196:199],a[4:7],v[12:15]
 MM v[16:19],a[196:199],a[8:11],v[16:19]
 MM v[20:23],a[196:199],a[12:15],v[20:23]
 MM v[8:11],a[200:203],a[16:19],v[8:11]
 MM v[12:15],a[200:203],a[20:23],v[12:15]
 MM v[16:19],a[200:203],a[24:27],v[16:19]
 MM v[20:23],a[200:203],a[28:31],v[20:23]
 v_mov_b32 v70,0
 global_load_dword v71,v70,s[66:67] sc1
 s_waitcnt vmcnt(19)
 s_waitcnt lgkmcnt(0)
 s_barrier
 MM v[72:75],a[96:99],a[32:35],v[72:75]
 RQ a[0:3],v46 offset:49152
 MM v[76:79],a[100:103],a[32:35],v[76:79]
 RT a[64:65],v50 offset:16384
 MM v[80:83],a[104:107],a[32:35],v[80:83]
 RT a[66:67],v50 offset:17408
 MM v[84:87],a[108:111],a[32:35],v[84:87]
 RT a[68:69],v51 offset:16384
 MM v[88:91],a[96:99],a[36:39],v[88:91]
 RT a[70:71],v51 offset:17408
 MM v[92:95],a[100:103],a[36:39],v[92:95]
 RT a[72:73],v52 offset:16384
 MM v[96:99],a[104:107],a[36:39],v[96:99]
 RT a[74:75],v52 offset:17408
 MM v[100:103],a[108:111],a[36:39],v[100:103]
 RT a[76:77],v53 offset:16384
 MM v[104:107],a[96:99],a[40:43],v[104:107]
 RT a[78:79],v53 offset:17408
 MM v[108:111],a[100:103],a[40:43],v[108:111]
 RQ a[4:7],v46 offset:51200
 MM v[112:115],a[104:107],a[40:43],v[112:115]
 RQ a[8:11],v46 offset:53248
 MM v[116:119],a[108:111],a[40:43],v[116:119]
 RQ a[12:15],v46 offset:55296
 MM v[120:123],a[96:99],a[44:47],v[120:123]
 RQ a[16:19],v47 offset:49152
 MM v[124:127],a[100:103],a[44:47],v[124:127]
 RT a[80:81],v50 offset:24576
 MM v[128:131],a[104:107],a[44:47],v[128:131]
 RT a[82:83],v50 offset:25600
 MM v[132:135],a[108:111],a[44:47],v[132:135]
 RT a[84:85],v51 offset:24576
 MM v[72:75],a[112:115],a[48:51],v[72:75]
 RT a[86:87],v51 offset:25600
 MM v[76:79],a[116:119],a[48:51],v[76:79]
 RT a[88:89],v52 offset:24576
 MM v[80:83],a[120:123],a[48:51],v[80:83]
 RT a[90:91],v52 offset:25600
 MM v[8:11],a[204:207],a[32:35],v[8:11]
 BS v[240:243],v6,s[16:19],s84 offen offset:2048 sc1
 MM v[84:87],a[124:127],a[48:51],v[84:87]
 RT a[92:93],v53 offset:24576
 MM v[88:91],a[112:115],a[52:55],v[88:91]
 RT a[94:95],v53 offset:25600
 MM v[92:95],a[116:119],a[52:55],v[92:95]
 RQ a[20:23],v47 offset:51200
 MM v[96:99],a[120:123],a[52:55],v[96:99]
 RQ a[24:27],v47 offset:53248
 MM v[100:103],a[124:127],a[52:55],v[100:103]
 RQ a[28:31],v47 offset:55296
 s_add_u32 m0,s38,32768
 MM v[104:107],a[112:115],a[56:59],v[104:107]
 BL v58,s[88:91],s36 offen  lds
 MM v[108:111],a[116:119],a[56:59],v[108:111]
 BL v59,s[88:91],s36 offen offset:1024  lds
 MM v[112:115],a[120:123],a[56:59],v[112:115]
 BS v[244:247],v6,s[16:19],s84 offen offset:3072 sc1
 MM v[116:119],a[124:127],a[56:59],v[116:119]
 BL v60,s[88:91],s36 offen offset:2048  lds
 MM v[120:123],a[112:115],a[60:63],v[120:123]
 MM v[124:127],a[116:119],a[60:63],v[124:127]
 BL v61,s[88:91],s36 offen offset:3072  lds
 MM v[128:131],a[120:123],a[60:63],v[128:131]
 s_add_u32 s36,s36,128
 MM v[132:135],a[124:127],a[60:63],v[132:135]
 MM v[12:15],a[204:207],a[36:39],v[12:15]
 MM v[16:19],a[204:207],a[40:43],v[16:19]
 MM v[20:23],a[204:207],a[44:47],v[20:23]
 MM v[8:11],a[208:211],a[48:51],v[8:11]
 MM v[12:15],a[208:211],a[52:55],v[12:15]
 MM v[16:19],a[208:211],a[56:59],v[16:19]
 MM v[20:23],a[208:211],a[60:63],v[20:23]
 s_waitcnt lgkmcnt(0)
 s_barrier
 MM v[72:75],a[64:67],a[0:3],v[72:75]
 s_add_u32 s84,s84,4096
 MM v[8:11],a[212:215],a[0:3],v[8:11]
 s_add_u32 s84,s84,s29
 BS v[248:251],v6,s[16:19],s84 offen sc1
 MM v[76:79],a[68:71],a[0:3],v[76:79]
 MM v[80:83],a[72:75],a[0:3],v[80:83]
 MM v[84:87],a[76:79],a[0:3],v[84:87]
 MM v[88:91],a[64:67],a[4:7],v[88:91]
 MM v[92:95],a[68:71],a[4:7],v[92:95]
 MM v[96:99],a[72:75],a[4:7],v[96:99]
 MM v[100:103],a[76:79],a[4:7],v[100:103]
 MM v[104:107],a[64:67],a[8:11],v[104:107]
 MM v[108:111],a[68:71],a[8:11],v[108:111]
 MM v[112:115],a[72:75],a[8:11],v[112:115]
 MM v[116:119],a[76:79],a[8:11],v[116:119]
 MM v[120:123],a[64:67],a[12:15],v[120:123]
 MM v[124:127],a[68:71],a[12:15],v[124:127]
 MM v[128:131],a[72:75],a[12:15],v[128:131]
 MM v[132:135],a[76:79],a[12:15],v[132:135]
 MM v[72:75],a[80:83],a[16:19],v[72:75]
 BS v[252:255],v6,s[16:19],s84 offen offset:1024 sc1
 MM v[76:79],a[84:87],a[16:19],v[76:79]
 MM v[80:83],a[88:91],a[16:19],v[80:83]
 MM v[84:87],a[92:95],a[16:19],v[84:87]
 MM v[88:91],a[80:83],a[20:23],v[88:91]
 MM v[92:95],a[84:87],a[20:23],v[92:95]
 MM v[96:99],a[88:91],a[20:23],v[96:99]
 MM v[100:103],a[92:95],a[20:23],v[100:103]
 s_add_u32 m0,s38,49152
 MM v[104:107],a[80:83],a[24:27],v[104:107]
 BL v58,s[88:91],s36 offen  lds
 MM v[108:111],a[84:87],a[24:27],v[108:111]
 BL v59,s[88:91],s36 offen offset:1024  lds
 MM v[112:115],a[88:91],a[24:27],v[112:115]
 MM v[116:119],a[92:95],a[24:27],v[116:119]
 BL v60,s[88:91],s36 offen offset:2048  lds
 MM v[120:123],a[80:83],a[28:31],v[120:123]
 MM v[124:127],a[84:87],a[28:31],v[124:127]
 BL v61,s[88:91],s36 offen offset:3072  lds
 MM v[128:131],a[88:91],a[28:31],v[128:131]
 s_add_u32 s36,s36,128
 MM v[132:135],a[92:95],a[28:31],v[132:135]
 MM v[12:15],a[212:215],a[4:7],v[12:15]
 MM v[16:19],a[212:215],a[8:11],v[16:19]
 MM v[20:23],a[212:215],a[12:15],v[20:23]
 MM v[8:11],a[216:219],a[16:19],v[8:11]
 MM v[12:15],a[216:219],a[20:23],v[12:15]
 MM v[16:19],a[216:219],a[24:27],v[16:19]
 MM v[20:23],a[216:219],a[28:31],v[20:23]
 s_mov_b32 s27,0
wz_chk:
 s_waitcnt vmcnt(12)
 v_cmp_le_u32 vcc,32,v71
 s_nop 1
 s_cmp_eq_u64 vcc,-1
 s_cbranch_scc1 wz_ok
 s_add_u32 s27,s27,1
 s_cmp_ge_u32 s27,400000
 s_cbranch_scc1 wz_ok
 s_sleep 1
 global_load_dword v71,v70,s[66:67] sc1
 s_waitcnt vmcnt(0)
 s_branch wz_chk
wz_ok:
 s_add_u32 s92,s68,71303168
 s_addc_u32 s93,s69,0
 s_mov_b32 s94,3670016
 s_mov_b32 s95,0x20000
 s_lshl_b32 s37,s83,13
 s_add_u32 m0,s39,114688
 s_nop 0
 BL v62,s[92:95],s37 offen sc1 lds
 v_mov_b32 v28,0xc0135761
 BS a[152:155],v6,s[16:19],s84 offen offset:2048 sc1
 v_mov_b32 v29,0xc0135761
 v_mov_b32 v30,0xbdd2d3e8
 v_mov_b32 v31,0xbdd2d3e8
 PM v[200:201],v[72:73],v[72:73]
 PM v[202:203],v[74:75],v[74:75]
 PM v[204:205],v[76:77],v[76:77]
 PM v[206:207],v[78:79],v[78:79]
 PM v[208:209],v[80:81],v[80:81]
 PM v[210:211],v[82:83],v[82:83]
 PM v[212:213],v[84:85],v[84:85]
 BS a[156:159],v6,s[16:19],s84 offen offset:3072 sc1
 PM v[214:215],v[86:87],v[86:87]
 v_pk_fma_f32 v[200:201],v[200:201],v[30:31],v[28:29]
 v_pk_fma_f32 v[202:203],v[202:203],v[30:31],v[28:29]
 v_pk_fma_f32 v[204:205],v[204:205],v[30:31],v[28:29]
 v_pk_fma_f32 v[206:207],v[206:207],v[30:31],v[28:29]
 v_pk_fma_f32 v[208:209],v[208:209],v[30:31],v[28:29]
 v_pk_fma_f32 v[210:211],v[210:211],v[30:31],v[28:29]
 v_pk_fma_f32 v[212:213],v[212:213],v[30:31],v[28:29]
 v_pk_fma_f32 v[214:215],v[214:215],v[30:31],v[28:29]
 PM v[200:201],v[200:201],v[72:73]
 PM v[202:203],v[202:203],v[74:75]
 s_add_u32 s84,s84,4096
 s_add_u32 s84,s84,s30
 BS a[160:163],v6,s[16:19],s84 offen sc1
 PM v[204:205],v[204:205],v[76:77]
 PM v[206:207],v[206:207],v[78:79]
 PM v[208:209],v[208:209],v[80:81]
 PM v[210:211],v[210:211],v[82:83]
 PM v[212:213],v[212:213],v[84:85]
 PM v[214:215],v[214:215],v[86:87]
 v_exp_f32 v200,v200
 v_exp_f32 v201,v201
 v_exp_f32 v202,v202
 v_exp_f32 v203,v203
 v_exp_f32 v204,v204
 BS a[164:167],v6,s[16:19],s84 offen offset:1024 sc1
 v_exp_f32 v205,v205
 v_exp_f32 v206,v206
 v_exp_f32 v207,v207
 v_exp_f32 v208,v208
 v_exp_f32 v209,v209
 v_exp_f32 v210,v210
 v_exp_f32 v211,v211
 v_exp_f32 v212,v212
 v_exp_f32 v213,v213
 v_exp_f32 v214,v214
 BS a[168:171],v6,s[16:19],s84 offen offset:2048 sc1
 v_exp_f32 v215,v215
 v_pk_add_f32 v[200:201],v[200:201],1.0 op_sel_hi:[1,0]
 v_pk_add_f32 v[202:203],v[202:203],1.0 op_sel_hi:[1,0]
 v_pk_add_f32 v[204:205],v[204:205],1.0 op_sel_hi:[1,0]
 v_pk_add_f32 v[206:207],v[206:207],1.0 op_sel_hi:[1,0]
 v_pk_add_f32 v[208:209],v[208:209],1.0 op_sel_hi:[1,0]
 v_pk_add_f32 v[210:211],v[210:211],1.0 op_sel_hi:[1,0]
 v_pk_add_f32 v[212:213],v[212:213],1.0 op_sel_hi:[1,0]
 v_pk_add_f32 v[214:215],v[214:215],1.0 op_sel_hi:[1,0]
 v_rcp_f32 v200,v200
 v_rcp_f32 v201,v201
 BS a[172:175],v6,s[16:19],s84 offen offset:3072 sc1
 v_rcp_f32 v202,v202
 v_rcp_f32 v203,v203
 v_rcp_f32 v204,v204
 v_rcp_f32 v205,v205
 v_rcp_f32 v206,v206
 v_rcp_f32 v207,v207
 v_rcp_f32 v208,v208
 v_rcp_f32 v209,v209
 v_rcp_f32 v210,v210
 v_rcp_f32 v211,v211
 v_rcp_f32 v212,v212
 s_add_u32 s84,s84,4096
 s_add_u32 s84,s84,s29
 BS a[176:179],v6,s[16:19],s84 offen sc1
 v_rcp_f32 v213,v213
 v_rcp_f32 v214,v214
 v_rcp_f32 v215,v215
 PM v[72:73],v[72:73],v[200:201]
 PM v[74:75],v[74:75],v[202:203]
 PM v[76:77],v[76:77],v[204:205]
 PM v[78:79],v[78:79],v[206:207]
 PM v[80:81],v[80:81],v[208:209]
 PM v[82:83],v[82:83],v[210:211]
 PM v[84:85],v[84:85],v[212:213]
 PM v[86:87],v[86:87],v[214:215]
 BS a[180:183],v6,s[16:19],s84 offen offset:1024 sc1
 PM v[200:201],v[88:89],v[88:89]
 PM v[202:203],v[90:91],v[90:91]
 PM v[204:205],v[92:93],v[92:93]
 PM v[206:207],v[94:95],v[94:95]
 PM v[208:209],v[96:97],v[96:97]
 PM v[210:211],v[98:99],v[98:99]
 PM v[212:213],v[100:101],v[100:101]
 PM v[214:215],v[102:103],v[102:103]
 v_pk_fma_f32 v[200:201],v[200:201],v[30:31],v[28:29]
 v_pk_fma_f32 v[202:203],v[202:203],v[30:31],v[28:29]
 BS a[184:187],v6,s[16:19],s84 offen offset:2048 sc1
 v_pk_fma_f32 v[204:205],v[204:205],v[30:31],v[28:29]
 v_pk_fma_f32 v[206:207],v[206:207],v[30:31],v[28:29]
 v_pk_fma_f32 v[208:209],v[208:209],v[30:31],v[28:29]
 v_pk_fma_f32 v[210:211],v[210:211],v[30:31],v[28:29]
 v_pk_fma_f32 v[212:213],v[212:213],v[30:31],v[28:29]
 v_pk_fma_f32 v[214:215],v[214:215],v[30:31],v[28:29]
 PM v[200:201],v[200:201],v[88:89]
 PM v[202:203],v[202:203],v[90:91]
 PM v[204:205],v[204:205],v[92:93]
 PM v[206:207],v[206:207],v[94:95]
 PM v[208:209],v[208:209],v[96:97]
 BL v62,s[92:95],s37 offen offset:1024 sc1 lds
 PM v[210:211],v[210:211],v[98:99]
 PM v[212:213],v[212:213],v[100:101]
 PM v[214:215],v[214:215],v[102:103]
 v_exp_f32 v200,v200
 v_exp_f32 v201,v201
 v_exp_f32 v202,v202
 v_exp_f32 v203,v203
 v_exp_f32 v204,v204
 v_exp_f32 v205,v205
 v_exp_f32 v206,v206
 v_exp_f32 v207,v207
 BL v62,s[92:95],s37 offen offset:2048 sc1 lds
 v_exp_f32 v208,v208
 v_exp_f32 v209,v209
 v_exp_f32 v210,v210
 v_exp_f32 v211,v211
 v_exp_f32 v212,v212
 v_exp_f32 v213,v213
 v_exp_f32 v214,v214
 v_exp_f32 v215,v215
 v_pk_add_f32 v[200:201],v[200:201],1.0 op_sel_hi:[1,0]
 v_pk_add_f32 v[202:203],v[202:203],1.0 op_sel_hi:[1,0]
 BL v62,s[92:95],s37 offen offset:3072 sc1 lds
 s_add_u32 s37,s37,114688
 v_pk_add_f32 v[204:205],v[204:205],1.0 op_sel_hi:[1,0]
 v_pk_add_f32 v[206:207],v[206:207],1.0 op_sel_hi:[1,0]
 v_pk_add_f32 v[208:209],v[208:209],1.0 op_sel_hi:[1,0]
 v_pk_add_f32 v[210:211],v[210:211],1.0 op_sel_hi:[1,0]
 v_pk_add_f32 v[212:213],v[212:213],1.0 op_sel_hi:[1,0]
 v_pk_add_f32 v[214:215],v[214:215],1.0 op_sel_hi:[1,0]
 v_rcp_f32 v200,v200
 v_rcp_f32 v201,v201
 v_rcp_f32 v202,v202
 v_rcp_f32 v203,v203
 v_rcp_f32 v204,v204
 s_add_u32 m0,s39,131072
 s_nop 0
 BL v62,s[92:95],s37 offen sc1 lds
 v_rcp_f32 v205,v205
 v_rcp_f32 v206,v206
 v_rcp_f32 v207,v207
 v_rcp_f32 v208,v208
 v_rcp_f32 v209,v209
 v_rcp_f32 v210,v210
 v_rcp_f32 v211,v211
 v_rcp_f32 v212,v212
 v_rcp_f32 v213,v213
 v_rcp_f32 v214,v214
 v_rcp_f32 v215,v215
 BL v62,s[92:95],s37 offen offset:1024 sc1 lds
 PM v[88:89],v[88:89],v[200:201]
 PM v[90:91],v[90:91],v[202:203]
 PM v[92:93],v[92:93],v[204:205]
 PM v[94:95],v[94:95],v[206:207]
 PM v[96:97],v[96:97],v[208:209]
 PM v[98:99],v[98:99],v[210:211]
 PM v[100:101],v[100:101],v[212:213]
 PM v[102:103],v[102:103],v[214:215]
 PM v[200:201],v[104:105],v[104:105]
 PM v[202:203],v[106:107],v[106:107]
 PM v[204:205],v[108:109],v[108:109]
 BL v62,s[92:95],s37 offen offset:2048 sc1 lds
 PM v[206:207],v[110:111],v[110:111]
 PM v[208:209],v[112:113],v[112:113]
 PM v[210:211],v[114:115],v[114:115]
 PM v[212:213],v[116:117],v[116:117]
 PM v[214:215],v[118:119],v[118:119]
 v_pk_fma_f32 v[200:201],v[200:201],v[30:31],v[28:29]
 v_pk_fma_f32 v[202:203],v[202:203],v[30:31],v[28:29]
 v_pk_fma_f32 v[204:205],v[204:205],v[30:31],v[28:29]
 v_pk_fma_f32 v[206:207],v[206:207],v[30:31],v[28:29]
 v_pk_fma_f32 v[208:209],v[208:209],v[30:31],v[28:29]
 BL v62,s[92:95],s37 offen offset:3072 sc1 lds
 s_add_u32 s37,s37,114688
 v_pk_fma_f32 v[210:211],v[210:211],v[30:31],v[28:29]
 v_pk_fma_f32 v[212:213],v[212:213],v[30:31],v[28:29]
 v_pk_fma_f32 v[214:215],v[214:215],v[30:31],v[28:29]
 PM v[200:201],v[200:201],v[104:105]
 PM v[202:203],v[202:203],v[106:107]
 PM v[204:205],v[204:205],v[108:109]
 PM v[206:207],v[206:207],v[110:111]
 PM v[208:209],v[208:209],v[112:113]
 PM v[210:211],v[210:211],v[114:115]
 PM v[212:213],v[212:213],v[116:117]
 PM v[214:215],v[214:215],v[118:119]
 s_add_u32 m0,s39,147456
 s_nop 0
 BL v62,s[92:95],s37 offen sc1 lds
 v_exp_f32 v200,v200
 v_exp_f32 v201,v201
 v_exp_f32 v202,v202
 v_exp_f32 v203,v203
 v_exp_f32 v204,v204
 v_exp_f32 v205,v205
 v_exp_f32 v206,v206
 v_exp_f32 v207,v207
 v_exp_f32 v208,v208
 v_exp_f32 v209,v209
 v_exp_f32 v210,v210
 BL v62,s[92:95],s37 offen offset:1024 sc1 lds
 v_exp_f32 v211,v211
 v_exp_f32 v212,v212
 v_exp_f32 v213,v213
 v_exp_f32 v214,v214
 v_exp_f32 v215,v215
 v_pk_add_f32 v[200:201],v[200:201],1.0 op_sel_hi:[1,0]
 v_pk_add_f32 v[202:203],v[202:203],1.0 op_sel_hi:[1,0]
 v_pk_add_f32 v[204:205],v[204:205],1.0 op_sel_hi:[1,0]
 v_pk_add_f32 v[206:207],v[206:207],1.0 op_sel_hi:[1,0]
 v_pk_add_f32 v[208:209],v[208:209],1.0 op_sel_hi:[1,0]
 BL v62,s[92:95],s37 offen offset:2048 sc1 lds
 v_pk_add_f32 v[210:211],v[210:211],1.0 op_sel_hi:[1,0]
 v_pk_add_f32 v[212:213],v[212:213],1.0 op_sel_hi:[1,0]
 v_pk_add_f32 v[214:215],v[214:215],1.0 op_sel_hi:[1,0]
 v_rcp_f32 v200,v200
 v_rcp_f32 v201,v201
 v_rcp_f32 v202,v202
 v_rcp_f32 v203,v203
 v_rcp_f32 v204,v204
 v_rcp_f32 v205,v205
 v_rcp_f32 v206,v206
 v_rcp_f32 v207,v207
 BL v62,s[92:95],s37 offen offset:3072 sc1 lds
 s_add_u32 s37,s37,114688
 v_rcp_f32 v208,v208
 v_rcp_f32 v209,v209
 v_rcp_f32 v210,v210
 v_rcp_f32 v211,v211
 v_rcp_f32 v212,v212
 v_rcp_f32 v213,v213
 v_rcp_f32 v214,v214
 v_rcp_f32 v215,v215
 PM v[104:105],v[104:105],v[200:201]
 PM v[106:107],v[106:107],v[202:203]
 PM v[108:109],v[108:109],v[204:205]
 s_add_u32 m0,s39,81920
 s_nop 0
 BL v62,s[92:95],s37 offen sc1 lds
 PM v[110:111],v[110:111],v[206:207]
 PM v[112:113],v[112:113],v[208:209]
 PM v[114:115],v[114:115],v[210:211]
 PM v[116:117],v[116:117],v[212:213]
 PM v[118:119],v[118:119],v[214:215]
 PM v[200:201],v[120:121],v[120:121]
 PM v[202:203],v[122:123],v[122:123]
 PM v[204:205],v[124:125],v[124:125]
 PM v[206:207],v[126:127],v[126:127]
 PM v[208:209],v[128:129],v[128:129]
 PM v[210:211],v[130:131],v[130:131]
 BL v62,s[92:95],s37 offen offset:1024 sc1 lds
 PM v[212:213],v[132:133],v[132:133]
 PM v[214:215],v[134:135],v[134:135]
 v_pk_fma_f32 v[200:201],v[200:201],v[30:31],v[28:29]
 v_pk_fma_f32 v[202:203],v[202:203],v[30:31],v[28:29]
 v_pk_fma_f32 v[204:205],v[204:205],v[30:31],v[28:29]
 v_pk_fma_f32 v[206:207],v[206:207],v[30:31],v[28:29]
 v_pk_fma_f32 v[208:209],v[208:209],v[30:31],v[28:29]
 v_pk_fma_f32 v[210:211],v[210:211],v[30:31],v[28:29]
 v_pk_fma_f32 v[212:213],v[212:213],v[30:31],v[28:29]
 v_pk_fma_f32 v[214:215],v[214:215],v[30:31],v[28:29]
 BL v62,s[92:95],s37 offen offset:2048 sc1 lds
 PM v[200:201],v[200:201],v[120:121]
 PM v[202:203],v[202:203],v[122:123]
 PM v[204:205],v[204:205],v[124:125]
 PM v[206:207],v[206:207],v[126:127]
 PM v[208:209],v[208:209],v[128:129]
 PM v[210:211],v[210:211],v[130:131]
 PM v[212:213],v[212:213],v[132:133]
 PM v[214:215],v[214:215],v[134:135]
 v_exp_f32 v200,v200
 v_exp_f32 v201,v201
 v_exp_f32 v202,v202
 BL v62,s[92:95],s37 offen offset:3072 sc1 lds
 s_add_u32 s37,s37,114688
 v_exp_f32 v203,v203
 v_exp_f32 v204,v204
 v_exp_f32 v205,v205
 v_exp_f32 v206,v206
 v_exp_f32 v207,v207
 v_exp_f32 v208,v208
 v_exp_f32 v209,v209
 v_exp_f32 v210,v210
 v_exp_f32 v211,v211
 v_exp_f32 v212,v212
 v_exp_f32 v213,v213
 s_add_u32 m0,s39,98304
 s_nop 0
 BL v62,s[92:95],s37 offen sc1 lds
 v_exp_f32 v214,v214
 v_exp_f32 v215,v215
 v_pk_add_f32 v[200:201],v[200:201],1.0 op_sel_hi:[1,0]
 v_pk_add_f32 v[202:203],v[202:203],1.0 op_sel_hi:[1,0]
 v_pk_add_f32 v[204:205],v[204:205],1.0 op_sel_hi:[1,0]
 v_pk_add_f32 v[206:207],v[206:207],1.0 op_sel_hi:[1,0]
 v_pk_add_f32 v[208:209],v[208:209],1.0 op_sel_hi:[1,0]
 v_pk_add_f32 v[210:211],v[210:211],1.0 op_sel_hi:[1,0]
 v_pk_add_f32 v[212:213],v[212:213],1.0 op_sel_hi:[1,0]
 v_pk_add_f32 v[214:215],v[214:215],1.0 op_sel_hi:[1,0]
 BL v62,s[92:95],s37 offen offset:1024 sc1 lds
 v_rcp_f32 v200,v200
 v_rcp_f32 v201,v201
 v_rcp_f32 v202,v202
 v_rcp_f32 v203,v203
 v_rcp_f32 v204,v204
 v_rcp_f32 v205,v205
 v_rcp_f32 v206,v206
 v_rcp_f32 v207,v207
 v_rcp_f32 v208,v208
 v_rcp_f32 v209,v209
 v_rcp_f32 v210,v210
 BL v62,s[92:95],s37 offen offset:2048 sc1 lds
 v_rcp_f32 v211,v211
 v_rcp_f32 v212,v212
 v_rcp_f32 v213,v213
 v_rcp_f32 v214,v214
 v_rcp_f32 v215,v215
 PM v[120:121],v[120:121],v[200:201]
 PM v[122:123],v[122:123],v[202:203]
 PM v[124:125],v[124:125],v[204:205]
 PM v[126:127],v[126:127],v[206:207]
 PM v[128:129],v[128:129],v[208:209]
 PM v[130:131],v[130:131],v[210:211]
 BL v62,s[92:95],s37 offen offset:3072 sc1 lds
 s_add_u32 s37,s37,114688
 PM v[132:133],v[132:133],v[212:213]
 PM v[134:135],v[134:135],v[214:215]
 v_mul_f32 v8,0xbfb8aa3b,v8
 v_mul_f32 v12,0xbfb8aa3b,v12
 v_mul_f32 v16,0xbfb8aa3b,v16
 v_mul_f32 v20,0xbfb8aa3b,v20
 v_exp_f32 v8,v8
 v_exp_f32 v12,v12
 v_exp_f32 v16,v16
 v_exp_f32 v20,v20
 v_add_f32 v8,1.0,v8
 v_add_f32 v12,1.0,v12
 v_add_f32 v16,1.0,v16
 v_add_f32 v20,1.0,v20
 v_rcp_f32 v8,v8
 v_rcp_f32 v12,v12
 v_rcp_f32 v16,v16
 v_rcp_f32 v20,v20
 v_sub_f32 v10,1.0,v8
 v_sub_f32 v14,1.0,v12
 v_sub_f32 v18,1.0,v16
 v_sub_f32 v22,1.0,v20
 PM v[136:137],v[72:73],v[10:11] op_sel_hi:[1,0]
 PM v[138:139],v[74:75],v[10:11] op_sel_hi:[1,0]
 PM v[140:141],v[76:77],v[10:11] op_sel_hi:[1,0]
 PM v[142:143],v[78:79],v[10:11] op_sel_hi:[1,0]
 PM v[144:145],v[80:81],v[10:11] op_sel_hi:[1,0]
 PM v[146:147],v[82:83],v[10:11] op_sel_hi:[1,0]
 PM v[148:149],v[84:85],v[10:11] op_sel_hi:[1,0]
 PM v[150:151],v[86:87],v[10:11] op_sel_hi:[1,0]
 PM v[152:153],v[88:89],v[14:15] op_sel_hi:[1,0]
 PM v[154:155],v[90:91],v[14:15] op_sel_hi:[1,0]
 PM v[156:157],v[92:93],v[14:15] op_sel_hi:[1,0]
 PM v[158:159],v[94:95],v[14:15] op_sel_hi:[1,0]
 PM v[160:161],v[96:97],v[14:15] op_sel_hi:[1,0]
 PM v[162:163],v[98:99],v[14:15] op_sel_hi:[1,0]
 PM v[164:165],v[100:101],v[14:15] op_sel_hi:[1,0]
 PM v[166:167],v[102:103],v[14:15] op_sel_hi:[1,0]
 PM v[168:169],v[104:105],v[18:19] op_sel_hi:[1,0]
 PM v[170:171],v[106:107],v[18:19] op_sel_hi:[1,0]
 PM v[172:173],v[108:109],v[18:19] op_sel_hi:[1,0]
 PM v[174:175],v[110:111],v[18:19] op_sel_hi:[1,0]
 PM v[176:177],v[112:113],v[18:19] op_sel_hi:[1,0]
 PM v[178:179],v[114:115],v[18:19] op_sel_hi:[1,0]
 PM v[180:181],v[116:117],v[18:19] op_sel_hi:[1,0]
 PM v[182:183],v[118:119],v[18:19] op_sel_hi:[1,0]
 PM v[184:185],v[120:121],v[22:23] op_sel_hi:[1,0]
 PM v[186:187],v[122:123],v[22:23] op_sel_hi:[1,0]
 PM v[188:189],v[124:125],v[22:23] op_sel_hi:[1,0]
 PM v[190:191],v[126:127],v[22:23] op_sel_hi:[1,0]
 PM v[192:193],v[128:129],v[22:23] op_sel_hi:[1,0]
 PM v[194:195],v[130:131],v[22:23] op_sel_hi:[1,0]
 PM v[196:197],v[132:133],v[22:23] op_sel_hi:[1,0]
 PM v[198:199],v[134:135],v[22:23] op_sel_hi:[1,0]
 s_lshr_b32 s27,s35,1
 s_or_b32 s27,s27,s83
 s_cmp_lg_u32 s27,0
 s_cbranch_scc1 gh_ng
 s_add_u32 s4,s68,75497472
 s_addc_u32 s5,s69,0
 s_mov_b32 s6,8192
 s_mov_b32 s7,0x20000
 s_and_b32 s27,s35,1
 s_lshl_b32 s26,s82,1
 s_add_u32 s26,s26,s27
 s_lshl_b32 s26,s26,8
 v_and_b32 v1,15,v0
 v_lshlrev_b32 v1,2,v1
 buffer_store_dword v8,v1,s[4:7],s26 offen sc1
 buffer_store_dword v12,v1,s[4:7],s26 offen offset:64 sc1
 buffer_store_dword v16,v1,s[4:7],s26 offen offset:128 sc1
 buffer_store_dword v20,v1,s[4:7],s26 offen offset:192 sc1
gh_ng:
 s_waitcnt vmcnt(16)
 s_barrier
 RQ a[32:35],v48
 RQ a[96:99],v63 offset:32768
 RQ a[100:103],v63 offset:33792
 RQ a[104:107],v63 offset:34816
 RQ a[108:111],v63 offset:35840
 RQ a[36:39],v48 offset:2048
 RQ a[40:43],v48 offset:4096
 RQ a[44:47],v48 offset:6144
 RQ a[48:51],v49
 RQ a[112:115],v63 offset:40960
 RQ a[116:119],v63 offset:41984
 RQ a[120:123],v63 offset:43008
 RQ a[124:127],v63 offset:44032
 RQ a[52:55],v49 offset:2048
 RQ a[56:59],v49 offset:4096
 RQ a[60:63],v49 offset:6144
 s_waitcnt vmcnt(12)
 s_waitcnt lgkmcnt(0)
 s_barrier
 MM v[72:75],a[96:99],a[32:35],0
 RQ a[0:3],v46
 s_add_u32 m0,s39,114688
 s_nop 0
 BL v62,s[92:95],s37 offen sc1 lds
 MM v[76:79],a[100:103],a[32:35],0
 RQ a[64:67],v63 offset:49152
 MM v[80:83],a[104:107],a[32:35],0
 RQ a[68:71],v63 offset:50176
 MM v[84:87],a[108:111],a[32:35],0
 RQ a[72:75],v63 offset:51200
 BL v62,s[92:95],s37 offen offset:1024 sc1 lds
 MM v[88:91],a[96:99],a[36:39],0
 RQ a[76:79],v63 offset:52224
 MM v[92:95],a[100:103],a[36:39],0
 RQ a[4:7],v46 offset:2048
 MM v[96:99],a[104:107],a[36:39],0
 RQ a[8:11],v46 offset:4096
 MM v[100:103],a[108:111],a[36:39],0
 RQ a[12:15],v46 offset:6144
 BL v62,s[92:95],s37 offen offset:2048 sc1 lds
 MM v[104:107],a[96:99],a[40:43],0
 RQ a[16:19],v47
 MM v[108:111],a[100:103],a[40:43],0
 RQ a[80:83],v63 offset:57344
 MM v[112:115],a[104:107],a[40:43],0
 RQ a[84:87],v63 offset:58368
 MM v[116:119],a[108:111],a[40:43],0
 RQ a[88:91],v63 offset:59392
 BL v62,s[92:95],s37 offen offset:3072 sc1 lds
 MM v[120:123],a[96:99],a[44:47],0
 RQ a[92:95],v63 offset:60416
 s_add_u32 s37,s37,114688
 MM v[124:127],a[100:103],a[44:47],0
 RQ a[20:23],v47 offset:2048
 MM v[128:131],a[104:107],a[44:47],0
 RQ a[24:27],v47 offset:4096
 s_add_u32 m0,s38,65536
 MM v[132:135],a[108:111],a[44:47],0
 RQ a[28:31],v47 offset:6144
 BL v58,s[88:91],s36 offen  lds
 MM v[72:75],a[112:115],a[48:51],v[72:75]
 MM v[76:79],a[116:119],a[48:51],v[76:79]
 MM v[80:83],a[120:123],a[48:51],v[80:83]
 MM v[84:87],a[124:127],a[48:51],v[84:87]
 BL v59,s[88:91],s36 offen offset:1024  lds
 MM v[88:91],a[112:115],a[52:55],v[88:91]
 MM v[92:95],a[116:119],a[52:55],v[92:95]
 MM v[96:99],a[120:123],a[52:55],v[96:99]
 MM v[100:103],a[124:127],a[52:55],v[100:103]
 BL v60,s[88:91],s36 offen offset:2048  lds
 MM v[104:107],a[112:115],a[56:59],v[104:107]
 MM v[108:111],a[116:119],a[56:59],v[108:111]
 MM v[112:115],a[120:123],a[56:59],v[112:115]
 MM v[116:119],a[124:127],a[56:59],v[116:119]
 BL v61,s[88:91],s36 offen offset:3072  lds
 MM v[120:123],a[112:115],a[60:63],v[120:123]
 s_add_u32 s36,s36,128
 MM v[124:127],a[116:119],a[60:63],v[124:127]
 MM v[128:131],a[120:123],a[60:63],v[128:131]
 MM v[132:135],a[124:127],a[60:63],v[132:135]
 s_waitcnt vmcnt(8)
 s_waitcnt lgkmcnt(0)
 s_barrier
 MM v[72:75],a[64:67],a[0:3],v[72:75]
 RQ a[32:35],v46 offset:16384
 s_add_u32 m0,s39,131072
 s_nop 0
 BL v62,s[92:95],s37 offen sc1 lds
 MM v[76:79],a[68:71],a[0:3],v[76:79]
 RQ a[96:99],v64
 MM v[80:83],a[72:75],a[0:3],v[80:83]
 RQ a[100:103],v64 offset:1024
 MM v[84:87],a[76:79],a[0:3],v[84:87]
 RQ a[104:107],v64 offset:2048
 BL v62,s[92:95],s37 offen offset:1024 sc1 lds
 MM v[88:91],a[64:67],a[4:7],v[88:91]
 RQ a[108:111],v64 offset:3072
 MM v[92:95],a[68:71],a[4:7],v[92:95]
 RQ a[36:39],v46 offset:18432
 MM v[96:99],a[72:75],a[4:7],v[96:99]
 RQ a[40:43],v46 offset:20480
 MM v[100:103],a[76:79],a[4:7],v[100:103]
 RQ a[44:47],v46 offset:22528
 BL v62,s[92:95],s37 offen offset:2048 sc1 lds
 MM v[104:107],a[64:67],a[8:11],v[104:107]
 RQ a[48:51],v47 offset:16384
 MM v[108:111],a[68:71],a[8:11],v[108:111]
 RQ a[112:115],v64 offset:8192
 MM v[112:115],a[72:75],a[8:11],v[112:115]
 RQ a[116:119],v64 offset:9216
 MM v[116:119],a[76:79],a[8:11],v[116:119]
 RQ a[120:123],v64 offset:10240
 BL v62,s[92:95],s37 offen offset:3072 sc1 lds
 MM v[120:123],a[64:67],a[12:15],v[120:123]
 RQ a[124:127],v64 offset:11264
 s_add_u32 s37,s37,114688
 MM v[124:127],a[68:71],a[12:15],v[124:127]
 RQ a[52:55],v47 offset:18432
 MM v[128:131],a[72:75],a[12:15],v[128:131]
 RQ a[56:59],v47 offset:20480
 s_add_u32 m0,s38,0
 MM v[132:135],a[76:79],a[12:15],v[132:135]
 RQ a[60:63],v47 offset:22528
 BL v58,s[88:91],s36 offen  lds
 MM v[72:75],a[80:83],a[16:19],v[72:75]
 MM v[76:79],a[84:87],a[16:19],v[76:79]
 MM v[80:83],a[88:91],a[16:19],v[80:83]
 MM v[84:87],a[92:95],a[16:19],v[84:87]
 BL v59,s[88:91],s36 offen offset:1024  lds
 MM v[88:91],a[80:83],a[20:23],v[88:91]
 MM v[92:95],a[84:87],a[20:23],v[92:95]
 MM v[96:99],a[88:91],a[20:23],v[96:99]
 MM v[100:103],a[92:95],a[20:23],v[100:103]
 BL v60,s[88:91],s36 offen offset:2048  lds
 MM v[104:107],a[80:83],a[24:27],v[104:107]
 MM v[108:111],a[84:87],a[24:27],v[108:111]
 MM v[112:115],a[88:91],a[24:27],v[112:115]
 MM v[116:119],a[92:95],a[24:27],v[116:119]
 BL v61,s[88:91],s36 offen offset:3072  lds
 MM v[120:123],a[80:83],a[28:31],v[120:123]
 s_add_u32 s36,s36,128
 MM v[124:127],a[84:87],a[28:31],v[124:127]
 MM v[128:131],a[88:91],a[28:31],v[128:131]
 MM v[132:135],a[92:95],a[28:31],v[132:135]
 s_lshl_b32 s26,s73,2
 s_add_u32 s26,s26,s100
 s_cmp_lg_u32 s35,0
 s_cbranch_scc1 ks_ns
 v_mov_b32 v1,0
 v_mov_b32 v2,1
 s_mov_b64 exec,1
 buffer_store_dword v2,v1,s[0:3],s26 offen sc1
 s_mov_b64 exec,-1
ks_ns:
 s_cmp_lg_u32 s83,0
 s_cbranch_scc1 gs_n
 s_lshl_b32 s26,s82,2
 s_add_u32 s26,s26,1024
 s_cmp_lg_u32 s35,0
 s_cbranch_scc1 gs_ns
 v_mov_b32 v1,0
 v_mov_b32 v2,1
 s_mov_b64 exec,1
 buffer_store_dword v2,v1,s[0:3],s26 offen sc1
 s_mov_b64 exec,-1
gs_ns:
gs_n:
 s_waitcnt lgkmcnt(0)
 s_barrier
 MM v[72:75],a[96:99],a[32:35],v[72:75]
 RQ a[0:3],v46 offset:32768
 s_add_u32 m0,s39,147456
 s_nop 0
 BL v62,s[92:95],s37 offen sc1 lds
 MM v[76:79],a[100:103],a[32:35],v[76:79]
 RQ a[64:67],v63
 MM v[80:83],a[104:107],a[32:35],v[80:83]
 RQ a[68:71],v63 offset:1024
 MM v[84:87],a[108:111],a[32:35],v[84:87]
 RQ a[72:75],v63 offset:2048
 BL v62,s[92:95],s37 offen offset:1024 sc1 lds
 MM v[88:91],a[96:99],a[36:39],v[88:91]
 RQ a[76:79],v63 offset:3072
 MM v[92:95],a[100:103],a[36:39],v[92:95]
 RQ a[4:7],v46 offset:34816
 MM v[96:99],a[104:107],a[36:39],v[96:99]
 RQ a[8:11],v46 offset:36864
 MM v[100:103],a[108:111],a[36:39],v[100:103]
 RQ a[12:15],v46 offset:38912
 BL v62,s[92:95],s37 offen offset:2048 sc1 lds
 MM v[104:107],a[96:99],a[40:43],v[104:107]
 RQ a[16:19],v47 offset:32768
 MM v[108:111],a[100:103],a[40:43],v[108:111]
 RQ a[80:83],v63 offset:8192
 MM v[112:115],a[104:107],a[40:43],v[112:115]
 RQ a[84:87],v63 offset:9216
 MM v[116:119],a[108:111],a[40:43],v[116:119]
 RQ a[88:91],v63 offset:10240
 BL v62,s[92:95],s37 offen offset:3072 sc1 lds
 MM v[120:123],a[96:99],a[44:47],v[120:123]
 RQ a[92:95],v63 offset:11264
 s_add_u32 s37,s37,114688
 MM v[124:127],a[100:103],a[44:47],v[124:127]
 RQ a[20:23],v47 offset:34816
 MM v[128:131],a[104:107],a[44:47],v[128:131]
 RQ a[24:27],v47 offset:36864
 s_add_u32 m0,s38,16384
 MM v[132:135],a[108:111],a[44:47],v[132:135]
 RQ a[28:31],v47 offset:38912
 BL v58,s[88:91],s36 offen  lds
 MM v[72:75],a[112:115],a[48:51],v[72:75]
 MM v[76:79],a[116:119],a[48:51],v[76:79]
 MM v[80:83],a[120:123],a[48:51],v[80:83]
 MM v[84:87],a[124:127],a[48:51],v[84:87]
 BL v59,s[88:91],s36 offen offset:1024  lds
 MM v[88:91],a[112:115],a[52:55],v[88:91]
 MM v[92:95],a[116:119],a[52:55],v[92:95]
 MM v[96:99],a[120:123],a[52:55],v[96:99]
 MM v[100:103],a[124:127],a[52:55],v[100:103]
 BL v60,s[88:91],s36 offen offset:2048  lds
 MM v[104:107],a[112:115],a[56:59],v[104:107]
 MM v[108:111],a[116:119],a[56:59],v[108:111]
 MM v[112:115],a[120:123],a[56:59],v[112:115]
 MM v[116:119],a[124:127],a[56:59],v[116:119]
 BL v61,s[88:91],s36 offen offset:3072  lds
 MM v[120:123],a[112:115],a[60:63],v[120:123]
 s_add_u32 s36,s36,128
 MM v[124:127],a[116:119],a[60:63],v[124:127]
 MM v[128:131],a[120:123],a[60:63],v[128:131]
 MM v[132:135],a[124:127],a[60:63],v[132:135]
 s_waitcnt lgkmcnt(0)
 s_barrier
 MM v[72:75],a[64:67],a[0:3],v[72:75]
 RQ a[32:35],v46 offset:49152
 s_add_u32 m0,s39,81920
 s_nop 0
 BL v62,s[92:95],s37 offen sc1 lds
 MM v[76:79],a[68:71],a[0:3],v[76:79]
 RQ a[96:99],v63 offset:16384
 MM v[80:83],a[72:75],a[0:3],v[80:83]
 RQ a[100:103],v63 offset:17408
 MM v[84:87],a[76:79],a[0:3],v[84:87]
 RQ a[104:107],v63 offset:18432
 BL v62,s[92:95],s37 offen offset:1024 sc1 lds
 MM v[88:91],a[64:67],a[4:7],v[88:91]
 RQ a[108:111],v63 offset:19456
 MM v[92:95],a[68:71],a[4:7],v[92:95]
 RQ a[36:39],v46 offset:51200
 MM v[96:99],a[72:75],a[4:7],v[96:99]
 RQ a[40:43],v46 offset:53248
 MM v[100:103],a[76:79],a[4:7],v[100:103]
 RQ a[44:47],v46 offset:55296
 BL v62,s[92:95],s37 offen offset:2048 sc1 lds
 MM v[104:107],a[64:67],a[8:11],v[104:107]
 RQ a[48:51],v47 offset:49152
 MM v[108:111],a[68:71],a[8:11],v[108:111]
 RQ a[112:115],v63 offset:24576
 MM v[112:115],a[72:75],a[8:11],v[112:115]
 RQ a[116:119],v63 offset:25600
 MM v[116:119],a[76:79],a[8:11],v[116:119]
 RQ a[120:123],v63 offset:26624
 BL v62,s[92:95],s37 offen offset:3072 sc1 lds
 MM v[120:123],a[64:67],a[12:15],v[120:123]
 RQ a[124:127],v63 offset:27648
 s_add_u32 s37,s37,114688
 MM v[124:127],a[68:71],a[12:15],v[124:127]
 RQ a[52:55],v47 offset:51200
 MM v[128:131],a[72:75],a[12:15],v[128:131]
 RQ a[56:59],v47 offset:53248
 s_add_u32 m0,s38,32768
 MM v[132:135],a[76:79],a[12:15],v[132:135]
 RQ a[60:63],v47 offset:55296
 BL v58,s[88:91],s36 offen  lds
 MM v[72:75],a[80:83],a[16:19],v[72:75]
 MM v[76:79],a[84:87],a[16:19],v[76:79]
 MM v[80:83],a[88:91],a[16:19],v[80:83]
 MM v[84:87],a[92:95],a[16:19],v[84:87]
 BL v59,s[88:91],s36 offen offset:1024  lds
 MM v[88:91],a[80:83],a[20:23],v[88:91]
 MM v[92:95],a[84:87],a[20:23],v[92:95]
 MM v[96:99],a[88:91],a[20:23],v[96:99]
 MM v[100:103],a[92:95],a[20:23],v[100:103]
 BL v60,s[88:91],s36 offen offset:2048  lds
 MM v[104:107],a[80:83],a[24:27],v[104:107]
 MM v[108:111],a[84:87],a[24:27],v[108:111]
 MM v[112:115],a[88:91],a[24:27],v[112:115]
 MM v[116:119],a[92:95],a[24:27],v[116:119]
 BL v61,s[88:91],s36 offen offset:3072  lds
 MM v[120:123],a[80:83],a[28:31],v[120:123]
 s_add_u32 s36,s36,128
 MM v[124:127],a[84:87],a[28:31],v[124:127]
 MM v[128:131],a[88:91],a[28:31],v[128:131]
 MM v[132:135],a[92:95],a[28:31],v[132:135]
 s_waitcnt vmcnt(24)
 s_waitcnt lgkmcnt(0)
 s_barrier
 MM v[72:75],a[96:99],a[32:35],v[72:75]
 RQ a[0:3],v48
 s_add_u32 m0,s39,98304
 s_nop 0
 BL v62,s[92:95],s37 offen sc1 lds
 MM v[76:79],a[100:103],a[32:35],v[76:79]
 RQ a[64:67],v63 offset:32768
 MM v[80:83],a[104:107],a[32:35],v[80:83]
 RQ a[68:71],v63 offset:33792
 MM v[84:87],a[108:111],a[32:35],v[84:87]
 RQ a[72:75],v63 offset:34816
 BL v62,s[92:95],s37 offen offset:1024 sc1 lds
 MM v[88:91],a[96:99],a[36:39],v[88:91]
 RQ a[76:79],v63 offset:35840
 MM v[92:95],a[100:103],a[36:39],v[92:95]
 RQ a[4:7],v48 offset:2048
 MM v[96:99],a[104:107],a[36:39],v[96:99]
 RQ a[8:11],v48 offset:4096
 MM v[100:103],a[108:111],a[36:39],v[100:103]
 RQ a[12:15],v48 offset:6144
 BL v62,s[92:95],s37 offen offset:2048 sc1 lds
 MM v[104:107],a[96:99],a[40:43],v[104:107]
 RQ a[16:19],v49
 MM v[108:111],a[100:103],a[40:43],v[108:111]
 RQ a[80:83],v63 offset:40960
 MM v[112:115],a[104:107],a[40:43],v[112:115]
 RQ a[84:87],v63 offset:41984
 MM v[116:119],a[108:111],a[40:43],v[116:119]
 RQ a[88:91],v63 offset:43008
 BL v62,s[92:95],s37 offen offset:3072 sc1 lds
 MM v[120:123],a[96:99],a[44:47],v[120:123]
 RQ a[92:95],v63 offset:44032
 s_add_u32 s37,s37,114688
 MM v[124:127],a[100:103],a[44:47],v[124:127]
 RQ a[20:23],v49 offset:2048
 MM v[128:131],a[104:107],a[44:47],v[128:131]
 RQ a[24:27],v49 offset:4096
 s_add_u32 m0,s38,49152
 MM v[132:135],a[108:111],a[44:47],v[132:135]
 RQ a[28:31],v49 offset:6144
 BL v58,s[88:91],s36 offen  lds
 MM v[72:75],a[112:115],a[48:51],v[72:75]
 MM v[76:79],a[116:119],a[48:51],v[76:79]
 MM v[80:83],a[120:123],a[48:51],v[80:83]
 MM v[84:87],a[124:127],a[48:51],v[84:87]
 BL v59,s[88:91],s36 offen offset:1024  lds
 MM v[88:91],a[112:115],a[52:55],v[88:91]
 MM v[92:95],a[116:119],a[52:55],v[92:95]
 MM v[96:99],a[120:123],a[52:55],v[96:99]
 MM v[100:103],a[124:127],a[52:55],v[100:103]
 BL v60,s[88:91],s36 offen offset:2048  lds
 MM v[104:107],a[112:115],a[56:59],v[104:107]
 MM v[108:111],a[116:119],a[56:59],v[108:111]
 MM v[112:115],a[120:123],a[56:59],v[112:115]
 MM v[116:119],a[124:127],a[56:59],v[116:119]
 BL v61,s[88:91],s36 offen offset:3072  lds
 MM v[120:123],a[112:115],a[60:63],v[120:123]
 s_add_u32 s36,s36,128
 MM v[124:127],a[116:119],a[60:63],v[124:127]
 MM v[128:131],a[120:123],a[60:63],v[128:131]
 MM v[132:135],a[124:127],a[60:63],v[132:135]
 s_mov_b32 s28,2
gh_loop:
 s_waitcnt vmcnt(24)
 s_waitcnt lgkmcnt(0)
 s_barrier
 MM v[72:75],a[64:67],a[0:3],v[72:75]
 RQ a[32:35],v46
 s_add_u32 m0,s39,114688
 s_nop 0
 BL v62,s[92:95],s37 offen sc1 lds
 MM v[76:79],a[68:71],a[0:3],v[76:79]
 RQ a[96:99],v63 offset:49152
 MM v[80:83],a[72:75],a[0:3],v[80:83]
 RQ a[100:103],v63 offset:50176
 MM v[84:87],a[76:79],a[0:3],v[84:87]
 RQ a[104:107],v63 offset:51200
 BL v62,s[92:95],s37 offen offset:1024 sc1 lds
 MM v[88:91],a[64:67],a[4:7],v[88:91]
 RQ a[108:111],v63 offset:52224
 MM v[92:95],a[68:71],a[4:7],v[92:95]
 RQ a[36:39],v46 offset:2048
 MM v[96:99],a[72:75],a[4:7],v[96:99]
 RQ a[40:43],v46 offset:4096
 MM v[100:103],a[76:79],a[4:7],v[100:103]
 RQ a[44:47],v46 offset:6144
 BL v62,s[92:95],s37 offen offset:2048 sc1 lds
 MM v[104:107],a[64:67],a[8:11],v[104:107]
 RQ a[48:51],v47
 MM v[108:111],a[68:71],a[8:11],v[108:111]
 RQ a[112:115],v63 offset:57344
 MM v[112:115],a[72:75],a[8:11],v[112:115]
 RQ a[116:119],v63 offset:58368
 MM v[116:119],a[76:79],a[8:11],v[116:119]
 RQ a[120:123],v63 offset:59392
 BL v62,s[92:95],s37 offen offset:3072 sc1 lds
 MM v[120:123],a[64:67],a[12:15],v[120:123]
 RQ a[124:127],v63 offset:60416
 s_add_u32 s37,s37,114688
 MM v[124:127],a[68:71],a[12:15],v[124:127]
 RQ a[52:55],v47 offset:2048
 MM v[128:131],a[72:75],a[12:15],v[128:131]
 RQ a[56:59],v47 offset:4096
 s_add_u32 m0,s38,65536
 MM v[132:135],a[76:79],a[12:15],v[132:135]
 RQ a[60:63],v47 offset:6144
 BL v58,s[88:91],s36 offen  lds
 MM v[72:75],a[80:83],a[16:19],v[72:75]
 MM v[76:79],a[84:87],a[16:19],v[76:79]
 MM v[80:83],a[88:91],a[16:19],v[80:83]
 MM v[84:87],a[92:95],a[16:19],v[84:87]
 BL v59,s[88:91],s36 offen offset:1024  lds
 MM v[88:91],a[80:83],a[20:23],v[88:91]
 MM v[92:95],a[84:87],a[20:23],v[92:95]
 MM v[96:99],a[88:91],a[20:23],v[96:99]
 MM v[100:103],a[92:95],a[20:23],v[100:103]
 BL v60,s[88:91],s36 offen offset:2048  lds
 MM v[104:107],a[80:83],a[24:27],v[104:107]
 MM v[108:111],a[84:87],a[24:27],v[108:111]
 MM v[112:115],a[88:91],a[24:27],v[112:115]
 MM v[116:119],a[92:95],a[24:27],v[116:119]
 BL v61,s[88:91],s36 offen offset:3072  lds
 MM v[120:123],a[80:83],a[28:31],v[120:123]
 s_add_u32 s36,s36,128
 MM v[124:127],a[84:87],a[28:31],v[124:127]
 MM v[128:131],a[88:91],a[28:31],v[128:131]
 MM v[132:135],a[92:95],a[28:31],v[132:135]
 s_waitcnt vmcnt(24)
 s_waitcnt lgkmcnt(0)
 s_barrier
 MM v[72:75],a[96:99],a[32:35],v[72:75]
 RQ a[0:3],v46 offset:16384
 s_add_u32 m0,s39,131072
 s_nop 0
 BL v62,s[92:95],s37 offen sc1 lds
 MM v[76:79],a[100:103],a[32:35],v[76:79]
 RQ a[64:67],v64
 MM v[80:83],a[104:107],a[32:35],v[80:83]
 RQ a[68:71],v64 offset:1024
 MM v[84:87],a[108:111],a[32:35],v[84:87]
 RQ a[72:75],v64 offset:2048
 BL v62,s[92:95],s37 offen offset:1024 sc1 lds
 MM v[88:91],a[96:99],a[36:39],v[88:91]
 RQ a[76:79],v64 offset:3072
 MM v[92:95],a[100:103],a[36:39],v[92:95]
 RQ a[4:7],v46 offset:18432
 MM v[96:99],a[104:107],a[36:39],v[96:99]
 RQ a[8:11],v46 offset:20480
 MM v[100:103],a[108:111],a[36:39],v[100:103]
 RQ a[12:15],v46 offset:22528
 BL v62,s[92:95],s37 offen offset:2048 sc1 lds
 MM v[104:107],a[96:99],a[40:43],v[104:107]
 RQ a[16:19],v47 offset:16384
 MM v[108:111],a[100:103],a[40:43],v[108:111]
 RQ a[80:83],v64 offset:8192
 MM v[112:115],a[104:107],a[40:43],v[112:115]
 RQ a[84:87],v64 offset:9216
 MM v[116:119],a[108:111],a[40:43],v[116:119]
 RQ a[88:91],v64 offset:10240
 BL v62,s[92:95],s37 offen offset:3072 sc1 lds
 MM v[120:123],a[96:99],a[44:47],v[120:123]
 RQ a[92:95],v64 offset:11264
 s_add_u32 s37,s37,114688
 MM v[124:127],a[100:103],a[44:47],v[124:127]
 RQ a[20:23],v47 offset:18432
 MM v[128:131],a[104:107],a[44:47],v[128:131]
 RQ a[24:27],v47 offset:20480
 s_add_u32 m0,s38,0
 MM v[132:135],a[108:111],a[44:47],v[132:135]
 RQ a[28:31],v47 offset:22528
 BL v58,s[88:91],s36 offen  lds
 MM v[72:75],a[112:115],a[48:51],v[72:75]
 MM v[76:79],a[116:119],a[48:51],v[76:79]
 MM v[80:83],a[120:123],a[48:51],v[80:83]
 MM v[84:87],a[124:127],a[48:51],v[84:87]
 BL v59,s[88:91],s36 offen offset:1024  lds
 MM v[88:91],a[112:115],a[52:55],v[88:91]
 MM v[92:95],a[116:119],a[52:55],v[92:95]
 MM v[96:99],a[120:123],a[52:55],v[96:99]
 MM v[100:103],a[124:127],a[52:55],v[100:103]
 BL v60,s[88:91],s36 offen offset:2048  lds
 MM v[104:107],a[112:115],a[56:59],v[104:107]
 MM v[108:111],a[116:119],a[56:59],v[108:111]
 MM v[112:115],a[120:123],a[56:59],v[112:115]
 MM v[116:119],a[124:127],a[56:59],v[116:119]
 BL v61,s[88:91],s36 offen offset:3072  lds
 MM v[120:123],a[112:115],a[60:63],v[120:123]
 s_add_u32 s36,s36,128
 MM v[124:127],a[116:119],a[60:63],v[124:127]
 MM v[128:131],a[120:123],a[60:63],v[128:131]
 MM v[132:135],a[124:127],a[60:63],v[132:135]
 s_waitcnt vmcnt(24)
 s_waitcnt lgkmcnt(0)
 s_barrier
 MM v[72:75],a[64:67],a[0:3],v[72:75]
 RQ a[32:35],v46 offset:32768
 s_add_u32 m0,s39,147456
 s_nop 0
 BL v62,s[92:95],s37 offen sc1 lds
 MM v[76:79],a[68:71],a[0:3],v[76:79]
 RQ a[96:99],v63
 MM v[80:83],a[72:75],a[0:3],v[80:83]
 RQ a[100:103],v63 offset:1024
 MM v[84:87],a[76:79],a[0:3],v[84:87]
 RQ a[104:107],v63 offset:2048
 BL v62,s[92:95],s37 offen offset:1024 sc1 lds
 MM v[88:91],a[64:67],a[4:7],v[88:91]
 RQ a[108:111],v63 offset:3072
 MM v[92:95],a[68:71],a[4:7],v[92:95]
 RQ a[36:39],v46 offset:34816
 MM v[96:99],a[72:75],a[4:7],v[96:99]
 RQ a[40:43],v46 offset:36864
 MM v[100:103],a[76:79],a[4:7],v[100:103]
 RQ a[44:47],v46 offset:38912
 BL v62,s[92:95],s37 offen offset:2048 sc1 lds
 MM v[104:107],a[64:67],a[8:11],v[104:107]
 RQ a[48:51],v47 offset:32768
 MM v[108:111],a[68:71],a[8:11],v[108:111]
 RQ a[112:115],v63 offset:8192
 MM v[112:115],a[72:75],a[8:11],v[112:115]
 RQ a[116:119],v63 offset:9216
 MM v[116:119],a[76:79],a[8:11],v[116:119]
 RQ a[120:123],v63 offset:10240
 BL v62,s[92:95],s37 offen offset:3072 sc1 lds
 MM v[120:123],a[64:67],a[12:15],v[120:123]
 RQ a[124:127],v63 offset:11264
 s_add_u32 s37,s37,114688
 MM v[124:127],a[68:71],a[12:15],v[124:127]
 RQ a[52:55],v47 offset:34816
 MM v[128:131],a[72:75],a[12:15],v[128:131]
 RQ a[56:59],v47 offset:36864
 s_add_u32 m0,s38,16384
 MM v[132:135],a[76:79],a[12:15],v[132:135]
 RQ a[60:63],v47 offset:38912
 BL v58,s[88:91],s36 offen  lds
 MM v[72:75],a[80:83],a[16:19],v[72:75]
 MM v[76:79],a[84:87],a[16:19],v[76:79]
 MM v[80:83],a[88:91],a[16:19],v[80:83]
 MM v[84:87],a[92:95],a[16:19],v[84:87]
 BL v59,s[88:91],s36 offen offset:1024  lds
 MM v[88:91],a[80:83],a[20:23],v[88:91]
 MM v[92:95],a[84:87],a[20:23],v[92:95]
 MM v[96:99],a[88:91],a[20:23],v[96:99]
 MM v[100:103],a[92:95],a[20:23],v[100:103]
 BL v60,s[88:91],s36 offen offset:2048  lds
 MM v[104:107],a[80:83],a[24:27],v[104:107]
 MM v[108:111],a[84:87],a[24:27],v[108:111]
 MM v[112:115],a[88:91],a[24:27],v[112:115]
 MM v[116:119],a[92:95],a[24:27],v[116:119]
 BL v61,s[88:91],s36 offen offset:3072  lds
 MM v[120:123],a[80:83],a[28:31],v[120:123]
 s_add_u32 s36,s36,128
 MM v[124:127],a[84:87],a[28:31],v[124:127]
 MM v[128:131],a[88:91],a[28:31],v[128:131]
 MM v[132:135],a[92:95],a[28:31],v[132:135]
 s_waitcnt vmcnt(24)
 s_waitcnt lgkmcnt(0)
 s_barrier
 MM v[72:75],a[96:99],a[32:35],v[72:75]
 RQ a[0:3],v46 offset:49152
 s_add_u32 m0,s39,81920
 s_nop 0
 BL v62,s[92:95],s37 offen sc1 lds
 MM v[76:79],a[100:103],a[32:35],v[76:79]
 RQ a[64:67],v63 offset:16384
 MM v[80:83],a[104:107],a[32:35],v[80:83]
 RQ a[68:71],v63 offset:17408
 MM v[84:87],a[108:111],a[32:35],v[84:87]
 RQ a[72:75],v63 offset:18432
 BL v62,s[92:95],s37 offen offset:1024 sc1 lds
 MM v[88:91],a[96:99],a[36:39],v[88:91]
 RQ a[76:79],v63 offset:19456
 MM v[92:95],a[100:103],a[36:39],v[92:95]
 RQ a[4:7],v46 offset:51200
 MM v[96:99],a[104:107],a[36:39],v[96:99]
 RQ a[8:11],v46 offset:53248
 MM v[100:103],a[108:111],a[36:39],v[100:103]
 RQ a[12:15],v46 offset:55296
 BL v62,s[92:95],s37 offen offset:2048 sc1 lds
 MM v[104:107],a[96:99],a[40:43],v[104:107]
 RQ a[16:19],v47 offset:49152
 MM v[108:111],a[100:103],a[40:43],v[108:111]
 RQ a[80:83],v63 offset:24576
 MM v[112:115],a[104:107],a[40:43],v[112:115]
 RQ a[84:87],v63 offset:25600
 MM v[116:119],a[108:111],a[40:43],v[116:119]
 RQ a[88:91],v63 offset:26624
 BL v62,s[92:95],s37 offen offset:3072 sc1 lds
 MM v[120:123],a[96:99],a[44:47],v[120:123]
 RQ a[92:95],v63 offset:27648
 s_add_u32 s37,s37,114688
 MM v[124:127],a[100:103],a[44:47],v[124:127]
 RQ a[20:23],v47 offset:51200
 MM v[128:131],a[104:107],a[44:47],v[128:131]
 RQ a[24:27],v47 offset:53248
 s_add_u32 m0,s38,32768
 MM v[132:135],a[108:111],a[44:47],v[132:135]
 RQ a[28:31],v47 offset:55296
 BL v58,s[88:91],s36 offen  lds
 MM v[72:75],a[112:115],a[48:51],v[72:75]
 MM v[76:79],a[116:119],a[48:51],v[76:79]
 MM v[80:83],a[120:123],a[48:51],v[80:83]
 MM v[84:87],a[124:127],a[48:51],v[84:87]
 BL v59,s[88:91],s36 offen offset:1024  lds
 MM v[88:91],a[112:115],a[52:55],v[88:91]
 MM v[92:95],a[116:119],a[52:55],v[92:95]
 MM v[96:99],a[120:123],a[52:55],v[96:99]
 MM v[100:103],a[124:127],a[52:55],v[100:103]
 BL v60,s[88:91],s36 offen offset:2048  lds
 MM v[104:107],a[112:115],a[56:59],v[104:107]
 MM v[108:111],a[116:119],a[56:59],v[108:111]
 MM v[112:115],a[120:123],a[56:59],v[112:115]
 MM v[116:119],a[124:127],a[56:59],v[116:119]
 BL v61,s[88:91],s36 offen offset:3072  lds
 MM v[120:123],a[112:115],a[60:63],v[120:123]
 s_add_u32 s36,s36,128
 MM v[124:127],a[116:119],a[60:63],v[124:127]
 MM v[128:131],a[120:123],a[60:63],v[128:131]
 MM v[132:135],a[124:127],a[60:63],v[132:135]
 s_waitcnt vmcnt(24)
 s_waitcnt lgkmcnt(0)
 s_barrier
 MM v[72:75],a[64:67],a[0:3],v[72:75]
 RQ a[32:35],v48
 s_add_u32 m0,s39,98304
 s_nop 0
 BL v62,s[92:95],s37 offen sc1 lds
 MM v[76:79],a[68:71],a[0:3],v[76:79]
 RQ a[96:99],v63 offset:32768
 MM v[80:83],a[72:75],a[0:3],v[80:83]
 RQ a[100:103],v63 offset:33792
 MM v[84:87],a[76:79],a[0:3],v[84:87]
 RQ a[104:107],v63 offset:34816
 BL v62,s[92:95],s37 offen offset:1024 sc1 lds
 MM v[88:91],a[64:67],a[4:7],v[88:91]
 RQ a[108:111],v63 offset:35840
 MM v[92:95],a[68:71],a[4:7],v[92:95]
 RQ a[36:39],v48 offset:2048
 MM v[96:99],a[72:75],a[4:7],v[96:99]
 RQ a[40:43],v48 offset:4096
 MM v[100:103],a[76:79],a[4:7],v[100:103]
 RQ a[44:47],v48 offset:6144
 BL v62,s[92:95],s37 offen offset:2048 sc1 lds
 MM v[104:107],a[64:67],a[8:11],v[104:107]
 RQ a[48:51],v49
 MM v[108:111],a[68:71],a[8:11],v[108:111]
 RQ a[112:115],v63 offset:40960
 MM v[112:115],a[72:75],a[8:11],v[112:115]
 RQ a[116:119],v63 offset:41984
 MM v[116:119],a[76:79],a[8:11],v[116:119]
 RQ a[120:123],v63 offset:43008
 BL v62,s[92:95],s37 offen offset:3072 sc1 lds
 MM v[120:123],a[64:67],a[12:15],v[120:123]
 RQ a[124:127],v63 offset:44032
 s_add_u32 s37,s37,114688
 MM v[124:127],a[68:71],a[12:15],v[124:127]
 RQ a[52:55],v49 offset:2048
 MM v[128:131],a[72:75],a[12:15],v[128:131]
 RQ a[56:59],v49 offset:4096
 s_add_u32 m0,s38,49152
 MM v[132:135],a[76:79],a[12:15],v[132:135]
 RQ a[60:63],v49 offset:6144
 BL v58,s[88:91],s36 offen  lds
 MM v[72:75],a[80:83],a[16:19],v[72:75]
 MM v[76:79],a[84:87],a[16:19],v[76:79]
 MM v[80:83],a[88:91],a[16:19],v[80:83]
 MM v[84:87],a[92:95],a[16:19],v[84:87]
 BL v59,s[88:91],s36 offen offset:1024  lds
 MM v[88:91],a[80:83],a[20:23],v[88:91]
 MM v[92:95],a[84:87],a[20:23],v[92:95]
 MM v[96:99],a[88:91],a[20:23],v[96:99]
 MM v[100:103],a[92:95],a[20:23],v[100:103]
 BL v60,s[88:91],s36 offen offset:2048  lds
 MM v[104:107],a[80:83],a[24:27],v[104:107]
 MM v[108:111],a[84:87],a[24:27],v[108:111]
 MM v[112:115],a[88:91],a[24:27],v[112:115]
 MM v[116:119],a[92:95],a[24:27],v[116:119]
 BL v61,s[88:91],s36 offen offset:3072  lds
 MM v[120:123],a[80:83],a[28:31],v[120:123]
 s_add_u32 s36,s36,128
 MM v[124:127],a[84:87],a[28:31],v[124:127]
 MM v[128:131],a[88:91],a[28:31],v[128:131]
 MM v[132:135],a[92:95],a[28:31],v[132:135]
 s_waitcnt vmcnt(24)
 s_waitcnt lgkmcnt(0)
 s_barrier
 MM v[72:75],a[96:99],a[32:35],v[72:75]
 RQ a[0:3],v46
 s_add_u32 m0,s39,114688
 s_nop 0
 BL v62,s[92:95],s37 offen sc1 lds
 MM v[76:79],a[100:103],a[32:35],v[76:79]
 RQ a[64:67],v63 offset:49152
 MM v[80:83],a[104:107],a[32:35],v[80:83]
 RQ a[68:71],v63 offset:50176
 MM v[84:87],a[108:111],a[32:35],v[84:87]
 RQ a[72:75],v63 offset:51200
 BL v62,s[92:95],s37 offen offset:1024 sc1 lds
 MM v[88:91],a[96:99],a[36:39],v[88:91]
 RQ a[76:79],v63 offset:52224
 MM v[92:95],a[100:103],a[36:39],v[92:95]
 RQ a[4:7],v46 offset:2048
 MM v[96:99],a[104:107],a[36:39],v[96:99]
 RQ a[8:11],v46 offset:4096
 MM v[100:103],a[108:111],a[36:39],v[100:103]
 RQ a[12:15],v46 offset:6144
 BL v62,s[92:95],s37 offen offset:2048 sc1 lds
 MM v[104:107],a[96:99],a[40:43],v[104:107]
 RQ a[16:19],v47
 MM v[108:111],a[100:103],a[40:43],v[108:111]
 RQ a[80:83],v63 offset:57344
 MM v[112:115],a[104:107],a[40:43],v[112:115]
 RQ a[84:87],v63 offset:58368
 MM v[116:119],a[108:111],a[40:43],v[116:119]
 RQ a[88:91],v63 offset:59392
 BL v62,s[92:95],s37 offen offset:3072 sc1 lds
 MM v[120:123],a[96:99],a[44:47],v[120:123]
 RQ a[92:95],v63 offset:60416
 s_add_u32 s37,s37,114688
 MM v[124:127],a[100:103],a[44:47],v[124:127]
 RQ a[20:23],v47 offset:2048
 MM v[128:131],a[104:107],a[44:47],v[128:131]
 RQ a[24:27],v47 offset:4096
 s_add_u32 m0,s38,65536
 MM v[132:135],a[108:111],a[44:47],v[132:135]
 RQ a[28:31],v47 offset:6144
 BL v58,s[88:91],s36 offen  lds
 MM v[72:75],a[112:115],a[48:51],v[72:75]
 MM v[76:79],a[116:119],a[48:51],v[76:79]
 MM v[80:83],a[120:123],a[48:51],v[80:83]
 MM v[84:87],a[124:127],a[48:51],v[84:87]
 BL v59,s[88:91],s36 offen offset:1024  lds
 MM v[88:91],a[112:115],a[52:55],v[88:91]
 MM v[92:95],a[116:119],a[52:55],v[92:95]
 MM v[96:99],a[120:123],a[52:55],v[96:99]
 MM v[100:103],a[124:127],a[52:55],v[100:103]
 BL v60,s[88:91],s36 offen offset:2048  lds
 MM v[104:107],a[112:115],a[56:59],v[104:107]
 MM v[108:111],a[116:119],a[56:59],v[108:111]
 MM v[112:115],a[120:123],a[56:59],v[112:115]
 MM v[116:119],a[124:127],a[56:59],v[116:119]
 BL v61,s[88:91],s36 offen offset:3072  lds
 MM v[120:123],a[112:115],a[60:63],v[120:123]
 s_add_u32 s36,s36,128
 MM v[124:127],a[116:119],a[60:63],v[124:127]
 MM v[128:131],a[120:123],a[60:63],v[128:131]
 MM v[132:135],a[124:127],a[60:63],v[132:135]
 s_waitcnt vmcnt(24)
 s_waitcnt lgkmcnt(0)
 s_barrier
 MM v[72:75],a[64:67],a[0:3],v[72:75]
 RQ a[32:35],v46 offset:16384
 s_add_u32 m0,s39,131072
 s_nop 0
 BL v62,s[92:95],s37 offen sc1 lds
 MM v[76:79],a[68:71],a[0:3],v[76:79]
 RQ a[96:99],v64
 MM v[80:83],a[72:75],a[0:3],v[80:83]
 RQ a[100:103],v64 offset:1024
 MM v[84:87],a[76:79],a[0:3],v[84:87]
 RQ a[104:107],v64 offset:2048
 BL v62,s[92:95],s37 offen offset:1024 sc1 lds
 MM v[88:91],a[64:67],a[4:7],v[88:91]
 RQ a[108:111],v64 offset:3072
 MM v[92:95],a[68:71],a[4:7],v[92:95]
 RQ a[36:39],v46 offset:18432
 MM v[96:99],a[72:75],a[4:7],v[96:99]
 RQ a[40:43],v46 offset:20480
 MM v[100:103],a[76:79],a[4:7],v[100:103]
 RQ a[44:47],v46 offset:22528
 BL v62,s[92:95],s37 offen offset:2048 sc1 lds
 MM v[104:107],a[64:67],a[8:11],v[104:107]
 RQ a[48:51],v47 offset:16384
 MM v[108:111],a[68:71],a[8:11],v[108:111]
 RQ a[112:115],v64 offset:8192
 MM v[112:115],a[72:75],a[8:11],v[112:115]
 RQ a[116:119],v64 offset:9216
 MM v[116:119],a[76:79],a[8:11],v[116:119]
 RQ a[120:123],v64 offset:10240
 BL v62,s[92:95],s37 offen offset:3072 sc1 lds
 MM v[120:123],a[64:67],a[12:15],v[120:123]
 RQ a[124:127],v64 offset:11264
 s_add_u32 s37,s37,114688
 MM v[124:127],a[68:71],a[12:15],v[124:127]
 RQ a[52:55],v47 offset:18432
 MM v[128:131],a[72:75],a[12:15],v[128:131]
 RQ a[56:59],v47 offset:20480
 s_add_u32 m0,s38,0
 MM v[132:135],a[76:79],a[12:15],v[132:135]
 RQ a[60:63],v47 offset:22528
 BL v58,s[88:91],s36 offen  lds
 MM v[72:75],a[80:83],a[16:19],v[72:75]
 MM v[76:79],a[84:87],a[16:19],v[76:79]
 MM v[80:83],a[88:91],a[16:19],v[80:83]
 MM v[84:87],a[92:95],a[16:19],v[84:87]
 BL v59,s[88:91],s36 offen offset:1024  lds
 MM v[88:91],a[80:83],a[20:23],v[88:91]
 MM v[92:95],a[84:87],a[20:23],v[92:95]
 MM v[96:99],a[88:91],a[20:23],v[96:99]
 MM v[100:103],a[92:95],a[20:23],v[100:103]
 BL v60,s[88:91],s36 offen offset:2048  lds
 MM v[104:107],a[80:83],a[24:27],v[104:107]
 MM v[108:111],a[84:87],a[24:27],v[108:111]
 MM v[112:115],a[88:91],a[24:27],v[112:115]
 MM v[116:119],a[92:95],a[24:27],v[116:119]
 BL v61,s[88:91],s36 offen offset:3072  lds
 MM v[120:123],a[80:83],a[28:31],v[120:123]
 s_add_u32 s36,s36,128
 MM v[124:127],a[84:87],a[28:31],v[124:127]
 MM v[128:131],a[88:91],a[28:31],v[128:131]
 MM v[132:135],a[92:95],a[28:31],v[132:135]
 s_waitcnt vmcnt(24)
 s_waitcnt lgkmcnt(0)
 s_barrier
 MM v[72:75],a[96:99],a[32:35],v[72:75]
 RQ a[0:3],v46 offset:32768
 s_add_u32 m0,s39,147456
 s_nop 0
 BL v62,s[92:95],s37 offen sc1 lds
 MM v[76:79],a[100:103],a[32:35],v[76:79]
 RQ a[64:67],v63
 MM v[80:83],a[104:107],a[32:35],v[80:83]
 RQ a[68:71],v63 offset:1024
 MM v[84:87],a[108:111],a[32:35],v[84:87]
 RQ a[72:75],v63 offset:2048
 BL v62,s[92:95],s37 offen offset:1024 sc1 lds
 MM v[88:91],a[96:99],a[36:39],v[88:91]
 RQ a[76:79],v63 offset:3072
 MM v[92:95],a[100:103],a[36:39],v[92:95]
 RQ a[4:7],v46 offset:34816
 MM v[96:99],a[104:107],a[36:39],v[96:99]
 RQ a[8:11],v46 offset:36864
 MM v[100:103],a[108:111],a[36:39],v[100:103]
 RQ a[12:15],v46 offset:38912
 BL v62,s[92:95],s37 offen offset:2048 sc1 lds
 MM v[104:107],a[96:99],a[40:43],v[104:107]
 RQ a[16:19],v47 offset:32768
 MM v[108:111],a[100:103],a[40:43],v[108:111]
 RQ a[80:83],v63 offset:8192
 MM v[112:115],a[104:107],a[40:43],v[112:115]
 RQ a[84:87],v63 offset:9216
 MM v[116:119],a[108:111],a[40:43],v[116:119]
 RQ a[88:91],v63 offset:10240
 BL v62,s[92:95],s37 offen offset:3072 sc1 lds
 MM v[120:123],a[96:99],a[44:47],v[120:123]
 RQ a[92:95],v63 offset:11264
 s_add_u32 s37,s37,114688
 MM v[124:127],a[100:103],a[44:47],v[124:127]
 RQ a[20:23],v47 offset:34816
 MM v[128:131],a[104:107],a[44:47],v[128:131]
 RQ a[24:27],v47 offset:36864
 s_add_u32 m0,s38,16384
 MM v[132:135],a[108:111],a[44:47],v[132:135]
 RQ a[28:31],v47 offset:38912
 BL v58,s[88:91],s36 offen  lds
 MM v[72:75],a[112:115],a[48:51],v[72:75]
 MM v[76:79],a[116:119],a[48:51],v[76:79]
 MM v[80:83],a[120:123],a[48:51],v[80:83]
 MM v[84:87],a[124:127],a[48:51],v[84:87]
 BL v59,s[88:91],s36 offen offset:1024  lds
 MM v[88:91],a[112:115],a[52:55],v[88:91]
 MM v[92:95],a[116:119],a[52:55],v[92:95]
 MM v[96:99],a[120:123],a[52:55],v[96:99]
 MM v[100:103],a[124:127],a[52:55],v[100:103]
 BL v60,s[88:91],s36 offen offset:2048  lds
 MM v[104:107],a[112:115],a[56:59],v[104:107]
 MM v[108:111],a[116:119],a[56:59],v[108:111]
 MM v[112:115],a[120:123],a[56:59],v[112:115]
 MM v[116:119],a[124:127],a[56:59],v[116:119]
 BL v61,s[88:91],s36 offen offset:3072  lds
 MM v[120:123],a[112:115],a[60:63],v[120:123]
 s_add_u32 s36,s36,128
 MM v[124:127],a[116:119],a[60:63],v[124:127]
 MM v[128:131],a[120:123],a[60:63],v[128:131]
 MM v[132:135],a[124:127],a[60:63],v[132:135]
 s_waitcnt vmcnt(24)
 s_waitcnt lgkmcnt(0)
 s_barrier
 MM v[72:75],a[64:67],a[0:3],v[72:75]
 RQ a[32:35],v46 offset:49152
 s_add_u32 m0,s39,81920
 s_nop 0
 BL v62,s[92:95],s37 offen sc1 lds
 MM v[76:79],a[68:71],a[0:3],v[76:79]
 RQ a[96:99],v63 offset:16384
 MM v[80:83],a[72:75],a[0:3],v[80:83]
 RQ a[100:103],v63 offset:17408
 MM v[84:87],a[76:79],a[0:3],v[84:87]
 RQ a[104:107],v63 offset:18432
 BL v62,s[92:95],s37 offen offset:1024 sc1 lds
 MM v[88:91],a[64:67],a[4:7],v[88:91]
 RQ a[108:111],v63 offset:19456
 MM v[92:95],a[68:71],a[4:7],v[92:95]
 RQ a[36:39],v46 offset:51200
 MM v[96:99],a[72:75],a[4:7],v[96:99]
 RQ a[40:43],v46 offset:53248
 MM v[100:103],a[76:79],a[4:7],v[100:103]
 RQ a[44:47],v46 offset:55296
 BL v62,s[92:95],s37 offen offset:2048 sc1 lds
 MM v[104:107],a[64:67],a[8:11],v[104:107]
 RQ a[48:51],v47 offset:49152
 MM v[108:111],a[68:71],a[8:11],v[108:111]
 RQ a[112:115],v63 offset:24576
 MM v[112:115],a[72:75],a[8:11],v[112:115]
 RQ a[116:119],v63 offset:25600
 MM v[116:119],a[76:79],a[8:11],v[116:119]
 RQ a[120:123],v63 offset:26624
 BL v62,s[92:95],s37 offen offset:3072 sc1 lds
 MM v[120:123],a[64:67],a[12:15],v[120:123]
 RQ a[124:127],v63 offset:27648
 s_add_u32 s37,s37,114688
 MM v[124:127],a[68:71],a[12:15],v[124:127]
 RQ a[52:55],v47 offset:51200
 MM v[128:131],a[72:75],a[12:15],v[128:131]
 RQ a[56:59],v47 offset:53248
 s_add_u32 m0,s38,32768
 MM v[132:135],a[76:79],a[12:15],v[132:135]
 RQ a[60:63],v47 offset:55296
 BL v58,s[88:91],s36 offen  lds
 MM v[72:75],a[80:83],a[16:19],v[72:75]
 MM v[76:79],a[84:87],a[16:19],v[76:79]
 MM v[80:83],a[88:91],a[16:19],v[80:83]
 MM v[84:87],a[92:95],a[16:19],v[84:87]
 BL v59,s[88:91],s36 offen offset:1024  lds
 MM v[88:91],a[80:83],a[20:23],v[88:91]
 MM v[92:95],a[84:87],a[20:23],v[92:95]
 MM v[96:99],a[88:91],a[20:23],v[96:99]
 MM v[100:103],a[92:95],a[20:23],v[100:103]
 BL v60,s[88:91],s36 offen offset:2048  lds
 MM v[104:107],a[80:83],a[24:27],v[104:107]
 MM v[108:111],a[84:87],a[24:27],v[108:111]
 MM v[112:115],a[88:91],a[24:27],v[112:115]
 MM v[116:119],a[92:95],a[24:27],v[116:119]
 BL v61,s[88:91],s36 offen offset:3072  lds
 MM v[120:123],a[80:83],a[28:31],v[120:123]
 s_add_u32 s36,s36,128
 MM v[124:127],a[84:87],a[28:31],v[124:127]
 MM v[128:131],a[88:91],a[28:31],v[128:131]
 MM v[132:135],a[92:95],a[28:31],v[132:135]
 s_waitcnt vmcnt(24)
 s_waitcnt lgkmcnt(0)
 s_barrier
 MM v[72:75],a[96:99],a[32:35],v[72:75]
 RQ a[0:3],v48
 s_add_u32 m0,s39,98304
 s_nop 0
 BL v62,s[92:95],s37 offen sc1 lds
 MM v[76:79],a[100:103],a[32:35],v[76:79]
 RQ a[64:67],v63 offset:32768
 MM v[80:83],a[104:107],a[32:35],v[80:83]
 RQ a[68:71],v63 offset:33792
 MM v[84:87],a[108:111],a[32:35],v[84:87]
 RQ a[72:75],v63 offset:34816
 BL v62,s[92:95],s37 offen offset:1024 sc1 lds
 MM v[88:91],a[96:99],a[36:39],v[88:91]
 RQ a[76:79],v63 offset:35840
 MM v[92:95],a[100:103],a[36:39],v[92:95]
 RQ a[4:7],v48 offset:2048
 MM v[96:99],a[104:107],a[36:39],v[96:99]
 RQ a[8:11],v48 offset:4096
 MM v[100:103],a[108:111],a[36:39],v[100:103]
 RQ a[12:15],v48 offset:6144
 BL v62,s[92:95],s37 offen offset:2048 sc1 lds
 MM v[104:107],a[96:99],a[40:43],v[104:107]
 RQ a[16:19],v49
 MM v[108:111],a[100:103],a[40:43],v[108:111]
 RQ a[80:83],v63 offset:40960
 MM v[112:115],a[104:107],a[40:43],v[112:115]
 RQ a[84:87],v63 offset:41984
 MM v[116:119],a[108:111],a[40:43],v[116:119]
 RQ a[88:91],v63 offset:43008
 BL v62,s[92:95],s37 offen offset:3072 sc1 lds
 MM v[120:123],a[96:99],a[44:47],v[120:123]
 RQ a[92:95],v63 offset:44032
 s_add_u32 s37,s37,114688
 MM v[124:127],a[100:103],a[44:47],v[124:127]
 RQ a[20:23],v49 offset:2048
 MM v[128:131],a[104:107],a[44:47],v[128:131]
 RQ a[24:27],v49 offset:4096
 s_add_u32 m0,s38,49152
 MM v[132:135],a[108:111],a[44:47],v[132:135]
 RQ a[28:31],v49 offset:6144
 BL v58,s[88:91],s36 offen  lds
 MM v[72:75],a[112:115],a[48:51],v[72:75]
 MM v[76:79],a[116:119],a[48:51],v[76:79]
 MM v[80:83],a[120:123],a[48:51],v[80:83]
 MM v[84:87],a[124:127],a[48:51],v[84:87]
 BL v59,s[88:91],s36 offen offset:1024  lds
 MM v[88:91],a[112:115],a[52:55],v[88:91]
 MM v[92:95],a[116:119],a[52:55],v[92:95]
 MM v[96:99],a[120:123],a[52:55],v[96:99]
 MM v[100:103],a[124:127],a[52:55],v[100:103]
 BL v60,s[88:91],s36 offen offset:2048  lds
 MM v[104:107],a[112:115],a[56:59],v[104:107]
 MM v[108:111],a[116:119],a[56:59],v[108:111]
 MM v[112:115],a[120:123],a[56:59],v[112:115]
 MM v[116:119],a[124:127],a[56:59],v[116:119]
 BL v61,s[88:91],s36 offen offset:3072  lds
 MM v[120:123],a[112:115],a[60:63],v[120:123]
 s_add_u32 s36,s36,128
 MM v[124:127],a[116:119],a[60:63],v[124:127]
 MM v[128:131],a[120:123],a[60:63],v[128:131]
 MM v[132:135],a[124:127],a[60:63],v[132:135]
 s_sub_u32 s28,s28,1
 s_cmp_lg_u32 s28,0
 s_cbranch_scc1 gh_loop
 s_waitcnt vmcnt(24)
 s_waitcnt lgkmcnt(0)
 s_barrier
 MM v[72:75],a[64:67],a[0:3],v[72:75]
 RQ a[32:35],v46
 s_add_u32 m0,s39,114688
 s_nop 0
 BL v62,s[92:95],s37 offen sc1 lds
 MM v[76:79],a[68:71],a[0:3],v[76:79]
 RQ a[96:99],v63 offset:49152
 MM v[80:83],a[72:75],a[0:3],v[80:83]
 RQ a[100:103],v63 offset:50176
 MM v[84:87],a[76:79],a[0:3],v[84:87]
 RQ a[104:107],v63 offset:51200
 BL v62,s[92:95],s37 offen offset:1024 sc1 lds
 MM v[88:91],a[64:67],a[4:7],v[88:91]
 RQ a[108:111],v63 offset:52224
 MM v[92:95],a[68:71],a[4:7],v[92:95]
 RQ a[36:39],v46 offset:2048
 MM v[96:99],a[72:75],a[4:7],v[96:99]
 RQ a[40:43],v46 offset:4096
 MM v[100:103],a[76:79],a[4:7],v[100:103]
 RQ a[44:47],v46 offset:6144
 BL v62,s[92:95],s37 offen offset:2048 sc1 lds
 MM v[104:107],a[64:67],a[8:11],v[104:107]
 RQ a[48:51],v47
 MM v[108:111],a[68:71],a[8:11],v[108:111]
 RQ a[112:115],v63 offset:57344
 MM v[112:115],a[72:75],a[8:11],v[112:115]
 RQ a[116:119],v63 offset:58368
 MM v[116:119],a[76:79],a[8:11],v[116:119]
 RQ a[120:123],v63 offset:59392
 BL v62,s[92:95],s37 offen offset:3072 sc1 lds
 MM v[120:123],a[64:67],a[12:15],v[120:123]
 RQ a[124:127],v63 offset:60416
 s_add_u32 s37,s37,114688
 MM v[124:127],a[68:71],a[12:15],v[124:127]
 RQ a[52:55],v47 offset:2048
 MM v[128:131],a[72:75],a[12:15],v[128:131]
 RQ a[56:59],v47 offset:4096
 s_add_u32 m0,s38,65536
 MM v[132:135],a[76:79],a[12:15],v[132:135]
 RQ a[60:63],v47 offset:6144
 BL v58,s[88:91],s36 offen  lds
 MM v[72:75],a[80:83],a[16:19],v[72:75]
 MM v[76:79],a[84:87],a[16:19],v[76:79]
 MM v[80:83],a[88:91],a[16:19],v[80:83]
 MM v[84:87],a[92:95],a[16:19],v[84:87]
 BL v59,s[88:91],s36 offen offset:1024  lds
 MM v[88:91],a[80:83],a[20:23],v[88:91]
 MM v[92:95],a[84:87],a[20:23],v[92:95]
 MM v[96:99],a[88:91],a[20:23],v[96:99]
 MM v[100:103],a[92:95],a[20:23],v[100:103]
 BL v60,s[88:91],s36 offen offset:2048  lds
 MM v[104:107],a[80:83],a[24:27],v[104:107]
 MM v[108:111],a[84:87],a[24:27],v[108:111]
 MM v[112:115],a[88:91],a[24:27],v[112:115]
 MM v[116:119],a[92:95],a[24:27],v[116:119]
 BL v61,s[88:91],s36 offen offset:3072  lds
 MM v[120:123],a[80:83],a[28:31],v[120:123]
 s_add_u32 s36,s36,128
 MM v[124:127],a[84:87],a[28:31],v[124:127]
 MM v[128:131],a[88:91],a[28:31],v[128:131]
 MM v[132:135],a[92:95],a[28:31],v[132:135]
 v_min_u32 v69,27,v0
 v_lshlrev_b32 v69,2,v69
 v_add_u32 v68,s100,v69
 s_mov_b32 s27,0
 s_lshl_b32 s26,s74,4
 s_add_u32 s26,s26,s27
 s_lshl_b32 s26,s26,2
 s_add_u32 s26,s26,s35
 s_lshl_b32 s26,s26,2
 s_add_u32 s26,s26,8704
 v_and_b32 v1,7,v0
 v_lshlrev_b32 v1,2,v1
 s_mov_b32 s27,0x88763210
 v_lshrrev_b32 v1,v1,s27
 v_and_b32 v1,15,v1
 v_lshl_add_u32 v1,v1,4,s26
 v_cmp_gt_u32 vcc,48,v0
 s_nop 1
 v_cndmask_b32 v68,v1,v68,vcc
 buffer_load_dword v69,v68,s[0:3],0 offen sc1
 s_waitcnt vmcnt(25)
 s_waitcnt lgkmcnt(0)
 s_barrier
 MM v[72:75],a[96:99],a[32:35],v[72:75]
 RQ a[0:3],v46 offset:16384
 s_add_u32 m0,s39,131072
 s_nop 0
 BL v62,s[92:95],s37 offen sc1 lds
 MM v[76:79],a[100:103],a[32:35],v[76:79]
 RQ a[64:67],v64
 MM v[80:83],a[104:107],a[32:35],v[80:83]
 RQ a[68:71],v64 offset:1024
 MM v[84:87],a[108:111],a[32:35],v[84:87]
 RQ a[72:75],v64 offset:2048
 BL v62,s[92:95],s37 offen offset:1024 sc1 lds
 MM v[88:91],a[96:99],a[36:39],v[88:91]
 RQ a[76:79],v64 offset:3072
 MM v[92:95],a[100:103],a[36:39],v[92:95]
 RQ a[4:7],v46 offset:18432
 MM v[96:99],a[104:107],a[36:39],v[96:99]
 RQ a[8:11],v46 offset:20480
 MM v[100:103],a[108:111],a[36:39],v[100:103]
 RQ a[12:15],v46 offset:22528
 BL v62,s[92:95],s37 offen offset:2048 sc1 lds
 MM v[104:107],a[96:99],a[40:43],v[104:107]
 RQ a[16:19],v47 offset:16384
 MM v[108:111],a[100:103],a[40:43],v[108:111]
 RQ a[80:83],v64 offset:8192
 MM v[112:115],a[104:107],a[40:43],v[112:115]
 RQ a[84:87],v64 offset:9216
 MM v[116:119],a[108:111],a[40:43],v[116:119]
 RQ a[88:91],v64 offset:10240
 BL v62,s[92:95],s37 offen offset:3072 sc1 lds
 MM v[120:123],a[96:99],a[44:47],v[120:123]
 RQ a[92:95],v64 offset:11264
 s_add_u32 s37,s37,114688
 MM v[124:127],a[100:103],a[44:47],v[124:127]
 RQ a[20:23],v47 offset:18432
 MM v[128:131],a[104:107],a[44:47],v[128:131]
 RQ a[24:27],v47 offset:20480
 s_add_u32 m0,s38,0
 MM v[132:135],a[108:111],a[44:47],v[132:135]
 RQ a[28:31],v47 offset:22528
 BL v58,s[88:91],s36 offen  lds
 MM v[72:75],a[112:115],a[48:51],v[72:75]
 MM v[76:79],a[116:119],a[48:51],v[76:79]
 MM v[80:83],a[120:123],a[48:51],v[80:83]
 MM v[84:87],a[124:127],a[48:51],v[84:87]
 BL v59,s[88:91],s36 offen offset:1024  lds
 MM v[88:91],a[112:115],a[52:55],v[88:91]
 MM v[92:95],a[116:119],a[52:55],v[92:95]
 MM v[96:99],a[120:123],a[52:55],v[96:99]
 MM v[100:103],a[124:127],a[52:55],v[100:103]
 BL v60,s[88:91],s36 offen offset:2048  lds
 MM v[104:107],a[112:115],a[56:59],v[104:107]
 MM v[108:111],a[116:119],a[56:59],v[108:111]
 MM v[112:115],a[120:123],a[56:59],v[112:115]
 MM v[116:119],a[124:127],a[56:59],v[116:119]
 BL v61,s[88:91],s36 offen offset:3072  lds
 MM v[120:123],a[112:115],a[60:63],v[120:123]
 s_add_u32 s36,s36,128
 MM v[124:127],a[116:119],a[60:63],v[124:127]
 MM v[128:131],a[120:123],a[60:63],v[128:131]
 MM v[132:135],a[124:127],a[60:63],v[132:135]
 s_waitcnt vmcnt(25)
 s_waitcnt lgkmcnt(0)
 s_barrier
 MM v[72:75],a[64:67],a[0:3],v[72:75]
 RQ a[32:35],v46 offset:32768
 MM v[76:79],a[68:71],a[0:3],v[76:79]
 RQ a[96:99],v63
 MM v[80:83],a[72:75],a[0:3],v[80:83]
 RQ a[100:103],v63 offset:1024
 MM v[84:87],a[76:79],a[0:3],v[84:87]
 RQ a[104:107],v63 offset:2048
 MM v[88:91],a[64:67],a[4:7],v[88:91]
 RQ a[108:111],v63 offset:3072
 MM v[92:95],a[68:71],a[4:7],v[92:95]
 RQ a[36:39],v46 offset:34816
 MM v[96:99],a[72:75],a[4:7],v[96:99]
 RQ a[40:43],v46 offset:36864
 MM v[100:103],a[76:79],a[4:7],v[100:103]
 RQ a[44:47],v46 offset:38912
 MM v[104:107],a[64:67],a[8:11],v[104:107]
 RQ a[48:51],v47 offset:32768
 MM v[108:111],a[68:71],a[8:11],v[108:111]
 RQ a[112:115],v63 offset:8192
 MM v[112:115],a[72:75],a[8:11],v[112:115]
 RQ a[116:119],v63 offset:9216
 MM v[116:119],a[76:79],a[8:11],v[116:119]
 RQ a[120:123],v63 offset:10240
 MM v[120:123],a[64:67],a[12:15],v[120:123]
 RQ a[124:127],v63 offset:11264
 MM v[124:127],a[68:71],a[12:15],v[124:127]
 RQ a[52:55],v47 offset:34816
 MM v[128:131],a[72:75],a[12:15],v[128:131]
 RQ a[56:59],v47 offset:36864
 MM v[132:135],a[76:79],a[12:15],v[132:135]
 RQ a[60:63],v47 offset:38912
 MM v[72:75],a[80:83],a[16:19],v[72:75]
 MM v[76:79],a[84:87],a[16:19],v[76:79]
 MM v[80:83],a[88:91],a[16:19],v[80:83]
 MM v[84:87],a[92:95],a[16:19],v[84:87]
 MM v[88:91],a[80:83],a[20:23],v[88:91]
 MM v[92:95],a[84:87],a[20:23],v[92:95]
 MM v[96:99],a[88:91],a[20:23],v[96:99]
 MM v[100:103],a[92:95],a[20:23],v[100:103]
 MM v[104:107],a[80:83],a[24:27],v[104:107]
 MM v[108:111],a[84:87],a[24:27],v[108:111]
 MM v[112:115],a[88:91],a[24:27],v[112:115]
 MM v[116:119],a[92:95],a[24:27],v[116:119]
 MM v[120:123],a[80:83],a[28:31],v[120:123]
 MM v[124:127],a[84:87],a[28:31],v[124:127]
 MM v[128:131],a[88:91],a[28:31],v[128:131]
 MM v[132:135],a[92:95],a[28:31],v[132:135]
 s_waitcnt vmcnt(17)
 s_waitcnt lgkmcnt(0)
 s_barrier
 MM v[72:75],a[96:99],a[32:35],v[72:75]
 RQ a[0:3],v46 offset:49152
 MM v[76:79],a[100:103],a[32:35],v[76:79]
 RQ a[64:67],v63 offset:16384
 MM v[80:83],a[104:107],a[32:35],v[80:83]
 RQ a[68:71],v63 offset:17408
 MM v[84:87],a[108:111],a[32:35],v[84:87]
 RQ a[72:75],v63 offset:18432
 MM v[88:91],a[96:99],a[36:39],v[88:91]
 RQ a[76:79],v63 offset:19456
 MM v[92:95],a[100:103],a[36:39],v[92:95]
 RQ a[4:7],v46 offset:51200
 MM v[96:99],a[104:107],a[36:39],v[96:99]
 RQ a[8:11],v46 offset:53248
 MM v[100:103],a[108:111],a[36:39],v[100:103]
 RQ a[12:15],v46 offset:55296
 MM v[104:107],a[96:99],a[40:43],v[104:107]
 RQ a[16:19],v47 offset:49152
 MM v[108:111],a[100:103],a[40:43],v[108:111]
 RQ a[80:83],v63 offset:24576
 MM v[112:115],a[104:107],a[40:43],v[112:115]
 RQ a[84:87],v63 offset:25600
 MM v[116:119],a[108:111],a[40:43],v[116:119]
 RQ a[88:91],v63 offset:26624
 MM v[120:123],a[96:99],a[44:47],v[120:123]
 RQ a[92:95],v63 offset:27648
 MM v[124:127],a[100:103],a[44:47],v[124:127]
 RQ a[20:23],v47 offset:51200
 MM v[128:131],a[104:107],a[44:47],v[128:131]
 RQ a[24:27],v47 offset:53248
 MM v[132:135],a[108:111],a[44:47],v[132:135]
 RQ a[28:31],v47 offset:55296
 MM v[72:75],a[112:115],a[48:51],v[72:75]
 MM v[76:79],a[116:119],a[48:51],v[76:79]
 MM v[80:83],a[120:123],a[48:51],v[80:83]
 MM v[84:87],a[124:127],a[48:51],v[84:87]
 MM v[88:91],a[112:115],a[52:55],v[88:91]
 MM v[92:95],a[116:119],a[52:55],v[92:95]
 MM v[96:99],a[120:123],a[52:55],v[96:99]
 MM v[100:103],a[124:127],a[52:55],v[100:103]
 MM v[104:107],a[112:115],a[56:59],v[104:107]
 MM v[108:111],a[116:119],a[56:59],v[108:111]
 MM v[112:115],a[120:123],a[56:59],v[112:115]
 MM v[116:119],a[124:127],a[56:59],v[116:119]
 MM v[120:123],a[112:115],a[60:63],v[120:123]
 MM v[124:127],a[116:119],a[60:63],v[124:127]
 MM v[128:131],a[120:123],a[60:63],v[128:131]
 MM v[132:135],a[124:127],a[60:63],v[132:135]
 s_mov_b32 s27,0
wk_chk:
 s_waitcnt vmcnt(8)
 v_cmp_le_u32 vcc,1,v69
 s_nop 1
 s_cmp_eq_u64 vcc,-1
 s_cbranch_scc1 wk_ok
 s_add_u32 s27,s27,1
 s_cmp_ge_u32 s27,400000
 s_cbranch_scc1 wk_ok
 s_sleep 1
 buffer_load_dword v69,v68,s[0:3],0 offen sc1
 s_waitcnt vmcnt(0)
 s_branch wk_chk
wk_ok:
 s_waitcnt lgkmcnt(0)
 s_barrier
 MM v[72:75],a[64:67],a[0:3],v[72:75]
 RQ a[32:35],v48
 s_mov_b32 s8,s68
 s_mov_b32 s9,s69
 s_mov_b32 s10,16777216
 s_mov_b32 s11,0x20000
 s_add_u32 s12,s68,16777216
 s_addc_u32 s13,s69,0
 s_mov_b32 s14,16777216
 s_mov_b32 s15,0x20000
 s_lshl_b32 s81,s35,13
 v_add_u32 v2,s81,v6
 v_add_u32 v1,4096,v2
 s_mov_b32 s39,32768
 s_mov_b32 s25,163840
 s_mov_b32 s37,0
 s_lshl_b32 s31,s74,20
 s_lshl_b32 s32,s76,15
 s_add_u32 s20,s31,s32
 s_mov_b32 s21,s20
 s_lshl_b32 s32,s77,15
 s_add_u32 s24,s31,s32
 s_add_u32 s22,s39,s81
 s_mov_b32 s23,s22
 s_add_u32 s23,s23,65536
 s_sub_u32 s34,s23,163840
 s_min_u32 s23,s23,s34
 s_cmp_lt_u32 s20,s24
 s_cselect_b32 s10,16777216,0
 s_cselect_b32 m0,s22,196608
 s_nop 0
 BL v2,s[8:11],s20 offen sc1 lds
 MM v[76:79],a[68:71],a[0:3],v[76:79]
 RQ a[96:99],v63 offset:32768
 MM v[80:83],a[72:75],a[0:3],v[80:83]
 RQ a[100:103],v63 offset:33792
 MM v[84:87],a[76:79],a[0:3],v[84:87]
 RQ a[104:107],v63 offset:34816
 BL v2,s[8:11],s20 offen offset:1024 sc1 lds
 MM v[88:91],a[64:67],a[4:7],v[88:91]
 RQ a[108:111],v63 offset:35840
 MM v[92:95],a[68:71],a[4:7],v[92:95]
 RQ a[36:39],v48 offset:2048
 MM v[96:99],a[72:75],a[4:7],v[96:99]
 RQ a[40:43],v48 offset:4096
 MM v[100:103],a[76:79],a[4:7],v[100:103]
 RQ a[44:47],v48 offset:6144
 BL v2,s[8:11],s20 offen offset:2048 sc1 lds
 MM v[104:107],a[64:67],a[8:11],v[104:107]
 RQ a[48:51],v49
 MM v[108:111],a[68:71],a[8:11],v[108:111]
 RQ a[112:115],v63 offset:40960
 MM v[112:115],a[72:75],a[8:11],v[112:115]
 RQ a[116:119],v63 offset:41984
 MM v[116:119],a[76:79],a[8:11],v[116:119]
 RQ a[120:123],v63 offset:43008
 BL v2,s[8:11],s20 offen offset:3072 sc1 lds
 MM v[120:123],a[64:67],a[12:15],v[120:123]
 RQ a[124:127],v63 offset:44032
 MM v[124:127],a[68:71],a[12:15],v[124:127]
 RQ a[52:55],v49 offset:2048
 MM v[128:131],a[72:75],a[12:15],v[128:131]
 RQ a[56:59],v49 offset:4096
 s_add_u32 m0,m0,4096
 MM v[132:135],a[76:79],a[12:15],v[132:135]
 RQ a[60:63],v49 offset:6144
 BL v1,s[8:11],s20 offen sc1 lds
 MM v[72:75],a[80:83],a[16:19],v[72:75]
 MM v[76:79],a[84:87],a[16:19],v[76:79]
 MM v[80:83],a[88:91],a[16:19],v[80:83]
 MM v[84:87],a[92:95],a[16:19],v[84:87]
 BL v1,s[8:11],s20 offen offset:1024 sc1 lds
 MM v[88:91],a[80:83],a[20:23],v[88:91]
 MM v[92:95],a[84:87],a[20:23],v[92:95]
 MM v[96:99],a[88:91],a[20:23],v[96:99]
 MM v[100:103],a[92:95],a[20:23],v[100:103]
 BL v1,s[8:11],s20 offen offset:2048 sc1 lds
 MM v[104:107],a[80:83],a[24:27],v[104:107]
 MM v[108:111],a[84:87],a[24:27],v[108:111]
 MM v[112:115],a[88:91],a[24:27],v[112:115]
 MM v[116:119],a[92:95],a[24:27],v[116:119]
 BL v1,s[8:11],s20 offen offset:3072 sc1 lds
 MM v[120:123],a[80:83],a[28:31],v[120:123]
 s_add_u32 s20,s20,32768
 s_add_u32 s22,s22,32768
 s_sub_u32 s34,s22,163840
 s_min_u32 s22,s22,s34
 MM v[124:127],a[84:87],a[28:31],v[124:127]
 s_add_u32 s16,s68,33554432
 s_addc_u32 s17,s69,0
 s_mov_b32 s18,16777216
 s_mov_b32 s19,0x20000
 s_lshl_b32 s31,s74,20
 s_lshl_b32 s32,s75,16
 s_add_u32 s31,s31,s32
 s_lshl_b32 s32,s35,14
 s_add_u32 s31,s31,s32
 BL a[128:131],v6,s[16:19],s31 offen sc1
 BL a[132:135],v6,s[16:19],s31 offen offset:1024 sc1
 BL a[136:139],v6,s[16:19],s31 offen offset:2048 sc1
 BL a[140:143],v6,s[16:19],s31 offen offset:3072 sc1
 s_add_u32 s31,s31,4096
 BL a[144:147],v6,s[16:19],s31 offen sc1
 BL a[148:151],v6,s[16:19],s31 offen offset:1024 sc1
 BL a[152:155],v6,s[16:19],s31 offen offset:2048 sc1
 BL a[156:159],v6,s[16:19],s31 offen offset:3072 sc1
 s_add_u32 s31,s31,4096
 BL a[160:163],v6,s[16:19],s31 offen sc1
 BL a[164:167],v6,s[16:19],s31 offen offset:1024 sc1
 BL a[168:171],v6,s[16:19],s31 offen offset:2048 sc1
 BL a[172:175],v6,s[16:19],s31 offen offset:3072 sc1
 s_add_u32 s31,s31,4096
 BL a[176:179],v6,s[16:19],s31 offen sc1
 BL a[180:183],v6,s[16:19],s31 offen offset:1024 sc1
 BL a[184:187],v6,s[16:19],s31 offen offset:2048 sc1
 BL a[188:191],v6,s[16:19],s31 offen offset:3072 sc1
 MM v[128:131],a[88:91],a[28:31],v[128:131]
 MM v[132:135],a[92:95],a[28:31],v[132:135]
 s_waitcnt vmcnt(24)
 s_waitcnt lgkmcnt(0)
 s_barrier
 MM v[72:75],a[96:99],a[32:35],v[72:75]
 RQ a[0:3],v46
 s_cmp_lt_u32 s20,s24
 s_cselect_b32 s10,16777216,0
 s_cselect_b32 m0,s22,196608
 s_nop 0
 BL v2,s[8:11],s20 offen sc1 lds
 MM v[76:79],a[100:103],a[32:35],v[76:79]
 RQ a[64:67],v63 offset:49152
 BL v2,s[8:11],s20 offen offset:1024 sc1 lds
 MM v[80:83],a[104:107],a[32:35],v[80:83]
 RQ a[68:71],v63 offset:50176
 MM v[84:87],a[108:111],a[32:35],v[84:87]
 RQ a[72:75],v63 offset:51200
 BL v2,s[8:11],s20 offen offset:2048 sc1 lds
 MM v[88:91],a[96:99],a[36:39],v[88:91]
 RQ a[76:79],v63 offset:52224
 MM v[92:95],a[100:103],a[36:39],v[92:95]
 RQ a[4:7],v46 offset:2048
 BL v2,s[8:11],s20 offen offset:3072 sc1 lds
 MM v[96:99],a[104:107],a[36:39],v[96:99]
 RQ a[8:11],v46 offset:4096
 s_add_u32 m0,m0,4096
 MM v[100:103],a[108:111],a[36:39],v[100:103]
 RQ a[12:15],v46 offset:6144
 BL v1,s[8:11],s20 offen sc1 lds
 MM v[104:107],a[96:99],a[40:43],v[104:107]
 RQ a[16:19],v47
 MM v[108:111],a[100:103],a[40:43],v[108:111]
 RQ a[80:83],v63 offset:57344
 BL v1,s[8:11],s20 offen offset:1024 sc1 lds
 MM v[112:115],a[104:107],a[40:43],v[112:115]
 RQ a[84:87],v63 offset:58368
 MM v[116:119],a[108:111],a[40:43],v[116:119]
 RQ a[88:91],v63 offset:59392
 BL v1,s[8:11],s20 offen offset:2048 sc1 lds
 MM v[120:123],a[96:99],a[44:47],v[120:123]
 RQ a[92:95],v63 offset:60416
 MM v[124:127],a[100:103],a[44:47],v[124:127]
 RQ a[20:23],v47 offset:2048
 BL v1,s[8:11],s20 offen offset:3072 sc1 lds
 s_add_u32 s20,s20,32768
 s_add_u32 s22,s22,65536
 s_sub_u32 s34,s22,163840
 s_min_u32 s22,s22,s34
 MM v[128:131],a[104:107],a[44:47],v[128:131]
 RQ a[24:27],v47 offset:4096
 s_cmp_lt_u32 s21,s24
 s_cselect_b32 s14,16777216,0
 s_cselect_b32 m0,s23,196608
 MM v[132:135],a[108:111],a[44:47],v[132:135]
 RQ a[28:31],v47 offset:6144
 BL v2,s[12:15],s21 offen sc1 lds
 MM v[72:75],a[112:115],a[48:51],v[72:75]
 MM v[76:79],a[116:119],a[48:51],v[76:79]
 BL v2,s[12:15],s21 offen offset:1024 sc1 lds
 MM v[80:83],a[120:123],a[48:51],v[80:83]
 MM v[84:87],a[124:127],a[48:51],v[84:87]
 BL v2,s[12:15],s21 offen offset:2048 sc1 lds
 MM v[88:91],a[112:115],a[52:55],v[88:91]
 MM v[92:95],a[116:119],a[52:55],v[92:95]
 BL v2,s[12:15],s21 offen offset:3072 sc1 lds
 MM v[96:99],a[120:123],a[52:55],v[96:99]
 s_add_u32 m0,m0,4096
 MM v[100:103],a[124:127],a[52:55],v[100:103]
 BL v1,s[12:15],s21 offen sc1 lds
 MM v[104:107],a[112:115],a[56:59],v[104:107]
 MM v[108:111],a[116:119],a[56:59],v[108:111]
 BL v1,s[12:15],s21 offen offset:1024 sc1 lds
 MM v[112:115],a[120:123],a[56:59],v[112:115]
 MM v[116:119],a[124:127],a[56:59],v[116:119]
 BL v1,s[12:15],s21 offen offset:2048 sc1 lds
 MM v[120:123],a[112:115],a[60:63],v[120:123]
 MM v[124:127],a[116:119],a[60:63],v[124:127]
 BL v1,s[12:15],s21 offen offset:3072 sc1 lds
 MM v[128:131],a[120:123],a[60:63],v[128:131]
 s_add_u32 s21,s21,32768
 s_add_u32 s23,s23,65536
 s_sub_u32 s34,s23,163840
 s_min_u32 s23,s23,s34
 MM v[132:135],a[124:127],a[60:63],v[132:135]
 s_waitcnt lgkmcnt(0)
 s_barrier
 MM v[72:75],a[64:67],a[0:3],v[72:75]
 MM v[76:79],a[68:71],a[0:3],v[76:79]
 MM v[80:83],a[72:75],a[0:3],v[80:83]
 MM v[84:87],a[76:79],a[0:3],v[84:87]
 MM v[88:91],a[64:67],a[4:7],v[88:91]
 MM v[92:95],a[68:71],a[4:7],v[92:95]
 MM v[96:99],a[72:75],a[4:7],v[96:99]
 MM v[100:103],a[76:79],a[4:7],v[100:103]
 MM v[104:107],a[64:67],a[8:11],v[104:107]
 MM v[108:111],a[68:71],a[8:11],v[108:111]
 MM v[112:115],a[72:75],a[8:11],v[112:115]
 MM v[116:119],a[76:79],a[8:11],v[116:119]
 MM v[120:123],a[64:67],a[12:15],v[120:123]
 MM v[124:127],a[68:71],a[12:15],v[124:127]
 MM v[128:131],a[72:75],a[12:15],v[128:131]
 MM v[132:135],a[76:79],a[12:15],v[132:135]
 MM v[72:75],a[80:83],a[16:19],v[72:75]
 MM v[76:79],a[84:87],a[16:19],v[76:79]
 MM v[80:83],a[88:91],a[16:19],v[80:83]
 MM v[84:87],a[92:95],a[16:19],v[84:87]
 MM v[88:91],a[80:83],a[20:23],v[88:91]
 MM v[92:95],a[84:87],a[20:23],v[92:95]
 MM v[96:99],a[88:91],a[20:23],v[96:99]
 MM v[100:103],a[92:95],a[20:23],v[100:103]
 MM v[104:107],a[80:83],a[24:27],v[104:107]
 MM v[108:111],a[84:87],a[24:27],v[108:111]
 MM v[112:115],a[88:91],a[24:27],v[112:115]
 MM v[116:119],a[92:95],a[24:27],v[116:119]
 MM v[120:123],a[80:83],a[28:31],v[120:123]
 MM v[124:127],a[84:87],a[28:31],v[124:127]
 MM v[128:131],a[88:91],a[28:31],v[128:131]
 MM v[132:135],a[92:95],a[28:31],v[132:135]
 s_add_u32 s16,s68,50331648
 s_addc_u32 s17,s69,0
 s_mov_b32 s18,20447232
 s_mov_b32 s19,0x20000
 s_and_b32 s85,s35,1
 s_lshl_b32 s84,s82,1
 s_add_u32 s84,s84,s85
 s_mul_i32 s84,s84,624
 s_lshl_b32 s85,s83,2
 s_add_u32 s84,s84,s85
 s_lshr_b32 s85,s35,1
 s_lshl_b32 s85,s85,1
 s_add_u32 s84,s84,s85
 s_lshl_b32 s84,s84,10
 v_lshlrev_b32 v28,16,v24
 v_pk_add_f32 v[72:73],v[72:73],v[28:29] op_sel_hi:[1,0]
 PM v[72:73],v[72:73],v[136:137]
 v_pk_add_f32 v[74:75],v[74:75],v[28:29] op_sel_hi:[1,0]
 PM v[74:75],v[74:75],v[138:139]
 v_pk_add_f32 v[76:77],v[76:77],v[28:29] op_sel_hi:[1,0]
 PM v[76:77],v[76:77],v[140:141]
 v_pk_add_f32 v[78:79],v[78:79],v[28:29] op_sel_hi:[1,0]
 PM v[78:79],v[78:79],v[142:143]
 CV v72,v72,v73
 CV v73,v74,v75
 CV v74,v76,v77
 CV v75,v78,v79
 BS v[72:75],v6,s[16:19],s84 offen sc1
 v_pk_add_f32 v[80:81],v[80:81],v[28:29] op_sel_hi:[1,0]
 PM v[80:81],v[80:81],v[144:145]
 v_pk_add_f32 v[82:83],v[82:83],v[28:29] op_sel_hi:[1,0]
 PM v[82:83],v[82:83],v[146:147]
 v_pk_add_f32 v[84:85],v[84:85],v[28:29] op_sel_hi:[1,0]
 PM v[84:85],v[84:85],v[148:149]
 v_pk_add_f32 v[86:87],v[86:87],v[28:29] op_sel_hi:[1,0]
 PM v[86:87],v[86:87],v[150:151]
 CV v80,v80,v81
 CV v81,v82,v83
 CV v82,v84,v85
 CV v83,v86,v87
 BS v[80:83],v6,s[16:19],s84 offen offset:1024 sc1
 v_lshlrev_b32 v28,16,v25
 v_pk_add_f32 v[88:89],v[88:89],v[28:29] op_sel_hi:[1,0]
 PM v[88:89],v[88:89],v[152:153]
 v_pk_add_f32 v[90:91],v[90:91],v[28:29] op_sel_hi:[1,0]
 PM v[90:91],v[90:91],v[154:155]
 v_pk_add_f32 v[92:93],v[92:93],v[28:29] op_sel_hi:[1,0]
 PM v[92:93],v[92:93],v[156:157]
 v_pk_add_f32 v[94:95],v[94:95],v[28:29] op_sel_hi:[1,0]
 PM v[94:95],v[94:95],v[158:159]
 CV v88,v88,v89
 CV v89,v90,v91
 CV v90,v92,v93
 CV v91,v94,v95
 s_add_u32 s85,s84,159744
 BS v[88:91],v6,s[16:19],s85 offen sc1
 v_pk_add_f32 v[96:97],v[96:97],v[28:29] op_sel_hi:[1,0]
 PM v[96:97],v[96:97],v[160:161]
 v_pk_add_f32 v[98:99],v[98:99],v[28:29] op_sel_hi:[1,0]
 PM v[98:99],v[98:99],v[162:163]
 v_pk_add_f32 v[100:101],v[100:101],v[28:29] op_sel_hi:[1,0]
 PM v[100:101],v[100:101],v[164:165]
 v_pk_add_f32 v[102:103],v[102:103],v[28:29] op_sel_hi:[1,0]
 PM v[102:103],v[102:103],v[166:167]
 CV v96,v96,v97
 CV v97,v98,v99
 CV v98,v100,v101
 CV v99,v102,v103
 s_add_u32 s85,s84,159744
 BS v[96:99],v6,s[16:19],s85 offen offset:1024 sc1
 v_lshlrev_b32 v28,16,v26
 v_pk_add_f32 v[104:105],v[104:105],v[28:29] op_sel_hi:[1,0]
 PM v[104:105],v[104:105],v[168:169]
 v_pk_add_f32 v[106:107],v[106:107],v[28:29] op_sel_hi:[1,0]
 PM v[106:107],v[106:107],v[170:171]
 v_pk_add_f32 v[108:109],v[108:109],v[28:29] op_sel_hi:[1,0]
 PM v[108:109],v[108:109],v[172:173]
 v_pk_add_f32 v[110:111],v[110:111],v[28:29] op_sel_hi:[1,0]
 PM v[110:111],v[110:111],v[174:175]
 CV v104,v104,v105
 CV v105,v106,v107
 CV v106,v108,v109
 CV v107,v110,v111
 s_add_u32 s85,s84,319488
 BS v[104:107],v6,s[16:19],s85 offen sc1
 v_pk_add_f32 v[112:113],v[112:113],v[28:29] op_sel_hi:[1,0]
 PM v[112:113],v[112:113],v[176:177]
 v_pk_add_f32 v[114:115],v[114:115],v[28:29] op_sel_hi:[1,0]
 PM v[114:115],v[114:115],v[178:179]
 v_pk_add_f32 v[116:117],v[116:117],v[28:29] op_sel_hi:[1,0]
 PM v[116:117],v[116:117],v[180:181]
 v_pk_add_f32 v[118:119],v[118:119],v[28:29] op_sel_hi:[1,0]
 PM v[118:119],v[118:119],v[182:183]
 CV v112,v112,v113
 CV v113,v114,v115
 CV v114,v116,v117
 CV v115,v118,v119
 s_add_u32 s85,s84,319488
 BS v[112:115],v6,s[16:19],s85 offen offset:1024 sc1
 v_lshlrev_b32 v28,16,v27
 v_pk_add_f32 v[120:121],v[120:121],v[28:29] op_sel_hi:[1,0]
 PM v[120:121],v[120:121],v[184:185]
 v_pk_add_f32 v[122:123],v[122:123],v[28:29] op_sel_hi:[1,0]
 PM v[122:123],v[122:123],v[186:187]
 v_pk_add_f32 v[124:125],v[124:125],v[28:29] op_sel_hi:[1,0]
 PM v[124:125],v[124:125],v[188:189]
 v_pk_add_f32 v[126:127],v[126:127],v[28:29] op_sel_hi:[1,0]
 PM v[126:127],v[126:127],v[190:191]
 CV v120,v120,v121
 CV v121,v122,v123
 CV v122,v124,v125
 CV v123,v126,v127
 s_add_u32 s85,s84,479232
 BS v[120:123],v6,s[16:19],s85 offen sc1
 v_pk_add_f32 v[128:129],v[128:129],v[28:29] op_sel_hi:[1,0]
 PM v[128:129],v[128:129],v[192:193]
 v_pk_add_f32 v[130:131],v[130:131],v[28:29] op_sel_hi:[1,0]
 PM v[130:131],v[130:131],v[194:195]
 v_pk_add_f32 v[132:133],v[132:133],v[28:29] op_sel_hi:[1,0]
 PM v[132:133],v[132:133],v[196:197]
 v_pk_add_f32 v[134:135],v[134:135],v[28:29] op_sel_hi:[1,0]
 PM v[134:135],v[134:135],v[198:199]
 CV v128,v128,v129
 CV v129,v130,v131
 CV v130,v132,v133
 CV v131,v134,v135
 s_add_u32 s85,s84,479232
 BS v[128:131],v6,s[16:19],s85 offen offset:1024 sc1
 s_lshl_b32 s26,s82,4
 s_add_u32 s26,s26,s83
 s_lshl_b32 s26,s26,2
 s_add_u32 s26,s26,s35
 s_lshl_b32 s26,s26,2
 s_add_u32 s37,s26,4480
 s_waitcnt vmcnt(40)
 s_waitcnt vmcnt(24)
 s_branch L_seg
L_roleZ2:
 s_waitcnt vmcnt(0)
 s_barrier
 v_min_u32 v69,27,v0
 v_lshlrev_b32 v69,2,v69
 v_add_u32 v68,s100,v69
 buffer_load_dword v69,v68,s[0:3],0 offen sc1
 s_mov_b32 s27,0
wkz_chk:
 s_waitcnt vmcnt(0)
 v_cmp_le_u32 vcc,1,v69
 s_nop 1
 s_cmp_eq_u64 vcc,-1
 s_cbranch_scc1 wkz_ok
 s_add_u32 s27,s27,1
 s_cmp_ge_u32 s27,400000
 s_cbranch_scc1 wkz_ok
 s_sleep 1
 buffer_load_dword v69,v68,s[0:3],0 offen sc1
 s_waitcnt vmcnt(0)
 s_branch wkz_chk
wkz_ok:
 s_mov_b32 s8,s68
 s_mov_b32 s9,s69
 s_mov_b32 s10,16777216
 s_mov_b32 s11,0x20000
 s_add_u32 s12,s68,16777216
 s_addc_u32 s13,s69,0
 s_mov_b32 s14,16777216
 s_mov_b32 s15,0x20000
 s_lshl_b32 s81,s35,13
 v_add_u32 v2,s81,v6
 v_add_u32 v1,4096,v2
 s_mov_b32 s39,0
 s_mov_b32 s25,163840
 s_mov_b32 s37,0
 s_lshl_b32 s31,s74,20
 s_lshl_b32 s32,s76,15
 s_add_u32 s20,s31,s32
 s_mov_b32 s21,s20
 s_lshl_b32 s32,s77,15
 s_add_u32 s24,s31,s32
 s_add_u32 s22,s39,s81
 s_mov_b32 s23,s22
 s_add_u32 s23,s23,65536
 s_sub_u32 s34,s23,163840
 s_min_u32 s23,s23,s34
 s_cmp_lt_u32 s20,s24
 s_cselect_b32 s10,16777216,0
 s_cselect_b32 m0,s22,196608
 s_nop 0
 BL v2,s[8:11],s20 offen sc1 lds
 BL v2,s[8:11],s20 offen offset:1024 sc1 lds
 BL v2,s[8:11],s20 offen offset:2048 sc1 lds
 BL v2,s[8:11],s20 offen offset:3072 sc1 lds
 s_add_u32 m0,m0,4096
 s_nop 0
 BL v1,s[8:11],s20 offen sc1 lds
 BL v1,s[8:11],s20 offen offset:1024 sc1 lds
 BL v1,s[8:11],s20 offen offset:2048 sc1 lds
 BL v1,s[8:11],s20 offen offset:3072 sc1 lds
 s_add_u32 s20,s20,32768
 s_add_u32 s22,s22,32768
 s_sub_u32 s34,s22,163840
 s_min_u32 s22,s22,s34
 s_cmp_lt_u32 s20,s24
 s_cselect_b32 s10,16777216,0
 s_cselect_b32 m0,s22,196608
 s_nop 0
 BL v2,s[8:11],s20 offen sc1 lds
 BL v2,s[8:11],s20 offen offset:1024 sc1 lds
 BL v2,s[8:11],s20 offen offset:2048 sc1 lds
 BL v2,s[8:11],s20 offen offset:3072 sc1 lds
 s_add_u32 m0,m0,4096
 s_nop 0
 BL v1,s[8:11],s20 offen sc1 lds
 BL v1,s[8:11],s20 offen offset:1024 sc1 lds
 BL v1,s[8:11],s20 offen offset:2048 sc1 lds
 BL v1,s[8:11],s20 offen offset:3072 sc1 lds
 s_add_u32 s20,s20,32768
 s_add_u32 s22,s22,65536
 s_sub_u32 s34,s22,163840
 s_min_u32 s22,s22,s34
 s_cmp_lt_u32 s21,s24
 s_cselect_b32 s14,16777216,0
 s_cselect_b32 m0,s23,196608
 s_nop 0
 BL v2,s[12:15],s21 offen sc1 lds
 BL v2,s[12:15],s21 offen offset:1024 sc1 lds
 BL v2,s[12:15],s21 offen offset:2048 sc1 lds
 BL v2,s[12:15],s21 offen offset:3072 sc1 lds
 s_add_u32 m0,m0,4096
 s_nop 0
 BL v1,s[12:15],s21 offen sc1 lds
 BL v1,s[12:15],s21 offen offset:1024 sc1 lds
 BL v1,s[12:15],s21 offen offset:2048 sc1 lds
 BL v1,s[12:15],s21 offen offset:3072 sc1 lds
 s_add_u32 s21,s21,32768
 s_add_u32 s23,s23,65536
 s_sub_u32 s34,s23,163840
 s_min_u32 s23,s23,s34
 AW a128,v136
 AW a129,v137
 AW a130,v138
 AW a131,v139
 AW a132,v140
 AW a133,v141
 AW a134,v142
 AW a135,v143
 AW a136,v144
 AW a137,v145
 AW a138,v146
 AW a139,v147
 AW a140,v148
 AW a141,v149
 AW a142,v150
 AW a143,v151
 AW a144,v152
 AW a145,v153
 AW a146,v154
 AW a147,v155
 AW a148,v156
 AW a149,v157
 AW a150,v158
 AW a151,v159
 AW a152,v160
 AW a153,v161
 AW a154,v162
 AW a155,v163
 AW a156,v164
 AW a157,v165
 AW a158,v166
 AW a159,v167
 AW a160,v168
 AW a161,v169
 AW a162,v170
 AW a163,v171
 AW a164,v172
 AW a165,v173
 AW a166,v174
 AW a167,v175
 AW a168,v176
 AW a169,v177
 AW a170,v178
 AW a171,v179
 AW a172,v180
 AW a173,v181
 AW a174,v182
 AW a175,v183
 AW a176,v184
 AW a177,v185
 AW a178,v186
 AW a179,v187
 AW a180,v188
 AW a181,v189
 AW a182,v190
 AW a183,v191
 AW a184,v192
 AW a185,v193
 AW a186,v194
 AW a187,v195
 AW a188,v196
 AW a189,v197
 AW a190,v198
 AW a191,v199
 s_waitcnt vmcnt(16)
L_seg:
 v_add_u32 v3,s39,v6
 v_mov_b32 v4,v3
 v_add_u32 v4,65536,v4
 v_subrev_u32 v31,s25,v4
 v_min_u32 v4,v4,v31
 v_mov_b32 v8,0
 v_mov_b32 v9,0
 v_mov_b32 v10,0
 v_mov_b32 v11,0
 v_mov_b32 v16,0
 v_mov_b32 v12,0
 v_mov_b32 v13,0
 v_mov_b32 v14,0
 v_mov_b32 v15,0
 v_mov_b32 v17,0
 s_mov_b32 s36,0x41000000
 s_mov_b32 s27,s76
 s_lshl_b32 s38,s75,1
 s_cmp_gt_u32 s77,28
 s_cselect_b32 s29,24,64
 s_sub_u32 s31,s77,2
 s_cmp_eq_u32 s78,1
 s_cselect_b32 s29,s29,s31
 s_cselect_b32 s30,0,1
 s_add_u32 s85,s76,1
 s_min_u32 s26,s29,s38
 s_min_u32 s26,s26,s85
 s_waitcnt vmcnt(63)
 s_barrier
 s_waitcnt lgkmcnt(15)
 RQ a[0:3],v3
 RQ a[4:7],v3 offset:1024
 RQ a[8:11],v3 offset:2048
 RQ a[12:15],v3 offset:3072
 RQ a[16:19],v3 offset:4096
 RQ a[20:23],v3 offset:5120
 RQ a[24:27],v3 offset:6144
 RQ a[28:31],v3 offset:7168
 RQ a[32:35],v3 offset:8192
 RQ a[36:39],v3 offset:9216
 RQ a[40:43],v3 offset:10240
 RQ a[44:47],v3 offset:11264
 s_waitcnt lgkmcnt(4)
 MM v[32:35],a[0:3],a[128:131],v[8:11]
 RQ a[48:51],v3 offset:12288
 v_mov_b32 v128,0
 v_mov_b32 v129,0
 MM v[36:39],a[0:3],a[160:163],v[12:15]
 s_cmp_lt_u32 s20,s24
 s_cselect_b32 s10,16777216,0
 v_mov_b32 v130,0
 v_mov_b32 v131,0
 MM v[32:35],a[4:7],a[132:135],v[32:35]
 RQ a[52:55],v3 offset:13312
 s_cselect_b32 m0,s22,196608
 v_mov_b32 v132,0
 v_mov_b32 v133,0
 MM v[36:39],a[4:7],a[164:167],v[36:39]
 BL v2,s[8:11],s20 offen sc1 lds
 v_mov_b32 v134,0
 v_mov_b32 v135,0
 MM v[32:35],a[8:11],a[136:139],v[32:35]
 RQ a[56:59],v3 offset:14336
 v_mov_b32 v136,0
 v_mov_b32 v137,0
 MM v[36:39],a[8:11],a[168:171],v[36:39]
 v_mov_b32 v138,0
 v_mov_b32 v139,0
 MM v[32:35],a[12:15],a[140:143],v[32:35]
 RQ a[60:63],v3 offset:15360
 v_mov_b32 v140,0
 v_mov_b32 v141,0
 MM v[36:39],a[12:15],a[172:175],v[36:39]
 BL v2,s[8:11],s20 offen offset:1024 sc1 lds
 v_mov_b32 v142,0
 v_mov_b32 v143,0
 MM v[32:35],a[16:19],a[144:147],v[32:35]
 RQ a[0:3],v3 offset:16384
 v_mov_b32 v144,0
 v_mov_b32 v145,0
 MM v[36:39],a[16:19],a[176:179],v[36:39]
 v_mov_b32 v146,0
 v_mov_b32 v147,0
 MM v[32:35],a[20:23],a[148:151],v[32:35]
 RQ a[4:7],v3 offset:17408
 v_mov_b32 v148,0
 v_mov_b32 v149,0
 MM v[36:39],a[20:23],a[180:183],v[36:39]
 BL v2,s[8:11],s20 offen offset:2048 sc1 lds
 v_mov_b32 v150,0
 v_mov_b32 v151,0
 MM v[32:35],a[24:27],a[152:155],v[32:35]
 RQ a[8:11],v3 offset:18432
 v_mov_b32 v152,0
 v_mov_b32 v153,0
 MM v[36:39],a[24:27],a[184:187],v[36:39]
 v_mov_b32 v154,0
 v_mov_b32 v155,0
 MM v[32:35],a[28:31],a[156:159],v[32:35]
 RQ a[12:15],v3 offset:19456
 v_mov_b32 v156,0
 v_mov_b32 v157,0
 MM v[36:39],a[28:31],a[188:191],v[36:39]
 BL v2,s[8:11],s20 offen offset:3072 sc1 lds
 v_mov_b32 v158,0
 v_mov_b32 v159,0
 s_waitcnt lgkmcnt(4)
 MM v[40:43],a[32:35],a[128:131],v[8:11]
 RQ a[16:19],v3 offset:20480
 s_add_u32 m0,m0,4096
 v_mov_b32 v160,0
 v_mov_b32 v161,0
 MM v[44:47],a[32:35],a[160:163],v[12:15]
 v_mov_b32 v162,0
 v_mov_b32 v163,0
 MM v[40:43],a[36:39],a[132:135],v[40:43]
 RQ a[20:23],v3 offset:21504
 v_mov_b32 v164,0
 v_mov_b32 v165,0
 MM v[44:47],a[36:39],a[164:167],v[44:47]
 BL v1,s[8:11],s20 offen sc1 lds
 v_mov_b32 v166,0
 v_mov_b32 v167,0
 MM v[40:43],a[40:43],a[136:139],v[40:43]
 RQ a[24:27],v3 offset:22528
 v_mov_b32 v168,0
 v_mov_b32 v169,0
 MM v[44:47],a[40:43],a[168:171],v[44:47]
 v_mov_b32 v170,0
 v_mov_b32 v171,0
 MM v[40:43],a[44:47],a[140:143],v[40:43]
 RQ a[28:31],v3 offset:23552
 v_mov_b32 v172,0
 v_mov_b32 v173,0
 MM v[44:47],a[44:47],a[172:175],v[44:47]
 BL v1,s[8:11],s20 offen offset:1024 sc1 lds
 v_mov_b32 v174,0
 v_mov_b32 v175,0
 MM v[40:43],a[48:51],a[144:147],v[40:43]
 RQ a[32:35],v3 offset:24576
 v_mov_b32 v176,0
 v_mov_b32 v177,0
 MM v[44:47],a[48:51],a[176:179],v[44:47]
 v_mov_b32 v178,0
 v_mov_b32 v179,0
 MM v[40:43],a[52:55],a[148:151],v[40:43]
 RQ a[36:39],v3 offset:25600
 v_mov_b32 v180,0
 v_mov_b32 v181,0
 MM v[44:47],a[52:55],a[180:183],v[44:47]
 BL v1,s[8:11],s20 offen offset:2048 sc1 lds
 v_mov_b32 v182,0
 v_mov_b32 v183,0
 MM v[40:43],a[56:59],a[152:155],v[40:43]
 RQ a[40:43],v3 offset:26624
 v_mov_b32 v184,0
 v_mov_b32 v185,0
 MM v[44:47],a[56:59],a[184:187],v[44:47]
 BL v1,s[8:11],s20 offen offset:3072 sc1 lds
 v_mov_b32 v186,0
 v_mov_b32 v187,0
 MM v[40:43],a[60:63],a[156:159],v[40:43]
 RQ a[44:47],v3 offset:27648
 s_add_u32 s20,s20,32768
 v_mov_b32 v188,0
 v_mov_b32 v189,0
 MM v[44:47],a[60:63],a[188:191],v[44:47]
 s_add_u32 s22,s22,65536
 s_sub_u32 s34,s22,163840
 v_mov_b32 v190,0
 v_mov_b32 v191,0
 s_waitcnt lgkmcnt(4)
 MM v[48:51],a[0:3],a[128:131],v[8:11]
 RQ a[48:51],v3 offset:28672
 s_min_u32 s22,s22,s34
 v_mov_b32 v192,0
 v_mov_b32 v193,0
 MM v[52:55],a[0:3],a[160:163],v[12:15]
 s_cmp_lt_u32 s21,s24
 s_cselect_b32 s14,16777216,0
 v_mov_b32 v194,0
 v_mov_b32 v195,0
 MM v[48:51],a[4:7],a[132:135],v[48:51]
 RQ a[52:55],v3 offset:29696
 s_cselect_b32 m0,s23,196608
 v_mov_b32 v196,0
 v_mov_b32 v197,0
 MM v[52:55],a[4:7],a[164:167],v[52:55]
 BL v2,s[12:15],s21 offen sc1 lds
 v_mov_b32 v198,0
 v_mov_b32 v199,0
 MM v[48:51],a[8:11],a[136:139],v[48:51]
 RQ a[56:59],v3 offset:30720
 v_mov_b32 v200,0
 v_mov_b32 v201,0
 MM v[52:55],a[8:11],a[168:171],v[52:55]
 v_mov_b32 v202,0
 v_mov_b32 v203,0
 MM v[48:51],a[12:15],a[140:143],v[48:51]
 RQ a[60:63],v3 offset:31744
 v_mov_b32 v204,0
 v_mov_b32 v205,0
 MM v[52:55],a[12:15],a[172:175],v[52:55]
 BL v2,s[12:15],s21 offen offset:1024 sc1 lds
 v_mov_b32 v206,0
 v_mov_b32 v207,0
 MM v[48:51],a[16:19],a[144:147],v[48:51]
 v_mov_b32 v208,0
 v_mov_b32 v209,0
 MM v[52:55],a[16:19],a[176:179],v[52:55]
 v_mov_b32 v210,0
 v_mov_b32 v211,0
 MM v[48:51],a[20:23],a[148:151],v[48:51]
 v_mov_b32 v212,0
 v_mov_b32 v213,0
 MM v[52:55],a[20:23],a[180:183],v[52:55]
 BL v2,s[12:15],s21 offen offset:2048 sc1 lds
 v_mov_b32 v214,0
 v_mov_b32 v215,0
 MM v[48:51],a[24:27],a[152:155],v[48:51]
 v_mov_b32 v216,0
 v_mov_b32 v217,0
 MM v[52:55],a[24:27],a[184:187],v[52:55]
 v_mov_b32 v218,0
 v_mov_b32 v219,0
 MM v[48:51],a[28:31],a[156:159],v[48:51]
 v_mov_b32 v220,0
 v_mov_b32 v221,0
 MM v[52:55],a[28:31],a[188:191],v[52:55]
 BL v2,s[12:15],s21 offen offset:3072 sc1 lds
 v_mov_b32 v222,0
 v_mov_b32 v223,0
 s_waitcnt lgkmcnt(0)
 MM v[56:59],a[32:35],a[128:131],v[8:11]
 s_add_u32 m0,m0,4096
 v_mov_b32 v224,0
 v_mov_b32 v225,0
 MM v[60:63],a[32:35],a[160:163],v[12:15]
 v_mov_b32 v226,0
 v_mov_b32 v227,0
 MM v[56:59],a[36:39],a[132:135],v[56:59]
 v_mov_b32 v228,0
 v_mov_b32 v229,0
 MM v[60:63],a[36:39],a[164:167],v[60:63]
 BL v1,s[12:15],s21 offen sc1 lds
 v_mov_b32 v230,0
 v_mov_b32 v231,0
 MM v[56:59],a[40:43],a[136:139],v[56:59]
 v_mov_b32 v232,0
 v_mov_b32 v233,0
 MM v[60:63],a[40:43],a[168:171],v[60:63]
 v_mov_b32 v234,0
 v_mov_b32 v235,0
 MM v[56:59],a[44:47],a[140:143],v[56:59]
 v_mov_b32 v236,0
 v_mov_b32 v237,0
 MM v[60:63],a[44:47],a[172:175],v[60:63]
 BL v1,s[12:15],s21 offen offset:1024 sc1 lds
 v_mov_b32 v238,0
 v_mov_b32 v239,0
 MM v[56:59],a[48:51],a[144:147],v[56:59]
 v_mov_b32 v240,0
 v_mov_b32 v241,0
 MM v[60:63],a[48:51],a[176:179],v[60:63]
 BL v1,s[12:15],s21 offen offset:2048 sc1 lds
 v_mov_b32 v242,0
 v_mov_b32 v243,0
 MM v[56:59],a[52:55],a[148:151],v[56:59]
 v_mov_b32 v244,0
 v_mov_b32 v245,0
 MM v[60:63],a[52:55],a[180:183],v[60:63]
 BL v1,s[12:15],s21 offen offset:3072 sc1 lds
 v_mov_b32 v246,0
 v_mov_b32 v247,0
 MM v[56:59],a[56:59],a[152:155],v[56:59]
 s_add_u32 s21,s21,32768
 s_add_u32 s23,s23,65536
 v_mov_b32 v248,0
 v_mov_b32 v249,0
 MM v[60:63],a[56:59],a[184:187],v[60:63]
 s_sub_u32 s34,s23,163840
 s_min_u32 s23,s23,s34
 v_mov_b32 v250,0
 v_mov_b32 v251,0
 MM v[56:59],a[60:63],a[156:159],v[56:59]
 v_mov_b32 v252,0
 v_mov_b32 v253,0
 MM v[60:63],a[60:63],a[188:191],v[60:63]
 v_mov_b32 v254,0
 v_mov_b32 v255,0
 v_add_u32 v3,32768,v3
 v_subrev_u32 v31,s25,v3
 v_min_u32 v3,v3,v31
 s_waitcnt vmcnt(16)
 s_barrier
 RQ a[0:3],v3
 RQ a[4:7],v3 offset:1024
 RQ a[8:11],v3 offset:2048
 RQ a[12:15],v3 offset:3072
 RQ a[16:19],v3 offset:4096
 RQ a[20:23],v3 offset:5120
 RQ a[24:27],v3 offset:6144
 RQ a[28:31],v3 offset:7168
 RQ a[32:35],v3 offset:8192
 RQ a[36:39],v3 offset:9216
 RQ a[40:43],v3 offset:10240
 RQ a[44:47],v3 offset:11264
 s_cmp_ge_u32 s27,s26
 s_cbranch_scc1 a_h_mask
a_h_mb:
 v_max3_f32 v19,v32,v33,v34
 v_max3_f32 v19,v19,v35,v40
 v_max3_f32 v19,v19,v41,v42
 v_max3_f32 v19,v19,v43,v48
 v_max3_f32 v19,v19,v49,v50
 v_max3_f32 v19,v19,v51,v56
 v_max3_f32 v19,v19,v57,v58
 v_max_f32 v19,v19,v59
 v_max3_f32 v20,v36,v37,v38
 v_max3_f32 v20,v20,v39,v44
 v_max3_f32 v20,v20,v45,v46
 v_max3_f32 v20,v20,v47,v52
 v_max3_f32 v20,v20,v53,v54
 v_max3_f32 v20,v20,v55,v60
 v_max3_f32 v20,v20,v61,v62
 v_max_f32 v20,v20,v63
 v_mov_b32 v26,v19
 v_mov_b32 v27,v20
 s_nop 0
 v_permlane32_swap_b32 v19,v26
 s_nop 0
 v_permlane32_swap_b32 v20,v27
 v_max_f32 v19,v19,v26
 v_max_f32 v20,v20,v27
 v_mov_b32 v26,v19
 v_mov_b32 v27,v20
 s_nop 0
 v_permlane16_swap_b32 v19,v26
 s_nop 0
 v_permlane16_swap_b32 v20,v27
 v_max_f32 v19,v19,v26
 v_max_f32 v20,v20,v27
 v_sub_f32 v32,v32,v19
 v_sub_f32 v33,v33,v19
 v_sub_f32 v34,v34,v19
 v_sub_f32 v35,v35,v19
 v_sub_f32 v40,v40,v19
 v_sub_f32 v41,v41,v19
 v_sub_f32 v42,v42,v19
 v_sub_f32 v43,v43,v19
 v_sub_f32 v48,v48,v19
 v_sub_f32 v49,v49,v19
 v_sub_f32 v50,v50,v19
 v_sub_f32 v51,v51,v19
 v_sub_f32 v56,v56,v19
 v_sub_f32 v57,v57,v19
 v_sub_f32 v58,v58,v19
 v_sub_f32 v59,v59,v19
 v_sub_f32 v8,v8,v19
 v_sub_f32 v9,v9,v19
 v_sub_f32 v10,v10,v19
 v_sub_f32 v11,v11,v19
 v_sub_f32 v36,v36,v20
 v_sub_f32 v37,v37,v20
 v_sub_f32 v38,v38,v20
 v_sub_f32 v39,v39,v20
 v_sub_f32 v44,v44,v20
 v_sub_f32 v45,v45,v20
 v_sub_f32 v46,v46,v20
 v_sub_f32 v47,v47,v20
 v_sub_f32 v52,v52,v20
 v_sub_f32 v53,v53,v20
 v_sub_f32 v54,v54,v20
 v_sub_f32 v55,v55,v20
 v_sub_f32 v60,v60,v20
 v_sub_f32 v61,v61,v20
 v_sub_f32 v62,v62,v20
 v_sub_f32 v63,v63,v20
 v_sub_f32 v12,v12,v20
 v_sub_f32 v13,v13,v20
 v_sub_f32 v14,v14,v20
 v_sub_f32 v15,v15,v20
 s_add_u32 s27,s27,1
 s_cmp_eq_u32 s27,s77
 s_cbranch_scc1 a_tail0
 s_waitcnt lgkmcnt(4)
 s_branch a_loop
 .p2align 6
 s_nop 0
 s_nop 0
a_loop:
 MM v[64:67],a[0:3],a[128:131],v[8:11]
 RQ a[48:51],v3 offset:12288
 MM v[68:71],a[0:3],a[160:163],v[12:15]
 v_exp_f32 v32,v32
 MM v[64:67],a[4:7],a[132:135],v[64:67]
 RQ a[52:55],v3 offset:13312
 v_add_f32 v16,v16,v32
 MM v[68:71],a[4:7],a[164:167],v[68:71]
 s_cmp_lt_u32 s20,s24
 s_cselect_b32 s10,16777216,0
 MM v[64:67],a[8:11],a[136:139],v[64:67]
 RQ a[56:59],v3 offset:14336
 s_cselect_b32 m0,s22,196608
 MM v[68:71],a[8:11],a[168:171],v[68:71]
 BL v2,s[8:11],s20 offen sc1 lds
 MM v[64:67],a[12:15],a[140:143],v[64:67]
 RQ a[60:63],v3 offset:15360
 MM v[68:71],a[12:15],a[172:175],v[68:71]
 v_exp_f32 v33,v33
 MM v[64:67],a[16:19],a[144:147],v[64:67]
 RQ a[0:3],v3 offset:16384
 CV v96,v32,v33
 MM v[68:71],a[16:19],a[176:179],v[68:71]
 v_exp_f32 v34,v34
 MM v[64:67],a[20:23],a[148:151],v[64:67]
 RQ a[4:7],v3 offset:17408
 v_add_f32 v16,v16,v33
 MM v[68:71],a[20:23],a[180:183],v[68:71]
 BL v2,s[8:11],s20 offen offset:1024 sc1 lds
 MM v[64:67],a[24:27],a[152:155],v[64:67]
 RQ a[8:11],v3 offset:18432
 v_add_f32 v16,v16,v34
 MM v[68:71],a[24:27],a[184:187],v[68:71]
 v_exp_f32 v35,v35
 MM v[64:67],a[28:31],a[156:159],v[64:67]
 RQ a[12:15],v3 offset:19456
 s_waitcnt lgkmcnt(4)
 MM v[68:71],a[28:31],a[188:191],v[68:71]
 v_exp_f32 v40,v40
 MM v[72:75],a[32:35],a[128:131],v[8:11]
 RQ a[16:19],v3 offset:20480
 CV v97,v34,v35
 MM v[76:79],a[32:35],a[160:163],v[12:15]
 v_exp_f32 v41,v41
 MM v[72:75],a[36:39],a[132:135],v[72:75]
 RQ a[20:23],v3 offset:21504
 CV v98,v40,v41
 MM v[76:79],a[36:39],a[164:167],v[76:79]
 BL v2,s[8:11],s20 offen offset:2048 sc1 lds
 MM v[72:75],a[40:43],a[136:139],v[72:75]
 RQ a[24:27],v3 offset:22528
 v_add_f32 v16,v16,v35
 MM v[76:79],a[40:43],a[168:171],v[76:79]
 v_exp_f32 v42,v42
 MM v[72:75],a[44:47],a[140:143],v[72:75]
 RQ a[28:31],v3 offset:23552
 v_add_f32 v16,v16,v40
 MM v[76:79],a[44:47],a[172:175],v[76:79]
 v_exp_f32 v43,v43
 MM v[72:75],a[48:51],a[144:147],v[72:75]
 RQ a[32:35],v3 offset:24576
 CV v99,v42,v43
 MM v[76:79],a[48:51],a[176:179],v[76:79]
 BL v2,s[8:11],s20 offen offset:3072 sc1 lds
 MM v[72:75],a[52:55],a[148:151],v[72:75]
 RQ a[36:39],v3 offset:25600
 s_add_u32 m0,m0,4096
 MM v[76:79],a[52:55],a[180:183],v[76:79]
 v_exp_f32 v36,v36
 MM v[72:75],a[56:59],a[152:155],v[72:75]
 RQ a[40:43],v3 offset:26624
 v_add_f32 v16,v16,v41
 MM v[76:79],a[56:59],a[184:187],v[76:79]
 v_exp_f32 v37,v37
 MM v[72:75],a[60:63],a[156:159],v[72:75]
 RQ a[44:47],v3 offset:27648
 s_waitcnt lgkmcnt(4)
 MM v[76:79],a[60:63],a[188:191],v[76:79]
 v_exp_f32 v38,v38
 MM v[80:83],a[0:3],a[128:131],v[8:11]
 RQ a[48:51],v3 offset:28672
 CV v100,v36,v37
 MM v[84:87],a[0:3],a[160:163],v[12:15]
 BL v1,s[8:11],s20 offen sc1 lds
 MM v[80:83],a[4:7],a[132:135],v[80:83]
 RQ a[52:55],v3 offset:29696
 v_add_f32 v16,v16,v42
 MM v[84:87],a[4:7],a[164:167],v[84:87]
 v_exp_f32 v39,v39
 MM v[80:83],a[8:11],a[136:139],v[80:83]
 RQ a[56:59],v3 offset:30720
 CV v101,v38,v39
 MM v[84:87],a[8:11],a[168:171],v[84:87]
 v_exp_f32 v44,v44
 MM v[80:83],a[12:15],a[140:143],v[80:83]
 RQ a[60:63],v3 offset:31744
 v_add_f32 v16,v16,v43
 MM v[84:87],a[12:15],a[172:175],v[84:87]
 BL v1,s[8:11],s20 offen offset:1024 sc1 lds
 MM v[80:83],a[16:19],a[144:147],v[80:83]
 RQ a[0:3],v4
 v_add_f32 v17,v17,v36
 MM v[84:87],a[16:19],a[176:179],v[84:87]
 v_exp_f32 v45,v45
 MM v[80:83],a[20:23],a[148:151],v[80:83]
 RQ a[4:7],v4 offset:1024
 CV v102,v44,v45
 MM v[84:87],a[20:23],a[180:183],v[84:87]
 v_exp_f32 v46,v46
 MM v[80:83],a[24:27],a[152:155],v[80:83]
 RQ a[8:11],v4 offset:2048
 v_add_f32 v17,v17,v37
 MM v[84:87],a[24:27],a[184:187],v[84:87]
 v_exp_f32 v47,v47
 MM v[80:83],a[28:31],a[156:159],v[80:83]
 RQ a[12:15],v4 offset:3072
 s_waitcnt lgkmcnt(4)
 MM v[84:87],a[28:31],a[188:191],v[84:87]
 BL v1,s[8:11],s20 offen offset:2048 sc1 lds
 MM v[88:91],a[32:35],a[128:131],v[8:11]
 RQ a[16:19],v4 offset:4096
 CV v103,v46,v47
 MM v[92:95],a[32:35],a[160:163],v[12:15]
 v_exp_f32 v48,v48
 MM v[88:91],a[36:39],a[132:135],v[88:91]
 RQ a[20:23],v4 offset:5120
 v_add_f32 v17,v17,v38
 MM v[92:95],a[36:39],a[164:167],v[92:95]
 v_exp_f32 v49,v49
 MM v[88:91],a[40:43],a[136:139],v[88:91]
 RQ a[24:27],v4 offset:6144
 CV v104,v48,v49
 MM v[92:95],a[40:43],a[168:171],v[92:95]
 BL v1,s[8:11],s20 offen offset:3072 sc1 lds
 MM v[88:91],a[44:47],a[140:143],v[88:91]
 RQ a[28:31],v4 offset:7168
 s_add_u32 s20,s20,32768
 MM v[92:95],a[44:47],a[172:175],v[92:95]
 s_add_u32 s22,s22,65536
 s_sub_u32 s34,s22,163840
 MM v[88:91],a[48:51],a[144:147],v[88:91]
 RQ a[32:35],v4 offset:8192
 s_min_u32 s22,s22,s34
 MM v[92:95],a[48:51],a[176:179],v[92:95]
 v_exp_f32 v50,v50
 MM v[88:91],a[52:55],a[148:151],v[88:91]
 RQ a[36:39],v4 offset:9216
 v_add_f32 v17,v17,v39
 MM v[92:95],a[52:55],a[180:183],v[92:95]
 v_exp_f32 v51,v51
 MM v[88:91],a[56:59],a[152:155],v[88:91]
 RQ a[40:43],v4 offset:10240
 CV v105,v50,v51
 MM v[92:95],a[56:59],a[184:187],v[92:95]
 v_exp_f32 v56,v56
 MM v[88:91],a[60:63],a[156:159],v[88:91]
 RQ a[44:47],v4 offset:11264
 s_waitcnt lgkmcnt(4)
 MM v[92:95],a[60:63],a[188:191],v[92:95]
 s_waitcnt vmcnt(16)
 s_barrier
 s_cmp_ge_u32 s27,s26
 s_cbranch_scc1 a_i0_mask
a_i0_mb:
 MM v[128:131],a[0:3],v[96:99],v[128:131]
 RQ a[48:51],v4 offset:12288
 v_add_f32 v17,v17,v44
 MM v[132:135],a[0:3],v[100:103],v[132:135]
 v_exp_f32 v57,v57
 MM v[136:139],a[4:7],v[96:99],v[136:139]
 RQ a[52:55],v4 offset:13312
 CV v106,v56,v57
 MM v[140:143],a[4:7],v[100:103],v[140:143]
 v_exp_f32 v58,v58
 MM v[144:147],a[8:11],v[96:99],v[144:147]
 RQ a[56:59],v4 offset:14336
 s_add_u32 s27,s27,1
 v_add_f32 v16,v16,v58
 MM v[148:151],a[8:11],v[100:103],v[148:151]
 v_exp_f32 v59,v59
 MM v[152:155],a[12:15],v[96:99],v[152:155]
 RQ a[60:63],v4 offset:15360
 CV v107,v58,v59
 v_add_f32 v16,v16,v59
 MM v[156:159],a[12:15],v[100:103],v[156:159]
 v_exp_f32 v52,v52
 MM v[160:163],a[16:19],v[96:99],v[160:163]
 RQ a[0:3],v4 offset:16384
 v_max3_f32 v18,v64,v65,v66
 v_add_f32 v17,v17,v52
 MM v[164:167],a[16:19],v[100:103],v[164:167]
 v_exp_f32 v53,v53
 MM v[168:171],a[20:23],v[96:99],v[168:171]
 RQ a[4:7],v4 offset:17408
 CV v108,v52,v53
 v_add_f32 v17,v17,v53
 MM v[172:175],a[20:23],v[100:103],v[172:175]
 v_exp_f32 v54,v54
 MM v[176:179],a[24:27],v[96:99],v[176:179]
 RQ a[8:11],v4 offset:18432
 v_max3_f32 v18,v18,v67,v68
 v_add_f32 v17,v17,v54
 MM v[180:183],a[24:27],v[100:103],v[180:183]
 v_exp_f32 v55,v55
 MM v[184:187],a[28:31],v[96:99],v[184:187]
 RQ a[12:15],v4 offset:19456
 s_waitcnt lgkmcnt(4)
 v_add_f32 v17,v17,v55
 MM v[188:191],a[28:31],v[100:103],v[188:191]
 v_exp_f32 v60,v60
 MM v[192:195],a[32:35],v[96:99],v[192:195]
 RQ a[16:19],v4 offset:20480
 CV v109,v54,v55
 v_add_f32 v17,v17,v60
 MM v[196:199],a[32:35],v[100:103],v[196:199]
 v_exp_f32 v61,v61
 MM v[200:203],a[36:39],v[96:99],v[200:203]
 RQ a[20:23],v4 offset:21504
 CV v110,v60,v61
 v_add_f32 v17,v17,v61
 MM v[204:207],a[36:39],v[100:103],v[204:207]
 v_exp_f32 v62,v62
 MM v[208:211],a[40:43],v[96:99],v[208:211]
 RQ a[24:27],v4 offset:22528
 v_add_u32 v3,65536,v3
 v_add_f32 v17,v17,v62
 MM v[212:215],a[40:43],v[100:103],v[212:215]
 v_subrev_u32 v31,s25,v3
 v_min_u32 v3,v3,v31
 MM v[216:219],a[44:47],v[96:99],v[216:219]
 RQ a[28:31],v4 offset:23552
 v_max3_f32 v18,v18,v69,v70
 MM v[220:223],a[44:47],v[100:103],v[220:223]
 v_exp_f32 v63,v63
 MM v[224:227],a[48:51],v[96:99],v[224:227]
 RQ a[32:35],v4 offset:24576
 CV v111,v62,v63
 v_add_f32 v17,v17,v63
 MM v[228:231],a[48:51],v[100:103],v[228:231]
 s_cmp_lt_u32 s21,s24
 s_cselect_b32 s14,16777216,0
 MM v[232:235],a[52:55],v[96:99],v[232:235]
 RQ a[36:39],v4 offset:25600
 s_cselect_b32 m0,s23,196608
 MM v[236:239],a[52:55],v[100:103],v[236:239]
 BL v2,s[12:15],s21 offen sc1 lds
 MM v[240:243],a[56:59],v[96:99],v[240:243]
 RQ a[40:43],v4 offset:26624
 v_max3_f32 v18,v18,v71,v72
 MM v[244:247],a[56:59],v[100:103],v[244:247]
 v_max3_f32 v18,v18,v73,v74
 v_max3_f32 v18,v18,v75,v76
 MM v[248:251],a[60:63],v[96:99],v[248:251]
 RQ a[44:47],v4 offset:27648
 s_waitcnt lgkmcnt(4)
 MM v[252:255],a[60:63],v[100:103],v[252:255]
 BL v2,s[12:15],s21 offen offset:1024 sc1 lds
 MM v[128:131],a[0:3],v[104:107],v[128:131]
 RQ a[48:51],v4 offset:28672
 v_max3_f32 v18,v18,v77,v78
 MM v[132:135],a[0:3],v[108:111],v[132:135]
 v_max3_f32 v18,v18,v79,v80
 v_max3_f32 v18,v18,v81,v82
 MM v[136:139],a[4:7],v[104:107],v[136:139]
 RQ a[52:55],v4 offset:29696
 v_max3_f32 v18,v18,v83,v84
 MM v[140:143],a[4:7],v[108:111],v[140:143]
 BL v2,s[12:15],s21 offen offset:2048 sc1 lds
 MM v[144:147],a[8:11],v[104:107],v[144:147]
 RQ a[56:59],v4 offset:30720
 v_max3_f32 v18,v18,v85,v86
 MM v[148:151],a[8:11],v[108:111],v[148:151]
 v_max3_f32 v18,v18,v87,v88
 v_max3_f32 v18,v18,v89,v90
 MM v[152:155],a[12:15],v[104:107],v[152:155]
 RQ a[60:63],v4 offset:31744
 v_max3_f32 v18,v18,v91,v92
 MM v[156:159],a[12:15],v[108:111],v[156:159]
 BL v2,s[12:15],s21 offen offset:3072 sc1 lds
 MM v[160:163],a[16:19],v[104:107],v[160:163]
 RQ a[0:3],v3
 s_add_u32 m0,m0,4096
 MM v[164:167],a[16:19],v[108:111],v[164:167]
 v_add_u32 v4,65536,v4
 v_subrev_u32 v31,s25,v4
 MM v[168:171],a[20:23],v[104:107],v[168:171]
 RQ a[4:7],v3 offset:1024
 v_min_u32 v4,v4,v31
 MM v[172:175],a[20:23],v[108:111],v[172:175]
 BL v1,s[12:15],s21 offen sc1 lds
 MM v[176:179],a[24:27],v[104:107],v[176:179]
 RQ a[8:11],v3 offset:2048
 v_max3_f32 v18,v18,v93,v94
 MM v[180:183],a[24:27],v[108:111],v[180:183]
 v_max_f32 v18,v18,v95
 v_cmp_lt_f32 vcc,s36,v18
 MM v[184:187],a[28:31],v[104:107],v[184:187]
 RQ a[12:15],v3 offset:3072
 s_waitcnt lgkmcnt(4)
 MM v[188:191],a[28:31],v[108:111],v[188:191]
 BL v1,s[12:15],s21 offen offset:1024 sc1 lds
 MM v[192:195],a[32:35],v[104:107],v[192:195]
 RQ a[16:19],v3 offset:4096
 v_add_f32 v17,v17,v45
 MM v[196:199],a[32:35],v[108:111],v[196:199]
 v_add_f32 v17,v17,v46
 v_add_f32 v17,v17,v47
 MM v[200:203],a[36:39],v[104:107],v[200:203]
 RQ a[20:23],v3 offset:5120
 v_add_f32 v16,v16,v48
 MM v[204:207],a[36:39],v[108:111],v[204:207]
 BL v1,s[12:15],s21 offen offset:2048 sc1 lds
 MM v[208:211],a[40:43],v[104:107],v[208:211]
 RQ a[24:27],v3 offset:6144
 v_add_f32 v16,v16,v49
 MM v[212:215],a[40:43],v[108:111],v[212:215]
 v_add_f32 v16,v16,v50
 v_add_f32 v16,v16,v51
 MM v[216:219],a[44:47],v[104:107],v[216:219]
 RQ a[28:31],v3 offset:7168
 v_add_f32 v16,v16,v56
 MM v[220:223],a[44:47],v[108:111],v[220:223]
 BL v1,s[12:15],s21 offen offset:3072 sc1 lds
 MM v[224:227],a[48:51],v[104:107],v[224:227]
 RQ a[32:35],v3 offset:8192
 s_add_u32 s21,s21,32768
 MM v[228:231],a[48:51],v[108:111],v[228:231]
 s_add_u32 s23,s23,65536
 s_sub_u32 s34,s23,163840
 MM v[232:235],a[52:55],v[104:107],v[232:235]
 RQ a[36:39],v3 offset:9216
 s_min_u32 s23,s23,s34
 MM v[236:239],a[52:55],v[108:111],v[236:239]
 s_cmp_eq_u32 s27,s77
 s_cselect_b32 s33,-1,0
 MM v[240:243],a[56:59],v[104:107],v[240:243]
 RQ a[40:43],v3 offset:10240
 v_add_f32 v16,v16,v57
 MM v[244:247],a[56:59],v[108:111],v[244:247]
 s_or_b32 s33,s33,vcc_lo
 s_or_b32 s33,s33,vcc_hi
 MM v[248:251],a[60:63],v[104:107],v[248:251]
 RQ a[44:47],v3 offset:11264
 s_waitcnt lgkmcnt(4)
 MM v[252:255],a[60:63],v[108:111],v[252:255]
 s_waitcnt vmcnt(16)
 s_barrier
 s_cbranch_scc1 a_i0_ev
a_mid:
 MM v[32:35],a[0:3],a[128:131],v[8:11]
 RQ a[48:51],v3 offset:12288
 MM v[36:39],a[0:3],a[160:163],v[12:15]
 v_exp_f32 v64,v64
 MM v[32:35],a[4:7],a[132:135],v[32:35]
 RQ a[52:55],v3 offset:13312
 v_add_f32 v16,v16,v64
 MM v[36:39],a[4:7],a[164:167],v[36:39]
 s_cmp_lt_u32 s20,s24
 s_cselect_b32 s10,16777216,0
 MM v[32:35],a[8:11],a[136:139],v[32:35]
 RQ a[56:59],v3 offset:14336
 s_cselect_b32 m0,s22,196608
 MM v[36:39],a[8:11],a[168:171],v[36:39]
 BL v2,s[8:11],s20 offen sc1 lds
 MM v[32:35],a[12:15],a[140:143],v[32:35]
 RQ a[60:63],v3 offset:15360
 MM v[36:39],a[12:15],a[172:175],v[36:39]
 v_exp_f32 v65,v65
 MM v[32:35],a[16:19],a[144:147],v[32:35]
 RQ a[0:3],v3 offset:16384
 CV v96,v64,v65
 MM v[36:39],a[16:19],a[176:179],v[36:39]
 v_exp_f32 v66,v66
 MM v[32:35],a[20:23],a[148:151],v[32:35]
 RQ a[4:7],v3 offset:17408
 v_add_f32 v16,v16,v65
 MM v[36:39],a[20:23],a[180:183],v[36:39]
 BL v2,s[8:11],s20 offen offset:1024 sc1 lds
 MM v[32:35],a[24:27],a[152:155],v[32:35]
 RQ a[8:11],v3 offset:18432
 v_add_f32 v16,v16,v66
 MM v[36:39],a[24:27],a[184:187],v[36:39]
 v_exp_f32 v67,v67
 MM v[32:35],a[28:31],a[156:159],v[32:35]
 RQ a[12:15],v3 offset:19456
 s_waitcnt lgkmcnt(4)
 MM v[36:39],a[28:31],a[188:191],v[36:39]
 v_exp_f32 v72,v72
 MM v[40:43],a[32:35],a[128:131],v[8:11]
 RQ a[16:19],v3 offset:20480
 CV v97,v66,v67
 MM v[44:47],a[32:35],a[160:163],v[12:15]
 v_exp_f32 v73,v73
 MM v[40:43],a[36:39],a[132:135],v[40:43]
 RQ a[20:23],v3 offset:21504
 CV v98,v72,v73
 MM v[44:47],a[36:39],a[164:167],v[44:47]
 BL v2,s[8:11],s20 offen offset:2048 sc1 lds
 MM v[40:43],a[40:43],a[136:139],v[40:43]
 RQ a[24:27],v3 offset:22528
 v_add_f32 v16,v16,v67
 MM v[44:47],a[40:43],a[168:171],v[44:47]
 v_exp_f32 v74,v74
 MM v[40:43],a[44:47],a[140:143],v[40:43]
 RQ a[28:31],v3 offset:23552
 v_add_f32 v16,v16,v72
 MM v[44:47],a[44:47],a[172:175],v[44:47]
 v_exp_f32 v75,v75
 MM v[40:43],a[48:51],a[144:147],v[40:43]
 RQ a[32:35],v3 offset:24576
 CV v99,v74,v75
 MM v[44:47],a[48:51],a[176:179],v[44:47]
 BL v2,s[8:11],s20 offen offset:3072 sc1 lds
 MM v[40:43],a[52:55],a[148:151],v[40:43]
 RQ a[36:39],v3 offset:25600
 s_add_u32 m0,m0,4096
 MM v[44:47],a[52:55],a[180:183],v[44:47]
 v_exp_f32 v68,v68
 MM v[40:43],a[56:59],a[152:155],v[40:43]
 RQ a[40:43],v3 offset:26624
 v_add_f32 v16,v16,v73
 MM v[44:47],a[56:59],a[184:187],v[44:47]
 v_exp_f32 v69,v69
 MM v[40:43],a[60:63],a[156:159],v[40:43]
 RQ a[44:47],v3 offset:27648
 s_waitcnt lgkmcnt(4)
 MM v[44:47],a[60:63],a[188:191],v[44:47]
 v_exp_f32 v70,v70
 MM v[48:51],a[0:3],a[128:131],v[8:11]
 RQ a[48:51],v3 offset:28672
 CV v100,v68,v69
 MM v[52:55],a[0:3],a[160:163],v[12:15]
 BL v1,s[8:11],s20 offen sc1 lds
 MM v[48:51],a[4:7],a[132:135],v[48:51]
 RQ a[52:55],v3 offset:29696
 v_add_f32 v16,v16,v74
 MM v[52:55],a[4:7],a[164:167],v[52:55]
 v_exp_f32 v71,v71
 MM v[48:51],a[8:11],a[136:139],v[48:51]
 RQ a[56:59],v3 offset:30720
 CV v101,v70,v71
 MM v[52:55],a[8:11],a[168:171],v[52:55]
 v_exp_f32 v76,v76
 MM v[48:51],a[12:15],a[140:143],v[48:51]
 RQ a[60:63],v3 offset:31744
 v_add_f32 v16,v16,v75
 MM v[52:55],a[12:15],a[172:175],v[52:55]
 BL v1,s[8:11],s20 offen offset:1024 sc1 lds
 MM v[48:51],a[16:19],a[144:147],v[48:51]
 RQ a[0:3],v4
 v_add_f32 v17,v17,v68
 MM v[52:55],a[16:19],a[176:179],v[52:55]
 v_exp_f32 v77,v77
 MM v[48:51],a[20:23],a[148:151],v[48:51]
 RQ a[4:7],v4 offset:1024
 CV v102,v76,v77
 MM v[52:55],a[20:23],a[180:183],v[52:55]
 v_exp_f32 v78,v78
 MM v[48:51],a[24:27],a[152:155],v[48:51]
 RQ a[8:11],v4 offset:2048
 v_add_f32 v17,v17,v69
 MM v[52:55],a[24:27],a[184:187],v[52:55]
 v_exp_f32 v79,v79
 MM v[48:51],a[28:31],a[156:159],v[48:51]
 RQ a[12:15],v4 offset:3072
 s_waitcnt lgkmcnt(4)
 MM v[52:55],a[28:31],a[188:191],v[52:55]
 BL v1,s[8:11],s20 offen offset:2048 sc1 lds
 MM v[56:59],a[32:35],a[128:131],v[8:11]
 RQ a[16:19],v4 offset:4096
 CV v103,v78,v79
 MM v[60:63],a[32:35],a[160:163],v[12:15]
 v_exp_f32 v80,v80
 MM v[56:59],a[36:39],a[132:135],v[56:59]
 RQ a[20:23],v4 offset:5120
 v_add_f32 v17,v17,v70
 MM v[60:63],a[36:39],a[164:167],v[60:63]
 v_exp_f32 v81,v81
 MM v[56:59],a[40:43],a[136:139],v[56:59]
 RQ a[24:27],v4 offset:6144
 CV v104,v80,v81
 MM v[60:63],a[40:43],a[168:171],v[60:63]
 BL v1,s[8:11],s20 offen offset:3072 sc1 lds
 MM v[56:59],a[44:47],a[140:143],v[56:59]
 RQ a[28:31],v4 offset:7168
 s_add_u32 s20,s20,32768
 MM v[60:63],a[44:47],a[172:175],v[60:63]
 s_add_u32 s22,s22,65536
 s_sub_u32 s34,s22,163840
 MM v[56:59],a[48:51],a[144:147],v[56:59]
 RQ a[32:35],v4 offset:8192
 s_min_u32 s22,s22,s34
 MM v[60:63],a[48:51],a[176:179],v[60:63]
 v_exp_f32 v82,v82
 MM v[56:59],a[52:55],a[148:151],v[56:59]
 RQ a[36:39],v4 offset:9216
 v_add_f32 v17,v17,v71
 MM v[60:63],a[52:55],a[180:183],v[60:63]
 v_exp_f32 v83,v83
 MM v[56:59],a[56:59],a[152:155],v[56:59]
 RQ a[40:43],v4 offset:10240
 CV v105,v82,v83
 MM v[60:63],a[56:59],a[184:187],v[60:63]
 v_exp_f32 v88,v88
 MM v[56:59],a[60:63],a[156:159],v[56:59]
 RQ a[44:47],v4 offset:11264
 s_waitcnt lgkmcnt(4)
 MM v[60:63],a[60:63],a[188:191],v[60:63]
 s_waitcnt vmcnt(16)
 s_barrier
 s_cmp_ge_u32 s27,s26
 s_cbranch_scc1 a_i1_mask
a_i1_mb:
 MM v[128:131],a[0:3],v[96:99],v[128:131]
 RQ a[48:51],v4 offset:12288
 v_add_f32 v17,v17,v76
 MM v[132:135],a[0:3],v[100:103],v[132:135]
 v_exp_f32 v89,v89
 MM v[136:139],a[4:7],v[96:99],v[136:139]
 RQ a[52:55],v4 offset:13312
 CV v106,v88,v89
 MM v[140:143],a[4:7],v[100:103],v[140:143]
 v_exp_f32 v90,v90
 MM v[144:147],a[8:11],v[96:99],v[144:147]
 RQ a[56:59],v4 offset:14336
 s_add_u32 s27,s27,1
 v_add_f32 v16,v16,v90
 MM v[148:151],a[8:11],v[100:103],v[148:151]
 v_exp_f32 v91,v91
 MM v[152:155],a[12:15],v[96:99],v[152:155]
 RQ a[60:63],v4 offset:15360
 CV v107,v90,v91
 v_add_f32 v16,v16,v91
 MM v[156:159],a[12:15],v[100:103],v[156:159]
 v_exp_f32 v84,v84
 MM v[160:163],a[16:19],v[96:99],v[160:163]
 RQ a[0:3],v4 offset:16384
 v_max3_f32 v18,v32,v33,v34
 v_add_f32 v17,v17,v84
 MM v[164:167],a[16:19],v[100:103],v[164:167]
 v_exp_f32 v85,v85
 MM v[168:171],a[20:23],v[96:99],v[168:171]
 RQ a[4:7],v4 offset:17408
 CV v108,v84,v85
 v_add_f32 v17,v17,v85
 MM v[172:175],a[20:23],v[100:103],v[172:175]
 v_exp_f32 v86,v86
 MM v[176:179],a[24:27],v[96:99],v[176:179]
 RQ a[8:11],v4 offset:18432
 v_max3_f32 v18,v18,v35,v36
 v_add_f32 v17,v17,v86
 MM v[180:183],a[24:27],v[100:103],v[180:183]
 v_exp_f32 v87,v87
 MM v[184:187],a[28:31],v[96:99],v[184:187]
 RQ a[12:15],v4 offset:19456
 s_waitcnt lgkmcnt(4)
 v_add_f32 v17,v17,v87
 MM v[188:191],a[28:31],v[100:103],v[188:191]
 v_exp_f32 v92,v92
 MM v[192:195],a[32:35],v[96:99],v[192:195]
 RQ a[16:19],v4 offset:20480
 CV v109,v86,v87
 v_add_f32 v17,v17,v92
 MM v[196:199],a[32:35],v[100:103],v[196:199]
 v_exp_f32 v93,v93
 MM v[200:203],a[36:39],v[96:99],v[200:203]
 RQ a[20:23],v4 offset:21504
 CV v110,v92,v93
 v_add_f32 v17,v17,v93
 MM v[204:207],a[36:39],v[100:103],v[204:207]
 v_exp_f32 v94,v94
 MM v[208:211],a[40:43],v[96:99],v[208:211]
 RQ a[24:27],v4 offset:22528
 v_add_u32 v3,65536,v3
 v_add_f32 v17,v17,v94
 MM v[212:215],a[40:43],v[100:103],v[212:215]
 v_subrev_u32 v31,s25,v3
 v_min_u32 v3,v3,v31
 MM v[216:219],a[44:47],v[96:99],v[216:219]
 RQ a[28:31],v4 offset:23552
 v_max3_f32 v18,v18,v37,v38
 MM v[220:223],a[44:47],v[100:103],v[220:223]
 v_exp_f32 v95,v95
 MM v[224:227],a[48:51],v[96:99],v[224:227]
 RQ a[32:35],v4 offset:24576
 CV v111,v94,v95
 v_add_f32 v17,v17,v95
 MM v[228:231],a[48:51],v[100:103],v[228:231]
 s_cmp_lt_u32 s21,s24
 s_cselect_b32 s14,16777216,0
 MM v[232:235],a[52:55],v[96:99],v[232:235]
 RQ a[36:39],v4 offset:25600
 s_cselect_b32 m0,s23,196608
 MM v[236:239],a[52:55],v[100:103],v[236:239]
 BL v2,s[12:15],s21 offen sc1 lds
 MM v[240:243],a[56:59],v[96:99],v[240:243]
 RQ a[40:43],v4 offset:26624
 v_max3_f32 v18,v18,v39,v40
 MM v[244:247],a[56:59],v[100:103],v[244:247]
 v_max3_f32 v18,v18,v41,v42
 v_max3_f32 v18,v18,v43,v44
 MM v[248:251],a[60:63],v[96:99],v[248:251]
 RQ a[44:47],v4 offset:27648
 s_waitcnt lgkmcnt(4)
 MM v[252:255],a[60:63],v[100:103],v[252:255]
 BL v2,s[12:15],s21 offen offset:1024 sc1 lds
 MM v[128:131],a[0:3],v[104:107],v[128:131]
 RQ a[48:51],v4 offset:28672
 v_max3_f32 v18,v18,v45,v46
 MM v[132:135],a[0:3],v[108:111],v[132:135]
 v_max3_f32 v18,v18,v47,v48
 v_max3_f32 v18,v18,v49,v50
 MM v[136:139],a[4:7],v[104:107],v[136:139]
 RQ a[52:55],v4 offset:29696
 v_max3_f32 v18,v18,v51,v52
 MM v[140:143],a[4:7],v[108:111],v[140:143]
 BL v2,s[12:15],s21 offen offset:2048 sc1 lds
 MM v[144:147],a[8:11],v[104:107],v[144:147]
 RQ a[56:59],v4 offset:30720
 v_max3_f32 v18,v18,v53,v54
 MM v[148:151],a[8:11],v[108:111],v[148:151]
 v_max3_f32 v18,v18,v55,v56
 v_max3_f32 v18,v18,v57,v58
 MM v[152:155],a[12:15],v[104:107],v[152:155]
 RQ a[60:63],v4 offset:31744
 v_max3_f32 v18,v18,v59,v60
 MM v[156:159],a[12:15],v[108:111],v[156:159]
 BL v2,s[12:15],s21 offen offset:3072 sc1 lds
 MM v[160:163],a[16:19],v[104:107],v[160:163]
 RQ a[0:3],v3
 s_add_u32 m0,m0,4096
 MM v[164:167],a[16:19],v[108:111],v[164:167]
 v_add_u32 v4,65536,v4
 v_subrev_u32 v31,s25,v4
 MM v[168:171],a[20:23],v[104:107],v[168:171]
 RQ a[4:7],v3 offset:1024
 v_min_u32 v4,v4,v31
 MM v[172:175],a[20:23],v[108:111],v[172:175]
 BL v1,s[12:15],s21 offen sc1 lds
 MM v[176:179],a[24:27],v[104:107],v[176:179]
 RQ a[8:11],v3 offset:2048
 v_max3_f32 v18,v18,v61,v62
 MM v[180:183],a[24:27],v[108:111],v[180:183]
 v_max_f32 v18,v18,v63
 v_cmp_lt_f32 vcc,s36,v18
 MM v[184:187],a[28:31],v[104:107],v[184:187]
 RQ a[12:15],v3 offset:3072
 s_waitcnt lgkmcnt(4)
 MM v[188:191],a[28:31],v[108:111],v[188:191]
 BL v1,s[12:15],s21 offen offset:1024 sc1 lds
 MM v[192:195],a[32:35],v[104:107],v[192:195]
 RQ a[16:19],v3 offset:4096
 v_add_f32 v17,v17,v77
 MM v[196:199],a[32:35],v[108:111],v[196:199]
 v_add_f32 v17,v17,v78
 v_add_f32 v17,v17,v79
 MM v[200:203],a[36:39],v[104:107],v[200:203]
 RQ a[20:23],v3 offset:5120
 v_add_f32 v16,v16,v80
 MM v[204:207],a[36:39],v[108:111],v[204:207]
 BL v1,s[12:15],s21 offen offset:2048 sc1 lds
 MM v[208:211],a[40:43],v[104:107],v[208:211]
 RQ a[24:27],v3 offset:6144
 v_add_f32 v16,v16,v81
 MM v[212:215],a[40:43],v[108:111],v[212:215]
 v_add_f32 v16,v16,v82
 v_add_f32 v16,v16,v83
 MM v[216:219],a[44:47],v[104:107],v[216:219]
 RQ a[28:31],v3 offset:7168
 v_add_f32 v16,v16,v88
 MM v[220:223],a[44:47],v[108:111],v[220:223]
 BL v1,s[12:15],s21 offen offset:3072 sc1 lds
 MM v[224:227],a[48:51],v[104:107],v[224:227]
 RQ a[32:35],v3 offset:8192
 s_add_u32 s21,s21,32768
 MM v[228:231],a[48:51],v[108:111],v[228:231]
 s_add_u32 s23,s23,65536
 s_sub_u32 s34,s23,163840
 MM v[232:235],a[52:55],v[104:107],v[232:235]
 RQ a[36:39],v3 offset:9216
 s_min_u32 s23,s23,s34
 MM v[236:239],a[52:55],v[108:111],v[236:239]
 s_cmp_eq_u32 s27,s77
 s_cselect_b32 s33,-1,0
 MM v[240:243],a[56:59],v[104:107],v[240:243]
 RQ a[40:43],v3 offset:10240
 v_add_f32 v16,v16,v89
 MM v[244:247],a[56:59],v[108:111],v[244:247]
 s_or_b32 s33,s33,vcc_lo
 s_or_b32 s33,s33,vcc_hi
 MM v[248:251],a[60:63],v[104:107],v[248:251]
 RQ a[44:47],v3 offset:11264
 s_waitcnt lgkmcnt(4)
 MM v[252:255],a[60:63],v[108:111],v[252:255]
 s_waitcnt vmcnt(16)
 s_barrier
 s_cbranch_scc1 a_i1_ev
 s_branch a_loop
a_i0_ev:
 s_cbranch_vccnz a_i0_resc
a_i0_rb:
 s_cmp_lg_u32 s27,s77
 s_cbranch_scc1 a_mid
 s_branch a_tail1
a_i1_ev:
 s_cbranch_vccnz a_i1_resc
a_i1_rb:
 s_cmp_lg_u32 s27,s77
 s_cbranch_scc1 a_loop
 s_branch a_tail0
a_tail0:
 s_cmp_eq_u32 s78,1
 s_cbranch_scc1 a_pre0
 v_readfirstlane_b32 s91,v4
 s_nop 1
 s_add_u32 s88,s91,32768
 s_sub_u32 s34,s88,163840
 s_min_u32 s88,s88,s34
 s_add_u32 s89,s88,32768
 s_sub_u32 s34,s89,163840
 s_min_u32 s89,s89,s34
 s_add_u32 s90,s89,32768
 s_sub_u32 s34,s90,163840
 s_min_u32 s90,s90,s34
 s_add_u32 s91,s90,32768
 s_sub_u32 s34,s91,163840
 s_min_u32 s91,s91,s34
 s_add_u32 s8,s68,50331648
 s_addc_u32 s9,s69,0
 s_mov_b32 s10,20447232
 s_mov_b32 s11,0x20000
 s_mul_i32 s20,s53,1277952
 s_lshl_b32 s34,s99,13
 s_add_u32 s20,s20,s34
 s_mul_i32 s34,s35,319488
 v_lshl_add_u32 v118,v0,4,s34
 v_add_u32 v119,157696,v118
 s_mov_b32 s12,s60
 s_mov_b32 s13,s61
 s_mov_b32 s14,802816
 s_mov_b32 s15,0x20000
 s_mul_i32 s21,s99,229376
 s_lshl_b32 s34,s98,8
 s_add_u32 s21,s21,s34
 v_lshrrev_b32 v124,4,v0
 v_and_b32 v125,15,v0
 v_bfe_u32 v126,v124,0,1
 v_lshlrev_b32 v126,1,v126
 v_xor_b32 v125,v125,v126
 v_bfe_u32 v126,v124,1,1
 v_lshlrev_b32 v126,2,v126
 v_xor_b32 v125,v125,v126
 v_lshlrev_b32 v125,4,v125
 s_mul_i32 s34,s35,14336
 v_mul_u32_u24 v124,896,v124
 v_add_u32 v124,s34,v124
 v_add_u32 v120,v125,v124
 v_xor_b32 v126,128,v125
 v_add_u32 v121,v126,v124
 v_add_u32 v121,2560,v121
 v_add_u32 v122,5120,v120
 v_add_u32 v123,5120,v121
 s_lshl_b32 s34,s35,12
 s_add_u32 s22,s88,s34
 s_add_u32 s24,s89,s34
 s_add_u32 s23,s90,s34
 s_add_u32 s25,s91,s34
 s_waitcnt lgkmcnt(0)
 v_exp_f32 v32,v32
 v_exp_f32 v33,v33
 v_exp_f32 v34,v34
 RQ a[0:3],v4
 v_exp_f32 v35,v35
 v_add_f32 v16,v16,v32
 CV v96,v32,v33
 RQ a[4:7],v4 offset:1024
 v_add_f32 v16,v16,v33
 v_exp_f32 v40,v40
 v_exp_f32 v41,v41
 RQ a[8:11],v4 offset:2048
 v_add_f32 v16,v16,v34
 CV v97,v34,v35
 v_add_f32 v16,v16,v35
 RQ a[12:15],v4 offset:3072
 v_exp_f32 v42,v42
 v_exp_f32 v43,v43
 v_add_f32 v16,v16,v40
 RQ a[16:19],v4 offset:4096
 CV v98,v40,v41
 v_add_f32 v16,v16,v41
 v_exp_f32 v36,v36
 RQ a[20:23],v4 offset:5120
 v_exp_f32 v37,v37
 v_add_f32 v16,v16,v42
 CV v99,v42,v43
 RQ a[24:27],v4 offset:6144
 v_add_f32 v16,v16,v43
 v_exp_f32 v38,v38
 v_exp_f32 v39,v39
 RQ a[28:31],v4 offset:7168
 v_add_f32 v17,v17,v36
 CV v100,v36,v37
 v_add_f32 v17,v17,v37
 RQ a[32:35],v4 offset:8192
 v_exp_f32 v44,v44
 v_exp_f32 v45,v45
 v_add_f32 v17,v17,v38
 RQ a[36:39],v4 offset:9216
 CV v101,v38,v39
 v_add_f32 v17,v17,v39
 v_exp_f32 v46,v46
 RQ a[40:43],v4 offset:10240
 v_exp_f32 v47,v47
 v_add_f32 v17,v17,v44
 CV v102,v44,v45
 RQ a[44:47],v4 offset:11264
 v_add_f32 v17,v17,v45
 v_exp_f32 v48,v48
 v_exp_f32 v49,v49
 v_add_f32 v17,v17,v46
 CV v103,v46,v47
 v_add_f32 v17,v17,v47
 s_waitcnt lgkmcnt(4)
 MM v[128:131],a[0:3],v[96:99],v[128:131]
 RQ a[48:51],v4 offset:12288
 s_add_u32 m0,s23,0
 CV v104,v48,v49
 MM v[132:135],a[0:3],v[100:103],v[132:135]
 BL v120,s[12:15],s21 offen  lds
 v_add_f32 v16,v16,v48
 MM v[136:139],a[4:7],v[96:99],v[136:139]
 RQ a[52:55],v4 offset:13312
 v_exp_f32 v50,v50
 MM v[140:143],a[4:7],v[100:103],v[140:143]
 v_exp_f32 v51,v51
 v_add_f32 v16,v16,v49
 MM v[144:147],a[8:11],v[96:99],v[144:147]
 RQ a[56:59],v4 offset:14336
 v_exp_f32 v56,v56
 MM v[148:151],a[8:11],v[100:103],v[148:151]
 BL v121,s[12:15],s21 offen offset:1024  lds
 CV v105,v50,v51
 MM v[152:155],a[12:15],v[96:99],v[152:155]
 RQ a[60:63],v4 offset:15360
 v_exp_f32 v57,v57
 MM v[156:159],a[12:15],v[100:103],v[156:159]
 v_exp_f32 v58,v58
 CV v106,v56,v57
 MM v[160:163],a[16:19],v[96:99],v[160:163]
 RQ a[0:3],v4 offset:16384
 v_exp_f32 v59,v59
 MM v[164:167],a[16:19],v[100:103],v[164:167]
 BL v122,s[12:15],s21 offen offset:2048  lds
 CV v107,v58,v59
 MM v[168:171],a[20:23],v[96:99],v[168:171]
 RQ a[4:7],v4 offset:17408
 v_exp_f32 v52,v52
 MM v[172:175],a[20:23],v[100:103],v[172:175]
 v_exp_f32 v53,v53
 v_add_f32 v16,v16,v50
 MM v[176:179],a[24:27],v[96:99],v[176:179]
 RQ a[8:11],v4 offset:18432
 v_exp_f32 v54,v54
 MM v[180:183],a[24:27],v[100:103],v[180:183]
 BL v123,s[12:15],s21 offen offset:3072  lds
 CV v108,v52,v53
 MM v[184:187],a[28:31],v[96:99],v[184:187]
 RQ a[12:15],v4 offset:19456
 s_add_u32 s21,s21,57344
 v_add_f32 v16,v16,v51
 MM v[188:191],a[28:31],v[100:103],v[188:191]
 s_add_u32 m0,s22,0
 v_exp_f32 v55,v55
 s_waitcnt lgkmcnt(4)
 MM v[192:195],a[32:35],v[96:99],v[192:195]
 RQ a[16:19],v4 offset:20480
 v_exp_f32 v60,v60
 MM v[196:199],a[32:35],v[100:103],v[196:199]
 BL v118,s[8:11],s20 offen sc1 lds
 CV v109,v54,v55
 MM v[200:203],a[36:39],v[96:99],v[200:203]
 RQ a[20:23],v4 offset:21504
 v_exp_f32 v61,v61
 MM v[204:207],a[36:39],v[100:103],v[204:207]
 v_exp_f32 v62,v62
 CV v110,v60,v61
 MM v[208:211],a[40:43],v[96:99],v[208:211]
 RQ a[24:27],v4 offset:22528
 v_exp_f32 v63,v63
 MM v[212:215],a[40:43],v[100:103],v[212:215]
 BL v118,s[8:11],s20 offen offset:1024 sc1 lds
 CV v111,v62,v63
 MM v[216:219],a[44:47],v[96:99],v[216:219]
 RQ a[28:31],v4 offset:23552
 v_add_f32 v16,v16,v56
 v_add_f32 v16,v16,v57
 MM v[220:223],a[44:47],v[100:103],v[220:223]
 v_add_f32 v16,v16,v58
 v_add_f32 v16,v16,v59
 v_add_f32 v17,v17,v52
 MM v[224:227],a[48:51],v[96:99],v[224:227]
 RQ a[32:35],v4 offset:24576
 v_add_f32 v17,v17,v53
 v_add_f32 v17,v17,v54
 MM v[228:231],a[48:51],v[100:103],v[228:231]
 BL v119,s[8:11],s20 offen offset:2048 sc1 lds
 v_add_f32 v17,v17,v55
 MM v[232:235],a[52:55],v[96:99],v[232:235]
 RQ a[36:39],v4 offset:25600
 v_add_f32 v17,v17,v60
 v_add_f32 v17,v17,v61
 MM v[236:239],a[52:55],v[100:103],v[236:239]
 v_add_f32 v17,v17,v62
 v_add_f32 v17,v17,v63
 MM v[240:243],a[56:59],v[96:99],v[240:243]
 RQ a[40:43],v4 offset:26624
 MM v[244:247],a[56:59],v[100:103],v[244:247]
 BL v119,s[8:11],s20 offen offset:3072 sc1 lds
 MM v[248:251],a[60:63],v[96:99],v[248:251]
 RQ a[44:47],v4 offset:27648
 s_add_u32 s20,s20,2048
 MM v[252:255],a[60:63],v[100:103],v[252:255]
 s_add_u32 m0,s23,16384
 s_waitcnt lgkmcnt(4)
 MM v[128:131],a[0:3],v[104:107],v[128:131]
 RQ a[48:51],v4 offset:28672
 MM v[132:135],a[0:3],v[108:111],v[132:135]
 BL v120,s[12:15],s21 offen  lds
 MM v[136:139],a[4:7],v[104:107],v[136:139]
 RQ a[52:55],v4 offset:29696
 MM v[140:143],a[4:7],v[108:111],v[140:143]
 MM v[144:147],a[8:11],v[104:107],v[144:147]
 RQ a[56:59],v4 offset:30720
 MM v[148:151],a[8:11],v[108:111],v[148:151]
 BL v121,s[12:15],s21 offen offset:1024  lds
 MM v[152:155],a[12:15],v[104:107],v[152:155]
 RQ a[60:63],v4 offset:31744
 MM v[156:159],a[12:15],v[108:111],v[156:159]
 MM v[160:163],a[16:19],v[104:107],v[160:163]
 MM v[164:167],a[16:19],v[108:111],v[164:167]
 BL v122,s[12:15],s21 offen offset:2048  lds
 MM v[168:171],a[20:23],v[104:107],v[168:171]
 MM v[172:175],a[20:23],v[108:111],v[172:175]
 MM v[176:179],a[24:27],v[104:107],v[176:179]
 MM v[180:183],a[24:27],v[108:111],v[180:183]
 BL v123,s[12:15],s21 offen offset:3072  lds
 MM v[184:187],a[28:31],v[104:107],v[184:187]
 s_add_u32 s21,s21,57344
 s_add_u32 m0,s22,16384
 MM v[188:191],a[28:31],v[108:111],v[188:191]
 s_waitcnt lgkmcnt(0)
 MM v[192:195],a[32:35],v[104:107],v[192:195]
 MM v[196:199],a[32:35],v[108:111],v[196:199]
 BL v118,s[8:11],s20 offen sc1 lds
 MM v[200:203],a[36:39],v[104:107],v[200:203]
 MM v[204:207],a[36:39],v[108:111],v[204:207]
 MM v[208:211],a[40:43],v[104:107],v[208:211]
 MM v[212:215],a[40:43],v[108:111],v[212:215]
 BL v118,s[8:11],s20 offen offset:1024 sc1 lds
 MM v[216:219],a[44:47],v[104:107],v[216:219]
 MM v[220:223],a[44:47],v[108:111],v[220:223]
 MM v[224:227],a[48:51],v[104:107],v[224:227]
 MM v[228:231],a[48:51],v[108:111],v[228:231]
 BL v119,s[8:11],s20 offen offset:2048 sc1 lds
 MM v[232:235],a[52:55],v[104:107],v[232:235]
 MM v[236:239],a[52:55],v[108:111],v[236:239]
 MM v[240:243],a[56:59],v[104:107],v[240:243]
 MM v[244:247],a[56:59],v[108:111],v[244:247]
 BL v119,s[8:11],s20 offen offset:3072 sc1 lds
 MM v[248:251],a[60:63],v[104:107],v[248:251]
 s_add_u32 s20,s20,2048
 MM v[252:255],a[60:63],v[108:111],v[252:255]
 s_branch a_end
a_tail1:
 s_cmp_eq_u32 s78,1
 s_cbranch_scc1 a_pre1
 v_readfirstlane_b32 s91,v4
 s_nop 1
 s_add_u32 s88,s91,32768
 s_sub_u32 s34,s88,163840
 s_min_u32 s88,s88,s34
 s_add_u32 s89,s88,32768
 s_sub_u32 s34,s89,163840
 s_min_u32 s89,s89,s34
 s_add_u32 s90,s89,32768
 s_sub_u32 s34,s90,163840
 s_min_u32 s90,s90,s34
 s_add_u32 s91,s90,32768
 s_sub_u32 s34,s91,163840
 s_min_u32 s91,s91,s34
 s_add_u32 s8,s68,50331648
 s_addc_u32 s9,s69,0
 s_mov_b32 s10,20447232
 s_mov_b32 s11,0x20000
 s_mul_i32 s20,s53,1277952
 s_lshl_b32 s34,s99,13
 s_add_u32 s20,s20,s34
 s_mul_i32 s34,s35,319488
 v_lshl_add_u32 v118,v0,4,s34
 v_add_u32 v119,157696,v118
 s_mov_b32 s12,s60
 s_mov_b32 s13,s61
 s_mov_b32 s14,802816
 s_mov_b32 s15,0x20000
 s_mul_i32 s21,s99,229376
 s_lshl_b32 s34,s98,8
 s_add_u32 s21,s21,s34
 v_lshrrev_b32 v124,4,v0
 v_and_b32 v125,15,v0
 v_bfe_u32 v126,v124,0,1
 v_lshlrev_b32 v126,1,v126
 v_xor_b32 v125,v125,v126
 v_bfe_u32 v126,v124,1,1
 v_lshlrev_b32 v126,2,v126
 v_xor_b32 v125,v125,v126
 v_lshlrev_b32 v125,4,v125
 s_mul_i32 s34,s35,14336
 v_mul_u32_u24 v124,896,v124
 v_add_u32 v124,s34,v124
 v_add_u32 v120,v125,v124
 v_xor_b32 v126,128,v125
 v_add_u32 v121,v126,v124
 v_add_u32 v121,2560,v121
 v_add_u32 v122,5120,v120
 v_add_u32 v123,5120,v121
 s_lshl_b32 s34,s35,12
 s_add_u32 s22,s88,s34
 s_add_u32 s24,s89,s34
 s_add_u32 s23,s90,s34
 s_add_u32 s25,s91,s34
 s_waitcnt lgkmcnt(0)
 v_exp_f32 v64,v64
 v_exp_f32 v65,v65
 v_exp_f32 v66,v66
 RQ a[0:3],v4
 v_exp_f32 v67,v67
 v_add_f32 v16,v16,v64
 CV v96,v64,v65
 RQ a[4:7],v4 offset:1024
 v_add_f32 v16,v16,v65
 v_exp_f32 v72,v72
 v_exp_f32 v73,v73
 RQ a[8:11],v4 offset:2048
 v_add_f32 v16,v16,v66
 CV v97,v66,v67
 v_add_f32 v16,v16,v67
 RQ a[12:15],v4 offset:3072
 v_exp_f32 v74,v74
 v_exp_f32 v75,v75
 v_add_f32 v16,v16,v72
 RQ a[16:19],v4 offset:4096
 CV v98,v72,v73
 v_add_f32 v16,v16,v73
 v_exp_f32 v68,v68
 RQ a[20:23],v4 offset:5120
 v_exp_f32 v69,v69
 v_add_f32 v16,v16,v74
 CV v99,v74,v75
 RQ a[24:27],v4 offset:6144
 v_add_f32 v16,v16,v75
 v_exp_f32 v70,v70
 v_exp_f32 v71,v71
 RQ a[28:31],v4 offset:7168
 v_add_f32 v17,v17,v68
 CV v100,v68,v69
 v_add_f32 v17,v17,v69
 RQ a[32:35],v4 offset:8192
 v_exp_f32 v76,v76
 v_exp_f32 v77,v77
 v_add_f32 v17,v17,v70
 RQ a[36:39],v4 offset:9216
 CV v101,v70,v71
 v_add_f32 v17,v17,v71
 v_exp_f32 v78,v78
 RQ a[40:43],v4 offset:10240
 v_exp_f32 v79,v79
 v_add_f32 v17,v17,v76
 CV v102,v76,v77
 RQ a[44:47],v4 offset:11264
 v_add_f32 v17,v17,v77
 v_exp_f32 v80,v80
 v_exp_f32 v81,v81
 v_add_f32 v17,v17,v78
 CV v103,v78,v79
 v_add_f32 v17,v17,v79
 s_waitcnt lgkmcnt(4)
 MM v[128:131],a[0:3],v[96:99],v[128:131]
 RQ a[48:51],v4 offset:12288
 s_add_u32 m0,s23,0
 CV v104,v80,v81
 MM v[132:135],a[0:3],v[100:103],v[132:135]
 BL v120,s[12:15],s21 offen  lds
 v_add_f32 v16,v16,v80
 MM v[136:139],a[4:7],v[96:99],v[136:139]
 RQ a[52:55],v4 offset:13312
 v_exp_f32 v82,v82
 MM v[140:143],a[4:7],v[100:103],v[140:143]
 v_exp_f32 v83,v83
 v_add_f32 v16,v16,v81
 MM v[144:147],a[8:11],v[96:99],v[144:147]
 RQ a[56:59],v4 offset:14336
 v_exp_f32 v88,v88
 MM v[148:151],a[8:11],v[100:103],v[148:151]
 BL v121,s[12:15],s21 offen offset:1024  lds
 CV v105,v82,v83
 MM v[152:155],a[12:15],v[96:99],v[152:155]
 RQ a[60:63],v4 offset:15360
 v_exp_f32 v89,v89
 MM v[156:159],a[12:15],v[100:103],v[156:159]
 v_exp_f32 v90,v90
 CV v106,v88,v89
 MM v[160:163],a[16:19],v[96:99],v[160:163]
 RQ a[0:3],v4 offset:16384
 v_exp_f32 v91,v91
 MM v[164:167],a[16:19],v[100:103],v[164:167]
 BL v122,s[12:15],s21 offen offset:2048  lds
 CV v107,v90,v91
 MM v[168:171],a[20:23],v[96:99],v[168:171]
 RQ a[4:7],v4 offset:17408
 v_exp_f32 v84,v84
 MM v[172:175],a[20:23],v[100:103],v[172:175]
 v_exp_f32 v85,v85
 v_add_f32 v16,v16,v82
 MM v[176:179],a[24:27],v[96:99],v[176:179]
 RQ a[8:11],v4 offset:18432
 v_exp_f32 v86,v86
 MM v[180:183],a[24:27],v[100:103],v[180:183]
 BL v123,s[12:15],s21 offen offset:3072  lds
 CV v108,v84,v85
 MM v[184:187],a[28:31],v[96:99],v[184:187]
 RQ a[12:15],v4 offset:19456
 s_add_u32 s21,s21,57344
 v_add_f32 v16,v16,v83
 MM v[188:191],a[28:31],v[100:103],v[188:191]
 s_add_u32 m0,s22,0
 v_exp_f32 v87,v87
 s_waitcnt lgkmcnt(4)
 MM v[192:195],a[32:35],v[96:99],v[192:195]
 RQ a[16:19],v4 offset:20480
 v_exp_f32 v92,v92
 MM v[196:199],a[32:35],v[100:103],v[196:199]
 BL v118,s[8:11],s20 offen sc1 lds
 CV v109,v86,v87
 MM v[200:203],a[36:39],v[96:99],v[200:203]
 RQ a[20:23],v4 offset:21504
 v_exp_f32 v93,v93
 MM v[204:207],a[36:39],v[100:103],v[204:207]
 v_exp_f32 v94,v94
 CV v110,v92,v93
 MM v[208:211],a[40:43],v[96:99],v[208:211]
 RQ a[24:27],v4 offset:22528
 v_exp_f32 v95,v95
 MM v[212:215],a[40:43],v[100:103],v[212:215]
 BL v118,s[8:11],s20 offen offset:1024 sc1 lds
 CV v111,v94,v95
 MM v[216:219],a[44:47],v[96:99],v[216:219]
 RQ a[28:31],v4 offset:23552
 v_add_f32 v16,v16,v88
 v_add_f32 v16,v16,v89
 MM v[220:223],a[44:47],v[100:103],v[220:223]
 v_add_f32 v16,v16,v90
 v_add_f32 v16,v16,v91
 v_add_f32 v17,v17,v84
 MM v[224:227],a[48:51],v[96:99],v[224:227]
 RQ a[32:35],v4 offset:24576
 v_add_f32 v17,v17,v85
 v_add_f32 v17,v17,v86
 MM v[228:231],a[48:51],v[100:103],v[228:231]
 BL v119,s[8:11],s20 offen offset:2048 sc1 lds
 v_add_f32 v17,v17,v87
 MM v[232:235],a[52:55],v[96:99],v[232:235]
 RQ a[36:39],v4 offset:25600
 v_add_f32 v17,v17,v92
 v_add_f32 v17,v17,v93
 MM v[236:239],a[52:55],v[100:103],v[236:239]
 v_add_f32 v17,v17,v94
 v_add_f32 v17,v17,v95
 MM v[240:243],a[56:59],v[96:99],v[240:243]
 RQ a[40:43],v4 offset:26624
 MM v[244:247],a[56:59],v[100:103],v[244:247]
 BL v119,s[8:11],s20 offen offset:3072 sc1 lds
 MM v[248:251],a[60:63],v[96:99],v[248:251]
 RQ a[44:47],v4 offset:27648
 s_add_u32 s20,s20,2048
 MM v[252:255],a[60:63],v[100:103],v[252:255]
 s_add_u32 m0,s23,16384
 s_waitcnt lgkmcnt(4)
 MM v[128:131],a[0:3],v[104:107],v[128:131]
 RQ a[48:51],v4 offset:28672
 MM v[132:135],a[0:3],v[108:111],v[132:135]
 BL v120,s[12:15],s21 offen  lds
 MM v[136:139],a[4:7],v[104:107],v[136:139]
 RQ a[52:55],v4 offset:29696
 MM v[140:143],a[4:7],v[108:111],v[140:143]
 MM v[144:147],a[8:11],v[104:107],v[144:147]
 RQ a[56:59],v4 offset:30720
 MM v[148:151],a[8:11],v[108:111],v[148:151]
 BL v121,s[12:15],s21 offen offset:1024  lds
 MM v[152:155],a[12:15],v[104:107],v[152:155]
 RQ a[60:63],v4 offset:31744
 MM v[156:159],a[12:15],v[108:111],v[156:159]
 MM v[160:163],a[16:19],v[104:107],v[160:163]
 MM v[164:167],a[16:19],v[108:111],v[164:167]
 BL v122,s[12:15],s21 offen offset:2048  lds
 MM v[168:171],a[20:23],v[104:107],v[168:171]
 MM v[172:175],a[20:23],v[108:111],v[172:175]
 MM v[176:179],a[24:27],v[104:107],v[176:179]
 MM v[180:183],a[24:27],v[108:111],v[180:183]
 BL v123,s[12:15],s21 offen offset:3072  lds
 MM v[184:187],a[28:31],v[104:107],v[184:187]
 s_add_u32 s21,s21,57344
 s_add_u32 m0,s22,16384
 MM v[188:191],a[28:31],v[108:111],v[188:191]
 s_waitcnt lgkmcnt(0)
 MM v[192:195],a[32:35],v[104:107],v[192:195]
 MM v[196:199],a[32:35],v[108:111],v[196:199]
 BL v118,s[8:11],s20 offen sc1 lds
 MM v[200:203],a[36:39],v[104:107],v[200:203]
 MM v[204:207],a[36:39],v[108:111],v[204:207]
 MM v[208:211],a[40:43],v[104:107],v[208:211]
 MM v[212:215],a[40:43],v[108:111],v[212:215]
 BL v118,s[8:11],s20 offen offset:1024 sc1 lds
 MM v[216:219],a[44:47],v[104:107],v[216:219]
 MM v[220:223],a[44:47],v[108:111],v[220:223]
 MM v[224:227],a[48:51],v[104:107],v[224:227]
 MM v[228:231],a[48:51],v[108:111],v[228:231]
 BL v119,s[8:11],s20 offen offset:2048 sc1 lds
 MM v[232:235],a[52:55],v[104:107],v[232:235]
 MM v[236:239],a[52:55],v[108:111],v[236:239]
 MM v[240:243],a[56:59],v[104:107],v[240:243]
 MM v[244:247],a[56:59],v[108:111],v[244:247]
 BL v119,s[8:11],s20 offen offset:3072 sc1 lds
 MM v[248:251],a[60:63],v[104:107],v[248:251]
 s_add_u32 s20,s20,2048
 MM v[252:255],a[60:63],v[108:111],v[252:255]
 s_branch a_end
a_pre0:
 s_cmp_eq_u32 s85,64
 s_cbranch_scc1 a_pre0_n0
 s_mov_b32 s85,64
 s_cmp_eq_u32 s37,0
 s_cbranch_scc1 a_pre0_np0
 s_waitcnt vmcnt(0)
 v_mov_b32 v28,0
 v_mov_b32 v29,1
 s_mov_b64 exec,1
 buffer_store_dword v29,v28,s[0:3],s37 offen sc1
 s_mov_b64 exec,-1
a_pre0_np0:
 s_cmp_eq_u32 s87,0
 s_cbranch_scc1 a_pre0_nopf
 s_mov_b32 s4,s50
 s_mov_b32 s5,s51
 s_mov_b32 s6,3670016
 s_mov_b32 s7,0x20000
 s_lshl_b32 s87,s52,2
 s_add_u32 s87,s87,s35
 s_lshl_b32 s87,s87,10
 BL a[68:71],v6,s[4:7],s87 offen
 s_add_u32 s87,s87,1048576
 BL a[68:71],v6,s[4:7],s87 offen
 s_add_u32 s87,s87,1048576
 BL a[68:71],v6,s[4:7],s87 offen
 s_add_u32 s87,s87,1048576
 BL a[68:71],v6,s[4:7],s87 offen
 s_add_u32 s87,s87,1048576
 s_mov_b32 s4,s60
 s_mov_b32 s5,s61
 s_mov_b32 s6,802816
 s_mov_b32 s7,0x20000
 s_lshl_b32 s87,s52,2
 s_add_u32 s87,s87,s35
 s_lshl_b32 s87,s87,10
 BL a[68:71],v6,s[4:7],s87 offen
 s_add_u32 s87,s87,1048576
 s_mov_b32 s87,0
a_pre0_nopf:
a_pre0_n0:
 v_readfirstlane_b32 s39,v4
 s_nop 1
 s_add_u32 s39,s39,32768
 s_nop 0
 s_sub_u32 s34,s39,163840
 s_min_u32 s39,s39,s34
 s_cmp_lg_u32 s80,0
 s_cselect_b32 s75,s80,s86
 s_cselect_b32 s76,22,0
 s_cselect_b32 s28,1,0
 s_lshl_b32 s77,s75,1
 s_add_u32 s77,s77,2
 s_mov_b32 s80,0
 s_lshl_b32 s31,s74,20
 s_lshl_b32 s32,s76,15
 s_add_u32 s20,s31,s32
 s_mov_b32 s21,s20
 s_lshl_b32 s32,s77,15
 s_add_u32 s24,s31,s32
 s_add_u32 s22,s39,s81
 s_mov_b32 s23,s22
 s_add_u32 s23,s23,65536
 s_sub_u32 s34,s23,163840
 s_min_u32 s23,s23,s34
 s_add_u32 s16,s68,33554432
 s_addc_u32 s17,s69,0
 s_mov_b32 s18,16777216
 s_mov_b32 s19,0x20000
 s_lshl_b32 s31,s74,20
 s_lshl_b32 s32,s75,16
 s_add_u32 s31,s31,s32
 s_lshl_b32 s32,s35,14
 s_add_u32 s31,s31,s32
 BL a[128:131],v6,s[16:19],s31 offen sc1
 BL a[132:135],v6,s[16:19],s31 offen offset:1024 sc1
 BL a[136:139],v6,s[16:19],s31 offen offset:2048 sc1
 BL a[140:143],v6,s[16:19],s31 offen offset:3072 sc1
 s_add_u32 s31,s31,4096
 BL a[144:147],v6,s[16:19],s31 offen sc1
 BL a[148:151],v6,s[16:19],s31 offen offset:1024 sc1
 BL a[152:155],v6,s[16:19],s31 offen offset:2048 sc1
 BL a[156:159],v6,s[16:19],s31 offen offset:3072 sc1
 s_add_u32 s31,s31,4096
 BL a[160:163],v6,s[16:19],s31 offen sc1
 BL a[164:167],v6,s[16:19],s31 offen offset:1024 sc1
 BL a[168:171],v6,s[16:19],s31 offen offset:2048 sc1
 BL a[172:175],v6,s[16:19],s31 offen offset:3072 sc1
 s_add_u32 s31,s31,4096
 BL a[176:179],v6,s[16:19],s31 offen sc1
 BL a[180:183],v6,s[16:19],s31 offen offset:1024 sc1
 BL a[184:187],v6,s[16:19],s31 offen offset:2048 sc1
 BL a[188:191],v6,s[16:19],s31 offen offset:3072 sc1
 s_waitcnt lgkmcnt(0)
 v_exp_f32 v32,v32
 v_exp_f32 v33,v33
 v_exp_f32 v34,v34
 RQ a[0:3],v4
 v_exp_f32 v35,v35
 v_add_f32 v16,v16,v32
 CV v96,v32,v33
 RQ a[4:7],v4 offset:1024
 v_add_f32 v16,v16,v33
 v_exp_f32 v40,v40
 v_exp_f32 v41,v41
 RQ a[8:11],v4 offset:2048
 v_add_f32 v16,v16,v34
 CV v97,v34,v35
 v_add_f32 v16,v16,v35
 RQ a[12:15],v4 offset:3072
 v_exp_f32 v42,v42
 v_exp_f32 v43,v43
 v_add_f32 v16,v16,v40
 RQ a[16:19],v4 offset:4096
 CV v98,v40,v41
 v_add_f32 v16,v16,v41
 v_exp_f32 v36,v36
 RQ a[20:23],v4 offset:5120
 v_exp_f32 v37,v37
 v_add_f32 v16,v16,v42
 CV v99,v42,v43
 RQ a[24:27],v4 offset:6144
 v_add_f32 v16,v16,v43
 v_exp_f32 v38,v38
 v_exp_f32 v39,v39
 RQ a[28:31],v4 offset:7168
 v_add_f32 v17,v17,v36
 CV v100,v36,v37
 v_add_f32 v17,v17,v37
 RQ a[32:35],v4 offset:8192
 v_exp_f32 v44,v44
 v_exp_f32 v45,v45
 v_add_f32 v17,v17,v38
 RQ a[36:39],v4 offset:9216
 CV v101,v38,v39
 v_add_f32 v17,v17,v39
 v_exp_f32 v46,v46
 RQ a[40:43],v4 offset:10240
 v_exp_f32 v47,v47
 v_add_f32 v17,v17,v44
 CV v102,v44,v45
 RQ a[44:47],v4 offset:11264
 v_add_f32 v17,v17,v45
 v_exp_f32 v48,v48
 v_exp_f32 v49,v49
 v_add_f32 v17,v17,v46
 CV v103,v46,v47
 v_add_f32 v17,v17,v47
 s_waitcnt lgkmcnt(4)
 MM v[128:131],a[0:3],v[96:99],v[128:131]
 RQ a[48:51],v4 offset:12288
 v_exp_f32 v50,v50
 MM v[132:135],a[0:3],v[100:103],v[132:135]
 s_cmp_lt_u32 s20,s24
 s_cselect_b32 s10,16777216,0
 CV v104,v48,v49
 MM v[136:139],a[4:7],v[96:99],v[136:139]
 RQ a[52:55],v4 offset:13312
 s_cselect_b32 m0,s22,196608
 v_add_f32 v16,v16,v48
 MM v[140:143],a[4:7],v[100:103],v[140:143]
 BL v2,s[8:11],s20 offen sc1 lds
 v_add_f32 v16,v16,v49
 MM v[144:147],a[8:11],v[96:99],v[144:147]
 RQ a[56:59],v4 offset:14336
 v_exp_f32 v51,v51
 MM v[148:151],a[8:11],v[100:103],v[148:151]
 v_exp_f32 v56,v56
 CV v105,v50,v51
 MM v[152:155],a[12:15],v[96:99],v[152:155]
 RQ a[60:63],v4 offset:15360
 v_exp_f32 v57,v57
 MM v[156:159],a[12:15],v[100:103],v[156:159]
 BL v2,s[8:11],s20 offen offset:1024 sc1 lds
 CV v106,v56,v57
 MM v[160:163],a[16:19],v[96:99],v[160:163]
 RQ a[0:3],v4 offset:16384
 v_exp_f32 v58,v58
 MM v[164:167],a[16:19],v[100:103],v[164:167]
 v_exp_f32 v59,v59
 v_add_f32 v16,v16,v50
 MM v[168:171],a[20:23],v[96:99],v[168:171]
 RQ a[4:7],v4 offset:17408
 v_exp_f32 v52,v52
 MM v[172:175],a[20:23],v[100:103],v[172:175]
 BL v2,s[8:11],s20 offen offset:2048 sc1 lds
 CV v107,v58,v59
 MM v[176:179],a[24:27],v[96:99],v[176:179]
 RQ a[8:11],v4 offset:18432
 v_exp_f32 v53,v53
 MM v[180:183],a[24:27],v[100:103],v[180:183]
 v_exp_f32 v54,v54
 CV v108,v52,v53
 MM v[184:187],a[28:31],v[96:99],v[184:187]
 RQ a[12:15],v4 offset:19456
 v_exp_f32 v55,v55
 MM v[188:191],a[28:31],v[100:103],v[188:191]
 BL v2,s[8:11],s20 offen offset:3072 sc1 lds
 CV v109,v54,v55
 s_waitcnt lgkmcnt(4)
 MM v[192:195],a[32:35],v[96:99],v[192:195]
 RQ a[16:19],v4 offset:20480
 s_add_u32 m0,m0,4096
 v_add_f32 v16,v16,v51
 MM v[196:199],a[32:35],v[100:103],v[196:199]
 v_exp_f32 v60,v60
 v_add_f32 v16,v16,v56
 MM v[200:203],a[36:39],v[96:99],v[200:203]
 RQ a[20:23],v4 offset:21504
 v_exp_f32 v61,v61
 MM v[204:207],a[36:39],v[100:103],v[204:207]
 BL v1,s[8:11],s20 offen sc1 lds
 CV v110,v60,v61
 MM v[208:211],a[40:43],v[96:99],v[208:211]
 RQ a[24:27],v4 offset:22528
 v_exp_f32 v62,v62
 MM v[212:215],a[40:43],v[100:103],v[212:215]
 v_exp_f32 v63,v63
 v_add_f32 v16,v16,v57
 MM v[216:219],a[44:47],v[96:99],v[216:219]
 RQ a[28:31],v4 offset:23552
 CV v111,v62,v63
 v_add_f32 v16,v16,v58
 MM v[220:223],a[44:47],v[100:103],v[220:223]
 BL v1,s[8:11],s20 offen offset:1024 sc1 lds
 v_add_f32 v16,v16,v59
 MM v[224:227],a[48:51],v[96:99],v[224:227]
 RQ a[32:35],v4 offset:24576
 v_add_f32 v17,v17,v52
 v_add_f32 v17,v17,v53
 MM v[228:231],a[48:51],v[100:103],v[228:231]
 v_add_f32 v17,v17,v54
 v_add_f32 v17,v17,v55
 v_add_f32 v17,v17,v60
 MM v[232:235],a[52:55],v[96:99],v[232:235]
 RQ a[36:39],v4 offset:25600
 v_add_f32 v17,v17,v61
 v_add_f32 v17,v17,v62
 MM v[236:239],a[52:55],v[100:103],v[236:239]
 BL v1,s[8:11],s20 offen offset:2048 sc1 lds
 v_add_f32 v17,v17,v63
 MM v[240:243],a[56:59],v[96:99],v[240:243]
 RQ a[40:43],v4 offset:26624
 MM v[244:247],a[56:59],v[100:103],v[244:247]
 BL v1,s[8:11],s20 offen offset:3072 sc1 lds
 MM v[248:251],a[60:63],v[96:99],v[248:251]
 RQ a[44:47],v4 offset:27648
 s_add_u32 s20,s20,32768
 MM v[252:255],a[60:63],v[100:103],v[252:255]
 s_add_u32 s22,s22,32768
 s_sub_u32 s34,s22,163840
 s_waitcnt lgkmcnt(4)
 MM v[128:131],a[0:3],v[104:107],v[128:131]
 RQ a[48:51],v4 offset:28672
 s_min_u32 s22,s22,s34
 MM v[132:135],a[0:3],v[108:111],v[132:135]
 s_cmp_lt_u32 s20,s24
 s_cselect_b32 s10,16777216,0
 MM v[136:139],a[4:7],v[104:107],v[136:139]
 RQ a[52:55],v4 offset:29696
 s_cselect_b32 m0,s22,196608
 MM v[140:143],a[4:7],v[108:111],v[140:143]
 BL v2,s[8:11],s20 offen sc1 lds
 MM v[144:147],a[8:11],v[104:107],v[144:147]
 RQ a[56:59],v4 offset:30720
 MM v[148:151],a[8:11],v[108:111],v[148:151]
 MM v[152:155],a[12:15],v[104:107],v[152:155]
 RQ a[60:63],v4 offset:31744
 MM v[156:159],a[12:15],v[108:111],v[156:159]
 BL v2,s[8:11],s20 offen offset:1024 sc1 lds
 MM v[160:163],a[16:19],v[104:107],v[160:163]
 MM v[164:167],a[16:19],v[108:111],v[164:167]
 MM v[168:171],a[20:23],v[104:107],v[168:171]
 MM v[172:175],a[20:23],v[108:111],v[172:175]
 BL v2,s[8:11],s20 offen offset:2048 sc1 lds
 MM v[176:179],a[24:27],v[104:107],v[176:179]
 MM v[180:183],a[24:27],v[108:111],v[180:183]
 MM v[184:187],a[28:31],v[104:107],v[184:187]
 MM v[188:191],a[28:31],v[108:111],v[188:191]
 BL v2,s[8:11],s20 offen offset:3072 sc1 lds
 s_waitcnt lgkmcnt(0)
 MM v[192:195],a[32:35],v[104:107],v[192:195]
 s_add_u32 m0,m0,4096
 MM v[196:199],a[32:35],v[108:111],v[196:199]
 MM v[200:203],a[36:39],v[104:107],v[200:203]
 MM v[204:207],a[36:39],v[108:111],v[204:207]
 BL v1,s[8:11],s20 offen sc1 lds
 MM v[208:211],a[40:43],v[104:107],v[208:211]
 MM v[212:215],a[40:43],v[108:111],v[212:215]
 MM v[216:219],a[44:47],v[104:107],v[216:219]
 MM v[220:223],a[44:47],v[108:111],v[220:223]
 BL v1,s[8:11],s20 offen offset:1024 sc1 lds
 MM v[224:227],a[48:51],v[104:107],v[224:227]
 MM v[228:231],a[48:51],v[108:111],v[228:231]
 BL v1,s[8:11],s20 offen offset:2048 sc1 lds
 MM v[232:235],a[52:55],v[104:107],v[232:235]
 MM v[236:239],a[52:55],v[108:111],v[236:239]
 BL v1,s[8:11],s20 offen offset:3072 sc1 lds
 MM v[240:243],a[56:59],v[104:107],v[240:243]
 s_add_u32 s20,s20,32768
 s_add_u32 s22,s22,65536
 MM v[244:247],a[56:59],v[108:111],v[244:247]
 s_sub_u32 s34,s22,163840
 s_min_u32 s22,s22,s34
 MM v[248:251],a[60:63],v[104:107],v[248:251]
 MM v[252:255],a[60:63],v[108:111],v[252:255]
 s_branch f_part
a_pre1:
 s_cmp_eq_u32 s85,64
 s_cbranch_scc1 a_pre1_n0
 s_mov_b32 s85,64
 s_cmp_eq_u32 s37,0
 s_cbranch_scc1 a_pre1_np0
 s_waitcnt vmcnt(0)
 v_mov_b32 v28,0
 v_mov_b32 v29,1
 s_mov_b64 exec,1
 buffer_store_dword v29,v28,s[0:3],s37 offen sc1
 s_mov_b64 exec,-1
a_pre1_np0:
 s_cmp_eq_u32 s87,0
 s_cbranch_scc1 a_pre1_nopf
 s_mov_b32 s4,s50
 s_mov_b32 s5,s51
 s_mov_b32 s6,3670016
 s_mov_b32 s7,0x20000
 s_lshl_b32 s87,s52,2
 s_add_u32 s87,s87,s35
 s_lshl_b32 s87,s87,10
 BL a[68:71],v6,s[4:7],s87 offen
 s_add_u32 s87,s87,1048576
 BL a[68:71],v6,s[4:7],s87 offen
 s_add_u32 s87,s87,1048576
 BL a[68:71],v6,s[4:7],s87 offen
 s_add_u32 s87,s87,1048576
 BL a[68:71],v6,s[4:7],s87 offen
 s_add_u32 s87,s87,1048576
 s_mov_b32 s4,s60
 s_mov_b32 s5,s61
 s_mov_b32 s6,802816
 s_mov_b32 s7,0x20000
 s_lshl_b32 s87,s52,2
 s_add_u32 s87,s87,s35
 s_lshl_b32 s87,s87,10
 BL a[68:71],v6,s[4:7],s87 offen
 s_add_u32 s87,s87,1048576
 s_mov_b32 s87,0
a_pre1_nopf:
a_pre1_n0:
 v_readfirstlane_b32 s39,v4
 s_nop 1
 s_add_u32 s39,s39,32768
 s_nop 0
 s_sub_u32 s34,s39,163840
 s_min_u32 s39,s39,s34
 s_cmp_lg_u32 s80,0
 s_cselect_b32 s75,s80,s86
 s_cselect_b32 s76,22,0
 s_cselect_b32 s28,1,0
 s_lshl_b32 s77,s75,1
 s_add_u32 s77,s77,2
 s_mov_b32 s80,0
 s_lshl_b32 s31,s74,20
 s_lshl_b32 s32,s76,15
 s_add_u32 s20,s31,s32
 s_mov_b32 s21,s20
 s_lshl_b32 s32,s77,15
 s_add_u32 s24,s31,s32
 s_add_u32 s22,s39,s81
 s_mov_b32 s23,s22
 s_add_u32 s23,s23,65536
 s_sub_u32 s34,s23,163840
 s_min_u32 s23,s23,s34
 s_add_u32 s16,s68,33554432
 s_addc_u32 s17,s69,0
 s_mov_b32 s18,16777216
 s_mov_b32 s19,0x20000
 s_lshl_b32 s31,s74,20
 s_lshl_b32 s32,s75,16
 s_add_u32 s31,s31,s32
 s_lshl_b32 s32,s35,14
 s_add_u32 s31,s31,s32
 BL a[128:131],v6,s[16:19],s31 offen sc1
 BL a[132:135],v6,s[16:19],s31 offen offset:1024 sc1
 BL a[136:139],v6,s[16:19],s31 offen offset:2048 sc1
 BL a[140:143],v6,s[16:19],s31 offen offset:3072 sc1
 s_add_u32 s31,s31,4096
 BL a[144:147],v6,s[16:19],s31 offen sc1
 BL a[148:151],v6,s[16:19],s31 offen offset:1024 sc1
 BL a[152:155],v6,s[16:19],s31 offen offset:2048 sc1
 BL a[156:159],v6,s[16:19],s31 offen offset:3072 sc1
 s_add_u32 s31,s31,4096
 BL a[160:163],v6,s[16:19],s31 offen sc1
 BL a[164:167],v6,s[16:19],s31 offen offset:1024 sc1
 BL a[168:171],v6,s[16:19],s31 offen offset:2048 sc1
 BL a[172:175],v6,s[16:19],s31 offen offset:3072 sc1
 s_add_u32 s31,s31,4096
 BL a[176:179],v6,s[16:19],s31 offen sc1
 BL a[180:183],v6,s[16:19],s31 offen offset:1024 sc1
 BL a[184:187],v6,s[16:19],s31 offen offset:2048 sc1
 BL a[188:191],v6,s[16:19],s31 offen offset:3072 sc1
 s_waitcnt lgkmcnt(0)
 v_exp_f32 v64,v64
 v_exp_f32 v65,v65
 v_exp_f32 v66,v66
 RQ a[0:3],v4
 v_exp_f32 v67,v67
 v_add_f32 v16,v16,v64
 CV v96,v64,v65
 RQ a[4:7],v4 offset:1024
 v_add_f32 v16,v16,v65
 v_exp_f32 v72,v72
 v_exp_f32 v73,v73
 RQ a[8:11],v4 offset:2048
 v_add_f32 v16,v16,v66
 CV v97,v66,v67
 v_add_f32 v16,v16,v67
 RQ a[12:15],v4 offset:3072
 v_exp_f32 v74,v74
 v_exp_f32 v75,v75
 v_add_f32 v16,v16,v72
 RQ a[16:19],v4 offset:4096
 CV v98,v72,v73
 v_add_f32 v16,v16,v73
 v_exp_f32 v68,v68
 RQ a[20:23],v4 offset:5120
 v_exp_f32 v69,v69
 v_add_f32 v16,v16,v74
 CV v99,v74,v75
 RQ a[24:27],v4 offset:6144
 v_add_f32 v16,v16,v75
 v_exp_f32 v70,v70
 v_exp_f32 v71,v71
 RQ a[28:31],v4 offset:7168
 v_add_f32 v17,v17,v68
 CV v100,v68,v69
 v_add_f32 v17,v17,v69
 RQ a[32:35],v4 offset:8192
 v_exp_f32 v76,v76
 v_exp_f32 v77,v77
 v_add_f32 v17,v17,v70
 RQ a[36:39],v4 offset:9216
 CV v101,v70,v71
 v_add_f32 v17,v17,v71
 v_exp_f32 v78,v78
 RQ a[40:43],v4 offset:10240
 v_exp_f32 v79,v79
 v_add_f32 v17,v17,v76
 CV v102,v76,v77
 RQ a[44:47],v4 offset:11264
 v_add_f32 v17,v17,v77
 v_exp_f32 v80,v80
 v_exp_f32 v81,v81
 v_add_f32 v17,v17,v78
 CV v103,v78,v79
 v_add_f32 v17,v17,v79
 s_waitcnt lgkmcnt(4)
 MM v[128:131],a[0:3],v[96:99],v[128:131]
 RQ a[48:51],v4 offset:12288
 v_exp_f32 v82,v82
 MM v[132:135],a[0:3],v[100:103],v[132:135]
 s_cmp_lt_u32 s20,s24
 s_cselect_b32 s10,16777216,0
 CV v104,v80,v81
 MM v[136:139],a[4:7],v[96:99],v[136:139]
 RQ a[52:55],v4 offset:13312
 s_cselect_b32 m0,s22,196608
 v_add_f32 v16,v16,v80
 MM v[140:143],a[4:7],v[100:103],v[140:143]
 BL v2,s[8:11],s20 offen sc1 lds
 v_add_f32 v16,v16,v81
 MM v[144:147],a[8:11],v[96:99],v[144:147]
 RQ a[56:59],v4 offset:14336
 v_exp_f32 v83,v83
 MM v[148:151],a[8:11],v[100:103],v[148:151]
 v_exp_f32 v88,v88
 CV v105,v82,v83
 MM v[152:155],a[12:15],v[96:99],v[152:155]
 RQ a[60:63],v4 offset:15360
 v_exp_f32 v89,v89
 MM v[156:159],a[12:15],v[100:103],v[156:159]
 BL v2,s[8:11],s20 offen offset:1024 sc1 lds
 CV v106,v88,v89
 MM v[160:163],a[16:19],v[96:99],v[160:163]
 RQ a[0:3],v4 offset:16384
 v_exp_f32 v90,v90
 MM v[164:167],a[16:19],v[100:103],v[164:167]
 v_exp_f32 v91,v91
 v_add_f32 v16,v16,v82
 MM v[168:171],a[20:23],v[96:99],v[168:171]
 RQ a[4:7],v4 offset:17408
 v_exp_f32 v84,v84
 MM v[172:175],a[20:23],v[100:103],v[172:175]
 BL v2,s[8:11],s20 offen offset:2048 sc1 lds
 CV v107,v90,v91
 MM v[176:179],a[24:27],v[96:99],v[176:179]
 RQ a[8:11],v4 offset:18432
 v_exp_f32 v85,v85
 MM v[180:183],a[24:27],v[100:103],v[180:183]
 v_exp_f32 v86,v86
 CV v108,v84,v85
 MM v[184:187],a[28:31],v[96:99],v[184:187]
 RQ a[12:15],v4 offset:19456
 v_exp_f32 v87,v87
 MM v[188:191],a[28:31],v[100:103],v[188:191]
 BL v2,s[8:11],s20 offen offset:3072 sc1 lds
 CV v109,v86,v87
 s_waitcnt lgkmcnt(4)
 MM v[192:195],a[32:35],v[96:99],v[192:195]
 RQ a[16:19],v4 offset:20480
 s_add_u32 m0,m0,4096
 v_add_f32 v16,v16,v83
 MM v[196:199],a[32:35],v[100:103],v[196:199]
 v_exp_f32 v92,v92
 v_add_f32 v16,v16,v88
 MM v[200:203],a[36:39],v[96:99],v[200:203]
 RQ a[20:23],v4 offset:21504
 v_exp_f32 v93,v93
 MM v[204:207],a[36:39],v[100:103],v[204:207]
 BL v1,s[8:11],s20 offen sc1 lds
 CV v110,v92,v93
 MM v[208:211],a[40:43],v[96:99],v[208:211]
 RQ a[24:27],v4 offset:22528
 v_exp_f32 v94,v94
 MM v[212:215],a[40:43],v[100:103],v[212:215]
 v_exp_f32 v95,v95
 v_add_f32 v16,v16,v89
 MM v[216:219],a[44:47],v[96:99],v[216:219]
 RQ a[28:31],v4 offset:23552
 CV v111,v94,v95
 v_add_f32 v16,v16,v90
 MM v[220:223],a[44:47],v[100:103],v[220:223]
 BL v1,s[8:11],s20 offen offset:1024 sc1 lds
 v_add_f32 v16,v16,v91
 MM v[224:227],a[48:51],v[96:99],v[224:227]
 RQ a[32:35],v4 offset:24576
 v_add_f32 v17,v17,v84
 v_add_f32 v17,v17,v85
 MM v[228:231],a[48:51],v[100:103],v[228:231]
 v_add_f32 v17,v17,v86
 v_add_f32 v17,v17,v87
 v_add_f32 v17,v17,v92
 MM v[232:235],a[52:55],v[96:99],v[232:235]
 RQ a[36:39],v4 offset:25600
 v_add_f32 v17,v17,v93
 v_add_f32 v17,v17,v94
 MM v[236:239],a[52:55],v[100:103],v[236:239]
 BL v1,s[8:11],s20 offen offset:2048 sc1 lds
 v_add_f32 v17,v17,v95
 MM v[240:243],a[56:59],v[96:99],v[240:243]
 RQ a[40:43],v4 offset:26624
 MM v[244:247],a[56:59],v[100:103],v[244:247]
 BL v1,s[8:11],s20 offen offset:3072 sc1 lds
 MM v[248:251],a[60:63],v[96:99],v[248:251]
 RQ a[44:47],v4 offset:27648
 s_add_u32 s20,s20,32768
 MM v[252:255],a[60:63],v[100:103],v[252:255]
 s_add_u32 s22,s22,32768
 s_sub_u32 s34,s22,163840
 s_waitcnt lgkmcnt(4)
 MM v[128:131],a[0:3],v[104:107],v[128:131]
 RQ a[48:51],v4 offset:28672
 s_min_u32 s22,s22,s34
 MM v[132:135],a[0:3],v[108:111],v[132:135]
 s_cmp_lt_u32 s20,s24
 s_cselect_b32 s10,16777216,0
 MM v[136:139],a[4:7],v[104:107],v[136:139]
 RQ a[52:55],v4 offset:29696
 s_cselect_b32 m0,s22,196608
 MM v[140:143],a[4:7],v[108:111],v[140:143]
 BL v2,s[8:11],s20 offen sc1 lds
 MM v[144:147],a[8:11],v[104:107],v[144:147]
 RQ a[56:59],v4 offset:30720
 MM v[148:151],a[8:11],v[108:111],v[148:151]
 MM v[152:155],a[12:15],v[104:107],v[152:155]
 RQ a[60:63],v4 offset:31744
 MM v[156:159],a[12:15],v[108:111],v[156:159]
 BL v2,s[8:11],s20 offen offset:1024 sc1 lds
 MM v[160:163],a[16:19],v[104:107],v[160:163]
 MM v[164:167],a[16:19],v[108:111],v[164:167]
 MM v[168:171],a[20:23],v[104:107],v[168:171]
 MM v[172:175],a[20:23],v[108:111],v[172:175]
 BL v2,s[8:11],s20 offen offset:2048 sc1 lds
 MM v[176:179],a[24:27],v[104:107],v[176:179]
 MM v[180:183],a[24:27],v[108:111],v[180:183]
 MM v[184:187],a[28:31],v[104:107],v[184:187]
 MM v[188:191],a[28:31],v[108:111],v[188:191]
 BL v2,s[8:11],s20 offen offset:3072 sc1 lds
 s_waitcnt lgkmcnt(0)
 MM v[192:195],a[32:35],v[104:107],v[192:195]
 s_add_u32 m0,m0,4096
 MM v[196:199],a[32:35],v[108:111],v[196:199]
 MM v[200:203],a[36:39],v[104:107],v[200:203]
 MM v[204:207],a[36:39],v[108:111],v[204:207]
 BL v1,s[8:11],s20 offen sc1 lds
 MM v[208:211],a[40:43],v[104:107],v[208:211]
 MM v[212:215],a[40:43],v[108:111],v[212:215]
 MM v[216:219],a[44:47],v[104:107],v[216:219]
 MM v[220:223],a[44:47],v[108:111],v[220:223]
 BL v1,s[8:11],s20 offen offset:1024 sc1 lds
 MM v[224:227],a[48:51],v[104:107],v[224:227]
 MM v[228:231],a[48:51],v[108:111],v[228:231]
 BL v1,s[8:11],s20 offen offset:2048 sc1 lds
 MM v[232:235],a[52:55],v[104:107],v[232:235]
 MM v[236:239],a[52:55],v[108:111],v[236:239]
 BL v1,s[8:11],s20 offen offset:3072 sc1 lds
 MM v[240:243],a[56:59],v[104:107],v[240:243]
 s_add_u32 s20,s20,32768
 s_add_u32 s22,s22,65536
 MM v[244:247],a[56:59],v[108:111],v[244:247]
 s_sub_u32 s34,s22,163840
 s_min_u32 s22,s22,s34
 MM v[248:251],a[60:63],v[104:107],v[248:251]
 MM v[252:255],a[60:63],v[108:111],v[252:255]
 s_branch f_part
a_h_mask:
 s_cmp_lt_u32 s27,s85
 s_cbranch_scc1 a_h_mask_n0
 s_mov_b32 s85,64
 s_cmp_eq_u32 s37,0
 s_cbranch_scc1 a_h_mask_np0
 s_waitcnt vmcnt(8)
 v_mov_b32 v28,0
 v_mov_b32 v29,1
 s_mov_b64 exec,1
 buffer_store_dword v29,v28,s[0:3],s37 offen sc1
 s_mov_b64 exec,-1
a_h_mask_np0:
 s_cmp_eq_u32 s87,0
 s_cbranch_scc1 a_h_mask_nopf
 s_mov_b32 s4,s50
 s_mov_b32 s5,s51
 s_mov_b32 s6,3670016
 s_mov_b32 s7,0x20000
 s_lshl_b32 s87,s52,2
 s_add_u32 s87,s87,s35
 s_lshl_b32 s87,s87,10
 BL a[68:71],v6,s[4:7],s87 offen
 s_add_u32 s87,s87,1048576
 BL a[68:71],v6,s[4:7],s87 offen
 s_add_u32 s87,s87,1048576
 BL a[68:71],v6,s[4:7],s87 offen
 s_add_u32 s87,s87,1048576
 BL a[68:71],v6,s[4:7],s87 offen
 s_add_u32 s87,s87,1048576
 s_mov_b32 s4,s60
 s_mov_b32 s5,s61
 s_mov_b32 s6,802816
 s_mov_b32 s7,0x20000
 s_lshl_b32 s87,s52,2
 s_add_u32 s87,s87,s35
 s_lshl_b32 s87,s87,10
 BL a[68:71],v6,s[4:7],s87 offen
 s_add_u32 s87,s87,1048576
 s_mov_b32 s87,0
a_h_mask_nopf:
a_h_mask_n0:
 s_cmp_lt_u32 s27,s29
 s_cbranch_scc1 a_h_mask_d
 s_cmp_eq_u32 s30,1
 s_cbranch_scc1 a_h_mask_e1
 s_cmp_eq_u32 s30,2
 s_cbranch_scc1 a_h_mask_e2
 v_min_u32 v29,3,v0
 v_lshlrev_b32 v29,2,v29
 v_add_u32 v28,s100,v29
 v_add_u32 v28,112,v28
 buffer_load_dword v29,v28,s[0:3],0 offen sc1
 s_mov_b32 s32,0
a_h_mask_l_chk:
 s_waitcnt vmcnt(0)
 v_cmp_le_u32 vcc,1,v29
 s_nop 1
 s_cmp_eq_u64 vcc,-1
 s_cbranch_scc1 a_h_mask_l_ok
 s_add_u32 s32,s32,1
 s_cmp_ge_u32 s32,400000
 s_cbranch_scc1 a_h_mask_l_ok
 s_sleep 1
 buffer_load_dword v29,v28,s[0:3],0 offen sc1
 s_waitcnt vmcnt(0)
 s_branch a_h_mask_l_chk
a_h_mask_l_ok:
 s_mov_b32 s29,64
 s_branch a_h_mask_d
a_h_mask_e1:
 s_lshl_b32 s31,s79,2
 s_add_u32 s31,s31,s35
 s_lshl_b32 s31,s31,2
 s_add_u32 s31,s31,2304
 v_mov_b32 v116,s31
 buffer_load_dword v117,v116,s[0:3],0 offen sc1
 s_lshl_b32 s31,s53,8
 s_lshl_b32 s32,s99,5
 s_add_u32 s31,s31,s32
 s_add_u32 s31,s31,4480
 s_cmp_eq_u32 s99,3
 s_cselect_b32 s32,3,7
 v_min_u32 v115,s32,v0
 v_lshlrev_b32 v115,2,v115
 v_add_u32 v114,s31,v115
 s_lshl_b32 s31,s86,2
 s_add_u32 s31,s31,1024
 v_mov_b32 v115,s31
 v_cmp_gt_u32 vcc,32,v0
 s_nop 1
 v_cndmask_b32 v114,v115,v114,vcc
 buffer_load_dword v115,v114,s[0:3],0 offen sc1
 s_add_u32 s4,s68,88080384
 s_addc_u32 s5,s69,0
 s_mov_b32 s6,8388608
 s_mov_b32 s7,0x20000
 s_lshl_b32 s31,s53,2
 s_add_u32 s31,s31,s98
 s_lshl_b32 s31,s31,2
 s_add_u32 s31,s31,s99
 s_lshl_b32 s31,s31,2
 s_add_u32 s31,s31,s35
 s_lshl_b32 s31,s31,13
 v_mov_b32 v124,-1
 v_mov_b32 v125,-1
 v_mov_b32 v126,-1
 v_mov_b32 v127,-1
 BS v[124:127],v6,s[4:7],s31 offen sc1
 BS v[124:127],v6,s[4:7],s31 offen offset:1024 sc1
 BS v[124:127],v6,s[4:7],s31 offen offset:2048 sc1
 BS v[124:127],v6,s[4:7],s31 offen offset:3072 sc1
 s_add_u32 s32,s31,4096
 BS v[124:127],v6,s[4:7],s32 offen sc1
 s_add_u32 s32,s31,4096
 BS v[124:127],v6,s[4:7],s32 offen offset:1024 sc1
 s_add_u32 s32,s31,4096
 BS v[124:127],v6,s[4:7],s32 offen offset:2048 sc1
 s_add_u32 s32,s31,4096
 BS v[124:127],v6,s[4:7],s32 offen offset:3072 sc1
 s_mov_b32 s30,2
 s_add_u32 s29,s29,1
 s_branch a_h_mask_d
a_h_mask_e2:
 s_cmp_lg_u32 s78,2
 s_cbranch_scc1 a_h_mask_np
 s_mov_b32 s32,0
a_h_mask_p_chk:
 v_cmp_le_u32 vcc,1,v117
 s_nop 1
 s_cmp_eq_u64 vcc,-1
 s_cbranch_scc1 a_h_mask_p_ok
 s_add_u32 s32,s32,1
 s_cmp_ge_u32 s32,400000
 s_cbranch_scc1 a_h_mask_p_ok
 s_sleep 1
 buffer_load_dword v117,v116,s[0:3],0 offen sc1
 s_waitcnt vmcnt(0)
 s_branch a_h_mask_p_chk
a_h_mask_p_ok:
 s_add_u32 s4,s68,76546048
 s_addc_u32 s5,s69,0
 s_mov_b32 s6,8912896
 s_mov_b32 s7,0x20000
 s_lshl_b32 s31,s79,2
 s_add_u32 s31,s31,s35
 s_mul_i32 s31,s31,17408
 BL a[192:195],v6,s[4:7],s31 offen sc1
 BL a[196:199],v6,s[4:7],s31 offen offset:1024 sc1
 BL a[200:203],v6,s[4:7],s31 offen offset:2048 sc1
 BL a[204:207],v6,s[4:7],s31 offen offset:3072 sc1
 s_add_u32 s31,s31,4096
 BL a[208:211],v6,s[4:7],s31 offen sc1
 BL a[212:215],v6,s[4:7],s31 offen offset:1024 sc1
 BL a[216:219],v6,s[4:7],s31 offen offset:2048 sc1
 BL a[220:223],v6,s[4:7],s31 offen offset:3072 sc1
 s_add_u32 s31,s31,4096
 BL a[224:227],v6,s[4:7],s31 offen sc1
 BL a[228:231],v6,s[4:7],s31 offen offset:1024 sc1
 BL a[232:235],v6,s[4:7],s31 offen offset:2048 sc1
 BL a[236:239],v6,s[4:7],s31 offen offset:3072 sc1
 s_add_u32 s31,s31,4096
 BL a[240:243],v6,s[4:7],s31 offen sc1
 BL a[244:247],v6,s[4:7],s31 offen offset:1024 sc1
 BL a[248:251],v6,s[4:7],s31 offen offset:2048 sc1
 BL a[252:255],v6,s[4:7],s31 offen offset:3072 sc1
 s_add_u32 s31,s31,4096
 BL a[64:67],v6,s[4:7],s31 offen sc1
a_h_mask_np:
 s_mov_b32 s32,0
a_h_mask_h_chk:
 v_cmp_le_u32 vcc,1,v115
 s_nop 1
 s_cmp_eq_u64 vcc,-1
 s_cbranch_scc1 a_h_mask_h_ok
 s_add_u32 s32,s32,1
 s_cmp_ge_u32 s32,400000
 s_cbranch_scc1 a_h_mask_h_ok
 s_sleep 1
 buffer_load_dword v115,v114,s[0:3],0 offen sc1
 s_waitcnt vmcnt(0)
 s_branch a_h_mask_h_chk
a_h_mask_h_ok:
 s_add_u32 s4,s68,75497472
 s_addc_u32 s5,s69,0
 s_mov_b32 s6,8192
 s_mov_b32 s7,0x20000
 s_lshl_b32 s31,s86,2
 s_add_u32 s31,s31,s35
 s_lshl_b32 s31,s31,7
 v_and_b32 v5,15,v0
 v_lshlrev_b32 v5,2,v5
 buffer_load_dword v112,v5,s[4:7],s31 offen sc1
 buffer_load_dword v113,v5,s[4:7],s31 offen offset:64 sc1
 s_mov_b32 s29,64
a_h_mask_d:
 s_min_u32 s26,s29,s38
 s_min_u32 s26,s26,s85
 s_cmp_lt_u32 s27,s38
 s_cbranch_scc1 a_h_mb
 s_lshl_b32 s31,s75,7
 s_lshl_b32 s32,s35,5
 s_add_u32 s31,s31,s32
 s_lshl_b32 s32,s27,6
 s_sub_u32 s31,s31,s32
 v_and_b32 v19,15,v0
 v_lshrrev_b32 v20,4,v0
 v_lshlrev_b32 v20,2,v20
 v_sub_u32 v19,v19,v20
 v_add_u32 v19,s31,v19
 v_mov_b32 v20,0xceabfb8f
 v_cmp_gt_i32 s[88:89],0,v19
 v_cmp_gt_i32 s[90:91],1,v19
 v_cmp_gt_i32 s[92:93],2,v19
 v_cmp_gt_i32 s[94:95],3,v19
 v_cndmask_b32 v32,v32,v20,s[88:89]
 v_cndmask_b32 v33,v33,v20,s[90:91]
 v_cndmask_b32 v34,v34,v20,s[92:93]
 v_cndmask_b32 v35,v35,v20,s[94:95]
 v_cmp_gt_i32 s[88:89],-16,v19
 v_cmp_gt_i32 s[90:91],-15,v19
 v_cmp_gt_i32 s[92:93],-14,v19
 v_cmp_gt_i32 s[94:95],-13,v19
 v_cndmask_b32 v36,v36,v20,s[88:89]
 v_cndmask_b32 v37,v37,v20,s[90:91]
 v_cndmask_b32 v38,v38,v20,s[92:93]
 v_cndmask_b32 v39,v39,v20,s[94:95]
 v_cmp_gt_i32 s[88:89],16,v19
 v_cmp_gt_i32 s[90:91],17,v19
 v_cmp_gt_i32 s[92:93],18,v19
 v_cmp_gt_i32 s[94:95],19,v19
 v_cndmask_b32 v40,v40,v20,s[88:89]
 v_cndmask_b32 v41,v41,v20,s[90:91]
 v_cndmask_b32 v42,v42,v20,s[92:93]
 v_cndmask_b32 v43,v43,v20,s[94:95]
 v_cmp_gt_i32 s[88:89],0,v19
 v_cmp_gt_i32 s[90:91],1,v19
 v_cmp_gt_i32 s[92:93],2,v19
 v_cmp_gt_i32 s[94:95],3,v19
 v_cndmask_b32 v44,v44,v20,s[88:89]
 v_cndmask_b32 v45,v45,v20,s[90:91]
 v_cndmask_b32 v46,v46,v20,s[92:93]
 v_cndmask_b32 v47,v47,v20,s[94:95]
 v_cmp_gt_i32 s[88:89],32,v19
 v_cmp_gt_i32 s[90:91],33,v19
 v_cmp_gt_i32 s[92:93],34,v19
 v_cmp_gt_i32 s[94:95],35,v19
 v_cndmask_b32 v48,v48,v20,s[88:89]
 v_cndmask_b32 v49,v49,v20,s[90:91]
 v_cndmask_b32 v50,v50,v20,s[92:93]
 v_cndmask_b32 v51,v51,v20,s[94:95]
 v_cmp_gt_i32 s[88:89],16,v19
 v_cmp_gt_i32 s[90:91],17,v19
 v_cmp_gt_i32 s[92:93],18,v19
 v_cmp_gt_i32 s[94:95],19,v19
 v_cndmask_b32 v52,v52,v20,s[88:89]
 v_cndmask_b32 v53,v53,v20,s[90:91]
 v_cndmask_b32 v54,v54,v20,s[92:93]
 v_cndmask_b32 v55,v55,v20,s[94:95]
 v_cmp_gt_i32 s[88:89],48,v19
 v_cmp_gt_i32 s[90:91],49,v19
 v_cmp_gt_i32 s[92:93],50,v19
 v_cmp_gt_i32 s[94:95],51,v19
 v_cndmask_b32 v56,v56,v20,s[88:89]
 v_cndmask_b32 v57,v57,v20,s[90:91]
 v_cndmask_b32 v58,v58,v20,s[92:93]
 v_cndmask_b32 v59,v59,v20,s[94:95]
 v_cmp_gt_i32 s[88:89],32,v19
 v_cmp_gt_i32 s[90:91],33,v19
 v_cmp_gt_i32 s[92:93],34,v19
 v_cmp_gt_i32 s[94:95],35,v19
 v_cndmask_b32 v60,v60,v20,s[88:89]
 v_cndmask_b32 v61,v61,v20,s[90:91]
 v_cndmask_b32 v62,v62,v20,s[92:93]
 v_cndmask_b32 v63,v63,v20,s[94:95]
 s_branch a_h_mb
a_i0_mask:
 s_cmp_lt_u32 s27,s85
 s_cbranch_scc1 a_i0_mask_n0
 s_mov_b32 s85,64
 s_cmp_eq_u32 s37,0
 s_cbranch_scc1 a_i0_mask_np0
 s_waitcnt vmcnt(8)
 v_mov_b32 v28,0
 v_mov_b32 v29,1
 s_mov_b64 exec,1
 buffer_store_dword v29,v28,s[0:3],s37 offen sc1
 s_mov_b64 exec,-1
a_i0_mask_np0:
 s_cmp_eq_u32 s87,0
 s_cbranch_scc1 a_i0_mask_nopf
 s_mov_b32 s4,s50
 s_mov_b32 s5,s51
 s_mov_b32 s6,3670016
 s_mov_b32 s7,0x20000
 s_lshl_b32 s87,s52,2
 s_add_u32 s87,s87,s35
 s_lshl_b32 s87,s87,10
 BL a[68:71],v6,s[4:7],s87 offen
 s_add_u32 s87,s87,1048576
 BL a[68:71],v6,s[4:7],s87 offen
 s_add_u32 s87,s87,1048576
 BL a[68:71],v6,s[4:7],s87 offen
 s_add_u32 s87,s87,1048576
 BL a[68:71],v6,s[4:7],s87 offen
 s_add_u32 s87,s87,1048576
 s_mov_b32 s4,s60
 s_mov_b32 s5,s61
 s_mov_b32 s6,802816
 s_mov_b32 s7,0x20000
 s_lshl_b32 s87,s52,2
 s_add_u32 s87,s87,s35
 s_lshl_b32 s87,s87,10
 BL a[68:71],v6,s[4:7],s87 offen
 s_add_u32 s87,s87,1048576
 s_mov_b32 s87,0
a_i0_mask_nopf:
a_i0_mask_n0:
 s_cmp_lt_u32 s27,s29
 s_cbranch_scc1 a_i0_mask_d
 s_cmp_eq_u32 s30,1
 s_cbranch_scc1 a_i0_mask_e1
 s_cmp_eq_u32 s30,2
 s_cbranch_scc1 a_i0_mask_e2
 v_min_u32 v29,3,v0
 v_lshlrev_b32 v29,2,v29
 v_add_u32 v28,s100,v29
 v_add_u32 v28,112,v28
 buffer_load_dword v29,v28,s[0:3],0 offen sc1
 s_mov_b32 s32,0
a_i0_mask_l_chk:
 s_waitcnt vmcnt(0)
 v_cmp_le_u32 vcc,1,v29
 s_nop 1
 s_cmp_eq_u64 vcc,-1
 s_cbranch_scc1 a_i0_mask_l_ok
 s_add_u32 s32,s32,1
 s_cmp_ge_u32 s32,400000
 s_cbranch_scc1 a_i0_mask_l_ok
 s_sleep 1
 buffer_load_dword v29,v28,s[0:3],0 offen sc1
 s_waitcnt vmcnt(0)
 s_branch a_i0_mask_l_chk
a_i0_mask_l_ok:
 s_mov_b32 s29,64
 s_branch a_i0_mask_d
a_i0_mask_e1:
 s_lshl_b32 s31,s79,2
 s_add_u32 s31,s31,s35
 s_lshl_b32 s31,s31,2
 s_add_u32 s31,s31,2304
 v_mov_b32 v116,s31
 buffer_load_dword v117,v116,s[0:3],0 offen sc1
 s_lshl_b32 s31,s53,8
 s_lshl_b32 s32,s99,5
 s_add_u32 s31,s31,s32
 s_add_u32 s31,s31,4480
 s_cmp_eq_u32 s99,3
 s_cselect_b32 s32,3,7
 v_min_u32 v115,s32,v0
 v_lshlrev_b32 v115,2,v115
 v_add_u32 v114,s31,v115
 s_lshl_b32 s31,s86,2
 s_add_u32 s31,s31,1024
 v_mov_b32 v115,s31
 v_cmp_gt_u32 vcc,32,v0
 s_nop 1
 v_cndmask_b32 v114,v115,v114,vcc
 buffer_load_dword v115,v114,s[0:3],0 offen sc1
 s_add_u32 s4,s68,88080384
 s_addc_u32 s5,s69,0
 s_mov_b32 s6,8388608
 s_mov_b32 s7,0x20000
 s_lshl_b32 s31,s53,2
 s_add_u32 s31,s31,s98
 s_lshl_b32 s31,s31,2
 s_add_u32 s31,s31,s99
 s_lshl_b32 s31,s31,2
 s_add_u32 s31,s31,s35
 s_lshl_b32 s31,s31,13
 v_mov_b32 v124,-1
 v_mov_b32 v125,-1
 v_mov_b32 v126,-1
 v_mov_b32 v127,-1
 BS v[124:127],v6,s[4:7],s31 offen sc1
 BS v[124:127],v6,s[4:7],s31 offen offset:1024 sc1
 BS v[124:127],v6,s[4:7],s31 offen offset:2048 sc1
 BS v[124:127],v6,s[4:7],s31 offen offset:3072 sc1
 s_add_u32 s32,s31,4096
 BS v[124:127],v6,s[4:7],s32 offen sc1
 s_add_u32 s32,s31,4096
 BS v[124:127],v6,s[4:7],s32 offen offset:1024 sc1
 s_add_u32 s32,s31,4096
 BS v[124:127],v6,s[4:7],s32 offen offset:2048 sc1
 s_add_u32 s32,s31,4096
 BS v[124:127],v6,s[4:7],s32 offen offset:3072 sc1
 s_mov_b32 s30,2
 s_add_u32 s29,s29,1
 s_branch a_i0_mask_d
a_i0_mask_e2:
 s_cmp_lg_u32 s78,2
 s_cbranch_scc1 a_i0_mask_np
 s_mov_b32 s32,0
a_i0_mask_p_chk:
 v_cmp_le_u32 vcc,1,v117
 s_nop 1
 s_cmp_eq_u64 vcc,-1
 s_cbranch_scc1 a_i0_mask_p_ok
 s_add_u32 s32,s32,1
 s_cmp_ge_u32 s32,400000
 s_cbranch_scc1 a_i0_mask_p_ok
 s_sleep 1
 buffer_load_dword v117,v116,s[0:3],0 offen sc1
 s_waitcnt vmcnt(0)
 s_branch a_i0_mask_p_chk
a_i0_mask_p_ok:
 s_add_u32 s4,s68,76546048
 s_addc_u32 s5,s69,0
 s_mov_b32 s6,8912896
 s_mov_b32 s7,0x20000
 s_lshl_b32 s31,s79,2
 s_add_u32 s31,s31,s35
 s_mul_i32 s31,s31,17408
 BL a[192:195],v6,s[4:7],s31 offen sc1
 BL a[196:199],v6,s[4:7],s31 offen offset:1024 sc1
 BL a[200:203],v6,s[4:7],s31 offen offset:2048 sc1
 BL a[204:207],v6,s[4:7],s31 offen offset:3072 sc1
 s_add_u32 s31,s31,4096
 BL a[208:211],v6,s[4:7],s31 offen sc1
 BL a[212:215],v6,s[4:7],s31 offen offset:1024 sc1
 BL a[216:219],v6,s[4:7],s31 offen offset:2048 sc1
 BL a[220:223],v6,s[4:7],s31 offen offset:3072 sc1
 s_add_u32 s31,s31,4096
 BL a[224:227],v6,s[4:7],s31 offen sc1
 BL a[228:231],v6,s[4:7],s31 offen offset:1024 sc1
 BL a[232:235],v6,s[4:7],s31 offen offset:2048 sc1
 s_waitcnt vmcnt(26)
 BL a[236:239],v6,s[4:7],s31 offen offset:3072 sc1
 s_add_u32 s31,s31,4096
 s_waitcnt vmcnt(26)
 BL a[240:243],v6,s[4:7],s31 offen sc1
 s_waitcnt vmcnt(26)
 BL a[244:247],v6,s[4:7],s31 offen offset:1024 sc1
 s_waitcnt vmcnt(26)
 BL a[248:251],v6,s[4:7],s31 offen offset:2048 sc1
 s_waitcnt vmcnt(26)
 BL a[252:255],v6,s[4:7],s31 offen offset:3072 sc1
 s_add_u32 s31,s31,4096
 s_waitcnt vmcnt(26)
 BL a[64:67],v6,s[4:7],s31 offen sc1
a_i0_mask_np:
 s_mov_b32 s32,0
a_i0_mask_h_chk:
 v_cmp_le_u32 vcc,1,v115
 s_nop 1
 s_cmp_eq_u64 vcc,-1
 s_cbranch_scc1 a_i0_mask_h_ok
 s_add_u32 s32,s32,1
 s_cmp_ge_u32 s32,400000
 s_cbranch_scc1 a_i0_mask_h_ok
 s_sleep 1
 buffer_load_dword v115,v114,s[0:3],0 offen sc1
 s_waitcnt vmcnt(0)
 s_branch a_i0_mask_h_chk
a_i0_mask_h_ok:
 s_add_u32 s4,s68,75497472
 s_addc_u32 s5,s69,0
 s_mov_b32 s6,8192
 s_mov_b32 s7,0x20000
 s_lshl_b32 s31,s86,2
 s_add_u32 s31,s31,s35
 s_lshl_b32 s31,s31,7
 v_and_b32 v5,15,v0
 v_lshlrev_b32 v5,2,v5
 s_waitcnt vmcnt(9)
 buffer_load_dword v112,v5,s[4:7],s31 offen sc1
 s_waitcnt vmcnt(9)
 buffer_load_dword v113,v5,s[4:7],s31 offen offset:64 sc1
 s_mov_b32 s29,64
a_i0_mask_d:
 s_min_u32 s26,s29,s38
 s_min_u32 s26,s26,s85
 s_cmp_lt_u32 s27,s38
 s_cbranch_scc1 a_i0_mb
 s_lshl_b32 s31,s75,7
 s_lshl_b32 s32,s35,5
 s_add_u32 s31,s31,s32
 s_lshl_b32 s32,s27,6
 s_sub_u32 s31,s31,s32
 v_and_b32 v19,15,v0
 v_lshrrev_b32 v20,4,v0
 v_lshlrev_b32 v20,2,v20
 v_sub_u32 v19,v19,v20
 v_add_u32 v19,s31,v19
 v_mov_b32 v20,0xceabfb8f
 v_cmp_gt_i32 s[88:89],0,v19
 v_cmp_gt_i32 s[90:91],1,v19
 v_cmp_gt_i32 s[92:93],2,v19
 v_cmp_gt_i32 s[94:95],3,v19
 v_cndmask_b32 v64,v64,v20,s[88:89]
 v_cndmask_b32 v65,v65,v20,s[90:91]
 v_cndmask_b32 v66,v66,v20,s[92:93]
 v_cndmask_b32 v67,v67,v20,s[94:95]
 v_cmp_gt_i32 s[88:89],-16,v19
 v_cmp_gt_i32 s[90:91],-15,v19
 v_cmp_gt_i32 s[92:93],-14,v19
 v_cmp_gt_i32 s[94:95],-13,v19
 v_cndmask_b32 v68,v68,v20,s[88:89]
 v_cndmask_b32 v69,v69,v20,s[90:91]
 v_cndmask_b32 v70,v70,v20,s[92:93]
 v_cndmask_b32 v71,v71,v20,s[94:95]
 v_cmp_gt_i32 s[88:89],16,v19
 v_cmp_gt_i32 s[90:91],17,v19
 v_cmp_gt_i32 s[92:93],18,v19
 v_cmp_gt_i32 s[94:95],19,v19
 v_cndmask_b32 v72,v72,v20,s[88:89]
 v_cndmask_b32 v73,v73,v20,s[90:91]
 v_cndmask_b32 v74,v74,v20,s[92:93]
 v_cndmask_b32 v75,v75,v20,s[94:95]
 v_cmp_gt_i32 s[88:89],0,v19
 v_cmp_gt_i32 s[90:91],1,v19
 v_cmp_gt_i32 s[92:93],2,v19
 v_cmp_gt_i32 s[94:95],3,v19
 v_cndmask_b32 v76,v76,v20,s[88:89]
 v_cndmask_b32 v77,v77,v20,s[90:91]
 v_cndmask_b32 v78,v78,v20,s[92:93]
 v_cndmask_b32 v79,v79,v20,s[94:95]
 v_cmp_gt_i32 s[88:89],32,v19
 v_cmp_gt_i32 s[90:91],33,v19
 v_cmp_gt_i32 s[92:93],34,v19
 v_cmp_gt_i32 s[94:95],35,v19
 v_cndmask_b32 v80,v80,v20,s[88:89]
 v_cndmask_b32 v81,v81,v20,s[90:91]
 v_cndmask_b32 v82,v82,v20,s[92:93]
 v_cndmask_b32 v83,v83,v20,s[94:95]
 v_cmp_gt_i32 s[88:89],16,v19
 v_cmp_gt_i32 s[90:91],17,v19
 v_cmp_gt_i32 s[92:93],18,v19
 v_cmp_gt_i32 s[94:95],19,v19
 v_cndmask_b32 v84,v84,v20,s[88:89]
 v_cndmask_b32 v85,v85,v20,s[90:91]
 v_cndmask_b32 v86,v86,v20,s[92:93]
 v_cndmask_b32 v87,v87,v20,s[94:95]
 v_cmp_gt_i32 s[88:89],48,v19
 v_cmp_gt_i32 s[90:91],49,v19
 v_cmp_gt_i32 s[92:93],50,v19
 v_cmp_gt_i32 s[94:95],51,v19
 v_cndmask_b32 v88,v88,v20,s[88:89]
 v_cndmask_b32 v89,v89,v20,s[90:91]
 v_cndmask_b32 v90,v90,v20,s[92:93]
 v_cndmask_b32 v91,v91,v20,s[94:95]
 v_cmp_gt_i32 s[88:89],32,v19
 v_cmp_gt_i32 s[90:91],33,v19
 v_cmp_gt_i32 s[92:93],34,v19
 v_cmp_gt_i32 s[94:95],35,v19
 v_cndmask_b32 v92,v92,v20,s[88:89]
 v_cndmask_b32 v93,v93,v20,s[90:91]
 v_cndmask_b32 v94,v94,v20,s[92:93]
 v_cndmask_b32 v95,v95,v20,s[94:95]
 s_branch a_i0_mb
a_i1_mask:
 s_cmp_lt_u32 s27,s85
 s_cbranch_scc1 a_i1_mask_n0
 s_mov_b32 s85,64
 s_cmp_eq_u32 s37,0
 s_cbranch_scc1 a_i1_mask_np0
 s_waitcnt vmcnt(8)
 v_mov_b32 v28,0
 v_mov_b32 v29,1
 s_mov_b64 exec,1
 buffer_store_dword v29,v28,s[0:3],s37 offen sc1
 s_mov_b64 exec,-1
a_i1_mask_np0:
 s_cmp_eq_u32 s87,0
 s_cbranch_scc1 a_i1_mask_nopf
 s_mov_b32 s4,s50
 s_mov_b32 s5,s51
 s_mov_b32 s6,3670016
 s_mov_b32 s7,0x20000
 s_lshl_b32 s87,s52,2
 s_add_u32 s87,s87,s35
 s_lshl_b32 s87,s87,10
 BL a[68:71],v6,s[4:7],s87 offen
 s_add_u32 s87,s87,1048576
 BL a[68:71],v6,s[4:7],s87 offen
 s_add_u32 s87,s87,1048576
 BL a[68:71],v6,s[4:7],s87 offen
 s_add_u32 s87,s87,1048576
 BL a[68:71],v6,s[4:7],s87 offen
 s_add_u32 s87,s87,1048576
 s_mov_b32 s4,s60
 s_mov_b32 s5,s61
 s_mov_b32 s6,802816
 s_mov_b32 s7,0x20000
 s_lshl_b32 s87,s52,2
 s_add_u32 s87,s87,s35
 s_lshl_b32 s87,s87,10
 BL a[68:71],v6,s[4:7],s87 offen
 s_add_u32 s87,s87,1048576
 s_mov_b32 s87,0
a_i1_mask_nopf:
a_i1_mask_n0:
 s_cmp_lt_u32 s27,s29
 s_cbranch_scc1 a_i1_mask_d
 s_cmp_eq_u32 s30,1
 s_cbranch_scc1 a_i1_mask_e1
 s_cmp_eq_u32 s30,2
 s_cbranch_scc1 a_i1_mask_e2
 v_min_u32 v29,3,v0
 v_lshlrev_b32 v29,2,v29
 v_add_u32 v28,s100,v29
 v_add_u32 v28,112,v28
 buffer_load_dword v29,v28,s[0:3],0 offen sc1
 s_mov_b32 s32,0
a_i1_mask_l_chk:
 s_waitcnt vmcnt(0)
 v_cmp_le_u32 vcc,1,v29
 s_nop 1
 s_cmp_eq_u64 vcc,-1
 s_cbranch_scc1 a_i1_mask_l_ok
 s_add_u32 s32,s32,1
 s_cmp_ge_u32 s32,400000
 s_cbranch_scc1 a_i1_mask_l_ok
 s_sleep 1
 buffer_load_dword v29,v28,s[0:3],0 offen sc1
 s_waitcnt vmcnt(0)
 s_branch a_i1_mask_l_chk
a_i1_mask_l_ok:
 s_mov_b32 s29,64
 s_branch a_i1_mask_d
a_i1_mask_e1:
 s_lshl_b32 s31,s79,2
 s_add_u32 s31,s31,s35
 s_lshl_b32 s31,s31,2
 s_add_u32 s31,s31,2304
 v_mov_b32 v116,s31
 buffer_load_dword v117,v116,s[0:3],0 offen sc1
 s_lshl_b32 s31,s53,8
 s_lshl_b32 s32,s99,5
 s_add_u32 s31,s31,s32
 s_add_u32 s31,s31,4480
 s_cmp_eq_u32 s99,3
 s_cselect_b32 s32,3,7
 v_min_u32 v115,s32,v0
 v_lshlrev_b32 v115,2,v115
 v_add_u32 v114,s31,v115
 s_lshl_b32 s31,s86,2
 s_add_u32 s31,s31,1024
 v_mov_b32 v115,s31
 v_cmp_gt_u32 vcc,32,v0
 s_nop 1
 v_cndmask_b32 v114,v115,v114,vcc
 buffer_load_dword v115,v114,s[0:3],0 offen sc1
 s_add_u32 s4,s68,88080384
 s_addc_u32 s5,s69,0
 s_mov_b32 s6,8388608
 s_mov_b32 s7,0x20000
 s_lshl_b32 s31,s53,2
 s_add_u32 s31,s31,s98
 s_lshl_b32 s31,s31,2
 s_add_u32 s31,s31,s99
 s_lshl_b32 s31,s31,2
 s_add_u32 s31,s31,s35
 s_lshl_b32 s31,s31,13
 v_mov_b32 v124,-1
 v_mov_b32 v125,-1
 v_mov_b32 v126,-1
 v_mov_b32 v127,-1
 BS v[124:127],v6,s[4:7],s31 offen sc1
 BS v[124:127],v6,s[4:7],s31 offen offset:1024 sc1
 BS v[124:127],v6,s[4:7],s31 offen offset:2048 sc1
 BS v[124:127],v6,s[4:7],s31 offen offset:3072 sc1
 s_add_u32 s32,s31,4096
 BS v[124:127],v6,s[4:7],s32 offen sc1
 s_add_u32 s32,s31,4096
 BS v[124:127],v6,s[4:7],s32 offen offset:1024 sc1
 s_add_u32 s32,s31,4096
 BS v[124:127],v6,s[4:7],s32 offen offset:2048 sc1
 s_add_u32 s32,s31,4096
 BS v[124:127],v6,s[4:7],s32 offen offset:3072 sc1
 s_mov_b32 s30,2
 s_add_u32 s29,s29,1
 s_branch a_i1_mask_d
a_i1_mask_e2:
 s_cmp_lg_u32 s78,2
 s_cbranch_scc1 a_i1_mask_np
 s_mov_b32 s32,0
a_i1_mask_p_chk:
 v_cmp_le_u32 vcc,1,v117
 s_nop 1
 s_cmp_eq_u64 vcc,-1
 s_cbranch_scc1 a_i1_mask_p_ok
 s_add_u32 s32,s32,1
 s_cmp_ge_u32 s32,400000
 s_cbranch_scc1 a_i1_mask_p_ok
 s_sleep 1
 buffer_load_dword v117,v116,s[0:3],0 offen sc1
 s_waitcnt vmcnt(0)
 s_branch a_i1_mask_p_chk
a_i1_mask_p_ok:
 s_add_u32 s4,s68,76546048
 s_addc_u32 s5,s69,0
 s_mov_b32 s6,8912896
 s_mov_b32 s7,0x20000
 s_lshl_b32 s31,s79,2
 s_add_u32 s31,s31,s35
 s_mul_i32 s31,s31,17408
 BL a[192:195],v6,s[4:7],s31 offen sc1
 BL a[196:199],v6,s[4:7],s31 offen offset:1024 sc1
 BL a[200:203],v6,s[4:7],s31 offen offset:2048 sc1
 BL a[204:207],v6,s[4:7],s31 offen offset:3072 sc1
 s_add_u32 s31,s31,4096
 BL a[208:211],v6,s[4:7],s31 offen sc1
 BL a[212:215],v6,s[4:7],s31 offen offset:1024 sc1
 BL a[216:219],v6,s[4:7],s31 offen offset:2048 sc1
 BL a[220:223],v6,s[4:7],s31 offen offset:3072 sc1
 s_add_u32 s31,s31,4096
 BL a[224:227],v6,s[4:7],s31 offen sc1
 BL a[228:231],v6,s[4:7],s31 offen offset:1024 sc1
 BL a[232:235],v6,s[4:7],s31 offen offset:2048 sc1
 BL a[236:239],v6,s[4:7],s31 offen offset:3072 sc1
 s_add_u32 s31,s31,4096
 BL a[240:243],v6,s[4:7],s31 offen sc1
 BL a[244:247],v6,s[4:7],s31 offen offset:1024 sc1
 BL a[248:251],v6,s[4:7],s31 offen offset:2048 sc1
 BL a[252:255],v6,s[4:7],s31 offen offset:3072 sc1
 s_add_u32 s31,s31,4096
 BL a[64:67],v6,s[4:7],s31 offen sc1
a_i1_mask_np:
 s_mov_b32 s32,0
a_i1_mask_h_chk:
 v_cmp_le_u32 vcc,1,v115
 s_nop 1
 s_cmp_eq_u64 vcc,-1
 s_cbranch_scc1 a_i1_mask_h_ok
 s_add_u32 s32,s32,1
 s_cmp_ge_u32 s32,400000
 s_cbranch_scc1 a_i1_mask_h_ok
 s_sleep 1
 buffer_load_dword v115,v114,s[0:3],0 offen sc1
 s_waitcnt vmcnt(0)
 s_branch a_i1_mask_h_chk
a_i1_mask_h_ok:
 s_add_u32 s4,s68,75497472
 s_addc_u32 s5,s69,0
 s_mov_b32 s6,8192
 s_mov_b32 s7,0x20000
 s_lshl_b32 s31,s86,2
 s_add_u32 s31,s31,s35
 s_lshl_b32 s31,s31,7
 v_and_b32 v5,15,v0
 v_lshlrev_b32 v5,2,v5
 buffer_load_dword v112,v5,s[4:7],s31 offen sc1
 buffer_load_dword v113,v5,s[4:7],s31 offen offset:64 sc1
 s_mov_b32 s29,64
a_i1_mask_d:
 s_min_u32 s26,s29,s38
 s_min_u32 s26,s26,s85
 s_cmp_lt_u32 s27,s38
 s_cbranch_scc1 a_i1_mb
 s_lshl_b32 s31,s75,7
 s_lshl_b32 s32,s35,5
 s_add_u32 s31,s31,s32
 s_lshl_b32 s32,s27,6
 s_sub_u32 s31,s31,s32
 v_and_b32 v19,15,v0
 v_lshrrev_b32 v20,4,v0
 v_lshlrev_b32 v20,2,v20
 v_sub_u32 v19,v19,v20
 v_add_u32 v19,s31,v19
 v_mov_b32 v20,0xceabfb8f
 v_cmp_gt_i32 s[88:89],0,v19
 v_cmp_gt_i32 s[90:91],1,v19
 v_cmp_gt_i32 s[92:93],2,v19
 v_cmp_gt_i32 s[94:95],3,v19
 v_cndmask_b32 v32,v32,v20,s[88:89]
 v_cndmask_b32 v33,v33,v20,s[90:91]
 v_cndmask_b32 v34,v34,v20,s[92:93]
 v_cndmask_b32 v35,v35,v20,s[94:95]
 v_cmp_gt_i32 s[88:89],-16,v19
 v_cmp_gt_i32 s[90:91],-15,v19
 v_cmp_gt_i32 s[92:93],-14,v19
 v_cmp_gt_i32 s[94:95],-13,v19
 v_cndmask_b32 v36,v36,v20,s[88:89]
 v_cndmask_b32 v37,v37,v20,s[90:91]
 v_cndmask_b32 v38,v38,v20,s[92:93]
 v_cndmask_b32 v39,v39,v20,s[94:95]
 v_cmp_gt_i32 s[88:89],16,v19
 v_cmp_gt_i32 s[90:91],17,v19
 v_cmp_gt_i32 s[92:93],18,v19
 v_cmp_gt_i32 s[94:95],19,v19
 v_cndmask_b32 v40,v40,v20,s[88:89]
 v_cndmask_b32 v41,v41,v20,s[90:91]
 v_cndmask_b32 v42,v42,v20,s[92:93]
 v_cndmask_b32 v43,v43,v20,s[94:95]
 v_cmp_gt_i32 s[88:89],0,v19
 v_cmp_gt_i32 s[90:91],1,v19
 v_cmp_gt_i32 s[92:93],2,v19
 v_cmp_gt_i32 s[94:95],3,v19
 v_cndmask_b32 v44,v44,v20,s[88:89]
 v_cndmask_b32 v45,v45,v20,s[90:91]
 v_cndmask_b32 v46,v46,v20,s[92:93]
 v_cndmask_b32 v47,v47,v20,s[94:95]
 v_cmp_gt_i32 s[88:89],32,v19
 v_cmp_gt_i32 s[90:91],33,v19
 v_cmp_gt_i32 s[92:93],34,v19
 v_cmp_gt_i32 s[94:95],35,v19
 v_cndmask_b32 v48,v48,v20,s[88:89]
 v_cndmask_b32 v49,v49,v20,s[90:91]
 v_cndmask_b32 v50,v50,v20,s[92:93]
 v_cndmask_b32 v51,v51,v20,s[94:95]
 v_cmp_gt_i32 s[88:89],16,v19
 v_cmp_gt_i32 s[90:91],17,v19
 v_cmp_gt_i32 s[92:93],18,v19
 v_cmp_gt_i32 s[94:95],19,v19
 v_cndmask_b32 v52,v52,v20,s[88:89]
 v_cndmask_b32 v53,v53,v20,s[90:91]
 v_cndmask_b32 v54,v54,v20,s[92:93]
 v_cndmask_b32 v55,v55,v20,s[94:95]
 v_cmp_gt_i32 s[88:89],48,v19
 v_cmp_gt_i32 s[90:91],49,v19
 v_cmp_gt_i32 s[92:93],50,v19
 v_cmp_gt_i32 s[94:95],51,v19
 v_cndmask_b32 v56,v56,v20,s[88:89]
 v_cndmask_b32 v57,v57,v20,s[90:91]
 v_cndmask_b32 v58,v58,v20,s[92:93]
 v_cndmask_b32 v59,v59,v20,s[94:95]
 v_cmp_gt_i32 s[88:89],32,v19
 v_cmp_gt_i32 s[90:91],33,v19
 v_cmp_gt_i32 s[92:93],34,v19
 v_cmp_gt_i32 s[94:95],35,v19
 v_cndmask_b32 v60,v60,v20,s[88:89]
 v_cndmask_b32 v61,v61,v20,s[90:91]
 v_cndmask_b32 v62,v62,v20,s[92:93]
 v_cndmask_b32 v63,v63,v20,s[94:95]
 s_branch a_i1_mb
a_i0_resc:
 v_max3_f32 v19,v64,v65,v66
 v_max3_f32 v19,v19,v67,v72
 v_max3_f32 v19,v19,v73,v74
 v_max3_f32 v19,v19,v75,v80
 v_max3_f32 v19,v19,v81,v82
 v_max3_f32 v19,v19,v83,v88
 v_max3_f32 v19,v19,v89,v90
 v_max_f32 v19,v19,v91
 v_max3_f32 v20,v68,v69,v70
 v_max3_f32 v20,v20,v71,v76
 v_max3_f32 v20,v20,v77,v78
 v_max3_f32 v20,v20,v79,v84
 v_max3_f32 v20,v20,v85,v86
 v_max3_f32 v20,v20,v87,v92
 v_max3_f32 v20,v20,v93,v94
 v_max_f32 v20,v20,v95
 v_mov_b32 v26,v19
 v_mov_b32 v27,v20
 s_nop 0
 v_permlane32_swap_b32 v19,v26
 s_nop 0
 v_permlane32_swap_b32 v20,v27
 v_max_f32 v19,v19,v26
 v_max_f32 v20,v20,v27
 v_mov_b32 v26,v19
 v_mov_b32 v27,v20
 s_nop 0
 v_permlane16_swap_b32 v19,v26
 s_nop 0
 v_permlane16_swap_b32 v20,v27
 v_max_f32 v19,v19,v26
 v_max_f32 v20,v20,v27
 v_max_f32 v19,0,v19
 v_sub_f32 v64,v64,v19
 v_sub_f32 v65,v65,v19
 v_sub_f32 v66,v66,v19
 v_sub_f32 v67,v67,v19
 v_sub_f32 v72,v72,v19
 v_sub_f32 v73,v73,v19
 v_sub_f32 v74,v74,v19
 v_sub_f32 v75,v75,v19
 v_sub_f32 v80,v80,v19
 v_sub_f32 v81,v81,v19
 v_sub_f32 v82,v82,v19
 v_sub_f32 v83,v83,v19
 v_sub_f32 v88,v88,v19
 v_sub_f32 v89,v89,v19
 v_sub_f32 v90,v90,v19
 v_sub_f32 v91,v91,v19
 v_sub_f32 v8,v8,v19
 v_sub_f32 v9,v9,v19
 v_sub_f32 v10,v10,v19
 v_sub_f32 v11,v11,v19
 v_max_f32 v20,0,v20
 v_sub_f32 v68,v68,v20
 v_sub_f32 v69,v69,v20
 v_sub_f32 v70,v70,v20
 v_sub_f32 v71,v71,v20
 v_sub_f32 v76,v76,v20
 v_sub_f32 v77,v77,v20
 v_sub_f32 v78,v78,v20
 v_sub_f32 v79,v79,v20
 v_sub_f32 v84,v84,v20
 v_sub_f32 v85,v85,v20
 v_sub_f32 v86,v86,v20
 v_sub_f32 v87,v87,v20
 v_sub_f32 v92,v92,v20
 v_sub_f32 v93,v93,v20
 v_sub_f32 v94,v94,v20
 v_sub_f32 v95,v95,v20
 v_sub_f32 v12,v12,v20
 v_sub_f32 v13,v13,v20
 v_sub_f32 v14,v14,v20
 v_sub_f32 v15,v15,v20
 v_exp_f32 v22,-v19
 v_exp_f32 v24,-v20
 v_mul_f32 v16,v16,v22
 v_mul_f32 v17,v17,v24
 PM v[128:129],v[128:129],v[22:23] op_sel_hi:[1,0]
 PM v[130:131],v[130:131],v[22:23] op_sel_hi:[1,0]
 PM v[132:133],v[132:133],v[24:25] op_sel_hi:[1,0]
 PM v[134:135],v[134:135],v[24:25] op_sel_hi:[1,0]
 PM v[136:137],v[136:137],v[22:23] op_sel_hi:[1,0]
 PM v[138:139],v[138:139],v[22:23] op_sel_hi:[1,0]
 PM v[140:141],v[140:141],v[24:25] op_sel_hi:[1,0]
 PM v[142:143],v[142:143],v[24:25] op_sel_hi:[1,0]
 PM v[144:145],v[144:145],v[22:23] op_sel_hi:[1,0]
 PM v[146:147],v[146:147],v[22:23] op_sel_hi:[1,0]
 PM v[148:149],v[148:149],v[24:25] op_sel_hi:[1,0]
 PM v[150:151],v[150:151],v[24:25] op_sel_hi:[1,0]
 PM v[152:153],v[152:153],v[22:23] op_sel_hi:[1,0]
 PM v[154:155],v[154:155],v[22:23] op_sel_hi:[1,0]
 PM v[156:157],v[156:157],v[24:25] op_sel_hi:[1,0]
 PM v[158:159],v[158:159],v[24:25] op_sel_hi:[1,0]
 PM v[160:161],v[160:161],v[22:23] op_sel_hi:[1,0]
 PM v[162:163],v[162:163],v[22:23] op_sel_hi:[1,0]
 PM v[164:165],v[164:165],v[24:25] op_sel_hi:[1,0]
 PM v[166:167],v[166:167],v[24:25] op_sel_hi:[1,0]
 PM v[168:169],v[168:169],v[22:23] op_sel_hi:[1,0]
 PM v[170:171],v[170:171],v[22:23] op_sel_hi:[1,0]
 PM v[172:173],v[172:173],v[24:25] op_sel_hi:[1,0]
 PM v[174:175],v[174:175],v[24:25] op_sel_hi:[1,0]
 PM v[176:177],v[176:177],v[22:23] op_sel_hi:[1,0]
 PM v[178:179],v[178:179],v[22:23] op_sel_hi:[1,0]
 PM v[180:181],v[180:181],v[24:25] op_sel_hi:[1,0]
 PM v[182:183],v[182:183],v[24:25] op_sel_hi:[1,0]
 PM v[184:185],v[184:185],v[22:23] op_sel_hi:[1,0]
 PM v[186:187],v[186:187],v[22:23] op_sel_hi:[1,0]
 PM v[188:189],v[188:189],v[24:25] op_sel_hi:[1,0]
 PM v[190:191],v[190:191],v[24:25] op_sel_hi:[1,0]
 PM v[192:193],v[192:193],v[22:23] op_sel_hi:[1,0]
 PM v[194:195],v[194:195],v[22:23] op_sel_hi:[1,0]
 PM v[196:197],v[196:197],v[24:25] op_sel_hi:[1,0]
 PM v[198:199],v[198:199],v[24:25] op_sel_hi:[1,0]
 PM v[200:201],v[200:201],v[22:23] op_sel_hi:[1,0]
 PM v[202:203],v[202:203],v[22:23] op_sel_hi:[1,0]
 PM v[204:205],v[204:205],v[24:25] op_sel_hi:[1,0]
 PM v[206:207],v[206:207],v[24:25] op_sel_hi:[1,0]
 PM v[208:209],v[208:209],v[22:23] op_sel_hi:[1,0]
 PM v[210:211],v[210:211],v[22:23] op_sel_hi:[1,0]
 PM v[212:213],v[212:213],v[24:25] op_sel_hi:[1,0]
 PM v[214:215],v[214:215],v[24:25] op_sel_hi:[1,0]
 PM v[216:217],v[216:217],v[22:23] op_sel_hi:[1,0]
 PM v[218:219],v[218:219],v[22:23] op_sel_hi:[1,0]
 PM v[220:221],v[220:221],v[24:25] op_sel_hi:[1,0]
 PM v[222:223],v[222:223],v[24:25] op_sel_hi:[1,0]
 PM v[224:225],v[224:225],v[22:23] op_sel_hi:[1,0]
 PM v[226:227],v[226:227],v[22:23] op_sel_hi:[1,0]
 PM v[228:229],v[228:229],v[24:25] op_sel_hi:[1,0]
 PM v[230:231],v[230:231],v[24:25] op_sel_hi:[1,0]
 PM v[232:233],v[232:233],v[22:23] op_sel_hi:[1,0]
 PM v[234:235],v[234:235],v[22:23] op_sel_hi:[1,0]
 PM v[236:237],v[236:237],v[24:25] op_sel_hi:[1,0]
 PM v[238:239],v[238:239],v[24:25] op_sel_hi:[1,0]
 PM v[240:241],v[240:241],v[22:23] op_sel_hi:[1,0]
 PM v[242:243],v[242:243],v[22:23] op_sel_hi:[1,0]
 PM v[244:245],v[244:245],v[24:25] op_sel_hi:[1,0]
 PM v[246:247],v[246:247],v[24:25] op_sel_hi:[1,0]
 PM v[248:249],v[248:249],v[22:23] op_sel_hi:[1,0]
 PM v[250:251],v[250:251],v[22:23] op_sel_hi:[1,0]
 PM v[252:253],v[252:253],v[24:25] op_sel_hi:[1,0]
 PM v[254:255],v[254:255],v[24:25] op_sel_hi:[1,0]
 s_branch a_i0_rb
a_i1_resc:
 v_max3_f32 v19,v32,v33,v34
 v_max3_f32 v19,v19,v35,v40
 v_max3_f32 v19,v19,v41,v42
 v_max3_f32 v19,v19,v43,v48
 v_max3_f32 v19,v19,v49,v50
 v_max3_f32 v19,v19,v51,v56
 v_max3_f32 v19,v19,v57,v58
 v_max_f32 v19,v19,v59
 v_max3_f32 v20,v36,v37,v38
 v_max3_f32 v20,v20,v39,v44
 v_max3_f32 v20,v20,v45,v46
 v_max3_f32 v20,v20,v47,v52
 v_max3_f32 v20,v20,v53,v54
 v_max3_f32 v20,v20,v55,v60
 v_max3_f32 v20,v20,v61,v62
 v_max_f32 v20,v20,v63
 v_mov_b32 v26,v19
 v_mov_b32 v27,v20
 s_nop 0
 v_permlane32_swap_b32 v19,v26
 s_nop 0
 v_permlane32_swap_b32 v20,v27
 v_max_f32 v19,v19,v26
 v_max_f32 v20,v20,v27
 v_mov_b32 v26,v19
 v_mov_b32 v27,v20
 s_nop 0
 v_permlane16_swap_b32 v19,v26
 s_nop 0
 v_permlane16_swap_b32 v20,v27
 v_max_f32 v19,v19,v26
 v_max_f32 v20,v20,v27
 v_max_f32 v19,0,v19
 v_sub_f32 v32,v32,v19
 v_sub_f32 v33,v33,v19
 v_sub_f32 v34,v34,v19
 v_sub_f32 v35,v35,v19
 v_sub_f32 v40,v40,v19
 v_sub_f32 v41,v41,v19
 v_sub_f32 v42,v42,v19
 v_sub_f32 v43,v43,v19
 v_sub_f32 v48,v48,v19
 v_sub_f32 v49,v49,v19
 v_sub_f32 v50,v50,v19
 v_sub_f32 v51,v51,v19
 v_sub_f32 v56,v56,v19
 v_sub_f32 v57,v57,v19
 v_sub_f32 v58,v58,v19
 v_sub_f32 v59,v59,v19
 v_sub_f32 v8,v8,v19
 v_sub_f32 v9,v9,v19
 v_sub_f32 v10,v10,v19
 v_sub_f32 v11,v11,v19
 v_max_f32 v20,0,v20
 v_sub_f32 v36,v36,v20
 v_sub_f32 v37,v37,v20
 v_sub_f32 v38,v38,v20
 v_sub_f32 v39,v39,v20
 v_sub_f32 v44,v44,v20
 v_sub_f32 v45,v45,v20
 v_sub_f32 v46,v46,v20
 v_sub_f32 v47,v47,v20
 v_sub_f32 v52,v52,v20
 v_sub_f32 v53,v53,v20
 v_sub_f32 v54,v54,v20
 v_sub_f32 v55,v55,v20
 v_sub_f32 v60,v60,v20
 v_sub_f32 v61,v61,v20
 v_sub_f32 v62,v62,v20
 v_sub_f32 v63,v63,v20
 v_sub_f32 v12,v12,v20
 v_sub_f32 v13,v13,v20
 v_sub_f32 v14,v14,v20
 v_sub_f32 v15,v15,v20
 v_exp_f32 v22,-v19
 v_exp_f32 v24,-v20
 v_mul_f32 v16,v16,v22
 v_mul_f32 v17,v17,v24
 PM v[128:129],v[128:129],v[22:23] op_sel_hi:[1,0]
 PM v[130:131],v[130:131],v[22:23] op_sel_hi:[1,0]
 PM v[132:133],v[132:133],v[24:25] op_sel_hi:[1,0]
 PM v[134:135],v[134:135],v[24:25] op_sel_hi:[1,0]
 PM v[136:137],v[136:137],v[22:23] op_sel_hi:[1,0]
 PM v[138:139],v[138:139],v[22:23] op_sel_hi:[1,0]
 PM v[140:141],v[140:141],v[24:25] op_sel_hi:[1,0]
 PM v[142:143],v[142:143],v[24:25] op_sel_hi:[1,0]
 PM v[144:145],v[144:145],v[22:23] op_sel_hi:[1,0]
 PM v[146:147],v[146:147],v[22:23] op_sel_hi:[1,0]
 PM v[148:149],v[148:149],v[24:25] op_sel_hi:[1,0]
 PM v[150:151],v[150:151],v[24:25] op_sel_hi:[1,0]
 PM v[152:153],v[152:153],v[22:23] op_sel_hi:[1,0]
 PM v[154:155],v[154:155],v[22:23] op_sel_hi:[1,0]
 PM v[156:157],v[156:157],v[24:25] op_sel_hi:[1,0]
 PM v[158:159],v[158:159],v[24:25] op_sel_hi:[1,0]
 PM v[160:161],v[160:161],v[22:23] op_sel_hi:[1,0]
 PM v[162:163],v[162:163],v[22:23] op_sel_hi:[1,0]
 PM v[164:165],v[164:165],v[24:25] op_sel_hi:[1,0]
 PM v[166:167],v[166:167],v[24:25] op_sel_hi:[1,0]
 PM v[168:169],v[168:169],v[22:23] op_sel_hi:[1,0]
 PM v[170:171],v[170:171],v[22:23] op_sel_hi:[1,0]
 PM v[172:173],v[172:173],v[24:25] op_sel_hi:[1,0]
 PM v[174:175],v[174:175],v[24:25] op_sel_hi:[1,0]
 PM v[176:177],v[176:177],v[22:23] op_sel_hi:[1,0]
 PM v[178:179],v[178:179],v[22:23] op_sel_hi:[1,0]
 PM v[180:181],v[180:181],v[24:25] op_sel_hi:[1,0]
 PM v[182:183],v[182:183],v[24:25] op_sel_hi:[1,0]
 PM v[184:185],v[184:185],v[22:23] op_sel_hi:[1,0]
 PM v[186:187],v[186:187],v[22:23] op_sel_hi:[1,0]
 PM v[188:189],v[188:189],v[24:25] op_sel_hi:[1,0]
 PM v[190:191],v[190:191],v[24:25] op_sel_hi:[1,0]
 PM v[192:193],v[192:193],v[22:23] op_sel_hi:[1,0]
 PM v[194:195],v[194:195],v[22:23] op_sel_hi:[1,0]
 PM v[196:197],v[196:197],v[24:25] op_sel_hi:[1,0]
 PM v[198:199],v[198:199],v[24:25] op_sel_hi:[1,0]
 PM v[200:201],v[200:201],v[22:23] op_sel_hi:[1,0]
 PM v[202:203],v[202:203],v[22:23] op_sel_hi:[1,0]
 PM v[204:205],v[204:205],v[24:25] op_sel_hi:[1,0]
 PM v[206:207],v[206:207],v[24:25] op_sel_hi:[1,0]
 PM v[208:209],v[208:209],v[22:23] op_sel_hi:[1,0]
 PM v[210:211],v[210:211],v[22:23] op_sel_hi:[1,0]
 PM v[212:213],v[212:213],v[24:25] op_sel_hi:[1,0]
 PM v[214:215],v[214:215],v[24:25] op_sel_hi:[1,0]
 PM v[216:217],v[216:217],v[22:23] op_sel_hi:[1,0]
 PM v[218:219],v[218:219],v[22:23] op_sel_hi:[1,0]
 PM v[220:221],v[220:221],v[24:25] op_sel_hi:[1,0]
 PM v[222:223],v[222:223],v[24:25] op_sel_hi:[1,0]
 PM v[224:225],v[224:225],v[22:23] op_sel_hi:[1,0]
 PM v[226:227],v[226:227],v[22:23] op_sel_hi:[1,0]
 PM v[228:229],v[228:229],v[24:25] op_sel_hi:[1,0]
 PM v[230:231],v[230:231],v[24:25] op_sel_hi:[1,0]
 PM v[232:233],v[232:233],v[22:23] op_sel_hi:[1,0]
 PM v[234:235],v[234:235],v[22:23] op_sel_hi:[1,0]
 PM v[236:237],v[236:237],v[24:25] op_sel_hi:[1,0]
 PM v[238:239],v[238:239],v[24:25] op_sel_hi:[1,0]
 PM v[240:241],v[240:241],v[22:23] op_sel_hi:[1,0]
 PM v[242:243],v[242:243],v[22:23] op_sel_hi:[1,0]
 PM v[244:245],v[244:245],v[24:25] op_sel_hi:[1,0]
 PM v[246:247],v[246:247],v[24:25] op_sel_hi:[1,0]
 PM v[248:249],v[248:249],v[22:23] op_sel_hi:[1,0]
 PM v[250:251],v[250:251],v[22:23] op_sel_hi:[1,0]
 PM v[252:253],v[252:253],v[24:25] op_sel_hi:[1,0]
 PM v[254:255],v[254:255],v[24:25] op_sel_hi:[1,0]
 s_branch a_i1_rb
a_end:
 v_mov_b32 v18,v16
 v_mov_b32 v19,v17
 s_nop 0
 v_permlane32_swap_b32 v16,v18
 s_nop 0
 v_permlane32_swap_b32 v17,v19
 v_add_f32 v16,v16,v18
 v_add_f32 v17,v17,v19
 v_mov_b32 v18,v16
 v_mov_b32 v19,v17
 s_nop 0
 v_permlane16_swap_b32 v16,v18
 s_nop 0
 v_permlane16_swap_b32 v17,v19
 v_add_f32 v16,v16,v18
 v_add_f32 v17,v17,v19
 s_cmp_eq_u32 s78,2
 s_cbranch_scc1 f_comb
 v_rcp_f32 v20,v16
 v_rcp_f32 v22,v17
 s_waitcnt vmcnt(17)
 v_mul_f32 v20,v20,v112
 s_waitcnt vmcnt(16)
 v_mul_f32 v22,v22,v113
 s_add_u32 s16,s68,50331648
 s_addc_u32 s17,s69,0
 s_mov_b32 s18,20447232
 s_mov_b32 s19,0x20000
 s_lshl_b32 s31,s75,2
 s_add_u32 s31,s31,s35
 s_mul_i32 s31,s31,319488
 s_lshl_b32 s32,s74,13
 s_add_u32 s31,s31,s32
 s_add_u32 s31,s31,28672
 PM v[128:129],v[128:129],v[20:21] op_sel_hi:[1,0]
 PM v[130:131],v[130:131],v[20:21] op_sel_hi:[1,0]
 PM v[136:137],v[136:137],v[20:21] op_sel_hi:[1,0]
 PM v[138:139],v[138:139],v[20:21] op_sel_hi:[1,0]
 CV v128,v128,v129
 CV v129,v130,v131
 CV v130,v136,v137
 CV v131,v138,v139
 BS v[128:131],v6,s[16:19],s31 offen sc1
 PM v[144:145],v[144:145],v[20:21] op_sel_hi:[1,0]
 PM v[146:147],v[146:147],v[20:21] op_sel_hi:[1,0]
 PM v[152:153],v[152:153],v[20:21] op_sel_hi:[1,0]
 PM v[154:155],v[154:155],v[20:21] op_sel_hi:[1,0]
 CV v144,v144,v145
 CV v145,v146,v147
 CV v146,v152,v153
 CV v147,v154,v155
 BS v[144:147],v6,s[16:19],s31 offen offset:1024 sc1
 PM v[160:161],v[160:161],v[20:21] op_sel_hi:[1,0]
 PM v[162:163],v[162:163],v[20:21] op_sel_hi:[1,0]
 PM v[168:169],v[168:169],v[20:21] op_sel_hi:[1,0]
 PM v[170:171],v[170:171],v[20:21] op_sel_hi:[1,0]
 CV v160,v160,v161
 CV v161,v162,v163
 CV v162,v168,v169
 CV v163,v170,v171
 BS v[160:163],v6,s[16:19],s31 offen offset:2048 sc1
 PM v[176:177],v[176:177],v[20:21] op_sel_hi:[1,0]
 PM v[178:179],v[178:179],v[20:21] op_sel_hi:[1,0]
 PM v[184:185],v[184:185],v[20:21] op_sel_hi:[1,0]
 PM v[186:187],v[186:187],v[20:21] op_sel_hi:[1,0]
 CV v176,v176,v177
 CV v177,v178,v179
 CV v178,v184,v185
 CV v179,v186,v187
 BS v[176:179],v6,s[16:19],s31 offen offset:3072 sc1
 PM v[192:193],v[192:193],v[20:21] op_sel_hi:[1,0]
 PM v[194:195],v[194:195],v[20:21] op_sel_hi:[1,0]
 PM v[200:201],v[200:201],v[20:21] op_sel_hi:[1,0]
 PM v[202:203],v[202:203],v[20:21] op_sel_hi:[1,0]
 CV v192,v192,v193
 CV v193,v194,v195
 CV v194,v200,v201
 CV v195,v202,v203
 s_add_u32 s32,s31,4096
 BS v[192:195],v6,s[16:19],s32 offen sc1
 PM v[208:209],v[208:209],v[20:21] op_sel_hi:[1,0]
 PM v[210:211],v[210:211],v[20:21] op_sel_hi:[1,0]
 PM v[216:217],v[216:217],v[20:21] op_sel_hi:[1,0]
 PM v[218:219],v[218:219],v[20:21] op_sel_hi:[1,0]
 CV v208,v208,v209
 CV v209,v210,v211
 CV v210,v216,v217
 CV v211,v218,v219
 s_add_u32 s32,s31,4096
 BS v[208:211],v6,s[16:19],s32 offen offset:1024 sc1
 PM v[224:225],v[224:225],v[20:21] op_sel_hi:[1,0]
 PM v[226:227],v[226:227],v[20:21] op_sel_hi:[1,0]
 PM v[232:233],v[232:233],v[20:21] op_sel_hi:[1,0]
 PM v[234:235],v[234:235],v[20:21] op_sel_hi:[1,0]
 CV v224,v224,v225
 CV v225,v226,v227
 CV v226,v232,v233
 CV v227,v234,v235
 s_add_u32 s32,s31,4096
 BS v[224:227],v6,s[16:19],s32 offen offset:2048 sc1
 PM v[240:241],v[240:241],v[20:21] op_sel_hi:[1,0]
 PM v[242:243],v[242:243],v[20:21] op_sel_hi:[1,0]
 PM v[248:249],v[248:249],v[20:21] op_sel_hi:[1,0]
 PM v[250:251],v[250:251],v[20:21] op_sel_hi:[1,0]
 CV v240,v240,v241
 CV v241,v242,v243
 CV v242,v248,v249
 CV v243,v250,v251
 s_add_u32 s32,s31,4096
 BS v[240:243],v6,s[16:19],s32 offen offset:3072 sc1
 PM v[132:133],v[132:133],v[22:23] op_sel_hi:[1,0]
 PM v[134:135],v[134:135],v[22:23] op_sel_hi:[1,0]
 PM v[140:141],v[140:141],v[22:23] op_sel_hi:[1,0]
 PM v[142:143],v[142:143],v[22:23] op_sel_hi:[1,0]
 CV v132,v132,v133
 CV v133,v134,v135
 CV v134,v140,v141
 CV v135,v142,v143
 s_add_u32 s32,s31,159744
 BS v[132:135],v6,s[16:19],s32 offen sc1
 PM v[148:149],v[148:149],v[22:23] op_sel_hi:[1,0]
 PM v[150:151],v[150:151],v[22:23] op_sel_hi:[1,0]
 PM v[156:157],v[156:157],v[22:23] op_sel_hi:[1,0]
 PM v[158:159],v[158:159],v[22:23] op_sel_hi:[1,0]
 CV v148,v148,v149
 CV v149,v150,v151
 CV v150,v156,v157
 CV v151,v158,v159
 s_add_u32 s32,s31,159744
 BS v[148:151],v6,s[16:19],s32 offen offset:1024 sc1
 PM v[164:165],v[164:165],v[22:23] op_sel_hi:[1,0]
 PM v[166:167],v[166:167],v[22:23] op_sel_hi:[1,0]
 PM v[172:173],v[172:173],v[22:23] op_sel_hi:[1,0]
 PM v[174:175],v[174:175],v[22:23] op_sel_hi:[1,0]
 CV v164,v164,v165
 CV v165,v166,v167
 CV v166,v172,v173
 CV v167,v174,v175
 s_add_u32 s32,s31,159744
 BS v[164:167],v6,s[16:19],s32 offen offset:2048 sc1
 PM v[180:181],v[180:181],v[22:23] op_sel_hi:[1,0]
 PM v[182:183],v[182:183],v[22:23] op_sel_hi:[1,0]
 PM v[188:189],v[188:189],v[22:23] op_sel_hi:[1,0]
 PM v[190:191],v[190:191],v[22:23] op_sel_hi:[1,0]
 CV v180,v180,v181
 CV v181,v182,v183
 CV v182,v188,v189
 CV v183,v190,v191
 s_add_u32 s32,s31,159744
 BS v[180:183],v6,s[16:19],s32 offen offset:3072 sc1
 PM v[196:197],v[196:197],v[22:23] op_sel_hi:[1,0]
 PM v[198:199],v[198:199],v[22:23] op_sel_hi:[1,0]
 PM v[204:205],v[204:205],v[22:23] op_sel_hi:[1,0]
 PM v[206:207],v[206:207],v[22:23] op_sel_hi:[1,0]
 CV v196,v196,v197
 CV v197,v198,v199
 CV v198,v204,v205
 CV v199,v206,v207
 s_add_u32 s32,s31,163840
 BS v[196:199],v6,s[16:19],s32 offen sc1
 PM v[212:213],v[212:213],v[22:23] op_sel_hi:[1,0]
 PM v[214:215],v[214:215],v[22:23] op_sel_hi:[1,0]
 PM v[220:221],v[220:221],v[22:23] op_sel_hi:[1,0]
 PM v[222:223],v[222:223],v[22:23] op_sel_hi:[1,0]
 CV v212,v212,v213
 CV v213,v214,v215
 CV v214,v220,v221
 CV v215,v222,v223
 s_add_u32 s32,s31,163840
 BS v[212:215],v6,s[16:19],s32 offen offset:1024 sc1
 PM v[228:229],v[228:229],v[22:23] op_sel_hi:[1,0]
 PM v[230:231],v[230:231],v[22:23] op_sel_hi:[1,0]
 PM v[236:237],v[236:237],v[22:23] op_sel_hi:[1,0]
 PM v[238:239],v[238:239],v[22:23] op_sel_hi:[1,0]
 CV v228,v228,v229
 CV v229,v230,v231
 CV v230,v236,v237
 CV v231,v238,v239
 s_add_u32 s32,s31,163840
 BS v[228:231],v6,s[16:19],s32 offen offset:2048 sc1
 PM v[244:245],v[244:245],v[22:23] op_sel_hi:[1,0]
 PM v[246:247],v[246:247],v[22:23] op_sel_hi:[1,0]
 PM v[252:253],v[252:253],v[22:23] op_sel_hi:[1,0]
 PM v[254:255],v[254:255],v[22:23] op_sel_hi:[1,0]
 CV v244,v244,v245
 CV v245,v246,v247
 CV v246,v252,v253
 CV v247,v254,v255
 s_add_u32 s32,s31,163840
 BS v[244:247],v6,s[16:19],s32 offen offset:3072 sc1
 s_branch f_fin
f_part:
 v_mov_b32 v18,v16
 v_mov_b32 v19,v17
 s_nop 0
 v_permlane32_swap_b32 v16,v18
 s_nop 0
 v_permlane32_swap_b32 v17,v19
 v_add_f32 v16,v16,v18
 v_add_f32 v17,v17,v19
 v_mov_b32 v18,v16
 v_mov_b32 v19,v17
 s_nop 0
 v_permlane16_swap_b32 v16,v18
 s_nop 0
 v_permlane16_swap_b32 v17,v19
 v_add_f32 v16,v16,v18
 v_add_f32 v17,v17,v19
 v_rcp_f32 v20,v16
 v_rcp_f32 v22,v17
 s_add_u32 s4,s68,76546048
 s_addc_u32 s5,s69,0
 s_mov_b32 s6,8912896
 s_mov_b32 s7,0x20000
 s_lshl_b32 s31,s79,2
 s_add_u32 s31,s31,s35
 s_mul_i32 s31,s31,17408
 PM v[128:129],v[128:129],v[20:21] op_sel_hi:[1,0]
 s_cmp_lt_u32 s21,s24
 s_cselect_b32 s14,16777216,0
 s_cselect_b32 m0,s23,196608
 PM v[130:131],v[130:131],v[20:21] op_sel_hi:[1,0]
 PM v[136:137],v[136:137],v[20:21] op_sel_hi:[1,0]
 PM v[138:139],v[138:139],v[20:21] op_sel_hi:[1,0]
 CV v128,v128,v129
 CV v129,v130,v131
 CV v130,v136,v137
 CV v131,v138,v139
 BS v[128:131],v6,s[4:7],s31 offen sc1
 PM v[144:145],v[144:145],v[20:21] op_sel_hi:[1,0]
 PM v[146:147],v[146:147],v[20:21] op_sel_hi:[1,0]
 PM v[152:153],v[152:153],v[20:21] op_sel_hi:[1,0]
 PM v[154:155],v[154:155],v[20:21] op_sel_hi:[1,0]
 BL v2,s[12:15],s21 offen sc1 lds
 CV v144,v144,v145
 CV v145,v146,v147
 CV v146,v152,v153
 CV v147,v154,v155
 BS v[144:147],v6,s[4:7],s31 offen offset:1024 sc1
 PM v[160:161],v[160:161],v[20:21] op_sel_hi:[1,0]
 PM v[162:163],v[162:163],v[20:21] op_sel_hi:[1,0]
 PM v[168:169],v[168:169],v[20:21] op_sel_hi:[1,0]
 PM v[170:171],v[170:171],v[20:21] op_sel_hi:[1,0]
 CV v160,v160,v161
 CV v161,v162,v163
 CV v162,v168,v169
 BL v2,s[12:15],s21 offen offset:1024 sc1 lds
 CV v163,v170,v171
 BS v[160:163],v6,s[4:7],s31 offen offset:2048 sc1
 PM v[176:177],v[176:177],v[20:21] op_sel_hi:[1,0]
 PM v[178:179],v[178:179],v[20:21] op_sel_hi:[1,0]
 PM v[184:185],v[184:185],v[20:21] op_sel_hi:[1,0]
 PM v[186:187],v[186:187],v[20:21] op_sel_hi:[1,0]
 CV v176,v176,v177
 CV v177,v178,v179
 CV v178,v184,v185
 CV v179,v186,v187
 BS v[176:179],v6,s[4:7],s31 offen offset:3072 sc1
 PM v[192:193],v[192:193],v[20:21] op_sel_hi:[1,0]
 BL v2,s[12:15],s21 offen offset:2048 sc1 lds
 PM v[194:195],v[194:195],v[20:21] op_sel_hi:[1,0]
 PM v[200:201],v[200:201],v[20:21] op_sel_hi:[1,0]
 PM v[202:203],v[202:203],v[20:21] op_sel_hi:[1,0]
 CV v192,v192,v193
 CV v193,v194,v195
 CV v194,v200,v201
 CV v195,v202,v203
 s_add_u32 s32,s31,4096
 BS v[192:195],v6,s[4:7],s32 offen sc1
 PM v[208:209],v[208:209],v[20:21] op_sel_hi:[1,0]
 PM v[210:211],v[210:211],v[20:21] op_sel_hi:[1,0]
 PM v[216:217],v[216:217],v[20:21] op_sel_hi:[1,0]
 BL v2,s[12:15],s21 offen offset:3072 sc1 lds
 PM v[218:219],v[218:219],v[20:21] op_sel_hi:[1,0]
 CV v208,v208,v209
 CV v209,v210,v211
 CV v210,v216,v217
 CV v211,v218,v219
 s_add_u32 s32,s31,4096
 BS v[208:211],v6,s[4:7],s32 offen offset:1024 sc1
 PM v[224:225],v[224:225],v[20:21] op_sel_hi:[1,0]
 PM v[226:227],v[226:227],v[20:21] op_sel_hi:[1,0]
 PM v[232:233],v[232:233],v[20:21] op_sel_hi:[1,0]
 PM v[234:235],v[234:235],v[20:21] op_sel_hi:[1,0]
 CV v224,v224,v225
 s_add_u32 m0,m0,4096
 CV v225,v226,v227
 CV v226,v232,v233
 CV v227,v234,v235
 s_add_u32 s32,s31,4096
 BS v[224:227],v6,s[4:7],s32 offen offset:2048 sc1
 PM v[240:241],v[240:241],v[20:21] op_sel_hi:[1,0]
 PM v[242:243],v[242:243],v[20:21] op_sel_hi:[1,0]
 PM v[248:249],v[248:249],v[20:21] op_sel_hi:[1,0]
 PM v[250:251],v[250:251],v[20:21] op_sel_hi:[1,0]
 CV v240,v240,v241
 CV v241,v242,v243
 CV v242,v248,v249
 BL v1,s[12:15],s21 offen sc1 lds
 CV v243,v250,v251
 s_add_u32 s32,s31,4096
 BS v[240:243],v6,s[4:7],s32 offen offset:3072 sc1
 PM v[132:133],v[132:133],v[22:23] op_sel_hi:[1,0]
 PM v[134:135],v[134:135],v[22:23] op_sel_hi:[1,0]
 PM v[140:141],v[140:141],v[22:23] op_sel_hi:[1,0]
 PM v[142:143],v[142:143],v[22:23] op_sel_hi:[1,0]
 CV v132,v132,v133
 CV v133,v134,v135
 CV v134,v140,v141
 CV v135,v142,v143
 s_add_u32 s32,s31,8192
 BS v[132:135],v6,s[4:7],s32 offen sc1
 BL v1,s[12:15],s21 offen offset:1024 sc1 lds
 PM v[148:149],v[148:149],v[22:23] op_sel_hi:[1,0]
 PM v[150:151],v[150:151],v[22:23] op_sel_hi:[1,0]
 PM v[156:157],v[156:157],v[22:23] op_sel_hi:[1,0]
 PM v[158:159],v[158:159],v[22:23] op_sel_hi:[1,0]
 CV v148,v148,v149
 CV v149,v150,v151
 CV v150,v156,v157
 CV v151,v158,v159
 s_add_u32 s32,s31,8192
 BS v[148:151],v6,s[4:7],s32 offen offset:1024 sc1
 PM v[164:165],v[164:165],v[22:23] op_sel_hi:[1,0]
 BL v1,s[12:15],s21 offen offset:2048 sc1 lds
 PM v[166:167],v[166:167],v[22:23] op_sel_hi:[1,0]
 PM v[172:173],v[172:173],v[22:23] op_sel_hi:[1,0]
 PM v[174:175],v[174:175],v[22:23] op_sel_hi:[1,0]
 CV v164,v164,v165
 CV v165,v166,v167
 CV v166,v172,v173
 CV v167,v174,v175
 s_add_u32 s32,s31,8192
 BS v[164:167],v6,s[4:7],s32 offen offset:2048 sc1
 PM v[180:181],v[180:181],v[22:23] op_sel_hi:[1,0]
 PM v[182:183],v[182:183],v[22:23] op_sel_hi:[1,0]
 PM v[188:189],v[188:189],v[22:23] op_sel_hi:[1,0]
 BL v1,s[12:15],s21 offen offset:3072 sc1 lds
 PM v[190:191],v[190:191],v[22:23] op_sel_hi:[1,0]
 CV v180,v180,v181
 CV v181,v182,v183
 CV v182,v188,v189
 CV v183,v190,v191
 s_add_u32 s32,s31,8192
 BS v[180:183],v6,s[4:7],s32 offen offset:3072 sc1
 PM v[196:197],v[196:197],v[22:23] op_sel_hi:[1,0]
 PM v[198:199],v[198:199],v[22:23] op_sel_hi:[1,0]
 PM v[204:205],v[204:205],v[22:23] op_sel_hi:[1,0]
 PM v[206:207],v[206:207],v[22:23] op_sel_hi:[1,0]
 CV v196,v196,v197
 s_add_u32 s21,s21,32768
 CV v197,v198,v199
 CV v198,v204,v205
 CV v199,v206,v207
 s_add_u32 s32,s31,12288
 BS v[196:199],v6,s[4:7],s32 offen sc1
 PM v[212:213],v[212:213],v[22:23] op_sel_hi:[1,0]
 PM v[214:215],v[214:215],v[22:23] op_sel_hi:[1,0]
 PM v[220:221],v[220:221],v[22:23] op_sel_hi:[1,0]
 PM v[222:223],v[222:223],v[22:23] op_sel_hi:[1,0]
 CV v212,v212,v213
 CV v213,v214,v215
 CV v214,v220,v221
 s_add_u32 s23,s23,65536
 CV v215,v222,v223
 s_add_u32 s32,s31,12288
 BS v[212:215],v6,s[4:7],s32 offen offset:1024 sc1
 PM v[228:229],v[228:229],v[22:23] op_sel_hi:[1,0]
 PM v[230:231],v[230:231],v[22:23] op_sel_hi:[1,0]
 PM v[236:237],v[236:237],v[22:23] op_sel_hi:[1,0]
 PM v[238:239],v[238:239],v[22:23] op_sel_hi:[1,0]
 CV v228,v228,v229
 CV v229,v230,v231
 CV v230,v236,v237
 CV v231,v238,v239
 s_add_u32 s32,s31,12288
 BS v[228:231],v6,s[4:7],s32 offen offset:2048 sc1
 s_sub_u32 s34,s23,163840
 s_min_u32 s23,s23,s34
 PM v[244:245],v[244:245],v[22:23] op_sel_hi:[1,0]
 PM v[246:247],v[246:247],v[22:23] op_sel_hi:[1,0]
 PM v[252:253],v[252:253],v[22:23] op_sel_hi:[1,0]
 PM v[254:255],v[254:255],v[22:23] op_sel_hi:[1,0]
 CV v244,v244,v245
 CV v245,v246,v247
 CV v246,v252,v253
 CV v247,v254,v255
 s_add_u32 s32,s31,12288
 BS v[244:247],v6,s[4:7],s32 offen offset:3072 sc1
 v_mov_b32 v80,v8
 v_mov_b32 v81,v16
 v_mov_b32 v82,v12
 v_mov_b32 v83,v17
 s_add_u32 s32,s31,16384
 BS v[80:83],v6,s[4:7],s32 offen sc1
 s_mov_b32 s78,s28
 s_lshl_b32 s37,s79,2
 s_add_u32 s37,s37,s35
 s_lshl_b32 s37,s37,2
 s_add_u32 s37,s37,2304
 s_barrier
 s_lshl_b32 s79,s74,3
 s_add_u32 s79,s79,s75
 s_sub_u32 s79,s79,9
 s_waitcnt vmcnt(33)
 s_branch L_seg
f_comb:
 s_waitcnt vmcnt(18)
 AR v80,a64
 AR v81,a65
 AR v82,a66
 AR v83,a67
 v_min_f32 v28,v8,v80
 v_sub_f32 v20,v28,v8
 v_sub_f32 v24,v28,v80
 v_exp_f32 v20,v20
 v_exp_f32 v24,v24
 s_nop 0
 v_mul_f32 v24,v24,v81
 v_fma_f32 v28,v20,v16,v24
 v_rcp_f32 v28,v28
 s_waitcnt vmcnt(17)
 v_mul_f32 v28,v28,v112
 v_mul_f32 v20,v20,v28
 v_mul_f32 v24,v24,v28
 v_min_f32 v28,v12,v82
 v_sub_f32 v22,v28,v12
 v_sub_f32 v26,v28,v82
 v_exp_f32 v22,v22
 v_exp_f32 v26,v26
 s_nop 0
 v_mul_f32 v26,v26,v83
 v_fma_f32 v28,v22,v17,v26
 v_rcp_f32 v28,v28
 s_waitcnt vmcnt(16)
 v_mul_f32 v28,v28,v113
 v_mul_f32 v22,v22,v28
 v_mul_f32 v26,v26,v28
 s_add_u32 s16,s68,50331648
 s_addc_u32 s17,s69,0
 s_mov_b32 s18,20447232
 s_mov_b32 s19,0x20000
 s_lshl_b32 s31,s75,2
 s_add_u32 s31,s31,s35
 s_mul_i32 s31,s31,319488
 s_lshl_b32 s32,s74,13
 s_add_u32 s31,s31,s32
 s_add_u32 s31,s31,28672
 PM v[128:129],v[128:129],v[20:21] op_sel_hi:[1,0]
 PM v[130:131],v[130:131],v[20:21] op_sel_hi:[1,0]
 PM v[136:137],v[136:137],v[20:21] op_sel_hi:[1,0]
 PM v[138:139],v[138:139],v[20:21] op_sel_hi:[1,0]
 AR v40,a192
 AR v41,a193
 AR v42,a194
 AR v43,a195
 v_lshlrev_b32 v32,16,v40
 v_and_b32 v33,0xffff0000,v40
 v_lshlrev_b32 v34,16,v41
 v_and_b32 v35,0xffff0000,v41
 v_lshlrev_b32 v36,16,v42
 v_and_b32 v37,0xffff0000,v42
 v_lshlrev_b32 v38,16,v43
 v_and_b32 v39,0xffff0000,v43
 v_pk_fma_f32 v[128:129],v[32:33],v[24:25],v[128:129] op_sel_hi:[1,0,1]
 v_pk_fma_f32 v[130:131],v[34:35],v[24:25],v[130:131] op_sel_hi:[1,0,1]
 v_pk_fma_f32 v[136:137],v[36:37],v[24:25],v[136:137] op_sel_hi:[1,0,1]
 v_pk_fma_f32 v[138:139],v[38:39],v[24:25],v[138:139] op_sel_hi:[1,0,1]
 CV v128,v128,v129
 CV v129,v130,v131
 CV v130,v136,v137
 CV v131,v138,v139
 BS v[128:131],v6,s[16:19],s31 offen sc1
 PM v[144:145],v[144:145],v[20:21] op_sel_hi:[1,0]
 PM v[146:147],v[146:147],v[20:21] op_sel_hi:[1,0]
 PM v[152:153],v[152:153],v[20:21] op_sel_hi:[1,0]
 PM v[154:155],v[154:155],v[20:21] op_sel_hi:[1,0]
 AR v52,a196
 AR v53,a197
 AR v54,a198
 AR v55,a199
 v_lshlrev_b32 v44,16,v52
 v_and_b32 v45,0xffff0000,v52
 v_lshlrev_b32 v46,16,v53
 v_and_b32 v47,0xffff0000,v53
 v_lshlrev_b32 v48,16,v54
 v_and_b32 v49,0xffff0000,v54
 v_lshlrev_b32 v50,16,v55
 v_and_b32 v51,0xffff0000,v55
 v_pk_fma_f32 v[144:145],v[44:45],v[24:25],v[144:145] op_sel_hi:[1,0,1]
 v_pk_fma_f32 v[146:147],v[46:47],v[24:25],v[146:147] op_sel_hi:[1,0,1]
 v_pk_fma_f32 v[152:153],v[48:49],v[24:25],v[152:153] op_sel_hi:[1,0,1]
 v_pk_fma_f32 v[154:155],v[50:51],v[24:25],v[154:155] op_sel_hi:[1,0,1]
 CV v144,v144,v145
 CV v145,v146,v147
 CV v146,v152,v153
 CV v147,v154,v155
 BS v[144:147],v6,s[16:19],s31 offen offset:1024 sc1
 PM v[160:161],v[160:161],v[20:21] op_sel_hi:[1,0]
 PM v[162:163],v[162:163],v[20:21] op_sel_hi:[1,0]
 PM v[168:169],v[168:169],v[20:21] op_sel_hi:[1,0]
 PM v[170:171],v[170:171],v[20:21] op_sel_hi:[1,0]
 AR v64,a200
 AR v65,a201
 AR v66,a202
 AR v67,a203
 v_lshlrev_b32 v56,16,v64
 v_and_b32 v57,0xffff0000,v64
 v_lshlrev_b32 v58,16,v65
 v_and_b32 v59,0xffff0000,v65
 v_lshlrev_b32 v60,16,v66
 v_and_b32 v61,0xffff0000,v66
 v_lshlrev_b32 v62,16,v67
 v_and_b32 v63,0xffff0000,v67
 v_pk_fma_f32 v[160:161],v[56:57],v[24:25],v[160:161] op_sel_hi:[1,0,1]
 v_pk_fma_f32 v[162:163],v[58:59],v[24:25],v[162:163] op_sel_hi:[1,0,1]
 v_pk_fma_f32 v[168:169],v[60:61],v[24:25],v[168:169] op_sel_hi:[1,0,1]
 v_pk_fma_f32 v[170:171],v[62:63],v[24:25],v[170:171] op_sel_hi:[1,0,1]
 CV v160,v160,v161
 CV v161,v162,v163
 CV v162,v168,v169
 CV v163,v170,v171
 BS v[160:163],v6,s[16:19],s31 offen offset:2048 sc1
 PM v[176:177],v[176:177],v[20:21] op_sel_hi:[1,0]
 PM v[178:179],v[178:179],v[20:21] op_sel_hi:[1,0]
 PM v[184:185],v[184:185],v[20:21] op_sel_hi:[1,0]
 PM v[186:187],v[186:187],v[20:21] op_sel_hi:[1,0]
 AR v76,a204
 AR v77,a205
 AR v78,a206
 AR v79,a207
 v_lshlrev_b32 v68,16,v76
 v_and_b32 v69,0xffff0000,v76
 v_lshlrev_b32 v70,16,v77
 v_and_b32 v71,0xffff0000,v77
 v_lshlrev_b32 v72,16,v78
 v_and_b32 v73,0xffff0000,v78
 v_lshlrev_b32 v74,16,v79
 v_and_b32 v75,0xffff0000,v79
 v_pk_fma_f32 v[176:177],v[68:69],v[24:25],v[176:177] op_sel_hi:[1,0,1]
 v_pk_fma_f32 v[178:179],v[70:71],v[24:25],v[178:179] op_sel_hi:[1,0,1]
 v_pk_fma_f32 v[184:185],v[72:73],v[24:25],v[184:185] op_sel_hi:[1,0,1]
 v_pk_fma_f32 v[186:187],v[74:75],v[24:25],v[186:187] op_sel_hi:[1,0,1]
 CV v176,v176,v177
 CV v177,v178,v179
 CV v178,v184,v185
 CV v179,v186,v187
 BS v[176:179],v6,s[16:19],s31 offen offset:3072 sc1
 PM v[192:193],v[192:193],v[20:21] op_sel_hi:[1,0]
 PM v[194:195],v[194:195],v[20:21] op_sel_hi:[1,0]
 PM v[200:201],v[200:201],v[20:21] op_sel_hi:[1,0]
 PM v[202:203],v[202:203],v[20:21] op_sel_hi:[1,0]
 AR v40,a208
 AR v41,a209
 AR v42,a210
 AR v43,a211
 v_lshlrev_b32 v32,16,v40
 v_and_b32 v33,0xffff0000,v40
 v_lshlrev_b32 v34,16,v41
 v_and_b32 v35,0xffff0000,v41
 v_lshlrev_b32 v36,16,v42
 v_and_b32 v37,0xffff0000,v42
 v_lshlrev_b32 v38,16,v43
 v_and_b32 v39,0xffff0000,v43
 v_pk_fma_f32 v[192:193],v[32:33],v[24:25],v[192:193] op_sel_hi:[1,0,1]
 v_pk_fma_f32 v[194:195],v[34:35],v[24:25],v[194:195] op_sel_hi:[1,0,1]
 v_pk_fma_f32 v[200:201],v[36:37],v[24:25],v[200:201] op_sel_hi:[1,0,1]
 v_pk_fma_f32 v[202:203],v[38:39],v[24:25],v[202:203] op_sel_hi:[1,0,1]
 CV v192,v192,v193
 CV v193,v194,v195
 CV v194,v200,v201
 CV v195,v202,v203
 s_add_u32 s32,s31,4096
 BS v[192:195],v6,s[16:19],s32 offen sc1
 PM v[208:209],v[208:209],v[20:21] op_sel_hi:[1,0]
 PM v[210:211],v[210:211],v[20:21] op_sel_hi:[1,0]
 PM v[216:217],v[216:217],v[20:21] op_sel_hi:[1,0]
 PM v[218:219],v[218:219],v[20:21] op_sel_hi:[1,0]
 AR v52,a212
 AR v53,a213
 AR v54,a214
 AR v55,a215
 v_lshlrev_b32 v44,16,v52
 v_and_b32 v45,0xffff0000,v52
 v_lshlrev_b32 v46,16,v53
 v_and_b32 v47,0xffff0000,v53
 v_lshlrev_b32 v48,16,v54
 v_and_b32 v49,0xffff0000,v54
 v_lshlrev_b32 v50,16,v55
 v_and_b32 v51,0xffff0000,v55
 v_pk_fma_f32 v[208:209],v[44:45],v[24:25],v[208:209] op_sel_hi:[1,0,1]
 v_pk_fma_f32 v[210:211],v[46:47],v[24:25],v[210:211] op_sel_hi:[1,0,1]
 v_pk_fma_f32 v[216:217],v[48:49],v[24:25],v[216:217] op_sel_hi:[1,0,1]
 v_pk_fma_f32 v[218:219],v[50:51],v[24:25],v[218:219] op_sel_hi:[1,0,1]
 CV v208,v208,v209
 CV v209,v210,v211
 CV v210,v216,v217
 CV v211,v218,v219
 s_add_u32 s32,s31,4096
 BS v[208:211],v6,s[16:19],s32 offen offset:1024 sc1
 PM v[224:225],v[224:225],v[20:21] op_sel_hi:[1,0]
 PM v[226:227],v[226:227],v[20:21] op_sel_hi:[1,0]
 PM v[232:233],v[232:233],v[20:21] op_sel_hi:[1,0]
 PM v[234:235],v[234:235],v[20:21] op_sel_hi:[1,0]
 AR v64,a216
 AR v65,a217
 AR v66,a218
 AR v67,a219
 v_lshlrev_b32 v56,16,v64
 v_and_b32 v57,0xffff0000,v64
 v_lshlrev_b32 v58,16,v65
 v_and_b32 v59,0xffff0000,v65
 v_lshlrev_b32 v60,16,v66
 v_and_b32 v61,0xffff0000,v66
 v_lshlrev_b32 v62,16,v67
 v_and_b32 v63,0xffff0000,v67
 v_pk_fma_f32 v[224:225],v[56:57],v[24:25],v[224:225] op_sel_hi:[1,0,1]
 v_pk_fma_f32 v[226:227],v[58:59],v[24:25],v[226:227] op_sel_hi:[1,0,1]
 v_pk_fma_f32 v[232:233],v[60:61],v[24:25],v[232:233] op_sel_hi:[1,0,1]
 v_pk_fma_f32 v[234:235],v[62:63],v[24:25],v[234:235] op_sel_hi:[1,0,1]
 CV v224,v224,v225
 CV v225,v226,v227
 CV v226,v232,v233
 CV v227,v234,v235
 s_add_u32 s32,s31,4096
 BS v[224:227],v6,s[16:19],s32 offen offset:2048 sc1
 PM v[240:241],v[240:241],v[20:21] op_sel_hi:[1,0]
 PM v[242:243],v[242:243],v[20:21] op_sel_hi:[1,0]
 PM v[248:249],v[248:249],v[20:21] op_sel_hi:[1,0]
 PM v[250:251],v[250:251],v[20:21] op_sel_hi:[1,0]
 AR v76,a220
 AR v77,a221
 AR v78,a222
 AR v79,a223
 v_lshlrev_b32 v68,16,v76
 v_and_b32 v69,0xffff0000,v76
 v_lshlrev_b32 v70,16,v77
 v_and_b32 v71,0xffff0000,v77
 v_lshlrev_b32 v72,16,v78
 v_and_b32 v73,0xffff0000,v78
 v_lshlrev_b32 v74,16,v79
 v_and_b32 v75,0xffff0000,v79
 v_pk_fma_f32 v[240:241],v[68:69],v[24:25],v[240:241] op_sel_hi:[1,0,1]
 v_pk_fma_f32 v[242:243],v[70:71],v[24:25],v[242:243] op_sel_hi:[1,0,1]
 v_pk_fma_f32 v[248:249],v[72:73],v[24:25],v[248:249] op_sel_hi:[1,0,1]
 v_pk_fma_f32 v[250:251],v[74:75],v[24:25],v[250:251] op_sel_hi:[1,0,1]
 CV v240,v240,v241
 CV v241,v242,v243
 CV v242,v248,v249
 CV v243,v250,v251
 s_add_u32 s32,s31,4096
 BS v[240:243],v6,s[16:19],s32 offen offset:3072 sc1
 PM v[132:133],v[132:133],v[22:23] op_sel_hi:[1,0]
 PM v[134:135],v[134:135],v[22:23] op_sel_hi:[1,0]
 PM v[140:141],v[140:141],v[22:23] op_sel_hi:[1,0]
 PM v[142:143],v[142:143],v[22:23] op_sel_hi:[1,0]
 AR v40,a224
 AR v41,a225
 AR v42,a226
 AR v43,a227
 v_lshlrev_b32 v32,16,v40
 v_and_b32 v33,0xffff0000,v40
 v_lshlrev_b32 v34,16,v41
 v_and_b32 v35,0xffff0000,v41
 v_lshlrev_b32 v36,16,v42
 v_and_b32 v37,0xffff0000,v42
 v_lshlrev_b32 v38,16,v43
 v_and_b32 v39,0xffff0000,v43
 v_pk_fma_f32 v[132:133],v[32:33],v[26:27],v[132:133] op_sel_hi:[1,0,1]
 v_pk_fma_f32 v[134:135],v[34:35],v[26:27],v[134:135] op_sel_hi:[1,0,1]
 v_pk_fma_f32 v[140:141],v[36:37],v[26:27],v[140:141] op_sel_hi:[1,0,1]
 v_pk_fma_f32 v[142:143],v[38:39],v[26:27],v[142:143] op_sel_hi:[1,0,1]
 CV v132,v132,v133
 CV v133,v134,v135
 CV v134,v140,v141
 CV v135,v142,v143
 s_add_u32 s32,s31,159744
 BS v[132:135],v6,s[16:19],s32 offen sc1
 PM v[148:149],v[148:149],v[22:23] op_sel_hi:[1,0]
 PM v[150:151],v[150:151],v[22:23] op_sel_hi:[1,0]
 PM v[156:157],v[156:157],v[22:23] op_sel_hi:[1,0]
 PM v[158:159],v[158:159],v[22:23] op_sel_hi:[1,0]
 AR v52,a228
 AR v53,a229
 AR v54,a230
 AR v55,a231
 v_lshlrev_b32 v44,16,v52
 v_and_b32 v45,0xffff0000,v52
 v_lshlrev_b32 v46,16,v53
 v_and_b32 v47,0xffff0000,v53
 v_lshlrev_b32 v48,16,v54
 v_and_b32 v49,0xffff0000,v54
 v_lshlrev_b32 v50,16,v55
 v_and_b32 v51,0xffff0000,v55
 v_pk_fma_f32 v[148:149],v[44:45],v[26:27],v[148:149] op_sel_hi:[1,0,1]
 v_pk_fma_f32 v[150:151],v[46:47],v[26:27],v[150:151] op_sel_hi:[1,0,1]
 v_pk_fma_f32 v[156:157],v[48:49],v[26:27],v[156:157] op_sel_hi:[1,0,1]
 v_pk_fma_f32 v[158:159],v[50:51],v[26:27],v[158:159] op_sel_hi:[1,0,1]
 CV v148,v148,v149
 CV v149,v150,v151
 CV v150,v156,v157
 CV v151,v158,v159
 s_add_u32 s32,s31,159744
 BS v[148:151],v6,s[16:19],s32 offen offset:1024 sc1
 PM v[164:165],v[164:165],v[22:23] op_sel_hi:[1,0]
 PM v[166:167],v[166:167],v[22:23] op_sel_hi:[1,0]
 PM v[172:173],v[172:173],v[22:23] op_sel_hi:[1,0]
 PM v[174:175],v[174:175],v[22:23] op_sel_hi:[1,0]
 AR v64,a232
 AR v65,a233
 AR v66,a234
 AR v67,a235
 v_lshlrev_b32 v56,16,v64
 v_and_b32 v57,0xffff0000,v64
 v_lshlrev_b32 v58,16,v65
 v_and_b32 v59,0xffff0000,v65
 v_lshlrev_b32 v60,16,v66
 v_and_b32 v61,0xffff0000,v66
 v_lshlrev_b32 v62,16,v67
 v_and_b32 v63,0xffff0000,v67
 v_pk_fma_f32 v[164:165],v[56:57],v[26:27],v[164:165] op_sel_hi:[1,0,1]
 v_pk_fma_f32 v[166:167],v[58:59],v[26:27],v[166:167] op_sel_hi:[1,0,1]
 v_pk_fma_f32 v[172:173],v[60:61],v[26:27],v[172:173] op_sel_hi:[1,0,1]
 v_pk_fma_f32 v[174:175],v[62:63],v[26:27],v[174:175] op_sel_hi:[1,0,1]
 CV v164,v164,v165
 CV v165,v166,v167
 CV v166,v172,v173
 CV v167,v174,v175
 s_add_u32 s32,s31,159744
 BS v[164:167],v6,s[16:19],s32 offen offset:2048 sc1
 PM v[180:181],v[180:181],v[22:23] op_sel_hi:[1,0]
 PM v[182:183],v[182:183],v[22:23] op_sel_hi:[1,0]
 PM v[188:189],v[188:189],v[22:23] op_sel_hi:[1,0]
 PM v[190:191],v[190:191],v[22:23] op_sel_hi:[1,0]
 AR v76,a236
 AR v77,a237
 AR v78,a238
 AR v79,a239
 v_lshlrev_b32 v68,16,v76
 v_and_b32 v69,0xffff0000,v76
 v_lshlrev_b32 v70,16,v77
 v_and_b32 v71,0xffff0000,v77
 v_lshlrev_b32 v72,16,v78
 v_and_b32 v73,0xffff0000,v78
 v_lshlrev_b32 v74,16,v79
 v_and_b32 v75,0xffff0000,v79
 v_pk_fma_f32 v[180:181],v[68:69],v[26:27],v[180:181] op_sel_hi:[1,0,1]
 v_pk_fma_f32 v[182:183],v[70:71],v[26:27],v[182:183] op_sel_hi:[1,0,1]
 v_pk_fma_f32 v[188:189],v[72:73],v[26:27],v[188:189] op_sel_hi:[1,0,1]
 v_pk_fma_f32 v[190:191],v[74:75],v[26:27],v[190:191] op_sel_hi:[1,0,1]
 CV v180,v180,v181
 CV v181,v182,v183
 CV v182,v188,v189
 CV v183,v190,v191
 s_add_u32 s32,s31,159744
 BS v[180:183],v6,s[16:19],s32 offen offset:3072 sc1
 PM v[196:197],v[196:197],v[22:23] op_sel_hi:[1,0]
 PM v[198:199],v[198:199],v[22:23] op_sel_hi:[1,0]
 PM v[204:205],v[204:205],v[22:23] op_sel_hi:[1,0]
 PM v[206:207],v[206:207],v[22:23] op_sel_hi:[1,0]
 AR v40,a240
 AR v41,a241
 AR v42,a242
 AR v43,a243
 v_lshlrev_b32 v32,16,v40
 v_and_b32 v33,0xffff0000,v40
 v_lshlrev_b32 v34,16,v41
 v_and_b32 v35,0xffff0000,v41
 v_lshlrev_b32 v36,16,v42
 v_and_b32 v37,0xffff0000,v42
 v_lshlrev_b32 v38,16,v43
 v_and_b32 v39,0xffff0000,v43
 v_pk_fma_f32 v[196:197],v[32:33],v[26:27],v[196:197] op_sel_hi:[1,0,1]
 v_pk_fma_f32 v[198:199],v[34:35],v[26:27],v[198:199] op_sel_hi:[1,0,1]
 v_pk_fma_f32 v[204:205],v[36:37],v[26:27],v[204:205] op_sel_hi:[1,0,1]
 v_pk_fma_f32 v[206:207],v[38:39],v[26:27],v[206:207] op_sel_hi:[1,0,1]
 CV v196,v196,v197
 CV v197,v198,v199
 CV v198,v204,v205
 CV v199,v206,v207
 s_add_u32 s32,s31,163840
 BS v[196:199],v6,s[16:19],s32 offen sc1
 PM v[212:213],v[212:213],v[22:23] op_sel_hi:[1,0]
 PM v[214:215],v[214:215],v[22:23] op_sel_hi:[1,0]
 PM v[220:221],v[220:221],v[22:23] op_sel_hi:[1,0]
 PM v[222:223],v[222:223],v[22:23] op_sel_hi:[1,0]
 AR v52,a244
 AR v53,a245
 AR v54,a246
 AR v55,a247
 v_lshlrev_b32 v44,16,v52
 v_and_b32 v45,0xffff0000,v52
 v_lshlrev_b32 v46,16,v53
 v_and_b32 v47,0xffff0000,v53
 v_lshlrev_b32 v48,16,v54
 v_and_b32 v49,0xffff0000,v54
 v_lshlrev_b32 v50,16,v55
 v_and_b32 v51,0xffff0000,v55
 v_pk_fma_f32 v[212:213],v[44:45],v[26:27],v[212:213] op_sel_hi:[1,0,1]
 v_pk_fma_f32 v[214:215],v[46:47],v[26:27],v[214:215] op_sel_hi:[1,0,1]
 v_pk_fma_f32 v[220:221],v[48:49],v[26:27],v[220:221] op_sel_hi:[1,0,1]
 v_pk_fma_f32 v[222:223],v[50:51],v[26:27],v[222:223] op_sel_hi:[1,0,1]
 CV v212,v212,v213
 CV v213,v214,v215
 CV v214,v220,v221
 CV v215,v222,v223
 s_add_u32 s32,s31,163840
 BS v[212:215],v6,s[16:19],s32 offen offset:1024 sc1
 PM v[228:229],v[228:229],v[22:23] op_sel_hi:[1,0]
 PM v[230:231],v[230:231],v[22:23] op_sel_hi:[1,0]
 PM v[236:237],v[236:237],v[22:23] op_sel_hi:[1,0]
 PM v[238:239],v[238:239],v[22:23] op_sel_hi:[1,0]
 AR v64,a248
 AR v65,a249
 AR v66,a250
 AR v67,a251
 v_lshlrev_b32 v56,16,v64
 v_and_b32 v57,0xffff0000,v64
 v_lshlrev_b32 v58,16,v65
 v_and_b32 v59,0xffff0000,v65
 v_lshlrev_b32 v60,16,v66
 v_and_b32 v61,0xffff0000,v66
 v_lshlrev_b32 v62,16,v67
 v_and_b32 v63,0xffff0000,v67
 v_pk_fma_f32 v[228:229],v[56:57],v[26:27],v[228:229] op_sel_hi:[1,0,1]
 v_pk_fma_f32 v[230:231],v[58:59],v[26:27],v[230:231] op_sel_hi:[1,0,1]
 v_pk_fma_f32 v[236:237],v[60:61],v[26:27],v[236:237] op_sel_hi:[1,0,1]
 v_pk_fma_f32 v[238:239],v[62:63],v[26:27],v[238:239] op_sel_hi:[1,0,1]
 CV v228,v228,v229
 CV v229,v230,v231
 CV v230,v236,v237
 CV v231,v238,v239
 s_add_u32 s32,s31,163840
 BS v[228:231],v6,s[16:19],s32 offen offset:2048 sc1
 PM v[244:245],v[244:245],v[22:23] op_sel_hi:[1,0]
 PM v[246:247],v[246:247],v[22:23] op_sel_hi:[1,0]
 PM v[252:253],v[252:253],v[22:23] op_sel_hi:[1,0]
 PM v[254:255],v[254:255],v[22:23] op_sel_hi:[1,0]
 AR v76,a252
 AR v77,a253
 AR v78,a254
 AR v79,a255
 v_lshlrev_b32 v68,16,v76
 v_and_b32 v69,0xffff0000,v76
 v_lshlrev_b32 v70,16,v77
 v_and_b32 v71,0xffff0000,v77
 v_lshlrev_b32 v72,16,v78
 v_and_b32 v73,0xffff0000,v78
 v_lshlrev_b32 v74,16,v79
 v_and_b32 v75,0xffff0000,v79
 v_pk_fma_f32 v[244:245],v[68:69],v[26:27],v[244:245] op_sel_hi:[1,0,1]
 v_pk_fma_f32 v[246:247],v[70:71],v[26:27],v[246:247] op_sel_hi:[1,0,1]
 v_pk_fma_f32 v[252:253],v[72:73],v[26:27],v[252:253] op_sel_hi:[1,0,1]
 v_pk_fma_f32 v[254:255],v[74:75],v[26:27],v[254:255] op_sel_hi:[1,0,1]
 CV v244,v244,v245
 CV v245,v246,v247
 CV v246,v252,v253
 CV v247,v254,v255
 s_add_u32 s32,s31,163840
 BS v[244:247],v6,s[16:19],s32 offen offset:3072 sc1
f_fin:
 s_cmp_eq_u32 s99,3
 s_cselect_b32 s10,0,s10
 s_add_u32 m0,s24,0
 s_nop 0
 BL v118,s[8:11],s20 offen sc1 lds
 BL v118,s[8:11],s20 offen offset:1024 sc1 lds
 BL v119,s[8:11],s20 offen offset:2048 sc1 lds
 BL v119,s[8:11],s20 offen offset:3072 sc1 lds
 s_add_u32 s20,s20,2048
 s_add_u32 m0,s25,0
 s_nop 0
 BL v120,s[12:15],s21 offen  lds
 BL v121,s[12:15],s21 offen offset:1024  lds
 BL v122,s[12:15],s21 offen offset:2048  lds
 BL v123,s[12:15],s21 offen offset:3072  lds
 s_add_u32 s21,s21,57344
 s_add_u32 m0,s24,16384
 s_nop 0
 BL v118,s[8:11],s20 offen sc1 lds
 BL v118,s[8:11],s20 offen offset:1024 sc1 lds
 BL v119,s[8:11],s20 offen offset:2048 sc1 lds
 BL v119,s[8:11],s20 offen offset:3072 sc1 lds
 s_add_u32 s20,s20,2048
 s_add_u32 m0,s25,16384
 s_nop 0
 BL v120,s[12:15],s21 offen  lds
 BL v121,s[12:15],s21 offen offset:1024  lds
 BL v122,s[12:15],s21 offen offset:2048  lds
 BL v123,s[12:15],s21 offen offset:3072  lds
 s_add_u32 s21,s21,57344
 s_and_b32 s26,s35,1
 s_mul_i32 s26,s26,8192
 v_lshl_add_u32 v84,v0,4,s26
 v_add_u32 v85,s89,v84
 v_add_u32 v84,s88,v84
 v_bfe_u32 v1,v0,2,2
 v_lshrrev_b32 v2,4,v0
 v_lshl_add_u32 v2,v2,2,v1
 v_bfe_u32 v4,v2,0,1
 v_bfe_u32 v5,v2,1,1
 v_lshl_or_b32 v4,v5,1,v4
 v_bfe_u32 v5,v2,2,1
 v_lshl_or_b32 v4,v5,2,v4
 v_mul_u32_u24 v2,256,v2
 v_and_b32 v3,3,v0
 v_lshl_add_u32 v2,v3,3,v2
 v_add_u32 v2,0,v2
 s_lshr_b32 s26,s35,1
 s_mul_i32 s26,s26,4
 v_xor_b32 v4,s26,v4
 v_xor_b32 v3,0,v4
 v_lshl_add_u32 v86,v3,5,v2
 v_xor_b32 v3,1,v4
 v_lshl_add_u32 v87,v3,5,v2
 v_xor_b32 v3,2,v4
 v_lshl_add_u32 v88,v3,5,v2
 v_xor_b32 v3,3,v4
 v_lshl_add_u32 v89,v3,5,v2
 v_add_u32 v90,s91,v86
 v_add_u32 v91,s91,v87
 v_add_u32 v92,s91,v88
 v_add_u32 v93,s91,v89
 v_add_u32 v86,s90,v86
 v_add_u32 v87,s90,v87
 v_add_u32 v88,s90,v88
 v_add_u32 v89,s90,v89
 s_waitcnt vmcnt(40)
 s_barrier
 RQ a[0:3],v84
 RT a[64:65],v86
 RT a[66:67],v86 offset:4096
 RT a[68:69],v87
 RT a[70:71],v87 offset:4096
 RT a[72:73],v88
 RT a[74:75],v88 offset:4096
 RT a[76:77],v89
 RT a[78:79],v89 offset:4096
 RQ a[4:7],v84 offset:2048
 RQ a[8:11],v84 offset:4096
 RQ a[12:15],v84 offset:6144
 RQ a[16:19],v84 offset:1024
 RT a[80:81],v86 offset:8192
 RT a[82:83],v86 offset:12288
 RT a[84:85],v87 offset:8192
 RT a[86:87],v87 offset:12288
 RT a[88:89],v88 offset:8192
 RT a[90:91],v88 offset:12288
 RT a[92:93],v89 offset:8192
 RT a[94:95],v89 offset:12288
 RQ a[20:23],v84 offset:3072
 RQ a[24:27],v84 offset:5120
 RQ a[28:31],v84 offset:7168
 s_waitcnt vmcnt(16)
 s_waitcnt lgkmcnt(0)
 s_barrier
 MM v[128:131],a[64:67],a[0:3],0
 RQ a[32:35],v84 offset:16384
 MM v[132:135],a[68:71],a[0:3],0
 RT a[96:97],v86 offset:16384
 MM v[136:139],a[72:75],a[0:3],0
 RT a[98:99],v86 offset:20480
 MM v[140:143],a[76:79],a[0:3],0
 RT a[100:101],v87 offset:16384
 MM v[144:147],a[64:67],a[4:7],0
 RT a[102:103],v87 offset:20480
 MM v[148:151],a[68:71],a[4:7],0
 RT a[104:105],v88 offset:16384
 MM v[152:155],a[72:75],a[4:7],0
 RT a[106:107],v88 offset:20480
 MM v[156:159],a[76:79],a[4:7],0
 RT a[108:109],v89 offset:16384
 MM v[160:163],a[64:67],a[8:11],0
 RT a[110:111],v89 offset:20480
 MM v[164:167],a[68:71],a[8:11],0
 RQ a[36:39],v84 offset:18432
 MM v[168:171],a[72:75],a[8:11],0
 RQ a[40:43],v84 offset:20480
 MM v[172:175],a[76:79],a[8:11],0
 RQ a[44:47],v84 offset:22528
 MM v[176:179],a[64:67],a[12:15],0
 RQ a[48:51],v84 offset:17408
 MM v[180:183],a[68:71],a[12:15],0
 RT a[112:113],v86 offset:24576
 MM v[184:187],a[72:75],a[12:15],0
 RT a[114:115],v86 offset:28672
 MM v[188:191],a[76:79],a[12:15],0
 RT a[116:117],v87 offset:24576
 MM v[128:131],a[80:83],a[16:19],v[128:131]
 RT a[118:119],v87 offset:28672
 MM v[132:135],a[84:87],a[16:19],v[132:135]
 RT a[120:121],v88 offset:24576
 MM v[136:139],a[88:91],a[16:19],v[136:139]
 RT a[122:123],v88 offset:28672
 MM v[140:143],a[92:95],a[16:19],v[140:143]
 RT a[124:125],v89 offset:24576
 MM v[144:147],a[80:83],a[20:23],v[144:147]
 RT a[126:127],v89 offset:28672
 MM v[148:151],a[84:87],a[20:23],v[148:151]
 RQ a[52:55],v84 offset:19456
 MM v[152:155],a[88:91],a[20:23],v[152:155]
 RQ a[56:59],v84 offset:21504
 MM v[156:159],a[92:95],a[20:23],v[156:159]
 RQ a[60:63],v84 offset:23552
 s_mov_b32 s12,s50
 s_mov_b32 s13,s51
 s_mov_b32 s14,3670016
 s_mov_b32 s15,0x20000
 s_mul_i32 s21,s99,917504
 s_lshl_b32 s34,s98,8
 s_add_u32 s21,s21,s34
 s_add_u32 m0,s23,0
 MM v[160:163],a[80:83],a[24:27],v[160:163]
 BL v120,s[12:15],s21 offen  lds
 MM v[164:167],a[84:87],a[24:27],v[164:167]
 BL v121,s[12:15],s21 offen offset:1024  lds
 MM v[168:171],a[88:91],a[24:27],v[168:171]
 MM v[172:175],a[92:95],a[24:27],v[172:175]
 BL v122,s[12:15],s21 offen offset:2048  lds
 MM v[176:179],a[80:83],a[28:31],v[176:179]
 MM v[180:183],a[84:87],a[28:31],v[180:183]
 BL v123,s[12:15],s21 offen offset:3072  lds
 MM v[184:187],a[88:91],a[28:31],v[184:187]
 s_add_u32 s21,s21,57344
 MM v[188:191],a[92:95],a[28:31],v[188:191]
 s_lshl_b32 s26,s86,4
 s_add_u32 s26,s26,s74
 s_lshl_b32 s26,s26,2
 s_add_u32 s26,s26,1152
 s_cmp_lg_u32 s35,0
 s_cbranch_scc1 cs_ns
 v_mov_b32 v1,0
 v_mov_b32 v2,1
 s_mov_b64 exec,1
 buffer_store_dword v2,v1,s[0:3],s26 offen sc1
 s_mov_b64 exec,-1
cs_ns:
 s_waitcnt vmcnt(12)
 s_waitcnt lgkmcnt(0)
 s_barrier
 MM v[128:131],a[96:99],a[32:35],v[128:131]
 RQ a[0:3],v85
 MM v[132:135],a[100:103],a[32:35],v[132:135]
 RT a[64:65],v90
 MM v[136:139],a[104:107],a[32:35],v[136:139]
 RT a[66:67],v90 offset:4096
 MM v[140:143],a[108:111],a[32:35],v[140:143]
 RT a[68:69],v91
 MM v[144:147],a[96:99],a[36:39],v[144:147]
 RT a[70:71],v91 offset:4096
 MM v[148:151],a[100:103],a[36:39],v[148:151]
 RT a[72:73],v92
 MM v[152:155],a[104:107],a[36:39],v[152:155]
 RT a[74:75],v92 offset:4096
 MM v[156:159],a[108:111],a[36:39],v[156:159]
 RT a[76:77],v93
 MM v[160:163],a[96:99],a[40:43],v[160:163]
 RT a[78:79],v93 offset:4096
 MM v[164:167],a[100:103],a[40:43],v[164:167]
 RQ a[4:7],v85 offset:2048
 MM v[168:171],a[104:107],a[40:43],v[168:171]
 RQ a[8:11],v85 offset:4096
 MM v[172:175],a[108:111],a[40:43],v[172:175]
 RQ a[12:15],v85 offset:6144
 MM v[176:179],a[96:99],a[44:47],v[176:179]
 RQ a[16:19],v85 offset:1024
 MM v[180:183],a[100:103],a[44:47],v[180:183]
 RT a[80:81],v90 offset:8192
 MM v[184:187],a[104:107],a[44:47],v[184:187]
 RT a[82:83],v90 offset:12288
 MM v[188:191],a[108:111],a[44:47],v[188:191]
 RT a[84:85],v91 offset:8192
 MM v[128:131],a[112:115],a[48:51],v[128:131]
 RT a[86:87],v91 offset:12288
 MM v[132:135],a[116:119],a[48:51],v[132:135]
 RT a[88:89],v92 offset:8192
 MM v[136:139],a[120:123],a[48:51],v[136:139]
 RT a[90:91],v92 offset:12288
 MM v[140:143],a[124:127],a[48:51],v[140:143]
 RT a[92:93],v93 offset:8192
 MM v[144:147],a[112:115],a[52:55],v[144:147]
 RT a[94:95],v93 offset:12288
 MM v[148:151],a[116:119],a[52:55],v[148:151]
 RQ a[20:23],v85 offset:3072
 MM v[152:155],a[120:123],a[52:55],v[152:155]
 RQ a[24:27],v85 offset:5120
 MM v[156:159],a[124:127],a[52:55],v[156:159]
 RQ a[28:31],v85 offset:7168
 s_add_u32 m0,s23,16384
 MM v[160:163],a[112:115],a[56:59],v[160:163]
 BL v120,s[12:15],s21 offen  lds
 MM v[164:167],a[116:119],a[56:59],v[164:167]
 BL v121,s[12:15],s21 offen offset:1024  lds
 MM v[168:171],a[120:123],a[56:59],v[168:171]
 MM v[172:175],a[124:127],a[56:59],v[172:175]
 BL v122,s[12:15],s21 offen offset:2048  lds
 MM v[176:179],a[112:115],a[60:63],v[176:179]
 MM v[180:183],a[116:119],a[60:63],v[180:183]
 BL v123,s[12:15],s21 offen offset:3072  lds
 MM v[184:187],a[120:123],a[60:63],v[184:187]
 s_add_u32 s21,s21,57344
 MM v[188:191],a[124:127],a[60:63],v[188:191]
 s_lshl_b32 s26,s53,6
 s_lshl_b32 s27,s99,4
 s_add_u32 s26,s26,s27
 s_add_u32 s26,s26,1152
 v_mov_b32 v114,s26
 buffer_load_dword v115,v114,s[0:3],0 offen sc1
 s_waitcnt vmcnt(9)
 s_waitcnt lgkmcnt(0)
 s_barrier
 MM v[128:131],a[64:67],a[0:3],v[128:131]
 RQ a[32:35],v85 offset:16384
 s_mov_b32 s27,0
wc_chk:
 s_waitcnt vmcnt(0)
 v_cmp_le_u32 vcc,1,v115
 s_nop 1
 s_cmp_eq_u64 vcc,-1
 s_cbranch_scc1 wc_ok
 s_add_u32 s27,s27,1
 s_cmp_ge_u32 s27,400000
 s_cbranch_scc1 wc_ok
 s_sleep 1
 buffer_load_dword v115,v114,s[0:3],0 offen sc1
 s_waitcnt vmcnt(0)
 s_branch wc_chk
wc_ok:
 s_mov_b32 s10,20447232
 s_mul_i32 s20,s53,1277952
 s_lshl_b32 s34,s99,15
 s_add_u32 s20,s20,s34
 s_add_u32 s20,s20,28672
 s_add_u32 m0,s22,0
 s_nop 0
 BL v118,s[8:11],s20 offen sc1 lds
 MM v[132:135],a[68:71],a[0:3],v[132:135]
 RT a[96:97],v90 offset:16384
 BL v118,s[8:11],s20 offen offset:1024 sc1 lds
 MM v[136:139],a[72:75],a[0:3],v[136:139]
 RT a[98:99],v90 offset:20480
 MM v[140:143],a[76:79],a[0:3],v[140:143]
 RT a[100:101],v91 offset:16384
 BL v119,s[8:11],s20 offen offset:2048 sc1 lds
 MM v[144:147],a[64:67],a[4:7],v[144:147]
 RT a[102:103],v91 offset:20480
 MM v[148:151],a[68:71],a[4:7],v[148:151]
 RT a[104:105],v92 offset:16384
 BL v119,s[8:11],s20 offen offset:3072 sc1 lds
 s_add_u32 s20,s20,2048
 MM v[152:155],a[72:75],a[4:7],v[152:155]
 RT a[106:107],v92 offset:20480
 s_add_u32 m0,s22,16384
 MM v[156:159],a[76:79],a[4:7],v[156:159]
 RT a[108:109],v93 offset:16384
 BL v118,s[8:11],s20 offen sc1 lds
 MM v[160:163],a[64:67],a[8:11],v[160:163]
 RT a[110:111],v93 offset:20480
 MM v[164:167],a[68:71],a[8:11],v[164:167]
 RQ a[36:39],v85 offset:18432
 BL v118,s[8:11],s20 offen offset:1024 sc1 lds
 MM v[168:171],a[72:75],a[8:11],v[168:171]
 RQ a[40:43],v85 offset:20480
 MM v[172:175],a[76:79],a[8:11],v[172:175]
 RQ a[44:47],v85 offset:22528
 BL v119,s[8:11],s20 offen offset:2048 sc1 lds
 MM v[176:179],a[64:67],a[12:15],v[176:179]
 RQ a[48:51],v85 offset:17408
 MM v[180:183],a[68:71],a[12:15],v[180:183]
 RT a[112:113],v90 offset:24576
 BL v119,s[8:11],s20 offen offset:3072 sc1 lds
 s_add_u32 s20,s20,2048
 MM v[184:187],a[72:75],a[12:15],v[184:187]
 RT a[114:115],v90 offset:28672
 s_add_u32 m0,s25,0
 MM v[188:191],a[76:79],a[12:15],v[188:191]
 RT a[116:117],v91 offset:24576
 BL v120,s[12:15],s21 offen  lds
 MM v[128:131],a[80:83],a[16:19],v[128:131]
 RT a[118:119],v91 offset:28672
 MM v[132:135],a[84:87],a[16:19],v[132:135]
 RT a[120:121],v92 offset:24576
 BL v121,s[12:15],s21 offen offset:1024  lds
 MM v[136:139],a[88:91],a[16:19],v[136:139]
 RT a[122:123],v92 offset:28672
 MM v[140:143],a[92:95],a[16:19],v[140:143]
 RT a[124:125],v93 offset:24576
 BL v122,s[12:15],s21 offen offset:2048  lds
 MM v[144:147],a[80:83],a[20:23],v[144:147]
 RT a[126:127],v93 offset:28672
 MM v[148:151],a[84:87],a[20:23],v[148:151]
 RQ a[52:55],v85 offset:19456
 BL v123,s[12:15],s21 offen offset:3072  lds
 s_add_u32 s21,s21,57344
 MM v[152:155],a[88:91],a[20:23],v[152:155]
 RQ a[56:59],v85 offset:21504
 s_add_u32 m0,s24,0
 MM v[156:159],a[92:95],a[20:23],v[156:159]
 RQ a[60:63],v85 offset:23552
 BL v118,s[8:11],s20 offen sc1 lds
 MM v[160:163],a[80:83],a[24:27],v[160:163]
 MM v[164:167],a[84:87],a[24:27],v[164:167]
 BL v118,s[8:11],s20 offen offset:1024 sc1 lds
 MM v[168:171],a[88:91],a[24:27],v[168:171]
 MM v[172:175],a[92:95],a[24:27],v[172:175]
 BL v119,s[8:11],s20 offen offset:2048 sc1 lds
 MM v[176:179],a[80:83],a[28:31],v[176:179]
 MM v[180:183],a[84:87],a[28:31],v[180:183]
 BL v119,s[8:11],s20 offen offset:3072 sc1 lds
 MM v[184:187],a[88:91],a[28:31],v[184:187]
 s_add_u32 s20,s20,2048
 MM v[188:191],a[92:95],a[28:31],v[188:191]
 v_add_u32 v114,4,v114
 buffer_load_dword v115,v114,s[0:3],0 offen sc1
 s_waitcnt vmcnt(13)
 s_waitcnt lgkmcnt(0)
 s_barrier
 MM v[128:131],a[96:99],a[32:35],v[128:131]
 RQ a[0:3],v84
 s_add_u32 m0,s25,16384
 s_nop 0
 BL v120,s[12:15],s21 offen  lds
 MM v[132:135],a[100:103],a[32:35],v[132:135]
 RT a[64:65],v86
 MM v[136:139],a[104:107],a[32:35],v[136:139]
 RT a[66:67],v86 offset:4096
 MM v[140:143],a[108:111],a[32:35],v[140:143]
 RT a[68:69],v87
 BL v121,s[12:15],s21 offen offset:1024  lds
 MM v[144:147],a[96:99],a[36:39],v[144:147]
 RT a[70:71],v87 offset:4096
 MM v[148:151],a[100:103],a[36:39],v[148:151]
 RT a[72:73],v88
 MM v[152:155],a[104:107],a[36:39],v[152:155]
 RT a[74:75],v88 offset:4096
 MM v[156:159],a[108:111],a[36:39],v[156:159]
 RT a[76:77],v89
 BL v122,s[12:15],s21 offen offset:2048  lds
 MM v[160:163],a[96:99],a[40:43],v[160:163]
 RT a[78:79],v89 offset:4096
 MM v[164:167],a[100:103],a[40:43],v[164:167]
 RQ a[4:7],v84 offset:2048
 MM v[168:171],a[104:107],a[40:43],v[168:171]
 RQ a[8:11],v84 offset:4096
 MM v[172:175],a[108:111],a[40:43],v[172:175]
 RQ a[12:15],v84 offset:6144
 BL v123,s[12:15],s21 offen offset:3072  lds
 MM v[176:179],a[96:99],a[44:47],v[176:179]
 RQ a[16:19],v84 offset:1024
 s_add_u32 s21,s21,57344
 MM v[180:183],a[100:103],a[44:47],v[180:183]
 RT a[80:81],v86 offset:8192
 MM v[184:187],a[104:107],a[44:47],v[184:187]
 RT a[82:83],v86 offset:12288
 s_add_u32 m0,s24,16384
 MM v[188:191],a[108:111],a[44:47],v[188:191]
 RT a[84:85],v87 offset:8192
 BL v118,s[8:11],s20 offen sc1 lds
 MM v[128:131],a[112:115],a[48:51],v[128:131]
 RT a[86:87],v87 offset:12288
 MM v[132:135],a[116:119],a[48:51],v[132:135]
 RT a[88:89],v88 offset:8192
 MM v[136:139],a[120:123],a[48:51],v[136:139]
 RT a[90:91],v88 offset:12288
 MM v[140:143],a[124:127],a[48:51],v[140:143]
 RT a[92:93],v89 offset:8192
 BL v118,s[8:11],s20 offen offset:1024 sc1 lds
 MM v[144:147],a[112:115],a[52:55],v[144:147]
 RT a[94:95],v89 offset:12288
 MM v[148:151],a[116:119],a[52:55],v[148:151]
 RQ a[20:23],v84 offset:3072
 MM v[152:155],a[120:123],a[52:55],v[152:155]
 RQ a[24:27],v84 offset:5120
 MM v[156:159],a[124:127],a[52:55],v[156:159]
 RQ a[28:31],v84 offset:7168
 BL v119,s[8:11],s20 offen offset:2048 sc1 lds
 MM v[160:163],a[112:115],a[56:59],v[160:163]
 MM v[164:167],a[116:119],a[56:59],v[164:167]
 MM v[168:171],a[120:123],a[56:59],v[168:171]
 MM v[172:175],a[124:127],a[56:59],v[172:175]
 BL v119,s[8:11],s20 offen offset:3072 sc1 lds
 MM v[176:179],a[112:115],a[60:63],v[176:179]
 s_add_u32 s20,s20,2048
 MM v[180:183],a[116:119],a[60:63],v[180:183]
 MM v[184:187],a[120:123],a[60:63],v[184:187]
 MM v[188:191],a[124:127],a[60:63],v[188:191]
 s_waitcnt vmcnt(17)
 s_waitcnt lgkmcnt(0)
 s_barrier
 MM v[128:131],a[64:67],a[0:3],v[128:131]
 RQ a[32:35],v84 offset:16384
 s_add_u32 m0,s23,0
 s_nop 0
 BL v120,s[12:15],s21 offen  lds
 MM v[132:135],a[68:71],a[0:3],v[132:135]
 RT a[96:97],v86 offset:16384
 MM v[136:139],a[72:75],a[0:3],v[136:139]
 RT a[98:99],v86 offset:20480
 MM v[140:143],a[76:79],a[0:3],v[140:143]
 RT a[100:101],v87 offset:16384
 BL v121,s[12:15],s21 offen offset:1024  lds
 MM v[144:147],a[64:67],a[4:7],v[144:147]
 RT a[102:103],v87 offset:20480
 MM v[148:151],a[68:71],a[4:7],v[148:151]
 RT a[104:105],v88 offset:16384
 MM v[152:155],a[72:75],a[4:7],v[152:155]
 RT a[106:107],v88 offset:20480
 MM v[156:159],a[76:79],a[4:7],v[156:159]
 RT a[108:109],v89 offset:16384
 BL v122,s[12:15],s21 offen offset:2048  lds
 MM v[160:163],a[64:67],a[8:11],v[160:163]
 RT a[110:111],v89 offset:20480
 MM v[164:167],a[68:71],a[8:11],v[164:167]
 RQ a[36:39],v84 offset:18432
 MM v[168:171],a[72:75],a[8:11],v[168:171]
 RQ a[40:43],v84 offset:20480
 MM v[172:175],a[76:79],a[8:11],v[172:175]
 RQ a[44:47],v84 offset:22528
 BL v123,s[12:15],s21 offen offset:3072  lds
 MM v[176:179],a[64:67],a[12:15],v[176:179]
 RQ a[48:51],v84 offset:17408
 s_add_u32 s21,s21,57344
 MM v[180:183],a[68:71],a[12:15],v[180:183]
 RT a[112:113],v86 offset:24576
 MM v[184:187],a[72:75],a[12:15],v[184:187]
 RT a[114:115],v86 offset:28672
 s_mov_b32 s27,0
wd_chk:
 s_waitcnt vmcnt(12)
 v_cmp_le_u32 vcc,1,v115
 s_nop 1
 s_cmp_eq_u64 vcc,-1
 s_cbranch_scc1 wd_ok
 s_add_u32 s27,s27,1
 s_cmp_ge_u32 s27,400000
 s_cbranch_scc1 wd_ok
 s_sleep 1
 buffer_load_dword v115,v114,s[0:3],0 offen sc1
 s_waitcnt vmcnt(0)
 s_branch wd_chk
wd_ok:
 s_add_u32 m0,s22,0
 MM v[188:191],a[76:79],a[12:15],v[188:191]
 RT a[116:117],v87 offset:24576
 BL v118,s[8:11],s20 offen sc1 lds
 MM v[128:131],a[80:83],a[16:19],v[128:131]
 RT a[118:119],v87 offset:28672
 MM v[132:135],a[84:87],a[16:19],v[132:135]
 RT a[120:121],v88 offset:24576
 MM v[136:139],a[88:91],a[16:19],v[136:139]
 RT a[122:123],v88 offset:28672
 MM v[140:143],a[92:95],a[16:19],v[140:143]
 RT a[124:125],v89 offset:24576
 BL v118,s[8:11],s20 offen offset:1024 sc1 lds
 MM v[144:147],a[80:83],a[20:23],v[144:147]
 RT a[126:127],v89 offset:28672
 MM v[148:151],a[84:87],a[20:23],v[148:151]
 RQ a[52:55],v84 offset:19456
 MM v[152:155],a[88:91],a[20:23],v[152:155]
 RQ a[56:59],v84 offset:21504
 MM v[156:159],a[92:95],a[20:23],v[156:159]
 RQ a[60:63],v84 offset:23552
 BL v119,s[8:11],s20 offen offset:2048 sc1 lds
 MM v[160:163],a[80:83],a[24:27],v[160:163]
 MM v[164:167],a[84:87],a[24:27],v[164:167]
 MM v[168:171],a[88:91],a[24:27],v[168:171]
 MM v[172:175],a[92:95],a[24:27],v[172:175]
 BL v119,s[8:11],s20 offen offset:3072 sc1 lds
 MM v[176:179],a[80:83],a[28:31],v[176:179]
 s_add_u32 s20,s20,2048
 MM v[180:183],a[84:87],a[28:31],v[180:183]
 MM v[184:187],a[88:91],a[28:31],v[184:187]
 MM v[188:191],a[92:95],a[28:31],v[188:191]
 s_waitcnt lgkmcnt(0)
 s_barrier
 MM v[128:131],a[96:99],a[32:35],v[128:131]
 RQ a[0:3],v85
 s_add_u32 m0,s23,16384
 s_nop 0
 BL v120,s[12:15],s21 offen  lds
 MM v[132:135],a[100:103],a[32:35],v[132:135]
 RT a[64:65],v90
 MM v[136:139],a[104:107],a[32:35],v[136:139]
 RT a[66:67],v90 offset:4096
 MM v[140:143],a[108:111],a[32:35],v[140:143]
 RT a[68:69],v91
 BL v121,s[12:15],s21 offen offset:1024  lds
 MM v[144:147],a[96:99],a[36:39],v[144:147]
 RT a[70:71],v91 offset:4096
 MM v[148:151],a[100:103],a[36:39],v[148:151]
 RT a[72:73],v92
 MM v[152:155],a[104:107],a[36:39],v[152:155]
 RT a[74:75],v92 offset:4096
 MM v[156:159],a[108:111],a[36:39],v[156:159]
 RT a[76:77],v93
 BL v122,s[12:15],s21 offen offset:2048  lds
 MM v[160:163],a[96:99],a[40:43],v[160:163]
 RT a[78:79],v93 offset:4096
 MM v[164:167],a[100:103],a[40:43],v[164:167]
 RQ a[4:7],v85 offset:2048
 MM v[168:171],a[104:107],a[40:43],v[168:171]
 RQ a[8:11],v85 offset:4096
 MM v[172:175],a[108:111],a[40:43],v[172:175]
 RQ a[12:15],v85 offset:6144
 BL v123,s[12:15],s21 offen offset:3072  lds
 MM v[176:179],a[96:99],a[44:47],v[176:179]
 RQ a[16:19],v85 offset:1024
 s_add_u32 s21,s21,57344
 MM v[180:183],a[100:103],a[44:47],v[180:183]
 RT a[80:81],v90 offset:8192
 MM v[184:187],a[104:107],a[44:47],v[184:187]
 RT a[82:83],v90 offset:12288
 s_add_u32 m0,s22,16384
 MM v[188:191],a[108:111],a[44:47],v[188:191]
 RT a[84:85],v91 offset:8192
 BL v118,s[8:11],s20 offen sc1 lds
 MM v[128:131],a[112:115],a[48:51],v[128:131]
 RT a[86:87],v91 offset:12288
 MM v[132:135],a[116:119],a[48:51],v[132:135]
 RT a[88:89],v92 offset:8192
 MM v[136:139],a[120:123],a[48:51],v[136:139]
 RT a[90:91],v92 offset:12288
 MM v[140:143],a[124:127],a[48:51],v[140:143]
 RT a[92:93],v93 offset:8192
 BL v118,s[8:11],s20 offen offset:1024 sc1 lds
 MM v[144:147],a[112:115],a[52:55],v[144:147]
 RT a[94:95],v93 offset:12288
 MM v[148:151],a[116:119],a[52:55],v[148:151]
 RQ a[20:23],v85 offset:3072
 MM v[152:155],a[120:123],a[52:55],v[152:155]
 RQ a[24:27],v85 offset:5120
 MM v[156:159],a[124:127],a[52:55],v[156:159]
 RQ a[28:31],v85 offset:7168
 BL v119,s[8:11],s20 offen offset:2048 sc1 lds
 MM v[160:163],a[112:115],a[56:59],v[160:163]
 MM v[164:167],a[116:119],a[56:59],v[164:167]
 MM v[168:171],a[120:123],a[56:59],v[168:171]
 MM v[172:175],a[124:127],a[56:59],v[172:175]
 BL v119,s[8:11],s20 offen offset:3072 sc1 lds
 MM v[176:179],a[112:115],a[60:63],v[176:179]
 s_add_u32 s20,s20,2048
 MM v[180:183],a[116:119],a[60:63],v[180:183]
 MM v[184:187],a[120:123],a[60:63],v[184:187]
 MM v[188:191],a[124:127],a[60:63],v[188:191]
 s_waitcnt vmcnt(16)
 s_waitcnt lgkmcnt(0)
 s_barrier
 MM v[128:131],a[64:67],a[0:3],v[128:131]
 RQ a[32:35],v85 offset:16384
 s_add_u32 m0,s25,0
 s_nop 0
 BL v120,s[12:15],s21 offen  lds
 MM v[132:135],a[68:71],a[0:3],v[132:135]
 RT a[96:97],v90 offset:16384
 MM v[136:139],a[72:75],a[0:3],v[136:139]
 RT a[98:99],v90 offset:20480
 MM v[140:143],a[76:79],a[0:3],v[140:143]
 RT a[100:101],v91 offset:16384
 BL v121,s[12:15],s21 offen offset:1024  lds
 MM v[144:147],a[64:67],a[4:7],v[144:147]
 RT a[102:103],v91 offset:20480
 MM v[148:151],a[68:71],a[4:7],v[148:151]
 RT a[104:105],v92 offset:16384
 MM v[152:155],a[72:75],a[4:7],v[152:155]
 RT a[106:107],v92 offset:20480
 MM v[156:159],a[76:79],a[4:7],v[156:159]
 RT a[108:109],v93 offset:16384
 BL v122,s[12:15],s21 offen offset:2048  lds
 MM v[160:163],a[64:67],a[8:11],v[160:163]
 RT a[110:111],v93 offset:20480
 MM v[164:167],a[68:71],a[8:11],v[164:167]
 RQ a[36:39],v85 offset:18432
 MM v[168:171],a[72:75],a[8:11],v[168:171]
 RQ a[40:43],v85 offset:20480
 MM v[172:175],a[76:79],a[8:11],v[172:175]
 RQ a[44:47],v85 offset:22528
 BL v123,s[12:15],s21 offen offset:3072  lds
 MM v[176:179],a[64:67],a[12:15],v[176:179]
 RQ a[48:51],v85 offset:17408
 s_add_u32 s21,s21,57344
 MM v[180:183],a[68:71],a[12:15],v[180:183]
 RT a[112:113],v90 offset:24576
 MM v[184:187],a[72:75],a[12:15],v[184:187]
 RT a[114:115],v90 offset:28672
 s_add_u32 m0,s24,0
 MM v[188:191],a[76:79],a[12:15],v[188:191]
 RT a[116:117],v91 offset:24576
 BL v118,s[8:11],s20 offen sc1 lds
 MM v[128:131],a[80:83],a[16:19],v[128:131]
 RT a[118:119],v91 offset:28672
 MM v[132:135],a[84:87],a[16:19],v[132:135]
 RT a[120:121],v92 offset:24576
 MM v[136:139],a[88:91],a[16:19],v[136:139]
 RT a[122:123],v92 offset:28672
 MM v[140:143],a[92:95],a[16:19],v[140:143]
 RT a[124:125],v93 offset:24576
 BL v118,s[8:11],s20 offen offset:1024 sc1 lds
 MM v[144:147],a[80:83],a[20:23],v[144:147]
 RT a[126:127],v93 offset:28672
 MM v[148:151],a[84:87],a[20:23],v[148:151]
 RQ a[52:55],v85 offset:19456
 MM v[152:155],a[88:91],a[20:23],v[152:155]
 RQ a[56:59],v85 offset:21504
 MM v[156:159],a[92:95],a[20:23],v[156:159]
 RQ a[60:63],v85 offset:23552
 BL v119,s[8:11],s20 offen offset:2048 sc1 lds
 MM v[160:163],a[80:83],a[24:27],v[160:163]
 MM v[164:167],a[84:87],a[24:27],v[164:167]
 MM v[168:171],a[88:91],a[24:27],v[168:171]
 MM v[172:175],a[92:95],a[24:27],v[172:175]
 BL v119,s[8:11],s20 offen offset:3072 sc1 lds
 MM v[176:179],a[80:83],a[28:31],v[176:179]
 s_add_u32 s20,s20,2048
 MM v[180:183],a[84:87],a[28:31],v[180:183]
 MM v[184:187],a[88:91],a[28:31],v[184:187]
 MM v[188:191],a[92:95],a[28:31],v[188:191]
 v_add_u32 v114,4,v114
 buffer_load_dword v115,v114,s[0:3],0 offen sc1
 s_waitcnt vmcnt(17)
 s_waitcnt lgkmcnt(0)
 s_barrier
 MM v[128:131],a[96:99],a[32:35],v[128:131]
 RQ a[0:3],v84
 s_add_u32 m0,s25,16384
 s_nop 0
 BL v120,s[12:15],s21 offen  lds
 MM v[132:135],a[100:103],a[32:35],v[132:135]
 RT a[64:65],v86
 MM v[136:139],a[104:107],a[32:35],v[136:139]
 RT a[66:67],v86 offset:4096
 MM v[140:143],a[108:111],a[32:35],v[140:143]
 RT a[68:69],v87
 BL v121,s[12:15],s21 offen offset:1024  lds
 MM v[144:147],a[96:99],a[36:39],v[144:147]
 RT a[70:71],v87 offset:4096
 MM v[148:151],a[100:103],a[36:39],v[148:151]
 RT a[72:73],v88
 MM v[152:155],a[104:107],a[36:39],v[152:155]
 RT a[74:75],v88 offset:4096
 MM v[156:159],a[108:111],a[36:39],v[156:159]
 RT a[76:77],v89
 BL v122,s[12:15],s21 offen offset:2048  lds
 MM v[160:163],a[96:99],a[40:43],v[160:163]
 RT a[78:79],v89 offset:4096
 MM v[164:167],a[100:103],a[40:43],v[164:167]
 RQ a[4:7],v84 offset:2048
 MM v[168:171],a[104:107],a[40:43],v[168:171]
 RQ a[8:11],v84 offset:4096
 MM v[172:175],a[108:111],a[40:43],v[172:175]
 RQ a[12:15],v84 offset:6144
 BL v123,s[12:15],s21 offen offset:3072  lds
 MM v[176:179],a[96:99],a[44:47],v[176:179]
 RQ a[16:19],v84 offset:1024
 s_add_u32 s21,s21,57344
 MM v[180:183],a[100:103],a[44:47],v[180:183]
 RT a[80:81],v86 offset:8192
 MM v[184:187],a[104:107],a[44:47],v[184:187]
 RT a[82:83],v86 offset:12288
 s_add_u32 m0,s24,16384
 MM v[188:191],a[108:111],a[44:47],v[188:191]
 RT a[84:85],v87 offset:8192
 BL v118,s[8:11],s20 offen sc1 lds
 MM v[128:131],a[112:115],a[48:51],v[128:131]
 RT a[86:87],v87 offset:12288
 MM v[132:135],a[116:119],a[48:51],v[132:135]
 RT a[88:89],v88 offset:8192
 MM v[136:139],a[120:123],a[48:51],v[136:139]
 RT a[90:91],v88 offset:12288
 MM v[140:143],a[124:127],a[48:51],v[140:143]
 RT a[92:93],v89 offset:8192
 BL v118,s[8:11],s20 offen offset:1024 sc1 lds
 MM v[144:147],a[112:115],a[52:55],v[144:147]
 RT a[94:95],v89 offset:12288
 MM v[148:151],a[116:119],a[52:55],v[148:151]
 RQ a[20:23],v84 offset:3072
 MM v[152:155],a[120:123],a[52:55],v[152:155]
 RQ a[24:27],v84 offset:5120
 MM v[156:159],a[124:127],a[52:55],v[156:159]
 RQ a[28:31],v84 offset:7168
 BL v119,s[8:11],s20 offen offset:2048 sc1 lds
 MM v[160:163],a[112:115],a[56:59],v[160:163]
 MM v[164:167],a[116:119],a[56:59],v[164:167]
 MM v[168:171],a[120:123],a[56:59],v[168:171]
 MM v[172:175],a[124:127],a[56:59],v[172:175]
 BL v119,s[8:11],s20 offen offset:3072 sc1 lds
 MM v[176:179],a[112:115],a[60:63],v[176:179]
 s_add_u32 s20,s20,2048
 MM v[180:183],a[116:119],a[60:63],v[180:183]
 MM v[184:187],a[120:123],a[60:63],v[184:187]
 MM v[188:191],a[124:127],a[60:63],v[188:191]
 s_waitcnt vmcnt(17)
 s_waitcnt lgkmcnt(0)
 s_barrier
 MM v[128:131],a[64:67],a[0:3],v[128:131]
 RQ a[32:35],v84 offset:16384
 s_add_u32 m0,s23,0
 s_nop 0
 BL v120,s[12:15],s21 offen  lds
 MM v[132:135],a[68:71],a[0:3],v[132:135]
 RT a[96:97],v86 offset:16384
 MM v[136:139],a[72:75],a[0:3],v[136:139]
 RT a[98:99],v86 offset:20480
 MM v[140:143],a[76:79],a[0:3],v[140:143]
 RT a[100:101],v87 offset:16384
 BL v121,s[12:15],s21 offen offset:1024  lds
 MM v[144:147],a[64:67],a[4:7],v[144:147]
 RT a[102:103],v87 offset:20480
 MM v[148:151],a[68:71],a[4:7],v[148:151]
 RT a[104:105],v88 offset:16384
 MM v[152:155],a[72:75],a[4:7],v[152:155]
 RT a[106:107],v88 offset:20480
 MM v[156:159],a[76:79],a[4:7],v[156:159]
 RT a[108:109],v89 offset:16384
 BL v122,s[12:15],s21 offen offset:2048  lds
 MM v[160:163],a[64:67],a[8:11],v[160:163]
 RT a[110:111],v89 offset:20480
 MM v[164:167],a[68:71],a[8:11],v[164:167]
 RQ a[36:39],v84 offset:18432
 MM v[168:171],a[72:75],a[8:11],v[168:171]
 RQ a[40:43],v84 offset:20480
 MM v[172:175],a[76:79],a[8:11],v[172:175]
 RQ a[44:47],v84 offset:22528
 BL v123,s[12:15],s21 offen offset:3072  lds
 MM v[176:179],a[64:67],a[12:15],v[176:179]
 RQ a[48:51],v84 offset:17408
 s_add_u32 s21,s21,57344
 MM v[180:183],a[68:71],a[12:15],v[180:183]
 RT a[112:113],v86 offset:24576
 MM v[184:187],a[72:75],a[12:15],v[184:187]
 RT a[114:115],v86 offset:28672
 s_mov_b32 s27,0
we_chk:
 s_waitcnt vmcnt(12)
 v_cmp_le_u32 vcc,1,v115
 s_nop 1
 s_cmp_eq_u64 vcc,-1
 s_cbranch_scc1 we_ok
 s_add_u32 s27,s27,1
 s_cmp_ge_u32 s27,400000
 s_cbranch_scc1 we_ok
 s_sleep 1
 buffer_load_dword v115,v114,s[0:3],0 offen sc1
 s_waitcnt vmcnt(0)
 s_branch we_chk
we_ok:
 s_add_u32 m0,s22,0
 MM v[188:191],a[76:79],a[12:15],v[188:191]
 RT a[116:117],v87 offset:24576
 BL v118,s[8:11],s20 offen sc1 lds
 MM v[128:131],a[80:83],a[16:19],v[128:131]
 RT a[118:119],v87 offset:28672
 MM v[132:135],a[84:87],a[16:19],v[132:135]
 RT a[120:121],v88 offset:24576
 MM v[136:139],a[88:91],a[16:19],v[136:139]
 RT a[122:123],v88 offset:28672
 MM v[140:143],a[92:95],a[16:19],v[140:143]
 RT a[124:125],v89 offset:24576
 BL v118,s[8:11],s20 offen offset:1024 sc1 lds
 MM v[144:147],a[80:83],a[20:23],v[144:147]
 RT a[126:127],v89 offset:28672
 MM v[148:151],a[84:87],a[20:23],v[148:151]
 RQ a[52:55],v84 offset:19456
 MM v[152:155],a[88:91],a[20:23],v[152:155]
 RQ a[56:59],v84 offset:21504
 MM v[156:159],a[92:95],a[20:23],v[156:159]
 RQ a[60:63],v84 offset:23552
 BL v119,s[8:11],s20 offen offset:2048 sc1 lds
 MM v[160:163],a[80:83],a[24:27],v[160:163]
 MM v[164:167],a[84:87],a[24:27],v[164:167]
 MM v[168:171],a[88:91],a[24:27],v[168:171]
 MM v[172:175],a[92:95],a[24:27],v[172:175]
 BL v119,s[8:11],s20 offen offset:3072 sc1 lds
 MM v[176:179],a[80:83],a[28:31],v[176:179]
 s_add_u32 s20,s20,2048
 MM v[180:183],a[84:87],a[28:31],v[180:183]
 MM v[184:187],a[88:91],a[28:31],v[184:187]
 MM v[188:191],a[92:95],a[28:31],v[188:191]
 s_waitcnt lgkmcnt(0)
 s_barrier
 MM v[128:131],a[96:99],a[32:35],v[128:131]
 RQ a[0:3],v85
 s_add_u32 m0,s23,16384
 s_nop 0
 BL v120,s[12:15],s21 offen  lds
 MM v[132:135],a[100:103],a[32:35],v[132:135]
 RT a[64:65],v90
 MM v[136:139],a[104:107],a[32:35],v[136:139]
 RT a[66:67],v90 offset:4096
 MM v[140:143],a[108:111],a[32:35],v[140:143]
 RT a[68:69],v91
 BL v121,s[12:15],s21 offen offset:1024  lds
 MM v[144:147],a[96:99],a[36:39],v[144:147]
 RT a[70:71],v91 offset:4096
 MM v[148:151],a[100:103],a[36:39],v[148:151]
 RT a[72:73],v92
 MM v[152:155],a[104:107],a[36:39],v[152:155]
 RT a[74:75],v92 offset:4096
 MM v[156:159],a[108:111],a[36:39],v[156:159]
 RT a[76:77],v93
 BL v122,s[12:15],s21 offen offset:2048  lds
 MM v[160:163],a[96:99],a[40:43],v[160:163]
 RT a[78:79],v93 offset:4096
 MM v[164:167],a[100:103],a[40:43],v[164:167]
 RQ a[4:7],v85 offset:2048
 MM v[168:171],a[104:107],a[40:43],v[168:171]
 RQ a[8:11],v85 offset:4096
 MM v[172:175],a[108:111],a[40:43],v[172:175]
 RQ a[12:15],v85 offset:6144
 BL v123,s[12:15],s21 offen offset:3072  lds
 MM v[176:179],a[96:99],a[44:47],v[176:179]
 RQ a[16:19],v85 offset:1024
 s_add_u32 s21,s21,57344
 MM v[180:183],a[100:103],a[44:47],v[180:183]
 RT a[80:81],v90 offset:8192
 MM v[184:187],a[104:107],a[44:47],v[184:187]
 RT a[82:83],v90 offset:12288
 s_add_u32 m0,s22,16384
 MM v[188:191],a[108:111],a[44:47],v[188:191]
 RT a[84:85],v91 offset:8192
 BL v118,s[8:11],s20 offen sc1 lds
 MM v[128:131],a[112:115],a[48:51],v[128:131]
 RT a[86:87],v91 offset:12288
 MM v[132:135],a[116:119],a[48:51],v[132:135]
 RT a[88:89],v92 offset:8192
 MM v[136:139],a[120:123],a[48:51],v[136:139]
 RT a[90:91],v92 offset:12288
 MM v[140:143],a[124:127],a[48:51],v[140:143]
 RT a[92:93],v93 offset:8192
 BL v118,s[8:11],s20 offen offset:1024 sc1 lds
 MM v[144:147],a[112:115],a[52:55],v[144:147]
 RT a[94:95],v93 offset:12288
 MM v[148:151],a[116:119],a[52:55],v[148:151]
 RQ a[20:23],v85 offset:3072
 MM v[152:155],a[120:123],a[52:55],v[152:155]
 RQ a[24:27],v85 offset:5120
 MM v[156:159],a[124:127],a[52:55],v[156:159]
 RQ a[28:31],v85 offset:7168
 BL v119,s[8:11],s20 offen offset:2048 sc1 lds
 MM v[160:163],a[112:115],a[56:59],v[160:163]
 MM v[164:167],a[116:119],a[56:59],v[164:167]
 MM v[168:171],a[120:123],a[56:59],v[168:171]
 MM v[172:175],a[124:127],a[56:59],v[172:175]
 BL v119,s[8:11],s20 offen offset:3072 sc1 lds
 MM v[176:179],a[112:115],a[60:63],v[176:179]
 s_add_u32 s20,s20,2048
 MM v[180:183],a[116:119],a[60:63],v[180:183]
 MM v[184:187],a[120:123],a[60:63],v[184:187]
 MM v[188:191],a[124:127],a[60:63],v[188:191]
 s_waitcnt vmcnt(16)
 s_waitcnt lgkmcnt(0)
 s_barrier
 MM v[128:131],a[64:67],a[0:3],v[128:131]
 RQ a[32:35],v85 offset:16384
 s_add_u32 m0,s25,0
 s_nop 0
 BL v120,s[12:15],s21 offen  lds
 MM v[132:135],a[68:71],a[0:3],v[132:135]
 RT a[96:97],v90 offset:16384
 MM v[136:139],a[72:75],a[0:3],v[136:139]
 RT a[98:99],v90 offset:20480
 MM v[140:143],a[76:79],a[0:3],v[140:143]
 RT a[100:101],v91 offset:16384
 BL v121,s[12:15],s21 offen offset:1024  lds
 MM v[144:147],a[64:67],a[4:7],v[144:147]
 RT a[102:103],v91 offset:20480
 MM v[148:151],a[68:71],a[4:7],v[148:151]
 RT a[104:105],v92 offset:16384
 MM v[152:155],a[72:75],a[4:7],v[152:155]
 RT a[106:107],v92 offset:20480
 MM v[156:159],a[76:79],a[4:7],v[156:159]
 RT a[108:109],v93 offset:16384
 BL v122,s[12:15],s21 offen offset:2048  lds
 MM v[160:163],a[64:67],a[8:11],v[160:163]
 RT a[110:111],v93 offset:20480
 MM v[164:167],a[68:71],a[8:11],v[164:167]
 RQ a[36:39],v85 offset:18432
 MM v[168:171],a[72:75],a[8:11],v[168:171]
 RQ a[40:43],v85 offset:20480
 MM v[172:175],a[76:79],a[8:11],v[172:175]
 RQ a[44:47],v85 offset:22528
 BL v123,s[12:15],s21 offen offset:3072  lds
 MM v[176:179],a[64:67],a[12:15],v[176:179]
 RQ a[48:51],v85 offset:17408
 s_add_u32 s21,s21,57344
 MM v[180:183],a[68:71],a[12:15],v[180:183]
 RT a[112:113],v90 offset:24576
 MM v[184:187],a[72:75],a[12:15],v[184:187]
 RT a[114:115],v90 offset:28672
 s_add_u32 m0,s24,0
 MM v[188:191],a[76:79],a[12:15],v[188:191]
 RT a[116:117],v91 offset:24576
 BL v118,s[8:11],s20 offen sc1 lds
 MM v[128:131],a[80:83],a[16:19],v[128:131]
 RT a[118:119],v91 offset:28672
 MM v[132:135],a[84:87],a[16:19],v[132:135]
 RT a[120:121],v92 offset:24576
 MM v[136:139],a[88:91],a[16:19],v[136:139]
 RT a[122:123],v92 offset:28672
 MM v[140:143],a[92:95],a[16:19],v[140:143]
 RT a[124:125],v93 offset:24576
 BL v118,s[8:11],s20 offen offset:1024 sc1 lds
 MM v[144:147],a[80:83],a[20:23],v[144:147]
 RT a[126:127],v93 offset:28672
 MM v[148:151],a[84:87],a[20:23],v[148:151]
 RQ a[52:55],v85 offset:19456
 MM v[152:155],a[88:91],a[20:23],v[152:155]
 RQ a[56:59],v85 offset:21504
 MM v[156:159],a[92:95],a[20:23],v[156:159]
 RQ a[60:63],v85 offset:23552
 BL v119,s[8:11],s20 offen offset:2048 sc1 lds
 MM v[160:163],a[80:83],a[24:27],v[160:163]
 MM v[164:167],a[84:87],a[24:27],v[164:167]
 MM v[168:171],a[88:91],a[24:27],v[168:171]
 MM v[172:175],a[92:95],a[24:27],v[172:175]
 BL v119,s[8:11],s20 offen offset:3072 sc1 lds
 MM v[176:179],a[80:83],a[28:31],v[176:179]
 s_add_u32 s20,s20,2048
 MM v[180:183],a[84:87],a[28:31],v[180:183]
 MM v[184:187],a[88:91],a[28:31],v[184:187]
 MM v[188:191],a[92:95],a[28:31],v[188:191]
 v_add_u32 v114,4,v114
 s_lshl_b32 s26,s86,4
 s_and_b32 s27,s74,3
 s_add_u32 s26,s26,s27
 s_lshl_b32 s26,s26,2
 s_add_u32 s26,s26,1152
 v_and_b32 v116,3,v0
 v_lshlrev_b32 v116,4,v116
 v_add_u32 v116,s26,v116
 v_cmp_gt_u32 vcc,32,v0
 s_nop 1
 v_cndmask_b32 v114,v116,v114,vcc
 buffer_load_dword v115,v114,s[0:3],0 offen sc1
 s_waitcnt vmcnt(17)
 s_waitcnt lgkmcnt(0)
 s_barrier
 MM v[128:131],a[96:99],a[32:35],v[128:131]
 RQ a[0:3],v84
 s_add_u32 m0,s25,16384
 s_nop 0
 BL v120,s[12:15],s21 offen  lds
 MM v[132:135],a[100:103],a[32:35],v[132:135]
 RT a[64:65],v86
 MM v[136:139],a[104:107],a[32:35],v[136:139]
 RT a[66:67],v86 offset:4096
 MM v[140:143],a[108:111],a[32:35],v[140:143]
 RT a[68:69],v87
 BL v121,s[12:15],s21 offen offset:1024  lds
 MM v[144:147],a[96:99],a[36:39],v[144:147]
 RT a[70:71],v87 offset:4096
 MM v[148:151],a[100:103],a[36:39],v[148:151]
 RT a[72:73],v88
 MM v[152:155],a[104:107],a[36:39],v[152:155]
 RT a[74:75],v88 offset:4096
 MM v[156:159],a[108:111],a[36:39],v[156:159]
 RT a[76:77],v89
 BL v122,s[12:15],s21 offen offset:2048  lds
 MM v[160:163],a[96:99],a[40:43],v[160:163]
 RT a[78:79],v89 offset:4096
 MM v[164:167],a[100:103],a[40:43],v[164:167]
 RQ a[4:7],v84 offset:2048
 MM v[168:171],a[104:107],a[40:43],v[168:171]
 RQ a[8:11],v84 offset:4096
 MM v[172:175],a[108:111],a[40:43],v[172:175]
 RQ a[12:15],v84 offset:6144
 BL v123,s[12:15],s21 offen offset:3072  lds
 MM v[176:179],a[96:99],a[44:47],v[176:179]
 RQ a[16:19],v84 offset:1024
 s_add_u32 s21,s21,57344
 MM v[180:183],a[100:103],a[44:47],v[180:183]
 RT a[80:81],v86 offset:8192
 MM v[184:187],a[104:107],a[44:47],v[184:187]
 RT a[82:83],v86 offset:12288
 s_add_u32 m0,s24,16384
 MM v[188:191],a[108:111],a[44:47],v[188:191]
 RT a[84:85],v87 offset:8192
 BL v118,s[8:11],s20 offen sc1 lds
 MM v[128:131],a[112:115],a[48:51],v[128:131]
 RT a[86:87],v87 offset:12288
 MM v[132:135],a[116:119],a[48:51],v[132:135]
 RT a[88:89],v88 offset:8192
 MM v[136:139],a[120:123],a[48:51],v[136:139]
 RT a[90:91],v88 offset:12288
 MM v[140:143],a[124:127],a[48:51],v[140:143]
 RT a[92:93],v89 offset:8192
 BL v118,s[8:11],s20 offen offset:1024 sc1 lds
 MM v[144:147],a[112:115],a[52:55],v[144:147]
 RT a[94:95],v89 offset:12288
 MM v[148:151],a[116:119],a[52:55],v[148:151]
 RQ a[20:23],v84 offset:3072
 MM v[152:155],a[120:123],a[52:55],v[152:155]
 RQ a[24:27],v84 offset:5120
 MM v[156:159],a[124:127],a[52:55],v[156:159]
 RQ a[28:31],v84 offset:7168
 BL v119,s[8:11],s20 offen offset:2048 sc1 lds
 MM v[160:163],a[112:115],a[56:59],v[160:163]
 MM v[164:167],a[116:119],a[56:59],v[164:167]
 MM v[168:171],a[120:123],a[56:59],v[168:171]
 MM v[172:175],a[124:127],a[56:59],v[172:175]
 BL v119,s[8:11],s20 offen offset:3072 sc1 lds
 MM v[176:179],a[112:115],a[60:63],v[176:179]
 s_add_u32 s20,s20,2048
 MM v[180:183],a[116:119],a[60:63],v[180:183]
 MM v[184:187],a[120:123],a[60:63],v[184:187]
 MM v[188:191],a[124:127],a[60:63],v[188:191]
 s_waitcnt vmcnt(17)
 s_waitcnt lgkmcnt(0)
 s_barrier
 MM v[128:131],a[64:67],a[0:3],v[128:131]
 RQ a[32:35],v84 offset:16384
 s_add_u32 m0,s23,0
 s_nop 0
 BL v120,s[12:15],s21 offen  lds
 MM v[132:135],a[68:71],a[0:3],v[132:135]
 RT a[96:97],v86 offset:16384
 MM v[136:139],a[72:75],a[0:3],v[136:139]
 RT a[98:99],v86 offset:20480
 MM v[140:143],a[76:79],a[0:3],v[140:143]
 RT a[100:101],v87 offset:16384
 BL v121,s[12:15],s21 offen offset:1024  lds
 MM v[144:147],a[64:67],a[4:7],v[144:147]
 RT a[102:103],v87 offset:20480
 MM v[148:151],a[68:71],a[4:7],v[148:151]
 RT a[104:105],v88 offset:16384
 MM v[152:155],a[72:75],a[4:7],v[152:155]
 RT a[106:107],v88 offset:20480
 MM v[156:159],a[76:79],a[4:7],v[156:159]
 RT a[108:109],v89 offset:16384
 BL v122,s[12:15],s21 offen offset:2048  lds
 MM v[160:163],a[64:67],a[8:11],v[160:163]
 RT a[110:111],v89 offset:20480
 MM v[164:167],a[68:71],a[8:11],v[164:167]
 RQ a[36:39],v84 offset:18432
 MM v[168:171],a[72:75],a[8:11],v[168:171]
 RQ a[40:43],v84 offset:20480
 MM v[172:175],a[76:79],a[8:11],v[172:175]
 RQ a[44:47],v84 offset:22528
 BL v123,s[12:15],s21 offen offset:3072  lds
 MM v[176:179],a[64:67],a[12:15],v[176:179]
 RQ a[48:51],v84 offset:17408
 s_add_u32 s21,s21,57344
 MM v[180:183],a[68:71],a[12:15],v[180:183]
 RT a[112:113],v86 offset:24576
 MM v[184:187],a[72:75],a[12:15],v[184:187]
 RT a[114:115],v86 offset:28672
 s_mov_b32 s27,0
wf_chk:
 s_waitcnt vmcnt(12)
 v_cmp_le_u32 vcc,1,v115
 s_nop 1
 s_cmp_eq_u64 vcc,-1
 s_cbranch_scc1 wf_ok
 s_add_u32 s27,s27,1
 s_cmp_ge_u32 s27,400000
 s_cbranch_scc1 wf_ok
 s_sleep 1
 buffer_load_dword v115,v114,s[0:3],0 offen sc1
 s_waitcnt vmcnt(0)
 s_branch wf_chk
wf_ok:
 s_add_u32 m0,s22,0
 MM v[188:191],a[76:79],a[12:15],v[188:191]
 RT a[116:117],v87 offset:24576
 BL v118,s[8:11],s20 offen sc1 lds
 MM v[128:131],a[80:83],a[16:19],v[128:131]
 RT a[118:119],v87 offset:28672
 MM v[132:135],a[84:87],a[16:19],v[132:135]
 RT a[120:121],v88 offset:24576
 MM v[136:139],a[88:91],a[16:19],v[136:139]
 RT a[122:123],v88 offset:28672
 MM v[140:143],a[92:95],a[16:19],v[140:143]
 RT a[124:125],v89 offset:24576
 BL v118,s[8:11],s20 offen offset:1024 sc1 lds
 MM v[144:147],a[80:83],a[20:23],v[144:147]
 RT a[126:127],v89 offset:28672
 MM v[148:151],a[84:87],a[20:23],v[148:151]
 RQ a[52:55],v84 offset:19456
 MM v[152:155],a[88:91],a[20:23],v[152:155]
 RQ a[56:59],v84 offset:21504
 MM v[156:159],a[92:95],a[20:23],v[156:159]
 RQ a[60:63],v84 offset:23552
 BL v119,s[8:11],s20 offen offset:2048 sc1 lds
 MM v[160:163],a[80:83],a[24:27],v[160:163]
 MM v[164:167],a[84:87],a[24:27],v[164:167]
 MM v[168:171],a[88:91],a[24:27],v[168:171]
 MM v[172:175],a[92:95],a[24:27],v[172:175]
 BL v119,s[8:11],s20 offen offset:3072 sc1 lds
 MM v[176:179],a[80:83],a[28:31],v[176:179]
 s_add_u32 s20,s20,2048
 MM v[180:183],a[84:87],a[28:31],v[180:183]
 MM v[184:187],a[88:91],a[28:31],v[184:187]
 MM v[188:191],a[92:95],a[28:31],v[188:191]
 s_waitcnt lgkmcnt(0)
 s_barrier
 MM v[128:131],a[96:99],a[32:35],v[128:131]
 RQ a[0:3],v85
 s_add_u32 m0,s23,16384
 s_nop 0
 BL v120,s[12:15],s21 offen  lds
 MM v[132:135],a[100:103],a[32:35],v[132:135]
 RT a[64:65],v90
 MM v[136:139],a[104:107],a[32:35],v[136:139]
 RT a[66:67],v90 offset:4096
 MM v[140:143],a[108:111],a[32:35],v[140:143]
 RT a[68:69],v91
 BL v121,s[12:15],s21 offen offset:1024  lds
 MM v[144:147],a[96:99],a[36:39],v[144:147]
 RT a[70:71],v91 offset:4096
 MM v[148:151],a[100:103],a[36:39],v[148:151]
 RT a[72:73],v92
 MM v[152:155],a[104:107],a[36:39],v[152:155]
 RT a[74:75],v92 offset:4096
 MM v[156:159],a[108:111],a[36:39],v[156:159]
 RT a[76:77],v93
 BL v122,s[12:15],s21 offen offset:2048  lds
 MM v[160:163],a[96:99],a[40:43],v[160:163]
 RT a[78:79],v93 offset:4096
 MM v[164:167],a[100:103],a[40:43],v[164:167]
 RQ a[4:7],v85 offset:2048
 MM v[168:171],a[104:107],a[40:43],v[168:171]
 RQ a[8:11],v85 offset:4096
 MM v[172:175],a[108:111],a[40:43],v[172:175]
 RQ a[12:15],v85 offset:6144
 BL v123,s[12:15],s21 offen offset:3072  lds
 MM v[176:179],a[96:99],a[44:47],v[176:179]
 RQ a[16:19],v85 offset:1024
 s_add_u32 s21,s21,57344
 MM v[180:183],a[100:103],a[44:47],v[180:183]
 RT a[80:81],v90 offset:8192
 MM v[184:187],a[104:107],a[44:47],v[184:187]
 RT a[82:83],v90 offset:12288
 s_add_u32 m0,s22,16384
 MM v[188:191],a[108:111],a[44:47],v[188:191]
 RT a[84:85],v91 offset:8192
 BL v118,s[8:11],s20 offen sc1 lds
 MM v[128:131],a[112:115],a[48:51],v[128:131]
 RT a[86:87],v91 offset:12288
 MM v[132:135],a[116:119],a[48:51],v[132:135]
 RT a[88:89],v92 offset:8192
 MM v[136:139],a[120:123],a[48:51],v[136:139]
 RT a[90:91],v92 offset:12288
 MM v[140:143],a[124:127],a[48:51],v[140:143]
 RT a[92:93],v93 offset:8192
 BL v118,s[8:11],s20 offen offset:1024 sc1 lds
 MM v[144:147],a[112:115],a[52:55],v[144:147]
 RT a[94:95],v93 offset:12288
 MM v[148:151],a[116:119],a[52:55],v[148:151]
 RQ a[20:23],v85 offset:3072
 MM v[152:155],a[120:123],a[52:55],v[152:155]
 RQ a[24:27],v85 offset:5120
 MM v[156:159],a[124:127],a[52:55],v[156:159]
 RQ a[28:31],v85 offset:7168
 BL v119,s[8:11],s20 offen offset:2048 sc1 lds
 MM v[160:163],a[112:115],a[56:59],v[160:163]
 MM v[164:167],a[116:119],a[56:59],v[164:167]
 MM v[168:171],a[120:123],a[56:59],v[168:171]
 MM v[172:175],a[124:127],a[56:59],v[172:175]
 BL v119,s[8:11],s20 offen offset:3072 sc1 lds
 MM v[176:179],a[112:115],a[60:63],v[176:179]
 s_add_u32 s20,s20,2048
 MM v[180:183],a[116:119],a[60:63],v[180:183]
 MM v[184:187],a[120:123],a[60:63],v[184:187]
 MM v[188:191],a[124:127],a[60:63],v[188:191]
 s_waitcnt vmcnt(16)
 s_waitcnt lgkmcnt(0)
 s_barrier
 MM v[128:131],a[64:67],a[0:3],v[128:131]
 RQ a[32:35],v85 offset:16384
 s_add_u32 m0,s25,0
 s_nop 0
 BL v120,s[12:15],s21 offen  lds
 MM v[132:135],a[68:71],a[0:3],v[132:135]
 RT a[96:97],v90 offset:16384
 MM v[136:139],a[72:75],a[0:3],v[136:139]
 RT a[98:99],v90 offset:20480
 MM v[140:143],a[76:79],a[0:3],v[140:143]
 RT a[100:101],v91 offset:16384
 BL v121,s[12:15],s21 offen offset:1024  lds
 MM v[144:147],a[64:67],a[4:7],v[144:147]
 RT a[102:103],v91 offset:20480
 MM v[148:151],a[68:71],a[4:7],v[148:151]
 RT a[104:105],v92 offset:16384
 MM v[152:155],a[72:75],a[4:7],v[152:155]
 RT a[106:107],v92 offset:20480
 MM v[156:159],a[76:79],a[4:7],v[156:159]
 RT a[108:109],v93 offset:16384
 BL v122,s[12:15],s21 offen offset:2048  lds
 MM v[160:163],a[64:67],a[8:11],v[160:163]
 RT a[110:111],v93 offset:20480
 MM v[164:167],a[68:71],a[8:11],v[164:167]
 RQ a[36:39],v85 offset:18432
 MM v[168:171],a[72:75],a[8:11],v[168:171]
 RQ a[40:43],v85 offset:20480
 MM v[172:175],a[76:79],a[8:11],v[172:175]
 RQ a[44:47],v85 offset:22528
 BL v123,s[12:15],s21 offen offset:3072  lds
 MM v[176:179],a[64:67],a[12:15],v[176:179]
 RQ a[48:51],v85 offset:17408
 s_add_u32 s21,s21,57344
 MM v[180:183],a[68:71],a[12:15],v[180:183]
 RT a[112:113],v90 offset:24576
 MM v[184:187],a[72:75],a[12:15],v[184:187]
 RT a[114:115],v90 offset:28672
 s_add_u32 m0,s24,0
 MM v[188:191],a[76:79],a[12:15],v[188:191]
 RT a[116:117],v91 offset:24576
 BL v118,s[8:11],s20 offen sc1 lds
 MM v[128:131],a[80:83],a[16:19],v[128:131]
 RT a[118:119],v91 offset:28672
 MM v[132:135],a[84:87],a[16:19],v[132:135]
 RT a[120:121],v92 offset:24576
 MM v[136:139],a[88:91],a[16:19],v[136:139]
 RT a[122:123],v92 offset:28672
 MM v[140:143],a[92:95],a[16:19],v[140:143]
 RT a[124:125],v93 offset:24576
 BL v118,s[8:11],s20 offen offset:1024 sc1 lds
 MM v[144:147],a[80:83],a[20:23],v[144:147]
 RT a[126:127],v93 offset:28672
 MM v[148:151],a[84:87],a[20:23],v[148:151]
 RQ a[52:55],v85 offset:19456
 MM v[152:155],a[88:91],a[20:23],v[152:155]
 RQ a[56:59],v85 offset:21504
 MM v[156:159],a[92:95],a[20:23],v[156:159]
 RQ a[60:63],v85 offset:23552
 BL v119,s[8:11],s20 offen offset:2048 sc1 lds
 MM v[160:163],a[80:83],a[24:27],v[160:163]
 MM v[164:167],a[84:87],a[24:27],v[164:167]
 MM v[168:171],a[88:91],a[24:27],v[168:171]
 MM v[172:175],a[92:95],a[24:27],v[172:175]
 BL v119,s[8:11],s20 offen offset:3072 sc1 lds
 MM v[176:179],a[80:83],a[28:31],v[176:179]
 s_add_u32 s20,s20,2048
 MM v[180:183],a[84:87],a[28:31],v[180:183]
 MM v[184:187],a[88:91],a[28:31],v[184:187]
 MM v[188:191],a[92:95],a[28:31],v[188:191]
 s_waitcnt vmcnt(16)
 s_waitcnt lgkmcnt(0)
 s_barrier
 MM v[128:131],a[96:99],a[32:35],v[128:131]
 RQ a[0:3],v84
 s_add_u32 m0,s25,16384
 s_nop 0
 BL v120,s[12:15],s21 offen  lds
 MM v[132:135],a[100:103],a[32:35],v[132:135]
 RT a[64:65],v86
 MM v[136:139],a[104:107],a[32:35],v[136:139]
 RT a[66:67],v86 offset:4096
 MM v[140:143],a[108:111],a[32:35],v[140:143]
 RT a[68:69],v87
 BL v121,s[12:15],s21 offen offset:1024  lds
 MM v[144:147],a[96:99],a[36:39],v[144:147]
 RT a[70:71],v87 offset:4096
 MM v[148:151],a[100:103],a[36:39],v[148:151]
 RT a[72:73],v88
 MM v[152:155],a[104:107],a[36:39],v[152:155]
 RT a[74:75],v88 offset:4096
 MM v[156:159],a[108:111],a[36:39],v[156:159]
 RT a[76:77],v89
 BL v122,s[12:15],s21 offen offset:2048  lds
 MM v[160:163],a[96:99],a[40:43],v[160:163]
 RT a[78:79],v89 offset:4096
 MM v[164:167],a[100:103],a[40:43],v[164:167]
 RQ a[4:7],v84 offset:2048
 MM v[168:171],a[104:107],a[40:43],v[168:171]
 RQ a[8:11],v84 offset:4096
 MM v[172:175],a[108:111],a[40:43],v[172:175]
 RQ a[12:15],v84 offset:6144
 BL v123,s[12:15],s21 offen offset:3072  lds
 MM v[176:179],a[96:99],a[44:47],v[176:179]
 RQ a[16:19],v84 offset:1024
 s_add_u32 s21,s21,57344
 MM v[180:183],a[100:103],a[44:47],v[180:183]
 RT a[80:81],v86 offset:8192
 MM v[184:187],a[104:107],a[44:47],v[184:187]
 RT a[82:83],v86 offset:12288
 s_add_u32 m0,s24,16384
 MM v[188:191],a[108:111],a[44:47],v[188:191]
 RT a[84:85],v87 offset:8192
 BL v118,s[8:11],s20 offen sc1 lds
 MM v[128:131],a[112:115],a[48:51],v[128:131]
 RT a[86:87],v87 offset:12288
 MM v[132:135],a[116:119],a[48:51],v[132:135]
 RT a[88:89],v88 offset:8192
 MM v[136:139],a[120:123],a[48:51],v[136:139]
 RT a[90:91],v88 offset:12288
 MM v[140:143],a[124:127],a[48:51],v[140:143]
 RT a[92:93],v89 offset:8192
 BL v118,s[8:11],s20 offen offset:1024 sc1 lds
 MM v[144:147],a[112:115],a[52:55],v[144:147]
 RT a[94:95],v89 offset:12288
 MM v[148:151],a[116:119],a[52:55],v[148:151]
 RQ a[20:23],v84 offset:3072
 MM v[152:155],a[120:123],a[52:55],v[152:155]
 RQ a[24:27],v84 offset:5120
 MM v[156:159],a[124:127],a[52:55],v[156:159]
 RQ a[28:31],v84 offset:7168
 BL v119,s[8:11],s20 offen offset:2048 sc1 lds
 MM v[160:163],a[112:115],a[56:59],v[160:163]
 MM v[164:167],a[116:119],a[56:59],v[164:167]
 MM v[168:171],a[120:123],a[56:59],v[168:171]
 MM v[172:175],a[124:127],a[56:59],v[172:175]
 BL v119,s[8:11],s20 offen offset:3072 sc1 lds
 MM v[176:179],a[112:115],a[60:63],v[176:179]
 s_add_u32 s20,s20,2048
 MM v[180:183],a[116:119],a[60:63],v[180:183]
 MM v[184:187],a[120:123],a[60:63],v[184:187]
 MM v[188:191],a[124:127],a[60:63],v[188:191]
 s_waitcnt vmcnt(16)
 s_waitcnt lgkmcnt(0)
 s_barrier
 MM v[128:131],a[64:67],a[0:3],v[128:131]
 RQ a[32:35],v84 offset:16384
 MM v[132:135],a[68:71],a[0:3],v[132:135]
 RT a[96:97],v86 offset:16384
 MM v[136:139],a[72:75],a[0:3],v[136:139]
 RT a[98:99],v86 offset:20480
 MM v[140:143],a[76:79],a[0:3],v[140:143]
 RT a[100:101],v87 offset:16384
 MM v[144:147],a[64:67],a[4:7],v[144:147]
 RT a[102:103],v87 offset:20480
 MM v[148:151],a[68:71],a[4:7],v[148:151]
 RT a[104:105],v88 offset:16384
 MM v[152:155],a[72:75],a[4:7],v[152:155]
 RT a[106:107],v88 offset:20480
 MM v[156:159],a[76:79],a[4:7],v[156:159]
 RT a[108:109],v89 offset:16384
 MM v[160:163],a[64:67],a[8:11],v[160:163]
 RT a[110:111],v89 offset:20480
 MM v[164:167],a[68:71],a[8:11],v[164:167]
 RQ a[36:39],v84 offset:18432
 MM v[168:171],a[72:75],a[8:11],v[168:171]
 RQ a[40:43],v84 offset:20480
 MM v[172:175],a[76:79],a[8:11],v[172:175]
 RQ a[44:47],v84 offset:22528
 MM v[176:179],a[64:67],a[12:15],v[176:179]
 RQ a[48:51],v84 offset:17408
 MM v[180:183],a[68:71],a[12:15],v[180:183]
 RT a[112:113],v86 offset:24576
 MM v[184:187],a[72:75],a[12:15],v[184:187]
 RT a[114:115],v86 offset:28672
 MM v[188:191],a[76:79],a[12:15],v[188:191]
 RT a[116:117],v87 offset:24576
 MM v[128:131],a[80:83],a[16:19],v[128:131]
 RT a[118:119],v87 offset:28672
 MM v[132:135],a[84:87],a[16:19],v[132:135]
 RT a[120:121],v88 offset:24576
 MM v[136:139],a[88:91],a[16:19],v[136:139]
 RT a[122:123],v88 offset:28672
 MM v[140:143],a[92:95],a[16:19],v[140:143]
 RT a[124:125],v89 offset:24576
 MM v[144:147],a[80:83],a[20:23],v[144:147]
 RT a[126:127],v89 offset:28672
 MM v[148:151],a[84:87],a[20:23],v[148:151]
 RQ a[52:55],v84 offset:19456
 MM v[152:155],a[88:91],a[20:23],v[152:155]
 RQ a[56:59],v84 offset:21504
 MM v[156:159],a[92:95],a[20:23],v[156:159]
 RQ a[60:63],v84 offset:23552
 MM v[160:163],a[80:83],a[24:27],v[160:163]
 MM v[164:167],a[84:87],a[24:27],v[164:167]
 MM v[168:171],a[88:91],a[24:27],v[168:171]
 MM v[172:175],a[92:95],a[24:27],v[172:175]
 MM v[176:179],a[80:83],a[28:31],v[176:179]
 MM v[180:183],a[84:87],a[28:31],v[180:183]
 MM v[184:187],a[88:91],a[28:31],v[184:187]
 MM v[188:191],a[92:95],a[28:31],v[188:191]
 s_waitcnt vmcnt(8)
 s_waitcnt lgkmcnt(0)
 s_barrier
 MM v[128:131],a[96:99],a[32:35],v[128:131]
 RQ a[0:3],v85
 MM v[132:135],a[100:103],a[32:35],v[132:135]
 RT a[64:65],v90
 MM v[136:139],a[104:107],a[32:35],v[136:139]
 RT a[66:67],v90 offset:4096
 MM v[140:143],a[108:111],a[32:35],v[140:143]
 RT a[68:69],v91
 MM v[144:147],a[96:99],a[36:39],v[144:147]
 RT a[70:71],v91 offset:4096
 MM v[148:151],a[100:103],a[36:39],v[148:151]
 RT a[72:73],v92
 MM v[152:155],a[104:107],a[36:39],v[152:155]
 RT a[74:75],v92 offset:4096
 MM v[156:159],a[108:111],a[36:39],v[156:159]
 RT a[76:77],v93
 MM v[160:163],a[96:99],a[40:43],v[160:163]
 RT a[78:79],v93 offset:4096
 MM v[164:167],a[100:103],a[40:43],v[164:167]
 RQ a[4:7],v85 offset:2048
 MM v[168:171],a[104:107],a[40:43],v[168:171]
 RQ a[8:11],v85 offset:4096
 MM v[172:175],a[108:111],a[40:43],v[172:175]
 RQ a[12:15],v85 offset:6144
 MM v[176:179],a[96:99],a[44:47],v[176:179]
 RQ a[16:19],v85 offset:1024
 MM v[180:183],a[100:103],a[44:47],v[180:183]
 RT a[80:81],v90 offset:8192
 MM v[184:187],a[104:107],a[44:47],v[184:187]
 RT a[82:83],v90 offset:12288
 MM v[188:191],a[108:111],a[44:47],v[188:191]
 RT a[84:85],v91 offset:8192
 MM v[128:131],a[112:115],a[48:51],v[128:131]
 RT a[86:87],v91 offset:12288
 MM v[132:135],a[116:119],a[48:51],v[132:135]
 RT a[88:89],v92 offset:8192
 MM v[136:139],a[120:123],a[48:51],v[136:139]
 RT a[90:91],v92 offset:12288
 MM v[140:143],a[124:127],a[48:51],v[140:143]
 RT a[92:93],v93 offset:8192
 MM v[144:147],a[112:115],a[52:55],v[144:147]
 RT a[94:95],v93 offset:12288
 MM v[148:151],a[116:119],a[52:55],v[148:151]
 RQ a[20:23],v85 offset:3072
 MM v[152:155],a[120:123],a[52:55],v[152:155]
 RQ a[24:27],v85 offset:5120
 MM v[156:159],a[124:127],a[52:55],v[156:159]
 RQ a[28:31],v85 offset:7168
 MM v[160:163],a[112:115],a[56:59],v[160:163]
 MM v[164:167],a[116:119],a[56:59],v[164:167]
 MM v[168:171],a[120:123],a[56:59],v[168:171]
 MM v[172:175],a[124:127],a[56:59],v[172:175]
 MM v[176:179],a[112:115],a[60:63],v[176:179]
 MM v[180:183],a[116:119],a[60:63],v[180:183]
 MM v[184:187],a[120:123],a[60:63],v[184:187]
 MM v[188:191],a[124:127],a[60:63],v[188:191]
 s_waitcnt vmcnt(0)
 s_waitcnt lgkmcnt(0)
 s_barrier
 MM v[128:131],a[64:67],a[0:3],v[128:131]
 RQ a[32:35],v85 offset:16384
 MM v[132:135],a[68:71],a[0:3],v[132:135]
 RT a[96:97],v90 offset:16384
 MM v[136:139],a[72:75],a[0:3],v[136:139]
 RT a[98:99],v90 offset:20480
 MM v[140:143],a[76:79],a[0:3],v[140:143]
 RT a[100:101],v91 offset:16384
 MM v[144:147],a[64:67],a[4:7],v[144:147]
 RT a[102:103],v91 offset:20480
 MM v[148:151],a[68:71],a[4:7],v[148:151]
 RT a[104:105],v92 offset:16384
 MM v[152:155],a[72:75],a[4:7],v[152:155]
 RT a[106:107],v92 offset:20480
 MM v[156:159],a[76:79],a[4:7],v[156:159]
 RT a[108:109],v93 offset:16384
 MM v[160:163],a[64:67],a[8:11],v[160:163]
 RT a[110:111],v93 offset:20480
 MM v[164:167],a[68:71],a[8:11],v[164:167]
 RQ a[36:39],v85 offset:18432
 MM v[168:171],a[72:75],a[8:11],v[168:171]
 RQ a[40:43],v85 offset:20480
 MM v[172:175],a[76:79],a[8:11],v[172:175]
 RQ a[44:47],v85 offset:22528
 MM v[176:179],a[64:67],a[12:15],v[176:179]
 RQ a[48:51],v85 offset:17408
 MM v[180:183],a[68:71],a[12:15],v[180:183]
 RT a[112:113],v90 offset:24576
 MM v[184:187],a[72:75],a[12:15],v[184:187]
 RT a[114:115],v90 offset:28672
 MM v[188:191],a[76:79],a[12:15],v[188:191]
 RT a[116:117],v91 offset:24576
 MM v[128:131],a[80:83],a[16:19],v[128:131]
 RT a[118:119],v91 offset:28672
 MM v[132:135],a[84:87],a[16:19],v[132:135]
 RT a[120:121],v92 offset:24576
 MM v[136:139],a[88:91],a[16:19],v[136:139]
 RT a[122:123],v92 offset:28672
 MM v[140:143],a[92:95],a[16:19],v[140:143]
 RT a[124:125],v93 offset:24576
 MM v[144:147],a[80:83],a[20:23],v[144:147]
 RT a[126:127],v93 offset:28672
 MM v[148:151],a[84:87],a[20:23],v[148:151]
 RQ a[52:55],v85 offset:19456
 MM v[152:155],a[88:91],a[20:23],v[152:155]
 RQ a[56:59],v85 offset:21504
 MM v[156:159],a[92:95],a[20:23],v[156:159]
 RQ a[60:63],v85 offset:23552
 MM v[160:163],a[80:83],a[24:27],v[160:163]
 MM v[164:167],a[84:87],a[24:27],v[164:167]
 MM v[168:171],a[88:91],a[24:27],v[168:171]
 MM v[172:175],a[92:95],a[24:27],v[172:175]
 MM v[176:179],a[80:83],a[28:31],v[176:179]
 MM v[180:183],a[84:87],a[28:31],v[180:183]
 MM v[184:187],a[88:91],a[28:31],v[184:187]
 MM v[188:191],a[92:95],a[28:31],v[188:191]
 s_waitcnt lgkmcnt(0)
 s_barrier
 MM v[128:131],a[96:99],a[32:35],v[128:131]
 MM v[132:135],a[100:103],a[32:35],v[132:135]
 MM v[136:139],a[104:107],a[32:35],v[136:139]
 MM v[140:143],a[108:111],a[32:35],v[140:143]
 MM v[144:147],a[96:99],a[36:39],v[144:147]
 MM v[148:151],a[100:103],a[36:39],v[148:151]
 MM v[152:155],a[104:107],a[36:39],v[152:155]
 MM v[156:159],a[108:111],a[36:39],v[156:159]
 MM v[160:163],a[96:99],a[40:43],v[160:163]
 MM v[164:167],a[100:103],a[40:43],v[164:167]
 MM v[168:171],a[104:107],a[40:43],v[168:171]
 MM v[172:175],a[108:111],a[40:43],v[172:175]
 MM v[176:179],a[96:99],a[44:47],v[176:179]
 MM v[180:183],a[100:103],a[44:47],v[180:183]
 MM v[184:187],a[104:107],a[44:47],v[184:187]
 MM v[188:191],a[108:111],a[44:47],v[188:191]
 MM v[128:131],a[112:115],a[48:51],v[128:131]
 MM v[132:135],a[116:119],a[48:51],v[132:135]
 MM v[136:139],a[120:123],a[48:51],v[136:139]
 MM v[140:143],a[124:127],a[48:51],v[140:143]
 MM v[144:147],a[112:115],a[52:55],v[144:147]
 MM v[148:151],a[116:119],a[52:55],v[148:151]
 MM v[152:155],a[120:123],a[52:55],v[152:155]
 MM v[156:159],a[124:127],a[52:55],v[156:159]
 MM v[160:163],a[112:115],a[56:59],v[160:163]
 MM v[164:167],a[116:119],a[56:59],v[164:167]
 MM v[168:171],a[120:123],a[56:59],v[168:171]
 MM v[172:175],a[124:127],a[56:59],v[172:175]
 MM v[176:179],a[112:115],a[60:63],v[176:179]
 MM v[180:183],a[116:119],a[60:63],v[180:183]
 MM v[184:187],a[120:123],a[60:63],v[184:187]
 MM v[188:191],a[124:127],a[60:63],v[188:191]
 s_add_u32 s16,s68,88080384
 s_addc_u32 s17,s69,0
 s_mov_b32 s18,8388608
 s_mov_b32 s19,0x20000
 s_lshl_b32 s84,s53,2
 s_add_u32 s84,s84,s98
 s_lshl_b32 s84,s84,2
 s_add_u32 s84,s84,s99
 s_lshl_b32 s84,s84,2
 s_add_u32 s84,s84,s35
 s_lshl_b32 s84,s84,13
 CV v128,v128,v129
 CV v129,v130,v131
 CV v130,v132,v133
 CV v131,v134,v135
 BS v[128:131],v6,s[16:19],s84 offen sc1
 CV v136,v136,v137
 CV v137,v138,v139
 CV v138,v140,v141
 CV v139,v142,v143
 BS v[136:139],v6,s[16:19],s84 offen offset:1024 sc1
 CV v144,v144,v145
 CV v145,v146,v147
 CV v146,v148,v149
 CV v147,v150,v151
 BS v[144:147],v6,s[16:19],s84 offen offset:2048 sc1
 CV v152,v152,v153
 CV v153,v154,v155
 CV v154,v156,v157
 CV v155,v158,v159
 BS v[152:155],v6,s[16:19],s84 offen offset:3072 sc1
 CV v160,v160,v161
 CV v161,v162,v163
 CV v162,v164,v165
 CV v163,v166,v167
 s_add_u32 s85,s84,4096
 BS v[160:163],v6,s[16:19],s85 offen sc1
 CV v168,v168,v169
 CV v169,v170,v171
 CV v170,v172,v173
 CV v171,v174,v175
 s_add_u32 s85,s84,4096
 BS v[168:171],v6,s[16:19],s85 offen offset:1024 sc1
 CV v176,v176,v177
 CV v177,v178,v179
 CV v178,v180,v181
 CV v179,v182,v183
 s_add_u32 s85,s84,4096
 BS v[176:179],v6,s[16:19],s85 offen offset:2048 sc1
 CV v184,v184,v185
 CV v185,v186,v187
 CV v186,v188,v189
 CV v187,v190,v191
 s_add_u32 s85,s84,4096
 BS v[184:187],v6,s[16:19],s85 offen offset:3072 sc1
 s_lshr_b32 s34,s35,1
 s_lshl_b32 s32,s98,1
 s_add_u32 s32,s32,s34
 s_cmp_ge_u32 s32,7
 s_cbranch_scc1 L_end_gated_mix__compressed_kv_cla__mixer_gmlp__prompt_kernel
 s_lshl_b32 s34,s99,15
 s_sub_u32 s84,s84,s34
 s_lshl_b32 s34,s99,11
 s_add_u32 s84,s84,s34
 v_and_b32 v2,15,v0
 v_mul_u32_u24 v2,896,v2
 v_bfe_u32 v3,v0,4,1
 v_lshl_add_u32 v2,v3,5,v2
 v_lshrrev_b32 v3,5,v0
 v_lshl_add_u32 v5,v3,4,v2
 s_mov_b32 s31,0
fx_again:
 BL v[16:19],v6,s[16:19],s84 offen sc1
 BL v[20:23],v6,s[16:19],s84 offen offset:1024 sc1
 s_add_u32 s85,s84,32768
 BL v[24:27],v6,s[16:19],s85 offen sc1
 BL v[28:31],v6,s[16:19],s85 offen offset:1024 sc1
 s_add_u32 s85,s84,65536
 BL v[32:35],v6,s[16:19],s85 offen sc1
 BL v[36:39],v6,s[16:19],s85 offen offset:1024 sc1
 s_add_u32 s85,s84,98304
 BL v[40:43],v6,s[16:19],s85 offen sc1
 BL v[44:47],v6,s[16:19],s85 offen offset:1024 sc1
 s_waitcnt vmcnt(7)
 v_max3_u32 v8,v16,v17,v18
 s_waitcnt vmcnt(6)
 v_max3_u32 v8,v8,v19,v20
 v_max3_u32 v8,v8,v21,v22
 s_waitcnt vmcnt(5)
 v_max3_u32 v8,v8,v23,v24
 v_max3_u32 v8,v8,v25,v26
 s_waitcnt vmcnt(4)
 v_max3_u32 v8,v8,v27,v28
 v_max3_u32 v8,v8,v29,v30
 s_waitcnt vmcnt(3)
 v_max3_u32 v8,v8,v31,v32
 v_max3_u32 v8,v8,v33,v34
 s_waitcnt vmcnt(2)
 v_max3_u32 v8,v8,v35,v36
 v_max3_u32 v8,v8,v37,v38
 s_waitcnt vmcnt(1)
 v_max3_u32 v8,v8,v39,v40
 v_max3_u32 v8,v8,v41,v42
 s_waitcnt vmcnt(0)
 v_max3_u32 v8,v8,v43,v44
 v_max3_u32 v8,v8,v45,v46
 v_max_u32 v8,v8,v47
 v_cmp_eq_u32 vcc,-1,v8
 s_add_u32 s31,s31,1
 s_cmp_ge_u32 s31,400000
 s_cbranch_scc1 fx_go
 s_cbranch_vccz fx_go
 s_sleep 2
 s_branch fx_again
fx_go:
 s_mov_b32 s4,s64
 s_mov_b32 s5,s65
 s_mov_b32 s6,1835008
 s_mov_b32 s7,0x20000
 s_and_b32 s34,s35,1
 s_lshl_b32 s84,s53,1
 s_add_u32 s84,s84,s34
 s_lshl_b32 s84,s84,2
 s_add_u32 s84,s84,s99
 s_mul_i32 s84,s84,14336
 s_lshl_b32 s32,s32,7
 s_add_u32 s84,s84,s32
 v_lshlrev_b32 v64,16,v16
 v_and_b32 v65,0xffff0000,v16
 v_lshlrev_b32 v66,16,v17
 v_and_b32 v67,0xffff0000,v17
 v_lshlrev_b32 v68,16,v18
 v_and_b32 v69,0xffff0000,v18
 v_lshlrev_b32 v70,16,v19
 v_and_b32 v71,0xffff0000,v19
 v_lshlrev_b32 v48,16,v24
 v_and_b32 v49,0xffff0000,v24
 v_lshlrev_b32 v50,16,v25
 v_and_b32 v51,0xffff0000,v25
 v_lshlrev_b32 v52,16,v26
 v_and_b32 v53,0xffff0000,v26
 v_lshlrev_b32 v54,16,v27
 v_and_b32 v55,0xffff0000,v27
 v_pk_add_f32 v[64:65],v[64:65],v[48:49]
 v_pk_add_f32 v[66:67],v[66:67],v[50:51]
 v_pk_add_f32 v[68:69],v[68:69],v[52:53]
 v_pk_add_f32 v[70:71],v[70:71],v[54:55]
 v_lshlrev_b32 v48,16,v32
 v_and_b32 v49,0xffff0000,v32
 v_lshlrev_b32 v50,16,v33
 v_and_b32 v51,0xffff0000,v33
 v_lshlrev_b32 v52,16,v34
 v_and_b32 v53,0xffff0000,v34
 v_lshlrev_b32 v54,16,v35
 v_and_b32 v55,0xffff0000,v35
 v_pk_add_f32 v[64:65],v[64:65],v[48:49]
 v_pk_add_f32 v[66:67],v[66:67],v[50:51]
 v_pk_add_f32 v[68:69],v[68:69],v[52:53]
 v_pk_add_f32 v[70:71],v[70:71],v[54:55]
 v_lshlrev_b32 v48,16,v40
 v_and_b32 v49,0xffff0000,v40
 v_lshlrev_b32 v50,16,v41
 v_and_b32 v51,0xffff0000,v41
 v_lshlrev_b32 v52,16,v42
 v_and_b32 v53,0xffff0000,v42
 v_lshlrev_b32 v54,16,v43
 v_and_b32 v55,0xffff0000,v43
 v_pk_add_f32 v[64:65],v[64:65],v[48:49]
 v_pk_add_f32 v[66:67],v[66:67],v[50:51]
 v_pk_add_f32 v[68:69],v[68:69],v[52:53]
 v_pk_add_f32 v[70:71],v[70:71],v[54:55]
 CV v64,v64,v65
 CV v65,v66,v67
 CV v66,v68,v69
 CV v67,v70,v71
 s_nop 0
 v_permlane16_swap_b32 v64,v66
 s_nop 0
 v_permlane16_swap_b32 v65,v67
 BS v[64:67],v5,s[4:7],s84 offen
 v_lshlrev_b32 v72,16,v20
 v_and_b32 v73,0xffff0000,v20
 v_lshlrev_b32 v74,16,v21
 v_and_b32 v75,0xffff0000,v21
 v_lshlrev_b32 v76,16,v22
 v_and_b32 v77,0xffff0000,v22
 v_lshlrev_b32 v78,16,v23
 v_and_b32 v79,0xffff0000,v23
 v_lshlrev_b32 v48,16,v28
 v_and_b32 v49,0xffff0000,v28
 v_lshlrev_b32 v50,16,v29
 v_and_b32 v51,0xffff0000,v29
 v_lshlrev_b32 v52,16,v30
 v_and_b32 v53,0xffff0000,v30
 v_lshlrev_b32 v54,16,v31
 v_and_b32 v55,0xffff0000,v31
 v_pk_add_f32 v[72:73],v[72:73],v[48:49]
 v_pk_add_f32 v[74:75],v[74:75],v[50:51]
 v_pk_add_f32 v[76:77],v[76:77],v[52:53]
 v_pk_add_f32 v[78:79],v[78:79],v[54:55]
 v_lshlrev_b32 v48,16,v36
 v_and_b32 v49,0xffff0000,v36
 v_lshlrev_b32 v50,16,v37
 v_and_b32 v51,0xffff0000,v37
 v_lshlrev_b32 v52,16,v38
 v_and_b32 v53,0xffff0000,v38
 v_lshlrev_b32 v54,16,v39
 v_and_b32 v55,0xffff0000,v39
 v_pk_add_f32 v[72:73],v[72:73],v[48:49]
 v_pk_add_f32 v[74:75],v[74:75],v[50:51]
 v_pk_add_f32 v[76:77],v[76:77],v[52:53]
 v_pk_add_f32 v[78:79],v[78:79],v[54:55]
 v_lshlrev_b32 v48,16,v44
 v_and_b32 v49,0xffff0000,v44
 v_lshlrev_b32 v50,16,v45
 v_and_b32 v51,0xffff0000,v45
 v_lshlrev_b32 v52,16,v46
 v_and_b32 v53,0xffff0000,v46
 v_lshlrev_b32 v54,16,v47
 v_and_b32 v55,0xffff0000,v47
 v_pk_add_f32 v[72:73],v[72:73],v[48:49]
 v_pk_add_f32 v[74:75],v[74:75],v[50:51]
 v_pk_add_f32 v[76:77],v[76:77],v[52:53]
 v_pk_add_f32 v[78:79],v[78:79],v[54:55]
 CV v72,v72,v73
 CV v73,v74,v75
 CV v74,v76,v77
 CV v75,v78,v79
 s_nop 0
 v_permlane16_swap_b32 v72,v74
 s_nop 0
 v_permlane16_swap_b32 v73,v75
 BS v[72:75],v5,s[4:7],s84 offen offset:64
 s_branch L_end_gated_mix__compressed_kv_cla__mixer_gmlp__prompt_kernel
L_end_gated_mix__compressed_kv_cla__mixer_gmlp__prompt_kernel:
 s_endpgm
L_codeend:
.section .rodata,"a"
.p2align 6
.amdhsa_kernel gated_mix__compressed_kv_cla__mixer_gmlp__prompt_kernel
  .amdhsa_next_free_vgpr 512
  .amdhsa_next_free_sgpr 102
  .amdhsa_accum_offset 256
  .amdhsa_group_segment_fixed_size 0
  .amdhsa_kernarg_size 120
  .amdhsa_user_sgpr_count 2
  .amdhsa_user_sgpr_kernarg_segment_ptr 1
  .amdhsa_system_sgpr_workgroup_id_x 1
  .amdhsa_float_denorm_mode_32 3
.end_amdhsa_kernel
```
